```python
import torch

def _softmax(x, axis=-1):
    return torch.softmax(x, dim=axis)
def _gelu(x):
    return torch.nn.functional.gelu(x, approximate="tanh")
def _silu(x):
    return torch.nn.functional.silu(x)
def _sigmoid(x):
    return torch.sigmoid(x)
def _layernorm(x, axis=-1, eps=1e-5):
    m = x.mean(dim=axis, keepdim=True)
    v = x.var(dim=axis, keepdim=True, unbiased=False)
    return (x - m) / torch.sqrt(v + eps)
def _scatter_add(tgt, idx, src, axis=0):
    return tgt.clone().index_add_(axis, idx, src)
def _segment_sum(src, seg, n):
    out = torch.zeros((n,) + src.shape[1:], dtype=src.dtype)
    return out.index_add_(0, seg, src)
def _pad(x, pw):
    flat = tuple(v for pair in reversed(pw) for v in pair)
    return torch.nn.functional.pad(x, flat)

kernel_name = 'concat_heads__mha_block_cached__mha_block_cached__near_ridge'

def setup_inputs():

    _w = (lambda a: (lambda t: t.to(torch.bfloat16) if t.is_floating_point() else t)(torch.as_tensor(a)))
    def _A_setup():
        B, Sq, D = 8, 144, 448
        H, Sk, Dh = 16, 1024, 256
        return {
            "x": _w((lambda *s: torch.randn(*s, dtype=torch.bfloat16) * 0.8)(B, Sq, D)),
            "k_cache": _w((lambda *s: torch.randn(*s, dtype=torch.bfloat16) * 0.8)(B, H, Sk, Dh)),
            "v_cache": _w((lambda *s: torch.randn(*s, dtype=torch.bfloat16) * 0.05)(B, H, Sk, Dh)),
            "wq": _w((lambda *s: torch.randn(*s, dtype=torch.bfloat16) * 0.8)(D, H * Dh) * (D ** -0.5)),
            "wo": _w((lambda *s: torch.randn(*s, dtype=torch.bfloat16) * 0.05)(H * Dh, D) * ((H * Dh) ** -0.5)),
        }
    _A_in = _A_setup()

    def _B_setup():
        B, Sq, D = 8, 144, 448
        H, Sk, Dh = 16, 1024, 256
        return {
            "x": _w((lambda *s: torch.randn(*s, dtype=torch.bfloat16) * 0.8)(B, Sq, D)),
            "k_cache": _w((lambda *s: torch.randn(*s, dtype=torch.bfloat16) * 0.8)(B, H, Sk, Dh)),
            "v_cache": _w((lambda *s: torch.randn(*s, dtype=torch.bfloat16) * 0.05)(B, H, Sk, Dh)),
            "wq": _w((lambda *s: torch.randn(*s, dtype=torch.bfloat16) * 0.8)(D, H * Dh) * (D ** -0.5)),
            "wo": _w((lambda *s: torch.randn(*s, dtype=torch.bfloat16) * 0.05)(H * Dh, D) * ((H * Dh) ** -0.5)),
        }
    _B_in = _B_setup()

    return {
        "A_x": _A_in["x"],
        "A_k_cache": _A_in["k_cache"],
        "A_v_cache": _A_in["v_cache"],
        "A_wq": _A_in["wq"],
        "A_wo": _A_in["wo"],
        "B_x": _B_in["x"],
        "B_k_cache": _B_in["k_cache"],
        "B_v_cache": _B_in["v_cache"],
        "B_wq": _B_in["wq"],
        "B_wo": _B_in["wo"],
    }

def reference(A_x, A_k_cache, A_v_cache, A_wq, A_wo, B_x, B_k_cache, B_v_cache, B_wq, B_wo):
    def _A_ref(x, k_cache, v_cache, wq, wo):
        B, Sq, D = x.shape
        H, Dh = 16, 256
        q = (lambda x, *d: x.permute(*d))((x @ wq).reshape(B, Sq, H, Dh), 0, 2, 1, 3)
        scores = torch.einsum("bhqd,bhkd->bhqk", q, k_cache) * (Dh ** -0.5)
        p = _softmax(scores, axis=-1)
        o = torch.einsum("bhqk,bhkd->bhqd", p, v_cache)
        return (lambda x, *d: x.permute(*d))(o, 0, 2, 1, 3).reshape(B, Sq, H * Dh) @ wo

    def _B_ref(x, k_cache, v_cache, wq, wo):
        B, Sq, D = x.shape
        H, Dh = 16, 256
        q = (lambda x, *d: x.permute(*d))((x @ wq).reshape(B, Sq, H, Dh), 0, 2, 1, 3)
        scores = torch.einsum("bhqd,bhkd->bhqk", q, k_cache) * (Dh ** -0.5)
        p = _softmax(scores, axis=-1)
        o = torch.einsum("bhqk,bhkd->bhqd", p, v_cache)
        return (lambda x, *d: x.permute(*d))(o, 0, 2, 1, 3).reshape(B, Sq, H * Dh) @ wo

    a = _A_ref(A_x, A_k_cache, A_v_cache, A_wq, A_wo)
    b = _B_ref(B_x, B_k_cache, B_v_cache, B_wq, B_wo)
    return torch.concatenate([a, b], axis=-1)
```

```asm
; @launch grid=(256,1,1) block=(256,1,1) lds=163840
.amdgcn_target "amdgcn-amd-amdhsa--gfx950"
.text
.globl concat_heads__mha_block_cached__mha_block_cached__near_ridge_kernel
.p2align 8
.type concat_heads__mha_block_cached__mha_block_cached__near_ridge_kernel,@function
concat_heads__mha_block_cached__mha_block_cached__near_ridge_kernel:
    s_cmp_ge_u32 s2, 256
    s_cbranch_scc1 L_end
    s_load_dwordx4 s[44:47], s[0:1], 0
    s_load_dwordx4 s[48:51], s[0:1], 16
    s_load_dwordx2 s[54:55], s[0:1], 40
    s_load_dwordx4 s[68:71], s[0:1], 64
    s_load_dwordx2 s[52:53], s[0:1], 32
    s_load_dwordx4 s[64:67], s[0:1], 48
    s_load_dwordx2 s[72:73], s[0:1], 96
    s_load_dwordx4 s[80:83], s[0:1], 80
    v_lshrrev_b32 v2, 6, v0
    v_and_b32 v1, 63, v0
    v_readfirstlane_b32 s3, v2
    s_lshr_b32 s75, s2, 3
    s_getpc_b64 s[56:57]
L_pc_entry:
    s_sub_u32 s56, s56, L_pc_entry-concat_heads__mha_block_cached__mha_block_cached__near_ridge_kernel
    s_subb_u32 s57, s57, 0
    s_mov_b32 s58, L_code_end-concat_heads__mha_block_cached__mha_block_cached__near_ridge_kernel
    s_mov_b32 s59, 0x20000
    v_lshlrev_b32 v4, 4, v1
    s_lshl_b32 s76, s75, 2
    s_add_u32 s76, s76, s3
    s_lshl_b32 s76, s76, 10
    buffer_load_dwordx4 a[236:239], v4, s[56:59], s76 offen
    s_and_b32 s74, s2, 7
    s_lshr_b32 s30, s74, 2
    s_and_b32 s76, s74, 3
    s_lshl_b32 s76, s76, 2
    s_and_b32 s77, s75, 3
    s_add_u32 s29, s76, s77
    s_lshr_b32 s28, s75, 2
    s_cmp_eq_u32 s3, 3
    s_cbranch_scc0 L_compute
L_loader:
    v_lshrrev_b32 v2, 5, v1
    v_and_b32 v3, 31, v1
    v_lshlrev_b32 v32, 4, v1
    v_add_u32 v4, 0, v2
    v_lshlrev_b32 v4, 1, v4
    v_xor_b32 v4, v4, v3
    v_lshlrev_b32 v5, 4, v4
    v_lshl_add_u32 v20, v2, 13, v5
    v_add_u32 v4, 2, v2
    v_lshlrev_b32 v4, 1, v4
    v_xor_b32 v4, v4, v3
    v_lshlrev_b32 v5, 4, v4
    v_lshl_add_u32 v21, v2, 13, v5
    v_add_u32 v4, 4, v2
    v_lshlrev_b32 v4, 1, v4
    v_xor_b32 v4, v4, v3
    v_lshlrev_b32 v5, 4, v4
    v_lshl_add_u32 v22, v2, 13, v5
    v_add_u32 v4, 6, v2
    v_lshlrev_b32 v4, 1, v4
    v_xor_b32 v4, v4, v3
    v_lshlrev_b32 v5, 4, v4
    v_lshl_add_u32 v23, v2, 13, v5
    s_mul_i32 s78, s28, 129024
    s_lshl_b32 s79, s29, 9
    s_mov_b32 s6, 129024
    s_mov_b32 s7, 0x20000
    s_sub_u32 s18, 3670016, s79
    s_mov_b32 s19, 0x20000
    s_waitcnt lgkmcnt(0)
    s_cmp_eq_u32 s30, 0
    s_cselect_b32 s4, s44, s54
    s_cselect_b32 s5, s45, s55
    s_cselect_b32 s16, s50, s68
    s_cselect_b32 s17, s51, s69
    s_cselect_b32 s8, s46, s64
    s_cselect_b32 s9, s47, s65
    s_cselect_b32 s12, s48, s66
    s_cselect_b32 s13, s49, s67
    s_cselect_b32 s20, s52, s70
    s_cselect_b32 s21, s53, s71
    s_add_u32 s4, s4, s78
    s_addc_u32 s5, s5, 0
    s_add_u32 s16, s16, s79
    s_addc_u32 s17, s17, 0
    s_mov_b32 s98, 1024
    s_mov_b32 s99, 16384
    s_mov_b32 s100, 49152
    s_mov_b32 m0, 131072
    s_mov_b32 s32, 0
    buffer_load_dwordx4 v20, s[16:19], s32 offen lds
    s_add_u32 m0, m0, s98
    s_add_u32 s32, s32, s99
    buffer_load_dwordx4 v21, s[16:19], s32 offen lds
    s_add_u32 m0, m0, s98
    s_add_u32 s32, s32, s100
    buffer_load_dwordx4 v22, s[16:19], s32 offen lds
    s_add_u32 m0, m0, s98
    s_add_u32 s32, s32, s99
    buffer_load_dwordx4 v23, s[16:19], s32 offen lds
    s_add_u32 m0, m0, s98
    s_add_u32 s32, s32, s100
    buffer_load_dwordx4 v20, s[16:19], s32 offen lds
    s_add_u32 m0, m0, s98
    s_add_u32 s32, s32, s99
    buffer_load_dwordx4 v21, s[16:19], s32 offen lds
    s_add_u32 m0, m0, s98
    s_add_u32 s32, s32, s100
    buffer_load_dwordx4 v22, s[16:19], s32 offen lds
    s_add_u32 m0, m0, s98
    s_add_u32 s32, s32, s99
    buffer_load_dwordx4 v23, s[16:19], s32 offen lds
    s_add_u32 m0, m0, s98
    s_sub_u32 s32, s32, 180224
    buffer_load_dwordx4 v20, s[16:19], s32 offen lds
    s_add_u32 m0, m0, s98
    s_add_u32 s32, s32, s99
    buffer_load_dwordx4 v21, s[16:19], s32 offen lds
    s_add_u32 m0, m0, s98
    s_add_u32 s32, s32, s100
    buffer_load_dwordx4 v22, s[16:19], s32 offen lds
    s_add_u32 m0, m0, s98
    s_add_u32 s32, s32, s99
    buffer_load_dwordx4 v23, s[16:19], s32 offen lds
    s_add_u32 m0, m0, s98
    s_add_u32 s32, s32, s100
    buffer_load_dwordx4 v20, s[16:19], s32 offen lds
    s_add_u32 m0, m0, s98
    s_add_u32 s32, s32, s99
    buffer_load_dwordx4 v21, s[16:19], s32 offen lds
    s_add_u32 m0, m0, s98
    s_add_u32 s32, s32, s100
    buffer_load_dwordx4 v22, s[16:19], s32 offen lds
    s_add_u32 m0, m0, s98
    s_add_u32 s32, s32, s99
    buffer_load_dwordx4 v23, s[16:19], s32 offen lds
    s_lshl_b32 s84, s30, 3
    s_add_u32 s84, s84, s28
    s_lshl_b32 s84, s84, 14
    s_add_u32 s84, s84, 34603008
    s_add_u32 s84, s72, s84
    s_addc_u32 s85, s73, 0
    s_mov_b32 s86, 16384
    s_mov_b32 s87, 0x20000
    s_mov_b32 s48, s82
    s_mov_b32 s49, s83
    s_mov_b32 s50, 256
    s_mov_b32 s51, 0x20000
    s_lshl_b32 s52, s30, 3
    s_add_u32 s52, s52, s28
    s_lshl_b32 s52, s52, 4
    s_cmp_lg_u32 s29, 0
    s_cbranch_scc1 L_noinit
    v_lshlrev_b32 v33, 12, v1
    v_mov_b32 v34, 0
    s_mov_b64 exec, 7
    buffer_store_dword v34, v33, s[84:87], 0 offen sc1
    s_mov_b64 exec, -1
L_noinit:
    s_mov_b32 m0, 147456
    s_mov_b32 s32, 262144
    buffer_load_dwordx4 v20, s[16:19], s32 offen lds
    s_add_u32 m0, m0, s98
    s_add_u32 s32, s32, s99
    buffer_load_dwordx4 v21, s[16:19], s32 offen lds
    s_add_u32 m0, m0, s98
    s_add_u32 s32, s32, s100
    buffer_load_dwordx4 v22, s[16:19], s32 offen lds
    s_add_u32 m0, m0, s98
    s_add_u32 s32, s32, s99
    buffer_load_dwordx4 v23, s[16:19], s32 offen lds
    s_add_u32 m0, m0, s98
    s_add_u32 s32, s32, s100
    buffer_load_dwordx4 v20, s[16:19], s32 offen lds
    s_add_u32 m0, m0, s98
    s_add_u32 s32, s32, s99
    buffer_load_dwordx4 v21, s[16:19], s32 offen lds
    s_add_u32 m0, m0, s98
    s_add_u32 s32, s32, s100
    buffer_load_dwordx4 v22, s[16:19], s32 offen lds
    s_add_u32 m0, m0, s98
    s_add_u32 s32, s32, s99
    buffer_load_dwordx4 v23, s[16:19], s32 offen lds
    s_add_u32 m0, m0, s98
    s_sub_u32 s32, s32, 180224
    buffer_load_dwordx4 v20, s[16:19], s32 offen lds
    s_add_u32 m0, m0, s98
    s_add_u32 s32, s32, s99
    buffer_load_dwordx4 v21, s[16:19], s32 offen lds
    s_add_u32 m0, m0, s98
    s_add_u32 s32, s32, s100
    buffer_load_dwordx4 v22, s[16:19], s32 offen lds
    s_add_u32 m0, m0, s98
    s_add_u32 s32, s32, s99
    buffer_load_dwordx4 v23, s[16:19], s32 offen lds
    s_add_u32 m0, m0, s98
    s_add_u32 s32, s32, s100
    buffer_load_dwordx4 v20, s[16:19], s32 offen lds
    s_add_u32 m0, m0, s98
    s_add_u32 s32, s32, s99
    buffer_load_dwordx4 v21, s[16:19], s32 offen lds
    s_add_u32 m0, m0, s98
    s_add_u32 s32, s32, s100
    buffer_load_dwordx4 v22, s[16:19], s32 offen lds
    s_add_u32 m0, m0, s98
    s_add_u32 s32, s32, s99
    buffer_load_dwordx4 v23, s[16:19], s32 offen lds
    s_lshl_b32 s74, s28, 4
    s_add_u32 s74, s74, s29
    s_lshl_b32 s75, s74, 19
    s_add_u32 s8, s8, s75
    s_addc_u32 s9, s9, 0
    s_mov_b32 s10, 524288
    s_mov_b32 s11, 0x20000
    s_add_u32 s12, s12, s75
    s_addc_u32 s13, s13, 0
    s_mov_b32 s14, 524288
    s_mov_b32 s15, 0x20000
    s_mul_i32 s75, s29, 229376
    s_add_u32 s20, s20, s75
    s_addc_u32 s21, s21, 0
    s_mov_b32 s22, 229376
    s_mov_b32 s23, 0x20000
    v_add_u32 v4, 0, v2
    v_xor_b32 v4, v4, v3
    v_lshlrev_b32 v4, 4, v4
    v_lshl_add_u32 v8, v2, 9, v4
    v_add_u32 v4, 2, v2
    v_xor_b32 v4, v4, v3
    v_lshlrev_b32 v4, 4, v4
    v_lshl_add_u32 v9, v2, 9, v4
    v_add_u32 v4, 4, v2
    v_xor_b32 v4, v4, v3
    v_lshlrev_b32 v4, 4, v4
    v_lshl_add_u32 v10, v2, 9, v4
    v_add_u32 v4, 6, v2
    v_xor_b32 v4, v4, v3
    v_lshlrev_b32 v4, 4, v4
    v_lshl_add_u32 v11, v2, 9, v4
    v_add_u32 v4, 8, v2
    v_xor_b32 v4, v4, v3
    v_lshlrev_b32 v4, 4, v4
    v_lshl_add_u32 v12, v2, 9, v4
    v_add_u32 v4, 10, v2
    v_xor_b32 v4, v4, v3
    v_lshlrev_b32 v4, 4, v4
    v_lshl_add_u32 v13, v2, 9, v4
    v_add_u32 v4, 12, v2
    v_xor_b32 v4, v4, v3
    v_lshlrev_b32 v4, 4, v4
    v_lshl_add_u32 v14, v2, 9, v4
    v_add_u32 v4, 14, v2
    v_xor_b32 v4, v4, v3
    v_lshlrev_b32 v4, 4, v4
    v_lshl_add_u32 v15, v2, 9, v4
    v_add_u32 v4, 0, v2
    v_lshlrev_b32 v4, 1, v4
    v_xor_b32 v4, v4, v3
    v_lshlrev_b32 v5, 4, v4
    v_lshl_add_u32 v16, v2, 9, v5
    v_lshrrev_b32 v6, 4, v4
    v_lshl_add_u32 v6, v6, 5, v2
    v_mul_u32_u24 v6, 896, v6
    v_and_b32 v7, 15, v4
    v_lshl_add_u32 v24, v7, 4, v6
    v_lshrrev_b32 v6, 3, v4
    v_lshl_add_u32 v6, v6, 5, v2
    v_mul_u32_u24 v6, 896, v6
    v_and_b32 v7, 7, v4
    v_lshl_add_u32 v28, v7, 4, v6
    v_add_u32 v4, 2, v2
    v_lshlrev_b32 v4, 1, v4
    v_xor_b32 v4, v4, v3
    v_lshlrev_b32 v5, 4, v4
    v_lshl_add_u32 v17, v2, 9, v5
    v_lshrrev_b32 v6, 4, v4
    v_lshl_add_u32 v6, v6, 5, v2
    v_mul_u32_u24 v6, 896, v6
    v_and_b32 v7, 15, v4
    v_lshl_add_u32 v25, v7, 4, v6
    v_lshrrev_b32 v6, 3, v4
    v_lshl_add_u32 v6, v6, 5, v2
    v_mul_u32_u24 v6, 896, v6
    v_and_b32 v7, 7, v4
    v_lshl_add_u32 v29, v7, 4, v6
    v_add_u32 v4, 4, v2
    v_lshlrev_b32 v4, 1, v4
    v_xor_b32 v4, v4, v3
    v_lshlrev_b32 v5, 4, v4
    v_lshl_add_u32 v18, v2, 9, v5
    v_lshrrev_b32 v6, 4, v4
    v_lshl_add_u32 v6, v6, 5, v2
    v_mul_u32_u24 v6, 896, v6
    v_and_b32 v7, 15, v4
    v_lshl_add_u32 v26, v7, 4, v6
    v_lshrrev_b32 v6, 3, v4
    v_lshl_add_u32 v6, v6, 5, v2
    v_mul_u32_u24 v6, 896, v6
    v_and_b32 v7, 7, v4
    v_lshl_add_u32 v30, v7, 4, v6
    v_add_u32 v4, 6, v2
    v_lshlrev_b32 v4, 1, v4
    v_xor_b32 v4, v4, v3
    v_lshlrev_b32 v5, 4, v4
    v_lshl_add_u32 v19, v2, 9, v5
    v_lshrrev_b32 v6, 4, v4
    v_lshl_add_u32 v6, v6, 5, v2
    v_mul_u32_u24 v6, 896, v6
    v_and_b32 v7, 15, v4
    v_lshl_add_u32 v27, v7, 4, v6
    v_lshrrev_b32 v6, 3, v4
    v_lshl_add_u32 v6, v6, 5, v2
    v_mul_u32_u24 v6, 896, v6
    v_and_b32 v7, 7, v4
    v_lshl_add_u32 v31, v7, 4, v6
    v_lshrrev_b32 v4, 3, v1
    v_and_b32 v5, 7, v1
    v_lshrrev_b32 v6, 1, v4
    v_xor_b32 v6, v6, v5
    v_mul_u32_u24 v7, 896, v4
    v_lshl_add_u32 v40, v6, 4, v7
    v_xor_b32 v6, 4, v6
    v_lshl_add_u32 v41, v6, 4, v7
    v_add_u32 v41, 7168, v41
    s_getreg_b32 s53, hwreg(HW_REG_XCC_ID, 0, 4)
    s_and_b32 s53, s53, 1
    s_xor_b32 s53, s53, 1
    s_mov_b32 m0, 98304
    s_mov_b32 s32, 524288
    buffer_load_dwordx4 v20, s[16:19], s32 offen lds
    s_add_u32 m0, m0, s98
    s_add_u32 s32, s32, s99
    buffer_load_dwordx4 v21, s[16:19], s32 offen lds
    s_add_u32 m0, m0, s98
    s_add_u32 s32, s32, s100
    buffer_load_dwordx4 v22, s[16:19], s32 offen lds
    s_add_u32 m0, m0, s98
    s_add_u32 s32, s32, s99
    buffer_load_dwordx4 v23, s[16:19], s32 offen lds
    s_add_u32 m0, m0, s98
    s_add_u32 s32, s32, s100
    buffer_load_dwordx4 v20, s[16:19], s32 offen lds
    s_add_u32 m0, m0, s98
    s_add_u32 s32, s32, s99
    buffer_load_dwordx4 v21, s[16:19], s32 offen lds
    s_add_u32 m0, m0, s98
    s_add_u32 s32, s32, s100
    buffer_load_dwordx4 v22, s[16:19], s32 offen lds
    s_add_u32 m0, m0, s98
    s_add_u32 s32, s32, s99
    buffer_load_dwordx4 v23, s[16:19], s32 offen lds
    s_add_u32 m0, m0, s98
    s_sub_u32 s32, s32, 180224
    buffer_load_dwordx4 v20, s[16:19], s32 offen lds
    s_add_u32 m0, m0, s98
    s_add_u32 s32, s32, s99
    buffer_load_dwordx4 v21, s[16:19], s32 offen lds
    s_add_u32 m0, m0, s98
    s_add_u32 s32, s32, s100
    buffer_load_dwordx4 v22, s[16:19], s32 offen lds
    s_add_u32 m0, m0, s98
    s_add_u32 s32, s32, s99
    buffer_load_dwordx4 v23, s[16:19], s32 offen lds
    s_add_u32 m0, m0, s98
    s_add_u32 s32, s32, s100
    buffer_load_dwordx4 v20, s[16:19], s32 offen lds
    s_add_u32 m0, m0, s98
    s_add_u32 s32, s32, s99
    buffer_load_dwordx4 v21, s[16:19], s32 offen lds
    s_add_u32 m0, m0, s98
    s_add_u32 s32, s32, s100
    buffer_load_dwordx4 v22, s[16:19], s32 offen lds
    s_add_u32 m0, m0, s98
    s_add_u32 s32, s32, s99
    buffer_load_dwordx4 v23, s[16:19], s32 offen lds
    s_branch L_loader2
L_compute:
    v_lshrrev_b32 v2, 3, v1
    v_and_b32 v3, 7, v1
    v_lshrrev_b32 v22, 1, v2
    v_xor_b32 v22, v22, v3
    v_mul_u32_u24 v23, 896, v2
    v_lshl_add_u32 v24, v22, 4, v23
    v_xor_b32 v22, 4, v22
    v_lshl_add_u32 v25, v22, 4, v23
    v_add_u32 v25, 7168, v25
    s_mul_i32 s78, s28, 129024
    s_lshl_b32 s79, s29, 9
    s_mov_b32 s6, 129024
    s_mov_b32 s7, 0x20000
    s_sub_u32 s18, 3670016, s79
    s_mov_b32 s19, 0x20000
    s_waitcnt lgkmcnt(0)
    s_cmp_eq_u32 s30, 0
    s_cselect_b32 s4, s44, s54
    s_cselect_b32 s5, s45, s55
    s_cselect_b32 s16, s50, s68
    s_cselect_b32 s17, s51, s69
    s_cselect_b32 s8, s46, s64
    s_cselect_b32 s9, s47, s65
    s_cselect_b32 s12, s48, s66
    s_cselect_b32 s13, s49, s67
    s_cselect_b32 s20, s52, s70
    s_cselect_b32 s21, s53, s71
    s_add_u32 s4, s4, s78
    s_addc_u32 s5, s5, 0
    s_add_u32 s16, s16, s79
    s_addc_u32 s17, s17, 0
    s_mul_i32 s74, s3, 24576
    s_mul_i32 s75, s3, 43008
    s_add_u32 m0, s74, 0
    s_add_u32 s32, s75, 0
    buffer_load_dwordx4 v24, s[4:7], s32 offen lds
    s_add_u32 m0, s74, 4096
    s_add_u32 s32, s75, 0
    buffer_load_dwordx4 v25, s[4:7], s32 offen lds
    s_add_u32 m0, s74, 8192
    s_add_u32 s32, s75, 14336
    buffer_load_dwordx4 v24, s[4:7], s32 offen lds
    s_add_u32 m0, s74, 12288
    s_add_u32 s32, s75, 14336
    buffer_load_dwordx4 v25, s[4:7], s32 offen lds
    s_add_u32 m0, s74, 16384
    s_add_u32 s32, s75, 28672
    buffer_load_dwordx4 v24, s[4:7], s32 offen lds
    s_add_u32 m0, s74, 20480
    s_add_u32 s32, s75, 28672
    buffer_load_dwordx4 v25, s[4:7], s32 offen lds
    s_add_u32 m0, s74, 1024
    s_add_u32 s32, s75, 128
    buffer_load_dwordx4 v24, s[4:7], s32 offen lds
    s_add_u32 m0, s74, 5120
    s_add_u32 s32, s75, 128
    buffer_load_dwordx4 v25, s[4:7], s32 offen lds
    s_add_u32 m0, s74, 9216
    s_add_u32 s32, s75, 14464
    buffer_load_dwordx4 v24, s[4:7], s32 offen lds
    s_add_u32 m0, s74, 13312
    s_add_u32 s32, s75, 14464
    buffer_load_dwordx4 v25, s[4:7], s32 offen lds
    s_add_u32 m0, s74, 17408
    s_add_u32 s32, s75, 28800
    buffer_load_dwordx4 v24, s[4:7], s32 offen lds
    s_add_u32 m0, s74, 21504
    s_add_u32 s32, s75, 28800
    buffer_load_dwordx4 v25, s[4:7], s32 offen lds
    s_add_u32 m0, s74, 2048
    s_add_u32 s32, s75, 256
    buffer_load_dwordx4 v24, s[4:7], s32 offen lds
    s_add_u32 m0, s74, 6144
    s_add_u32 s32, s75, 256
    buffer_load_dwordx4 v25, s[4:7], s32 offen lds
    s_add_u32 m0, s74, 10240
    s_add_u32 s32, s75, 14592
    buffer_load_dwordx4 v24, s[4:7], s32 offen lds
    s_add_u32 m0, s74, 14336
    s_add_u32 s32, s75, 14592
    buffer_load_dwordx4 v25, s[4:7], s32 offen lds
    s_add_u32 m0, s74, 18432
    s_add_u32 s32, s75, 28928
    buffer_load_dwordx4 v24, s[4:7], s32 offen lds
    s_add_u32 m0, s74, 22528
    s_add_u32 s32, s75, 28928
    buffer_load_dwordx4 v25, s[4:7], s32 offen lds
    s_add_u32 m0, s74, 3072
    s_add_u32 s32, s75, 384
    buffer_load_dwordx4 v24, s[4:7], s32 offen lds
    s_add_u32 m0, s74, 7168
    s_add_u32 s32, s75, 384
    buffer_load_dwordx4 v25, s[4:7], s32 offen lds
    s_add_u32 m0, s74, 11264
    s_add_u32 s32, s75, 14720
    buffer_load_dwordx4 v24, s[4:7], s32 offen lds
    s_add_u32 m0, s74, 15360
    s_add_u32 s32, s75, 14720
    buffer_load_dwordx4 v25, s[4:7], s32 offen lds
    s_add_u32 m0, s74, 19456
    s_add_u32 s32, s75, 29056
    buffer_load_dwordx4 v24, s[4:7], s32 offen lds
    s_add_u32 m0, s74, 23552
    s_add_u32 s32, s75, 29056
    buffer_load_dwordx4 v25, s[4:7], s32 offen lds
    v_lshrrev_b32 v2, 5, v1
    v_and_b32 v3, 31, v1
    v_lshlrev_b32 v3, 4, v3
    v_lshl_add_u32 v26, v2, 13, v3
    s_mul_i32 s75, s28, 48
    s_lshl_b32 s76, s3, 4
    s_add_u32 s75, s75, s76
    s_add_u32 s75, s75, 64
    s_lshl_b32 s75, s75, 13
    buffer_load_dwordx4 a[232:235], v26, s[16:19], s75 offen
    s_add_u32 s75, s75, 16384
    buffer_load_dwordx4 a[232:235], v26, s[16:19], s75 offen
    s_add_u32 s75, s75, 16384
    buffer_load_dwordx4 a[232:235], v26, s[16:19], s75 offen
    s_add_u32 s75, s75, 16384
    buffer_load_dwordx4 a[232:235], v26, s[16:19], s75 offen
    s_add_u32 s75, s75, 16384
    buffer_load_dwordx4 a[232:235], v26, s[16:19], s75 offen
    s_add_u32 s75, s75, 16384
    buffer_load_dwordx4 a[232:235], v26, s[16:19], s75 offen
    s_add_u32 s75, s75, 16384
    buffer_load_dwordx4 a[232:235], v26, s[16:19], s75 offen
    s_add_u32 s75, s75, 16384
    buffer_load_dwordx4 a[232:235], v26, s[16:19], s75 offen
    s_lshl_b32 s74, s28, 4
    s_add_u32 s74, s74, s29
    s_lshl_b32 s75, s30, 7
    s_add_u32 s74, s74, s75
    s_mul_i32 s74, s74, 129024
    s_add_u32 s24, s72, s74
    s_addc_u32 s25, s73, 0
    s_mov_b32 s26, 129024
    s_mov_b32 s27, 0x20000
    v_lshrrev_b32 v22, 4, v1
    v_and_b32 v23, 15, v1
    v_lshrrev_b32 v26, 1, v23
    v_lshrrev_b32 v27, 3, v23
    v_and_b32 v28, 7, v23
    v_lshlrev_b32 v28, 7, v28
    s_mul_i32 s74, s3, 24576
    s_mul_i32 s75, s3, 18432
    s_add_u32 s75, s75, 32768
    v_lshl_add_u32 v29, v27, 12, v28
    v_add_u32 v29, s74, v29
    v_mul_u32_u24 v27, 3072, v27
    v_add_u32 v27, v27, v28
    v_add_u32 v27, s75, v27
    v_add_u32 v2, 0, v22
    v_xor_b32 v2, v2, v26
    v_lshl_add_u32 v20, v2, 4, v29
    v_lshl_add_u32 v24, v2, 4, v27
    v_add_u32 v2, 4, v22
    v_xor_b32 v2, v2, v26
    v_lshl_add_u32 v21, v2, 4, v29
    v_lshl_add_u32 v25, v2, 4, v27
    v_add_u32 v2, 0, v22
    v_xor_b32 v2, v2, v23
    v_lshlrev_b32 v2, 4, v2
    v_lshl_add_u32 v4, v23, 9, v2
    v_add_u32 v2, 4, v22
    v_xor_b32 v2, v2, v23
    v_lshlrev_b32 v2, 4, v2
    v_lshl_add_u32 v5, v23, 9, v2
    v_add_u32 v2, 8, v22
    v_xor_b32 v2, v2, v23
    v_lshlrev_b32 v2, 4, v2
    v_lshl_add_u32 v6, v23, 9, v2
    v_add_u32 v2, 12, v22
    v_xor_b32 v2, v2, v23
    v_lshlrev_b32 v2, 4, v2
    v_lshl_add_u32 v7, v23, 9, v2
    v_lshrrev_b32 v26, 2, v23
    v_and_b32 v27, 3, v23
    v_lshl_add_u32 v28, v22, 2, v26
    v_and_b32 v29, 7, v28
    v_lshrrev_b32 v2, 1, v27
    v_lshlrev_b32 v2, 4, v2
    v_and_b32 v3, 1, v27
    v_lshl_add_u32 v2, v3, 3, v2
    v_lshl_add_u32 v30, v28, 9, v2
    v_xor_b32 v2, 0, v29
    v_lshl_add_u32 v2, v2, 5, v30
    v_add_u32 v8, 65536, v2
    v_xor_b32 v2, 1, v29
    v_lshl_add_u32 v2, v2, 5, v30
    v_add_u32 v9, 65536, v2
    v_xor_b32 v2, 2, v29
    v_lshl_add_u32 v2, v2, 5, v30
    v_add_u32 v10, 65536, v2
    v_xor_b32 v2, 3, v29
    v_lshl_add_u32 v2, v2, 5, v30
    v_add_u32 v11, 65536, v2
    v_xor_b32 v2, 4, v29
    v_lshl_add_u32 v2, v2, 5, v30
    v_add_u32 v12, 65536, v2
    v_xor_b32 v2, 5, v29
    v_lshl_add_u32 v2, v2, 5, v30
    v_add_u32 v13, 65536, v2
    v_xor_b32 v2, 6, v29
    v_lshl_add_u32 v2, v2, 5, v30
    v_add_u32 v14, 65536, v2
    v_xor_b32 v2, 7, v29
    v_lshl_add_u32 v2, v2, 5, v30
    v_add_u32 v15, 65536, v2
    v_lshlrev_b32 v31, 1, v29
    v_lshlrev_b32 v30, 9, v28
    v_add_u32 v2, 0, v27
    v_xor_b32 v2, v2, v31
    v_lshl_add_u32 v2, v2, 4, v30
    v_add_u32 v16, 98304, v2
    v_add_u32 v2, 4, v27
    v_xor_b32 v2, v2, v31
    v_lshl_add_u32 v2, v2, 4, v30
    v_add_u32 v17, 98304, v2
    v_add_u32 v2, 8, v27
    v_xor_b32 v2, v2, v31
    v_lshl_add_u32 v2, v2, 4, v30
    v_add_u32 v18, 98304, v2
    v_add_u32 v2, 12, v27
    v_xor_b32 v2, v2, v31
    v_lshl_add_u32 v2, v2, 4, v30
    v_add_u32 v19, 98304, v2
    s_mov_b32 s31, 0x41000000
    s_waitcnt vmcnt(8)
    ds_read_b128 a[0:3], v20 offset:0
    ds_read_b128 a[4:7], v20 offset:8192
    ds_read_b128 a[8:11], v20 offset:16384
    s_barrier
    s_waitcnt lgkmcnt(0)
    ds_read_b64_tr_b16 a[168:169], v16 offset:32768
    ds_read_b64_tr_b16 a[170:171], v16 offset:40960
    ds_read_b64_tr_b16 a[172:173], v16 offset:32776
    ds_read_b64_tr_b16 a[174:175], v16 offset:40968
    ds_read_b64_tr_b16 a[176:177], v17 offset:32768
    ds_read_b64_tr_b16 a[178:179], v17 offset:40960
    ds_read_b64_tr_b16 a[180:181], v17 offset:32776
    ds_read_b64_tr_b16 a[182:183], v17 offset:40968
    s_waitcnt lgkmcnt(4)
    v_mfma_f32_16x16x32_bf16 v[64:67], a[168:171], a[0:3], 0
    ds_read_b64_tr_b16 a[184:185], v18 offset:32768
    ds_read_b64_tr_b16 a[186:187], v18 offset:40960
    v_mfma_f32_16x16x32_bf16 v[128:131], a[168:171], a[4:7], 0
    ds_read_b64_tr_b16 a[188:189], v18 offset:32776
    ds_read_b64_tr_b16 a[190:191], v18 offset:40968
    v_mfma_f32_16x16x32_bf16 v[192:195], a[168:171], a[8:11], 0
    ds_read_b64_tr_b16 a[192:193], v19 offset:32768
    ds_read_b64_tr_b16 a[194:195], v19 offset:40960
    v_mfma_f32_16x16x32_bf16 v[68:71], a[172:175], a[0:3], 0
    ds_read_b64_tr_b16 a[196:197], v19 offset:32776
    ds_read_b128 a[12:15], v21 offset:0
    v_mfma_f32_16x16x32_bf16 v[132:135], a[172:175], a[4:7], 0
    ds_read_b64_tr_b16 a[198:199], v19 offset:40968
    ds_read_b128 a[16:19], v21 offset:8192
    v_mfma_f32_16x16x32_bf16 v[196:199], a[172:175], a[8:11], 0
    ds_read_b128 a[20:23], v21 offset:16384
    s_waitcnt lgkmcnt(11)
    v_mfma_f32_16x16x32_bf16 v[72:75], a[176:179], a[0:3], 0
    ds_read_b64_tr_b16 a[200:201], v16 offset:33024
    ds_read_b128 a[24:27], v20 offset:1024
    v_mfma_f32_16x16x32_bf16 v[136:139], a[176:179], a[4:7], 0
    ds_read_b64_tr_b16 a[202:203], v16 offset:41216
    v_mfma_f32_16x16x32_bf16 v[200:203], a[176:179], a[8:11], 0
    ds_read_b128 a[28:31], v20 offset:9216
    v_mfma_f32_16x16x32_bf16 v[76:79], a[180:183], a[0:3], 0
    s_waitcnt lgkmcnt(14)
    ds_read_b64_tr_b16 a[204:205], v16 offset:33032
    v_mfma_f32_16x16x32_bf16 v[140:143], a[180:183], a[4:7], 0
    s_waitcnt lgkmcnt(14)
    ds_read_b64_tr_b16 a[206:207], v16 offset:41224
    s_waitcnt lgkmcnt(14)
    ds_read_b128 a[32:35], v20 offset:17408
    v_mfma_f32_16x16x32_bf16 v[204:207], a[180:183], a[8:11], 0
    s_waitcnt lgkmcnt(14)
    v_mfma_f32_16x16x32_bf16 v[80:83], a[184:187], a[0:3], 0
    ds_read_b64_tr_b16 a[208:209], v17 offset:33024
    s_waitcnt lgkmcnt(14)
    ds_read_b128 a[36:39], v21 offset:1024
    v_mfma_f32_16x16x32_bf16 v[144:147], a[184:187], a[4:7], 0
    s_waitcnt lgkmcnt(14)
    ds_read_b64_tr_b16 a[210:211], v17 offset:41216
    v_mfma_f32_16x16x32_bf16 v[208:211], a[184:187], a[8:11], 0
    s_waitcnt lgkmcnt(14)
    ds_read_b128 a[40:43], v21 offset:9216
    v_mfma_f32_16x16x32_bf16 v[84:87], a[188:191], a[0:3], 0
    s_waitcnt lgkmcnt(14)
    ds_read_b64_tr_b16 a[212:213], v17 offset:33032
    v_mfma_f32_16x16x32_bf16 v[148:151], a[188:191], a[4:7], 0
    s_waitcnt lgkmcnt(14)
    ds_read_b64_tr_b16 a[214:215], v17 offset:41224
    s_waitcnt lgkmcnt(14)
    ds_read_b128 a[44:47], v21 offset:17408
    v_mfma_f32_16x16x32_bf16 v[212:215], a[188:191], a[8:11], 0
    v_mfma_f32_16x16x32_bf16 v[88:91], a[192:195], a[0:3], 0
    s_waitcnt lgkmcnt(14)
    ds_read_b64_tr_b16 a[216:217], v18 offset:33024
    s_waitcnt lgkmcnt(14)
    ds_read_b128 a[48:51], v20 offset:2048
    v_mfma_f32_16x16x32_bf16 v[152:155], a[192:195], a[4:7], 0
    s_waitcnt lgkmcnt(14)
    ds_read_b64_tr_b16 a[218:219], v18 offset:41216
    v_mfma_f32_16x16x32_bf16 v[216:219], a[192:195], a[8:11], 0
    s_waitcnt lgkmcnt(14)
    ds_read_b128 a[52:55], v20 offset:10240
    v_mfma_f32_16x16x32_bf16 v[92:95], a[196:199], a[0:3], 0
    s_waitcnt lgkmcnt(14)
    ds_read_b64_tr_b16 a[220:221], v18 offset:33032
    v_mfma_f32_16x16x32_bf16 v[156:159], a[196:199], a[4:7], 0
    s_waitcnt lgkmcnt(14)
    ds_read_b64_tr_b16 a[222:223], v18 offset:41224
    s_waitcnt lgkmcnt(14)
    ds_read_b128 a[56:59], v20 offset:18432
    v_mfma_f32_16x16x32_bf16 v[220:223], a[196:199], a[8:11], 0
    v_mfma_f32_16x16x32_bf16 v[96:99], a[200:203], a[0:3], 0
    s_waitcnt lgkmcnt(14)
    ds_read_b64_tr_b16 a[224:225], v19 offset:33024
    s_waitcnt lgkmcnt(14)
    ds_read_b128 a[60:63], v21 offset:2048
    v_mfma_f32_16x16x32_bf16 v[160:163], a[200:203], a[4:7], 0
    s_waitcnt lgkmcnt(14)
    ds_read_b64_tr_b16 a[226:227], v19 offset:41216
    v_mfma_f32_16x16x32_bf16 v[224:227], a[200:203], a[8:11], 0
    s_waitcnt lgkmcnt(14)
    ds_read_b128 a[64:67], v21 offset:10240
    v_mfma_f32_16x16x32_bf16 v[100:103], a[204:207], a[0:3], 0
    s_waitcnt lgkmcnt(14)
    ds_read_b64_tr_b16 a[228:229], v19 offset:33032
    v_mfma_f32_16x16x32_bf16 v[164:167], a[204:207], a[4:7], 0
    s_waitcnt lgkmcnt(14)
    ds_read_b64_tr_b16 a[230:231], v19 offset:41224
    s_waitcnt lgkmcnt(14)
    ds_read_b128 a[68:71], v21 offset:18432
    v_mfma_f32_16x16x32_bf16 v[228:231], a[204:207], a[8:11], 0
    v_mfma_f32_16x16x32_bf16 v[104:107], a[208:211], a[0:3], 0
    s_waitcnt lgkmcnt(14)
    ds_read_b64_tr_b16 a[168:169], v16 offset:49152
    s_waitcnt lgkmcnt(14)
    ds_read_b128 a[72:75], v20 offset:3072
    v_mfma_f32_16x16x32_bf16 v[168:171], a[208:211], a[4:7], 0
    s_waitcnt lgkmcnt(14)
    ds_read_b64_tr_b16 a[170:171], v16 offset:57344
    v_mfma_f32_16x16x32_bf16 v[232:235], a[208:211], a[8:11], 0
    s_waitcnt lgkmcnt(14)
    ds_read_b128 a[76:79], v20 offset:11264
    v_mfma_f32_16x16x32_bf16 v[108:111], a[212:215], a[0:3], 0
    s_waitcnt lgkmcnt(14)
    ds_read_b64_tr_b16 a[172:173], v16 offset:49160
    v_mfma_f32_16x16x32_bf16 v[172:175], a[212:215], a[4:7], 0
    s_waitcnt lgkmcnt(14)
    ds_read_b64_tr_b16 a[174:175], v16 offset:57352
    s_waitcnt lgkmcnt(14)
    ds_read_b128 a[80:83], v20 offset:19456
    v_mfma_f32_16x16x32_bf16 v[236:239], a[212:215], a[8:11], 0
    v_mfma_f32_16x16x32_bf16 v[112:115], a[216:219], a[0:3], 0
    s_waitcnt lgkmcnt(14)
    ds_read_b64_tr_b16 a[176:177], v17 offset:49152
    s_waitcnt lgkmcnt(14)
    ds_read_b128 a[84:87], v21 offset:3072
    v_mfma_f32_16x16x32_bf16 v[176:179], a[216:219], a[4:7], 0
    s_waitcnt lgkmcnt(14)
    ds_read_b64_tr_b16 a[178:179], v17 offset:57344
    v_mfma_f32_16x16x32_bf16 v[240:243], a[216:219], a[8:11], 0
    s_waitcnt lgkmcnt(14)
    ds_read_b128 a[88:91], v21 offset:11264
    v_mfma_f32_16x16x32_bf16 v[116:119], a[220:223], a[0:3], 0
    s_waitcnt lgkmcnt(14)
    ds_read_b64_tr_b16 a[180:181], v17 offset:49160
    v_mfma_f32_16x16x32_bf16 v[180:183], a[220:223], a[4:7], 0
    s_waitcnt lgkmcnt(14)
    ds_read_b64_tr_b16 a[182:183], v17 offset:57352
    s_waitcnt lgkmcnt(14)
    ds_read_b128 a[92:95], v21 offset:19456
    v_mfma_f32_16x16x32_bf16 v[244:247], a[220:223], a[8:11], 0
    v_mfma_f32_16x16x32_bf16 v[120:123], a[224:227], a[0:3], 0
    s_waitcnt lgkmcnt(14)
    ds_read_b64_tr_b16 a[184:185], v18 offset:49152
    v_mfma_f32_16x16x32_bf16 v[184:187], a[224:227], a[4:7], 0
    s_waitcnt lgkmcnt(14)
    ds_read_b64_tr_b16 a[186:187], v18 offset:57344
    v_mfma_f32_16x16x32_bf16 v[248:251], a[224:227], a[8:11], 0
    v_mfma_f32_16x16x32_bf16 v[124:127], a[228:231], a[0:3], 0
    s_waitcnt lgkmcnt(14)
    ds_read_b64_tr_b16 a[188:189], v18 offset:49160
    v_mfma_f32_16x16x32_bf16 v[188:191], a[228:231], a[4:7], 0
    s_waitcnt lgkmcnt(14)
    ds_read_b64_tr_b16 a[190:191], v18 offset:57352
    v_mfma_f32_16x16x32_bf16 v[252:255], a[228:231], a[8:11], 0
    s_waitcnt lgkmcnt(4)
    s_barrier
    v_mfma_f32_16x16x32_bf16 v[64:67], a[168:171], a[12:15], v[64:67]
    ds_read_b64_tr_b16 a[192:193], v19 offset:49152
    v_mfma_f32_16x16x32_bf16 v[128:131], a[168:171], a[16:19], v[128:131]
    ds_read_b64_tr_b16 a[194:195], v19 offset:57344
    v_mfma_f32_16x16x32_bf16 v[192:195], a[168:171], a[20:23], v[192:195]
    v_mfma_f32_16x16x32_bf16 v[68:71], a[172:175], a[12:15], v[68:71]
    ds_read_b64_tr_b16 a[196:197], v19 offset:49160
    v_mfma_f32_16x16x32_bf16 v[132:135], a[172:175], a[16:19], v[132:135]
    ds_read_b64_tr_b16 a[198:199], v19 offset:57352
    v_mfma_f32_16x16x32_bf16 v[196:199], a[172:175], a[20:23], v[196:199]
    v_mfma_f32_16x16x32_bf16 v[72:75], a[176:179], a[12:15], v[72:75]
    ds_read_b64_tr_b16 a[200:201], v16 offset:49408
    v_mfma_f32_16x16x32_bf16 v[136:139], a[176:179], a[16:19], v[136:139]
    ds_read_b64_tr_b16 a[202:203], v16 offset:57600
    v_mfma_f32_16x16x32_bf16 v[200:203], a[176:179], a[20:23], v[200:203]
    v_mfma_f32_16x16x32_bf16 v[76:79], a[180:183], a[12:15], v[76:79]
    ds_read_b64_tr_b16 a[204:205], v16 offset:49416
    v_mfma_f32_16x16x32_bf16 v[140:143], a[180:183], a[16:19], v[140:143]
    ds_read_b64_tr_b16 a[206:207], v16 offset:57608
    v_mfma_f32_16x16x32_bf16 v[204:207], a[180:183], a[20:23], v[204:207]
    s_waitcnt lgkmcnt(8)
    v_mfma_f32_16x16x32_bf16 v[80:83], a[184:187], a[12:15], v[80:83]
    ds_read_b64_tr_b16 a[208:209], v17 offset:49408
    v_mfma_f32_16x16x32_bf16 v[144:147], a[184:187], a[16:19], v[144:147]
    ds_read_b64_tr_b16 a[210:211], v17 offset:57600
    v_mfma_f32_16x16x32_bf16 v[208:211], a[184:187], a[20:23], v[208:211]
    v_mfma_f32_16x16x32_bf16 v[84:87], a[188:191], a[12:15], v[84:87]
    ds_read_b64_tr_b16 a[212:213], v17 offset:49416
    v_mfma_f32_16x16x32_bf16 v[148:151], a[188:191], a[16:19], v[148:151]
    ds_read_b64_tr_b16 a[214:215], v17 offset:57608
    v_mfma_f32_16x16x32_bf16 v[212:215], a[188:191], a[20:23], v[212:215]
    s_waitcnt lgkmcnt(8)
    v_mfma_f32_16x16x32_bf16 v[88:91], a[192:195], a[12:15], v[88:91]
    ds_read_b64_tr_b16 a[216:217], v18 offset:49408
    v_mfma_f32_16x16x32_bf16 v[152:155], a[192:195], a[16:19], v[152:155]
    ds_read_b64_tr_b16 a[218:219], v18 offset:57600
    v_mfma_f32_16x16x32_bf16 v[216:219], a[192:195], a[20:23], v[216:219]
    v_mfma_f32_16x16x32_bf16 v[92:95], a[196:199], a[12:15], v[92:95]
    ds_read_b64_tr_b16 a[220:221], v18 offset:49416
    v_mfma_f32_16x16x32_bf16 v[156:159], a[196:199], a[16:19], v[156:159]
    ds_read_b64_tr_b16 a[222:223], v18 offset:57608
    v_mfma_f32_16x16x32_bf16 v[220:223], a[196:199], a[20:23], v[220:223]
    s_waitcnt lgkmcnt(8)
    v_mfma_f32_16x16x32_bf16 v[96:99], a[200:203], a[12:15], v[96:99]
    ds_read_b64_tr_b16 a[224:225], v19 offset:49408
    v_mfma_f32_16x16x32_bf16 v[160:163], a[200:203], a[16:19], v[160:163]
    ds_read_b64_tr_b16 a[226:227], v19 offset:57600
    v_mfma_f32_16x16x32_bf16 v[224:227], a[200:203], a[20:23], v[224:227]
    v_mfma_f32_16x16x32_bf16 v[100:103], a[204:207], a[12:15], v[100:103]
    ds_read_b64_tr_b16 a[228:229], v19 offset:49416
    v_mfma_f32_16x16x32_bf16 v[164:167], a[204:207], a[16:19], v[164:167]
    ds_read_b64_tr_b16 a[230:231], v19 offset:57608
    v_mfma_f32_16x16x32_bf16 v[228:231], a[204:207], a[20:23], v[228:231]
    s_waitcnt lgkmcnt(8)
    v_mfma_f32_16x16x32_bf16 v[104:107], a[208:211], a[12:15], v[104:107]
    ds_read_b64_tr_b16 a[168:169], v16 offset:0
    v_mfma_f32_16x16x32_bf16 v[168:171], a[208:211], a[16:19], v[168:171]
    ds_read_b64_tr_b16 a[170:171], v16 offset:8192
    v_mfma_f32_16x16x32_bf16 v[232:235], a[208:211], a[20:23], v[232:235]
    v_mfma_f32_16x16x32_bf16 v[108:111], a[212:215], a[12:15], v[108:111]
    ds_read_b64_tr_b16 a[172:173], v16 offset:8
    v_mfma_f32_16x16x32_bf16 v[172:175], a[212:215], a[16:19], v[172:175]
    ds_read_b64_tr_b16 a[174:175], v16 offset:8200
    v_mfma_f32_16x16x32_bf16 v[236:239], a[212:215], a[20:23], v[236:239]
    s_waitcnt lgkmcnt(8)
    v_mfma_f32_16x16x32_bf16 v[112:115], a[216:219], a[12:15], v[112:115]
    ds_read_b64_tr_b16 a[176:177], v17 offset:0
    v_mfma_f32_16x16x32_bf16 v[176:179], a[216:219], a[16:19], v[176:179]
    ds_read_b64_tr_b16 a[178:179], v17 offset:8192
    v_mfma_f32_16x16x32_bf16 v[240:243], a[216:219], a[20:23], v[240:243]
    v_mfma_f32_16x16x32_bf16 v[116:119], a[220:223], a[12:15], v[116:119]
    ds_read_b64_tr_b16 a[180:181], v17 offset:8
    v_mfma_f32_16x16x32_bf16 v[180:183], a[220:223], a[16:19], v[180:183]
    ds_read_b64_tr_b16 a[182:183], v17 offset:8200
    v_mfma_f32_16x16x32_bf16 v[244:247], a[220:223], a[20:23], v[244:247]
    s_waitcnt lgkmcnt(8)
    v_mfma_f32_16x16x32_bf16 v[120:123], a[224:227], a[12:15], v[120:123]
    ds_read_b64_tr_b16 a[184:185], v18 offset:0
    v_mfma_f32_16x16x32_bf16 v[184:187], a[224:227], a[16:19], v[184:187]
    ds_read_b64_tr_b16 a[186:187], v18 offset:8192
    v_mfma_f32_16x16x32_bf16 v[248:251], a[224:227], a[20:23], v[248:251]
    v_mfma_f32_16x16x32_bf16 v[124:127], a[228:231], a[12:15], v[124:127]
    ds_read_b64_tr_b16 a[188:189], v18 offset:8
    v_mfma_f32_16x16x32_bf16 v[188:191], a[228:231], a[16:19], v[188:191]
    ds_read_b64_tr_b16 a[190:191], v18 offset:8200
    v_mfma_f32_16x16x32_bf16 v[252:255], a[228:231], a[20:23], v[252:255]
    s_barrier
    s_waitcnt lgkmcnt(8)
    v_mfma_f32_16x16x32_bf16 v[64:67], a[168:171], a[24:27], v[64:67]
    ds_read_b64_tr_b16 a[192:193], v19 offset:0
    v_mfma_f32_16x16x32_bf16 v[128:131], a[168:171], a[28:31], v[128:131]
    ds_read_b64_tr_b16 a[194:195], v19 offset:8192
    v_mfma_f32_16x16x32_bf16 v[192:195], a[168:171], a[32:35], v[192:195]
    v_mfma_f32_16x16x32_bf16 v[68:71], a[172:175], a[24:27], v[68:71]
    ds_read_b64_tr_b16 a[196:197], v19 offset:8
    v_mfma_f32_16x16x32_bf16 v[132:135], a[172:175], a[28:31], v[132:135]
    ds_read_b64_tr_b16 a[198:199], v19 offset:8200
    v_mfma_f32_16x16x32_bf16 v[196:199], a[172:175], a[32:35], v[196:199]
    s_waitcnt lgkmcnt(8)
    v_mfma_f32_16x16x32_bf16 v[72:75], a[176:179], a[24:27], v[72:75]
    ds_read_b64_tr_b16 a[200:201], v16 offset:256
    v_mfma_f32_16x16x32_bf16 v[136:139], a[176:179], a[28:31], v[136:139]
    ds_read_b64_tr_b16 a[202:203], v16 offset:8448
    v_mfma_f32_16x16x32_bf16 v[200:203], a[176:179], a[32:35], v[200:203]
    v_mfma_f32_16x16x32_bf16 v[76:79], a[180:183], a[24:27], v[76:79]
    ds_read_b64_tr_b16 a[204:205], v16 offset:264
    v_mfma_f32_16x16x32_bf16 v[140:143], a[180:183], a[28:31], v[140:143]
    ds_read_b64_tr_b16 a[206:207], v16 offset:8456
    v_mfma_f32_16x16x32_bf16 v[204:207], a[180:183], a[32:35], v[204:207]
    s_waitcnt lgkmcnt(8)
    v_mfma_f32_16x16x32_bf16 v[80:83], a[184:187], a[24:27], v[80:83]
    ds_read_b64_tr_b16 a[208:209], v17 offset:256
    v_mfma_f32_16x16x32_bf16 v[144:147], a[184:187], a[28:31], v[144:147]
    ds_read_b64_tr_b16 a[210:211], v17 offset:8448
    v_mfma_f32_16x16x32_bf16 v[208:211], a[184:187], a[32:35], v[208:211]
    v_mfma_f32_16x16x32_bf16 v[84:87], a[188:191], a[24:27], v[84:87]
    ds_read_b64_tr_b16 a[212:213], v17 offset:264
    v_mfma_f32_16x16x32_bf16 v[148:151], a[188:191], a[28:31], v[148:151]
    ds_read_b64_tr_b16 a[214:215], v17 offset:8456
    v_mfma_f32_16x16x32_bf16 v[212:215], a[188:191], a[32:35], v[212:215]
    s_waitcnt lgkmcnt(8)
    v_mfma_f32_16x16x32_bf16 v[88:91], a[192:195], a[24:27], v[88:91]
    ds_read_b64_tr_b16 a[216:217], v18 offset:256
    v_mfma_f32_16x16x32_bf16 v[152:155], a[192:195], a[28:31], v[152:155]
    ds_read_b64_tr_b16 a[218:219], v18 offset:8448
    v_mfma_f32_16x16x32_bf16 v[216:219], a[192:195], a[32:35], v[216:219]
    v_mfma_f32_16x16x32_bf16 v[92:95], a[196:199], a[24:27], v[92:95]
    ds_read_b64_tr_b16 a[220:221], v18 offset:264
    v_mfma_f32_16x16x32_bf16 v[156:159], a[196:199], a[28:31], v[156:159]
    ds_read_b64_tr_b16 a[222:223], v18 offset:8456
    v_mfma_f32_16x16x32_bf16 v[220:223], a[196:199], a[32:35], v[220:223]
    s_waitcnt lgkmcnt(8)
    v_mfma_f32_16x16x32_bf16 v[96:99], a[200:203], a[24:27], v[96:99]
    ds_read_b64_tr_b16 a[224:225], v19 offset:256
    v_mfma_f32_16x16x32_bf16 v[160:163], a[200:203], a[28:31], v[160:163]
    ds_read_b64_tr_b16 a[226:227], v19 offset:8448
    v_mfma_f32_16x16x32_bf16 v[224:227], a[200:203], a[32:35], v[224:227]
    v_mfma_f32_16x16x32_bf16 v[100:103], a[204:207], a[24:27], v[100:103]
    ds_read_b64_tr_b16 a[228:229], v19 offset:264
    v_mfma_f32_16x16x32_bf16 v[164:167], a[204:207], a[28:31], v[164:167]
    ds_read_b64_tr_b16 a[230:231], v19 offset:8456
    v_mfma_f32_16x16x32_bf16 v[228:231], a[204:207], a[32:35], v[228:231]
    s_waitcnt lgkmcnt(8)
    v_mfma_f32_16x16x32_bf16 v[104:107], a[208:211], a[24:27], v[104:107]
    ds_read_b64_tr_b16 a[168:169], v16 offset:16384
    v_mfma_f32_16x16x32_bf16 v[168:171], a[208:211], a[28:31], v[168:171]
    ds_read_b64_tr_b16 a[170:171], v16 offset:24576
    v_mfma_f32_16x16x32_bf16 v[232:235], a[208:211], a[32:35], v[232:235]
    v_mfma_f32_16x16x32_bf16 v[108:111], a[212:215], a[24:27], v[108:111]
    ds_read_b64_tr_b16 a[172:173], v16 offset:16392
    v_mfma_f32_16x16x32_bf16 v[172:175], a[212:215], a[28:31], v[172:175]
    ds_read_b64_tr_b16 a[174:175], v16 offset:24584
    v_mfma_f32_16x16x32_bf16 v[236:239], a[212:215], a[32:35], v[236:239]
    s_waitcnt lgkmcnt(8)
    v_mfma_f32_16x16x32_bf16 v[112:115], a[216:219], a[24:27], v[112:115]
    ds_read_b64_tr_b16 a[176:177], v17 offset:16384
    v_mfma_f32_16x16x32_bf16 v[176:179], a[216:219], a[28:31], v[176:179]
    ds_read_b64_tr_b16 a[178:179], v17 offset:24576
    v_mfma_f32_16x16x32_bf16 v[240:243], a[216:219], a[32:35], v[240:243]
    v_mfma_f32_16x16x32_bf16 v[116:119], a[220:223], a[24:27], v[116:119]
    ds_read_b64_tr_b16 a[180:181], v17 offset:16392
    v_mfma_f32_16x16x32_bf16 v[180:183], a[220:223], a[28:31], v[180:183]
    ds_read_b64_tr_b16 a[182:183], v17 offset:24584
    v_mfma_f32_16x16x32_bf16 v[244:247], a[220:223], a[32:35], v[244:247]
    s_waitcnt lgkmcnt(8)
    v_mfma_f32_16x16x32_bf16 v[120:123], a[224:227], a[24:27], v[120:123]
    ds_read_b64_tr_b16 a[184:185], v18 offset:16384
    v_mfma_f32_16x16x32_bf16 v[184:187], a[224:227], a[28:31], v[184:187]
    ds_read_b64_tr_b16 a[186:187], v18 offset:24576
    v_mfma_f32_16x16x32_bf16 v[248:251], a[224:227], a[32:35], v[248:251]
    v_mfma_f32_16x16x32_bf16 v[124:127], a[228:231], a[24:27], v[124:127]
    ds_read_b64_tr_b16 a[188:189], v18 offset:16392
    v_mfma_f32_16x16x32_bf16 v[188:191], a[228:231], a[28:31], v[188:191]
    ds_read_b64_tr_b16 a[190:191], v18 offset:24584
    v_mfma_f32_16x16x32_bf16 v[252:255], a[228:231], a[32:35], v[252:255]
    s_barrier
    s_waitcnt lgkmcnt(8)
    v_mfma_f32_16x16x32_bf16 v[64:67], a[168:171], a[36:39], v[64:67]
    ds_read_b64_tr_b16 a[192:193], v19 offset:16384
    v_mfma_f32_16x16x32_bf16 v[128:131], a[168:171], a[40:43], v[128:131]
    ds_read_b64_tr_b16 a[194:195], v19 offset:24576
    v_mfma_f32_16x16x32_bf16 v[192:195], a[168:171], a[44:47], v[192:195]
    v_mfma_f32_16x16x32_bf16 v[68:71], a[172:175], a[36:39], v[68:71]
    ds_read_b64_tr_b16 a[196:197], v19 offset:16392
    v_mfma_f32_16x16x32_bf16 v[132:135], a[172:175], a[40:43], v[132:135]
    ds_read_b64_tr_b16 a[198:199], v19 offset:24584
    v_mfma_f32_16x16x32_bf16 v[196:199], a[172:175], a[44:47], v[196:199]
    s_waitcnt lgkmcnt(8)
    v_mfma_f32_16x16x32_bf16 v[72:75], a[176:179], a[36:39], v[72:75]
    ds_read_b64_tr_b16 a[200:201], v16 offset:16640
    v_mfma_f32_16x16x32_bf16 v[136:139], a[176:179], a[40:43], v[136:139]
    ds_read_b64_tr_b16 a[202:203], v16 offset:24832
    v_mfma_f32_16x16x32_bf16 v[200:203], a[176:179], a[44:47], v[200:203]
    v_mfma_f32_16x16x32_bf16 v[76:79], a[180:183], a[36:39], v[76:79]
    ds_read_b64_tr_b16 a[204:205], v16 offset:16648
    v_mfma_f32_16x16x32_bf16 v[140:143], a[180:183], a[40:43], v[140:143]
    ds_read_b64_tr_b16 a[206:207], v16 offset:24840
    v_mfma_f32_16x16x32_bf16 v[204:207], a[180:183], a[44:47], v[204:207]
    s_waitcnt lgkmcnt(8)
    v_mfma_f32_16x16x32_bf16 v[80:83], a[184:187], a[36:39], v[80:83]
    ds_read_b64_tr_b16 a[208:209], v17 offset:16640
    v_mfma_f32_16x16x32_bf16 v[144:147], a[184:187], a[40:43], v[144:147]
    ds_read_b64_tr_b16 a[210:211], v17 offset:24832
    v_mfma_f32_16x16x32_bf16 v[208:211], a[184:187], a[44:47], v[208:211]
    v_mfma_f32_16x16x32_bf16 v[84:87], a[188:191], a[36:39], v[84:87]
    ds_read_b64_tr_b16 a[212:213], v17 offset:16648
    v_mfma_f32_16x16x32_bf16 v[148:151], a[188:191], a[40:43], v[148:151]
    ds_read_b64_tr_b16 a[214:215], v17 offset:24840
    v_mfma_f32_16x16x32_bf16 v[212:215], a[188:191], a[44:47], v[212:215]
    s_waitcnt lgkmcnt(8)
    v_mfma_f32_16x16x32_bf16 v[88:91], a[192:195], a[36:39], v[88:91]
    ds_read_b64_tr_b16 a[216:217], v18 offset:16640
    v_mfma_f32_16x16x32_bf16 v[152:155], a[192:195], a[40:43], v[152:155]
    ds_read_b64_tr_b16 a[218:219], v18 offset:24832
    v_mfma_f32_16x16x32_bf16 v[216:219], a[192:195], a[44:47], v[216:219]
    v_mfma_f32_16x16x32_bf16 v[92:95], a[196:199], a[36:39], v[92:95]
    ds_read_b64_tr_b16 a[220:221], v18 offset:16648
    v_mfma_f32_16x16x32_bf16 v[156:159], a[196:199], a[40:43], v[156:159]
    ds_read_b64_tr_b16 a[222:223], v18 offset:24840
    v_mfma_f32_16x16x32_bf16 v[220:223], a[196:199], a[44:47], v[220:223]
    s_waitcnt lgkmcnt(8)
    v_mfma_f32_16x16x32_bf16 v[96:99], a[200:203], a[36:39], v[96:99]
    ds_read_b64_tr_b16 a[224:225], v19 offset:16640
    v_mfma_f32_16x16x32_bf16 v[160:163], a[200:203], a[40:43], v[160:163]
    ds_read_b64_tr_b16 a[226:227], v19 offset:24832
    v_mfma_f32_16x16x32_bf16 v[224:227], a[200:203], a[44:47], v[224:227]
    v_mfma_f32_16x16x32_bf16 v[100:103], a[204:207], a[36:39], v[100:103]
    ds_read_b64_tr_b16 a[228:229], v19 offset:16648
    v_mfma_f32_16x16x32_bf16 v[164:167], a[204:207], a[40:43], v[164:167]
    ds_read_b64_tr_b16 a[230:231], v19 offset:24840
    v_mfma_f32_16x16x32_bf16 v[228:231], a[204:207], a[44:47], v[228:231]
    s_waitcnt lgkmcnt(8)
    v_mfma_f32_16x16x32_bf16 v[104:107], a[208:211], a[36:39], v[104:107]
    ds_read_b64_tr_b16 a[168:169], v16 offset:32768
    v_mfma_f32_16x16x32_bf16 v[168:171], a[208:211], a[40:43], v[168:171]
    ds_read_b64_tr_b16 a[170:171], v16 offset:40960
    v_mfma_f32_16x16x32_bf16 v[232:235], a[208:211], a[44:47], v[232:235]
    v_mfma_f32_16x16x32_bf16 v[108:111], a[212:215], a[36:39], v[108:111]
    ds_read_b64_tr_b16 a[172:173], v16 offset:32776
    v_mfma_f32_16x16x32_bf16 v[172:175], a[212:215], a[40:43], v[172:175]
    ds_read_b64_tr_b16 a[174:175], v16 offset:40968
    v_mfma_f32_16x16x32_bf16 v[236:239], a[212:215], a[44:47], v[236:239]
    s_waitcnt lgkmcnt(8)
    v_mfma_f32_16x16x32_bf16 v[112:115], a[216:219], a[36:39], v[112:115]
    ds_read_b64_tr_b16 a[176:177], v17 offset:32768
    v_mfma_f32_16x16x32_bf16 v[176:179], a[216:219], a[40:43], v[176:179]
    ds_read_b64_tr_b16 a[178:179], v17 offset:40960
    v_mfma_f32_16x16x32_bf16 v[240:243], a[216:219], a[44:47], v[240:243]
    v_mfma_f32_16x16x32_bf16 v[116:119], a[220:223], a[36:39], v[116:119]
    ds_read_b64_tr_b16 a[180:181], v17 offset:32776
    v_mfma_f32_16x16x32_bf16 v[180:183], a[220:223], a[40:43], v[180:183]
    ds_read_b64_tr_b16 a[182:183], v17 offset:40968
    v_mfma_f32_16x16x32_bf16 v[244:247], a[220:223], a[44:47], v[244:247]
    s_waitcnt lgkmcnt(8)
    v_mfma_f32_16x16x32_bf16 v[120:123], a[224:227], a[36:39], v[120:123]
    ds_read_b64_tr_b16 a[184:185], v18 offset:32768
    v_mfma_f32_16x16x32_bf16 v[184:187], a[224:227], a[40:43], v[184:187]
    ds_read_b64_tr_b16 a[186:187], v18 offset:40960
    v_mfma_f32_16x16x32_bf16 v[248:251], a[224:227], a[44:47], v[248:251]
    v_mfma_f32_16x16x32_bf16 v[124:127], a[228:231], a[36:39], v[124:127]
    ds_read_b64_tr_b16 a[188:189], v18 offset:32776
    v_mfma_f32_16x16x32_bf16 v[188:191], a[228:231], a[40:43], v[188:191]
    ds_read_b64_tr_b16 a[190:191], v18 offset:40968
    v_mfma_f32_16x16x32_bf16 v[252:255], a[228:231], a[44:47], v[252:255]
    s_barrier
    s_waitcnt lgkmcnt(8)
    v_mfma_f32_16x16x32_bf16 v[64:67], a[168:171], a[48:51], v[64:67]
    ds_read_b64_tr_b16 a[192:193], v19 offset:32768
    ds_read_b128 a[96:99], v24 offset:0
    v_mfma_f32_16x16x32_bf16 v[128:131], a[168:171], a[52:55], v[128:131]
    ds_read_b64_tr_b16 a[194:195], v19 offset:40960
    v_mfma_f32_16x16x32_bf16 v[192:195], a[168:171], a[56:59], v[192:195]
    ds_read_b128 a[100:103], v24 offset:6144
    v_mfma_f32_16x16x32_bf16 v[68:71], a[172:175], a[48:51], v[68:71]
    ds_read_b64_tr_b16 a[196:197], v19 offset:32776
    v_mfma_f32_16x16x32_bf16 v[132:135], a[172:175], a[52:55], v[132:135]
    ds_read_b64_tr_b16 a[198:199], v19 offset:40968
    ds_read_b128 a[104:107], v24 offset:12288
    v_mfma_f32_16x16x32_bf16 v[196:199], a[172:175], a[56:59], v[196:199]
    s_waitcnt lgkmcnt(11)
    v_mfma_f32_16x16x32_bf16 v[72:75], a[176:179], a[48:51], v[72:75]
    ds_read_b64_tr_b16 a[200:201], v16 offset:33024
    ds_read_b128 a[108:111], v25 offset:0
    v_mfma_f32_16x16x32_bf16 v[136:139], a[176:179], a[52:55], v[136:139]
    ds_read_b64_tr_b16 a[202:203], v16 offset:41216
    v_mfma_f32_16x16x32_bf16 v[200:203], a[176:179], a[56:59], v[200:203]
    ds_read_b128 a[112:115], v25 offset:6144
    v_mfma_f32_16x16x32_bf16 v[76:79], a[180:183], a[48:51], v[76:79]
    s_waitcnt lgkmcnt(14)
    ds_read_b64_tr_b16 a[204:205], v16 offset:33032
    v_mfma_f32_16x16x32_bf16 v[140:143], a[180:183], a[52:55], v[140:143]
    s_waitcnt lgkmcnt(14)
    ds_read_b64_tr_b16 a[206:207], v16 offset:41224
    s_waitcnt lgkmcnt(14)
    ds_read_b128 a[116:119], v25 offset:12288
    v_mfma_f32_16x16x32_bf16 v[204:207], a[180:183], a[56:59], v[204:207]
    s_waitcnt lgkmcnt(14)
    v_mfma_f32_16x16x32_bf16 v[80:83], a[184:187], a[48:51], v[80:83]
    ds_read_b64_tr_b16 a[208:209], v17 offset:33024
    s_waitcnt lgkmcnt(14)
    ds_read_b128 a[120:123], v24 offset:1024
    v_mfma_f32_16x16x32_bf16 v[144:147], a[184:187], a[52:55], v[144:147]
    s_waitcnt lgkmcnt(14)
    ds_read_b64_tr_b16 a[210:211], v17 offset:41216
    v_mfma_f32_16x16x32_bf16 v[208:211], a[184:187], a[56:59], v[208:211]
    s_waitcnt lgkmcnt(14)
    ds_read_b128 a[124:127], v24 offset:7168
    v_mfma_f32_16x16x32_bf16 v[84:87], a[188:191], a[48:51], v[84:87]
    s_waitcnt lgkmcnt(14)
    ds_read_b64_tr_b16 a[212:213], v17 offset:33032
    v_mfma_f32_16x16x32_bf16 v[148:151], a[188:191], a[52:55], v[148:151]
    s_waitcnt lgkmcnt(14)
    ds_read_b64_tr_b16 a[214:215], v17 offset:41224
    s_waitcnt lgkmcnt(14)
    ds_read_b128 a[128:131], v24 offset:13312
    v_mfma_f32_16x16x32_bf16 v[212:215], a[188:191], a[56:59], v[212:215]
    v_mfma_f32_16x16x32_bf16 v[88:91], a[192:195], a[48:51], v[88:91]
    s_waitcnt lgkmcnt(14)
    ds_read_b64_tr_b16 a[216:217], v18 offset:33024
    s_waitcnt lgkmcnt(14)
    ds_read_b128 a[132:135], v25 offset:1024
    v_mfma_f32_16x16x32_bf16 v[152:155], a[192:195], a[52:55], v[152:155]
    s_waitcnt lgkmcnt(14)
    ds_read_b64_tr_b16 a[218:219], v18 offset:41216
    v_mfma_f32_16x16x32_bf16 v[216:219], a[192:195], a[56:59], v[216:219]
    s_waitcnt lgkmcnt(14)
    ds_read_b128 a[136:139], v25 offset:7168
    v_mfma_f32_16x16x32_bf16 v[92:95], a[196:199], a[48:51], v[92:95]
    s_waitcnt lgkmcnt(14)
    ds_read_b64_tr_b16 a[220:221], v18 offset:33032
    v_mfma_f32_16x16x32_bf16 v[156:159], a[196:199], a[52:55], v[156:159]
    s_waitcnt lgkmcnt(14)
    ds_read_b64_tr_b16 a[222:223], v18 offset:41224
    s_waitcnt lgkmcnt(14)
    ds_read_b128 a[140:143], v25 offset:13312
    v_mfma_f32_16x16x32_bf16 v[220:223], a[196:199], a[56:59], v[220:223]
    v_mfma_f32_16x16x32_bf16 v[96:99], a[200:203], a[48:51], v[96:99]
    s_waitcnt lgkmcnt(14)
    ds_read_b64_tr_b16 a[224:225], v19 offset:33024
    s_waitcnt lgkmcnt(14)
    ds_read_b128 a[144:147], v24 offset:2048
    v_mfma_f32_16x16x32_bf16 v[160:163], a[200:203], a[52:55], v[160:163]
    s_waitcnt lgkmcnt(14)
    ds_read_b64_tr_b16 a[226:227], v19 offset:41216
    v_mfma_f32_16x16x32_bf16 v[224:227], a[200:203], a[56:59], v[224:227]
    s_waitcnt lgkmcnt(14)
    ds_read_b128 a[148:151], v24 offset:8192
    v_mfma_f32_16x16x32_bf16 v[100:103], a[204:207], a[48:51], v[100:103]
    s_waitcnt lgkmcnt(14)
    ds_read_b64_tr_b16 a[228:229], v19 offset:33032
    v_mfma_f32_16x16x32_bf16 v[164:167], a[204:207], a[52:55], v[164:167]
    s_waitcnt lgkmcnt(14)
    ds_read_b64_tr_b16 a[230:231], v19 offset:41224
    s_waitcnt lgkmcnt(14)
    ds_read_b128 a[152:155], v24 offset:14336
    v_mfma_f32_16x16x32_bf16 v[228:231], a[204:207], a[56:59], v[228:231]
    v_mfma_f32_16x16x32_bf16 v[104:107], a[208:211], a[48:51], v[104:107]
    s_waitcnt lgkmcnt(14)
    ds_read_b64_tr_b16 a[168:169], v16 offset:49152
    s_waitcnt lgkmcnt(14)
    ds_read_b128 a[156:159], v25 offset:2048
    v_mfma_f32_16x16x32_bf16 v[168:171], a[208:211], a[52:55], v[168:171]
    s_waitcnt lgkmcnt(14)
    ds_read_b64_tr_b16 a[170:171], v16 offset:57344
    v_mfma_f32_16x16x32_bf16 v[232:235], a[208:211], a[56:59], v[232:235]
    s_waitcnt lgkmcnt(14)
    ds_read_b128 a[160:163], v25 offset:8192
    v_mfma_f32_16x16x32_bf16 v[108:111], a[212:215], a[48:51], v[108:111]
    s_waitcnt lgkmcnt(14)
    ds_read_b64_tr_b16 a[172:173], v16 offset:49160
    v_mfma_f32_16x16x32_bf16 v[172:175], a[212:215], a[52:55], v[172:175]
    s_waitcnt lgkmcnt(14)
    ds_read_b64_tr_b16 a[174:175], v16 offset:57352
    s_waitcnt lgkmcnt(14)
    ds_read_b128 a[164:167], v25 offset:14336
    v_mfma_f32_16x16x32_bf16 v[236:239], a[212:215], a[56:59], v[236:239]
    v_mfma_f32_16x16x32_bf16 v[112:115], a[216:219], a[48:51], v[112:115]
    s_waitcnt lgkmcnt(14)
    ds_read_b64_tr_b16 a[176:177], v17 offset:49152
    v_mfma_f32_16x16x32_bf16 v[176:179], a[216:219], a[52:55], v[176:179]
    s_waitcnt lgkmcnt(14)
    ds_read_b64_tr_b16 a[178:179], v17 offset:57344
    v_mfma_f32_16x16x32_bf16 v[240:243], a[216:219], a[56:59], v[240:243]
    v_mfma_f32_16x16x32_bf16 v[116:119], a[220:223], a[48:51], v[116:119]
    s_waitcnt lgkmcnt(14)
    ds_read_b64_tr_b16 a[180:181], v17 offset:49160
    v_mfma_f32_16x16x32_bf16 v[180:183], a[220:223], a[52:55], v[180:183]
    s_waitcnt lgkmcnt(14)
    ds_read_b64_tr_b16 a[182:183], v17 offset:57352
    v_mfma_f32_16x16x32_bf16 v[244:247], a[220:223], a[56:59], v[244:247]
    s_waitcnt lgkmcnt(12)
    v_mfma_f32_16x16x32_bf16 v[120:123], a[224:227], a[48:51], v[120:123]
    ds_read_b64_tr_b16 a[184:185], v18 offset:49152
    v_mfma_f32_16x16x32_bf16 v[184:187], a[224:227], a[52:55], v[184:187]
    ds_read_b64_tr_b16 a[186:187], v18 offset:57344
    v_mfma_f32_16x16x32_bf16 v[248:251], a[224:227], a[56:59], v[248:251]
    v_mfma_f32_16x16x32_bf16 v[124:127], a[228:231], a[48:51], v[124:127]
    ds_read_b64_tr_b16 a[188:189], v18 offset:49160
    v_mfma_f32_16x16x32_bf16 v[188:191], a[228:231], a[52:55], v[188:191]
    s_waitcnt lgkmcnt(14)
    ds_read_b64_tr_b16 a[190:191], v18 offset:57352
    v_mfma_f32_16x16x32_bf16 v[252:255], a[228:231], a[56:59], v[252:255]
    s_waitcnt lgkmcnt(8)
    s_barrier
    v_mfma_f32_16x16x32_bf16 v[64:67], a[168:171], a[60:63], v[64:67]
    ds_read_b64_tr_b16 a[192:193], v19 offset:49152
    v_mfma_f32_16x16x32_bf16 v[128:131], a[168:171], a[64:67], v[128:131]
    ds_read_b64_tr_b16 a[194:195], v19 offset:57344
    v_mfma_f32_16x16x32_bf16 v[192:195], a[168:171], a[68:71], v[192:195]
    v_mfma_f32_16x16x32_bf16 v[68:71], a[172:175], a[60:63], v[68:71]
    ds_read_b64_tr_b16 a[196:197], v19 offset:49160
    v_mfma_f32_16x16x32_bf16 v[132:135], a[172:175], a[64:67], v[132:135]
    ds_read_b64_tr_b16 a[198:199], v19 offset:57352
    v_mfma_f32_16x16x32_bf16 v[196:199], a[172:175], a[68:71], v[196:199]
    s_waitcnt lgkmcnt(8)
    v_mfma_f32_16x16x32_bf16 v[72:75], a[176:179], a[60:63], v[72:75]
    ds_read_b64_tr_b16 a[200:201], v16 offset:49408
    v_mfma_f32_16x16x32_bf16 v[136:139], a[176:179], a[64:67], v[136:139]
    ds_read_b64_tr_b16 a[202:203], v16 offset:57600
    v_mfma_f32_16x16x32_bf16 v[200:203], a[176:179], a[68:71], v[200:203]
    v_mfma_f32_16x16x32_bf16 v[76:79], a[180:183], a[60:63], v[76:79]
    ds_read_b64_tr_b16 a[204:205], v16 offset:49416
    v_mfma_f32_16x16x32_bf16 v[140:143], a[180:183], a[64:67], v[140:143]
    ds_read_b64_tr_b16 a[206:207], v16 offset:57608
    v_mfma_f32_16x16x32_bf16 v[204:207], a[180:183], a[68:71], v[204:207]
    s_waitcnt lgkmcnt(8)
    v_mfma_f32_16x16x32_bf16 v[80:83], a[184:187], a[60:63], v[80:83]
    ds_read_b64_tr_b16 a[208:209], v17 offset:49408
    v_mfma_f32_16x16x32_bf16 v[144:147], a[184:187], a[64:67], v[144:147]
    ds_read_b64_tr_b16 a[210:211], v17 offset:57600
    v_mfma_f32_16x16x32_bf16 v[208:211], a[184:187], a[68:71], v[208:211]
    v_mfma_f32_16x16x32_bf16 v[84:87], a[188:191], a[60:63], v[84:87]
    ds_read_b64_tr_b16 a[212:213], v17 offset:49416
    v_mfma_f32_16x16x32_bf16 v[148:151], a[188:191], a[64:67], v[148:151]
    ds_read_b64_tr_b16 a[214:215], v17 offset:57608
    v_mfma_f32_16x16x32_bf16 v[212:215], a[188:191], a[68:71], v[212:215]
    s_waitcnt lgkmcnt(8)
    v_mfma_f32_16x16x32_bf16 v[88:91], a[192:195], a[60:63], v[88:91]
    ds_read_b64_tr_b16 a[216:217], v18 offset:49408
    v_mfma_f32_16x16x32_bf16 v[152:155], a[192:195], a[64:67], v[152:155]
    ds_read_b64_tr_b16 a[218:219], v18 offset:57600
    v_mfma_f32_16x16x32_bf16 v[216:219], a[192:195], a[68:71], v[216:219]
    v_mfma_f32_16x16x32_bf16 v[92:95], a[196:199], a[60:63], v[92:95]
    ds_read_b64_tr_b16 a[220:221], v18 offset:49416
    v_mfma_f32_16x16x32_bf16 v[156:159], a[196:199], a[64:67], v[156:159]
    ds_read_b64_tr_b16 a[222:223], v18 offset:57608
    v_mfma_f32_16x16x32_bf16 v[220:223], a[196:199], a[68:71], v[220:223]
    s_waitcnt lgkmcnt(8)
    v_mfma_f32_16x16x32_bf16 v[96:99], a[200:203], a[60:63], v[96:99]
    ds_read_b64_tr_b16 a[224:225], v19 offset:49408
    v_mfma_f32_16x16x32_bf16 v[160:163], a[200:203], a[64:67], v[160:163]
    ds_read_b64_tr_b16 a[226:227], v19 offset:57600
    v_mfma_f32_16x16x32_bf16 v[224:227], a[200:203], a[68:71], v[224:227]
    v_mfma_f32_16x16x32_bf16 v[100:103], a[204:207], a[60:63], v[100:103]
    ds_read_b64_tr_b16 a[228:229], v19 offset:49416
    v_mfma_f32_16x16x32_bf16 v[164:167], a[204:207], a[64:67], v[164:167]
    ds_read_b64_tr_b16 a[230:231], v19 offset:57608
    v_mfma_f32_16x16x32_bf16 v[228:231], a[204:207], a[68:71], v[228:231]
    s_waitcnt lgkmcnt(8)
    v_mfma_f32_16x16x32_bf16 v[104:107], a[208:211], a[60:63], v[104:107]
    ds_read_b64_tr_b16 a[168:169], v16 offset:0
    v_mfma_f32_16x16x32_bf16 v[168:171], a[208:211], a[64:67], v[168:171]
    ds_read_b64_tr_b16 a[170:171], v16 offset:8192
    v_mfma_f32_16x16x32_bf16 v[232:235], a[208:211], a[68:71], v[232:235]
    v_mfma_f32_16x16x32_bf16 v[108:111], a[212:215], a[60:63], v[108:111]
    ds_read_b64_tr_b16 a[172:173], v16 offset:8
    v_mfma_f32_16x16x32_bf16 v[172:175], a[212:215], a[64:67], v[172:175]
    ds_read_b64_tr_b16 a[174:175], v16 offset:8200
    v_mfma_f32_16x16x32_bf16 v[236:239], a[212:215], a[68:71], v[236:239]
    s_waitcnt lgkmcnt(8)
    v_mfma_f32_16x16x32_bf16 v[112:115], a[216:219], a[60:63], v[112:115]
    ds_read_b64_tr_b16 a[176:177], v17 offset:0
    v_mfma_f32_16x16x32_bf16 v[176:179], a[216:219], a[64:67], v[176:179]
    ds_read_b64_tr_b16 a[178:179], v17 offset:8192
    v_mfma_f32_16x16x32_bf16 v[240:243], a[216:219], a[68:71], v[240:243]
    v_mfma_f32_16x16x32_bf16 v[116:119], a[220:223], a[60:63], v[116:119]
    ds_read_b64_tr_b16 a[180:181], v17 offset:8
    v_mfma_f32_16x16x32_bf16 v[180:183], a[220:223], a[64:67], v[180:183]
    ds_read_b64_tr_b16 a[182:183], v17 offset:8200
    v_mfma_f32_16x16x32_bf16 v[244:247], a[220:223], a[68:71], v[244:247]
    s_waitcnt lgkmcnt(8)
    v_mfma_f32_16x16x32_bf16 v[120:123], a[224:227], a[60:63], v[120:123]
    ds_read_b64_tr_b16 a[184:185], v18 offset:0
    v_mfma_f32_16x16x32_bf16 v[184:187], a[224:227], a[64:67], v[184:187]
    ds_read_b64_tr_b16 a[186:187], v18 offset:8192
    v_mfma_f32_16x16x32_bf16 v[248:251], a[224:227], a[68:71], v[248:251]
    v_mfma_f32_16x16x32_bf16 v[124:127], a[228:231], a[60:63], v[124:127]
    ds_read_b64_tr_b16 a[188:189], v18 offset:8
    v_mfma_f32_16x16x32_bf16 v[188:191], a[228:231], a[64:67], v[188:191]
    ds_read_b64_tr_b16 a[190:191], v18 offset:8200
    v_mfma_f32_16x16x32_bf16 v[252:255], a[228:231], a[68:71], v[252:255]
    s_barrier
    s_waitcnt lgkmcnt(8)
    v_mfma_f32_16x16x32_bf16 v[64:67], a[168:171], a[72:75], v[64:67]
    ds_read_b64_tr_b16 a[192:193], v19 offset:0
    v_mfma_f32_16x16x32_bf16 v[128:131], a[168:171], a[76:79], v[128:131]
    ds_read_b64_tr_b16 a[194:195], v19 offset:8192
    v_mfma_f32_16x16x32_bf16 v[192:195], a[168:171], a[80:83], v[192:195]
    v_mfma_f32_16x16x32_bf16 v[68:71], a[172:175], a[72:75], v[68:71]
    ds_read_b64_tr_b16 a[196:197], v19 offset:8
    v_mfma_f32_16x16x32_bf16 v[132:135], a[172:175], a[76:79], v[132:135]
    ds_read_b64_tr_b16 a[198:199], v19 offset:8200
    v_mfma_f32_16x16x32_bf16 v[196:199], a[172:175], a[80:83], v[196:199]
    s_waitcnt lgkmcnt(8)
    v_mfma_f32_16x16x32_bf16 v[72:75], a[176:179], a[72:75], v[72:75]
    ds_read_b64_tr_b16 a[200:201], v16 offset:256
    v_mfma_f32_16x16x32_bf16 v[136:139], a[176:179], a[76:79], v[136:139]
    ds_read_b64_tr_b16 a[202:203], v16 offset:8448
    v_mfma_f32_16x16x32_bf16 v[200:203], a[176:179], a[80:83], v[200:203]
    v_mfma_f32_16x16x32_bf16 v[76:79], a[180:183], a[72:75], v[76:79]
    ds_read_b64_tr_b16 a[204:205], v16 offset:264
    v_mfma_f32_16x16x32_bf16 v[140:143], a[180:183], a[76:79], v[140:143]
    ds_read_b64_tr_b16 a[206:207], v16 offset:8456
    v_mfma_f32_16x16x32_bf16 v[204:207], a[180:183], a[80:83], v[204:207]
    s_waitcnt lgkmcnt(8)
    v_mfma_f32_16x16x32_bf16 v[80:83], a[184:187], a[72:75], v[80:83]
    ds_read_b64_tr_b16 a[208:209], v17 offset:256
    v_mfma_f32_16x16x32_bf16 v[144:147], a[184:187], a[76:79], v[144:147]
    ds_read_b64_tr_b16 a[210:211], v17 offset:8448
    v_mfma_f32_16x16x32_bf16 v[208:211], a[184:187], a[80:83], v[208:211]
    v_mfma_f32_16x16x32_bf16 v[84:87], a[188:191], a[72:75], v[84:87]
    ds_read_b64_tr_b16 a[212:213], v17 offset:264
    v_mfma_f32_16x16x32_bf16 v[148:151], a[188:191], a[76:79], v[148:151]
    ds_read_b64_tr_b16 a[214:215], v17 offset:8456
    v_mfma_f32_16x16x32_bf16 v[212:215], a[188:191], a[80:83], v[212:215]
    s_waitcnt lgkmcnt(8)
    v_mfma_f32_16x16x32_bf16 v[88:91], a[192:195], a[72:75], v[88:91]
    ds_read_b64_tr_b16 a[216:217], v18 offset:256
    v_mfma_f32_16x16x32_bf16 v[152:155], a[192:195], a[76:79], v[152:155]
    ds_read_b64_tr_b16 a[218:219], v18 offset:8448
    v_mfma_f32_16x16x32_bf16 v[216:219], a[192:195], a[80:83], v[216:219]
    v_mfma_f32_16x16x32_bf16 v[92:95], a[196:199], a[72:75], v[92:95]
    ds_read_b64_tr_b16 a[220:221], v18 offset:264
    v_mfma_f32_16x16x32_bf16 v[156:159], a[196:199], a[76:79], v[156:159]
    ds_read_b64_tr_b16 a[222:223], v18 offset:8456
    v_mfma_f32_16x16x32_bf16 v[220:223], a[196:199], a[80:83], v[220:223]
    s_waitcnt lgkmcnt(8)
    v_mfma_f32_16x16x32_bf16 v[96:99], a[200:203], a[72:75], v[96:99]
    ds_read_b64_tr_b16 a[224:225], v19 offset:256
    v_mfma_f32_16x16x32_bf16 v[160:163], a[200:203], a[76:79], v[160:163]
    ds_read_b64_tr_b16 a[226:227], v19 offset:8448
    v_mfma_f32_16x16x32_bf16 v[224:227], a[200:203], a[80:83], v[224:227]
    v_mfma_f32_16x16x32_bf16 v[100:103], a[204:207], a[72:75], v[100:103]
    ds_read_b64_tr_b16 a[228:229], v19 offset:264
    v_mfma_f32_16x16x32_bf16 v[164:167], a[204:207], a[76:79], v[164:167]
    ds_read_b64_tr_b16 a[230:231], v19 offset:8456
    v_mfma_f32_16x16x32_bf16 v[228:231], a[204:207], a[80:83], v[228:231]
    s_waitcnt lgkmcnt(8)
    v_mfma_f32_16x16x32_bf16 v[104:107], a[208:211], a[72:75], v[104:107]
    ds_read_b64_tr_b16 a[168:169], v16 offset:16384
    v_mfma_f32_16x16x32_bf16 v[168:171], a[208:211], a[76:79], v[168:171]
    ds_read_b64_tr_b16 a[170:171], v16 offset:24576
    v_mfma_f32_16x16x32_bf16 v[232:235], a[208:211], a[80:83], v[232:235]
    v_mfma_f32_16x16x32_bf16 v[108:111], a[212:215], a[72:75], v[108:111]
    ds_read_b64_tr_b16 a[172:173], v16 offset:16392
    v_mfma_f32_16x16x32_bf16 v[172:175], a[212:215], a[76:79], v[172:175]
    ds_read_b64_tr_b16 a[174:175], v16 offset:24584
    v_mfma_f32_16x16x32_bf16 v[236:239], a[212:215], a[80:83], v[236:239]
    s_waitcnt lgkmcnt(8)
    v_mfma_f32_16x16x32_bf16 v[112:115], a[216:219], a[72:75], v[112:115]
    ds_read_b64_tr_b16 a[176:177], v17 offset:16384
    v_mfma_f32_16x16x32_bf16 v[176:179], a[216:219], a[76:79], v[176:179]
    ds_read_b64_tr_b16 a[178:179], v17 offset:24576
    v_mfma_f32_16x16x32_bf16 v[240:243], a[216:219], a[80:83], v[240:243]
    v_mfma_f32_16x16x32_bf16 v[116:119], a[220:223], a[72:75], v[116:119]
    ds_read_b64_tr_b16 a[180:181], v17 offset:16392
    v_mfma_f32_16x16x32_bf16 v[180:183], a[220:223], a[76:79], v[180:183]
    ds_read_b64_tr_b16 a[182:183], v17 offset:24584
    v_mfma_f32_16x16x32_bf16 v[244:247], a[220:223], a[80:83], v[244:247]
    s_waitcnt lgkmcnt(8)
    v_mfma_f32_16x16x32_bf16 v[120:123], a[224:227], a[72:75], v[120:123]
    ds_read_b64_tr_b16 a[184:185], v18 offset:16384
    v_mfma_f32_16x16x32_bf16 v[184:187], a[224:227], a[76:79], v[184:187]
    ds_read_b64_tr_b16 a[186:187], v18 offset:24576
    v_mfma_f32_16x16x32_bf16 v[248:251], a[224:227], a[80:83], v[248:251]
    v_mfma_f32_16x16x32_bf16 v[124:127], a[228:231], a[72:75], v[124:127]
    ds_read_b64_tr_b16 a[188:189], v18 offset:16392
    v_mfma_f32_16x16x32_bf16 v[188:191], a[228:231], a[76:79], v[188:191]
    ds_read_b64_tr_b16 a[190:191], v18 offset:24584
    v_mfma_f32_16x16x32_bf16 v[252:255], a[228:231], a[80:83], v[252:255]
    s_barrier
    s_waitcnt lgkmcnt(8)
    v_mfma_f32_16x16x32_bf16 v[64:67], a[168:171], a[84:87], v[64:67]
    ds_read_b64_tr_b16 a[192:193], v19 offset:16384
    v_mfma_f32_16x16x32_bf16 v[128:131], a[168:171], a[88:91], v[128:131]
    ds_read_b64_tr_b16 a[194:195], v19 offset:24576
    v_mfma_f32_16x16x32_bf16 v[192:195], a[168:171], a[92:95], v[192:195]
    v_mfma_f32_16x16x32_bf16 v[68:71], a[172:175], a[84:87], v[68:71]
    ds_read_b64_tr_b16 a[196:197], v19 offset:16392
    v_mfma_f32_16x16x32_bf16 v[132:135], a[172:175], a[88:91], v[132:135]
    ds_read_b64_tr_b16 a[198:199], v19 offset:24584
    v_mfma_f32_16x16x32_bf16 v[196:199], a[172:175], a[92:95], v[196:199]
    s_waitcnt lgkmcnt(8)
    v_mfma_f32_16x16x32_bf16 v[72:75], a[176:179], a[84:87], v[72:75]
    ds_read_b64_tr_b16 a[200:201], v16 offset:16640
    v_mfma_f32_16x16x32_bf16 v[136:139], a[176:179], a[88:91], v[136:139]
    ds_read_b64_tr_b16 a[202:203], v16 offset:24832
    v_mfma_f32_16x16x32_bf16 v[200:203], a[176:179], a[92:95], v[200:203]
    v_mfma_f32_16x16x32_bf16 v[76:79], a[180:183], a[84:87], v[76:79]
    ds_read_b64_tr_b16 a[204:205], v16 offset:16648
    v_mfma_f32_16x16x32_bf16 v[140:143], a[180:183], a[88:91], v[140:143]
    ds_read_b64_tr_b16 a[206:207], v16 offset:24840
    v_mfma_f32_16x16x32_bf16 v[204:207], a[180:183], a[92:95], v[204:207]
    s_waitcnt lgkmcnt(8)
    v_mfma_f32_16x16x32_bf16 v[80:83], a[184:187], a[84:87], v[80:83]
    ds_read_b64_tr_b16 a[208:209], v17 offset:16640
    v_mfma_f32_16x16x32_bf16 v[144:147], a[184:187], a[88:91], v[144:147]
    ds_read_b64_tr_b16 a[210:211], v17 offset:24832
    v_mfma_f32_16x16x32_bf16 v[208:211], a[184:187], a[92:95], v[208:211]
    v_mfma_f32_16x16x32_bf16 v[84:87], a[188:191], a[84:87], v[84:87]
    ds_read_b64_tr_b16 a[212:213], v17 offset:16648
    v_mfma_f32_16x16x32_bf16 v[148:151], a[188:191], a[88:91], v[148:151]
    ds_read_b64_tr_b16 a[214:215], v17 offset:24840
    v_mfma_f32_16x16x32_bf16 v[212:215], a[188:191], a[92:95], v[212:215]
    s_waitcnt lgkmcnt(8)
    v_mfma_f32_16x16x32_bf16 v[88:91], a[192:195], a[84:87], v[88:91]
    ds_read_b64_tr_b16 a[216:217], v18 offset:16640
    v_mfma_f32_16x16x32_bf16 v[152:155], a[192:195], a[88:91], v[152:155]
    ds_read_b64_tr_b16 a[218:219], v18 offset:24832
    v_mfma_f32_16x16x32_bf16 v[216:219], a[192:195], a[92:95], v[216:219]
    v_mfma_f32_16x16x32_bf16 v[92:95], a[196:199], a[84:87], v[92:95]
    ds_read_b64_tr_b16 a[220:221], v18 offset:16648
    v_mfma_f32_16x16x32_bf16 v[156:159], a[196:199], a[88:91], v[156:159]
    ds_read_b64_tr_b16 a[222:223], v18 offset:24840
    v_mfma_f32_16x16x32_bf16 v[220:223], a[196:199], a[92:95], v[220:223]
    s_waitcnt lgkmcnt(8)
    v_mfma_f32_16x16x32_bf16 v[96:99], a[200:203], a[84:87], v[96:99]
    ds_read_b64_tr_b16 a[224:225], v19 offset:16640
    v_mfma_f32_16x16x32_bf16 v[160:163], a[200:203], a[88:91], v[160:163]
    ds_read_b64_tr_b16 a[226:227], v19 offset:24832
    v_mfma_f32_16x16x32_bf16 v[224:227], a[200:203], a[92:95], v[224:227]
    v_mfma_f32_16x16x32_bf16 v[100:103], a[204:207], a[84:87], v[100:103]
    ds_read_b64_tr_b16 a[228:229], v19 offset:16648
    v_mfma_f32_16x16x32_bf16 v[164:167], a[204:207], a[88:91], v[164:167]
    ds_read_b64_tr_b16 a[230:231], v19 offset:24840
    v_mfma_f32_16x16x32_bf16 v[228:231], a[204:207], a[92:95], v[228:231]
    s_waitcnt lgkmcnt(8)
    v_mfma_f32_16x16x32_bf16 v[104:107], a[208:211], a[84:87], v[104:107]
    ds_read_b64_tr_b16 a[168:169], v16 offset:32768
    v_mfma_f32_16x16x32_bf16 v[168:171], a[208:211], a[88:91], v[168:171]
    ds_read_b64_tr_b16 a[170:171], v16 offset:40960
    v_mfma_f32_16x16x32_bf16 v[232:235], a[208:211], a[92:95], v[232:235]
    v_mfma_f32_16x16x32_bf16 v[108:111], a[212:215], a[84:87], v[108:111]
    ds_read_b64_tr_b16 a[172:173], v16 offset:32776
    v_mfma_f32_16x16x32_bf16 v[172:175], a[212:215], a[88:91], v[172:175]
    ds_read_b64_tr_b16 a[174:175], v16 offset:40968
    v_mfma_f32_16x16x32_bf16 v[236:239], a[212:215], a[92:95], v[236:239]
    s_waitcnt lgkmcnt(8)
    v_mfma_f32_16x16x32_bf16 v[112:115], a[216:219], a[84:87], v[112:115]
    ds_read_b64_tr_b16 a[176:177], v17 offset:32768
    v_mfma_f32_16x16x32_bf16 v[176:179], a[216:219], a[88:91], v[176:179]
    ds_read_b64_tr_b16 a[178:179], v17 offset:40960
    v_mfma_f32_16x16x32_bf16 v[240:243], a[216:219], a[92:95], v[240:243]
    v_mfma_f32_16x16x32_bf16 v[116:119], a[220:223], a[84:87], v[116:119]
    ds_read_b64_tr_b16 a[180:181], v17 offset:32776
    v_mfma_f32_16x16x32_bf16 v[180:183], a[220:223], a[88:91], v[180:183]
    ds_read_b64_tr_b16 a[182:183], v17 offset:40968
    v_mfma_f32_16x16x32_bf16 v[244:247], a[220:223], a[92:95], v[244:247]
    s_waitcnt lgkmcnt(8)
    v_mfma_f32_16x16x32_bf16 v[120:123], a[224:227], a[84:87], v[120:123]
    ds_read_b64_tr_b16 a[184:185], v18 offset:32768
    v_mfma_f32_16x16x32_bf16 v[184:187], a[224:227], a[88:91], v[184:187]
    ds_read_b64_tr_b16 a[186:187], v18 offset:40960
    v_mfma_f32_16x16x32_bf16 v[248:251], a[224:227], a[92:95], v[248:251]
    v_mfma_f32_16x16x32_bf16 v[124:127], a[228:231], a[84:87], v[124:127]
    ds_read_b64_tr_b16 a[188:189], v18 offset:32776
    v_mfma_f32_16x16x32_bf16 v[188:191], a[228:231], a[88:91], v[188:191]
    ds_read_b64_tr_b16 a[190:191], v18 offset:40968
    v_mfma_f32_16x16x32_bf16 v[252:255], a[228:231], a[92:95], v[252:255]
    s_barrier
    s_waitcnt lgkmcnt(8)
    v_mfma_f32_16x16x32_bf16 v[64:67], a[168:171], a[96:99], v[64:67]
    ds_read_b64_tr_b16 a[192:193], v19 offset:32768
    v_mfma_f32_16x16x32_bf16 v[128:131], a[168:171], a[100:103], v[128:131]
    ds_read_b64_tr_b16 a[194:195], v19 offset:40960
    v_mfma_f32_16x16x32_bf16 v[192:195], a[168:171], a[104:107], v[192:195]
    v_mfma_f32_16x16x32_bf16 v[68:71], a[172:175], a[96:99], v[68:71]
    ds_read_b64_tr_b16 a[196:197], v19 offset:32776
    v_mfma_f32_16x16x32_bf16 v[132:135], a[172:175], a[100:103], v[132:135]
    ds_read_b64_tr_b16 a[198:199], v19 offset:40968
    v_mfma_f32_16x16x32_bf16 v[196:199], a[172:175], a[104:107], v[196:199]
    s_waitcnt lgkmcnt(8)
    v_mfma_f32_16x16x32_bf16 v[72:75], a[176:179], a[96:99], v[72:75]
    ds_read_b64_tr_b16 a[200:201], v16 offset:33024
    v_mfma_f32_16x16x32_bf16 v[136:139], a[176:179], a[100:103], v[136:139]
    ds_read_b64_tr_b16 a[202:203], v16 offset:41216
    v_mfma_f32_16x16x32_bf16 v[200:203], a[176:179], a[104:107], v[200:203]
    v_mfma_f32_16x16x32_bf16 v[76:79], a[180:183], a[96:99], v[76:79]
    ds_read_b64_tr_b16 a[204:205], v16 offset:33032
    v_mfma_f32_16x16x32_bf16 v[140:143], a[180:183], a[100:103], v[140:143]
    ds_read_b64_tr_b16 a[206:207], v16 offset:41224
    v_mfma_f32_16x16x32_bf16 v[204:207], a[180:183], a[104:107], v[204:207]
    s_waitcnt lgkmcnt(8)
    v_mfma_f32_16x16x32_bf16 v[80:83], a[184:187], a[96:99], v[80:83]
    ds_read_b64_tr_b16 a[208:209], v17 offset:33024
    v_mfma_f32_16x16x32_bf16 v[144:147], a[184:187], a[100:103], v[144:147]
    ds_read_b64_tr_b16 a[210:211], v17 offset:41216
    v_mfma_f32_16x16x32_bf16 v[208:211], a[184:187], a[104:107], v[208:211]
    v_mfma_f32_16x16x32_bf16 v[84:87], a[188:191], a[96:99], v[84:87]
    ds_read_b64_tr_b16 a[212:213], v17 offset:33032
    v_mfma_f32_16x16x32_bf16 v[148:151], a[188:191], a[100:103], v[148:151]
    ds_read_b64_tr_b16 a[214:215], v17 offset:41224
    v_mfma_f32_16x16x32_bf16 v[212:215], a[188:191], a[104:107], v[212:215]
    s_waitcnt lgkmcnt(8)
    v_mfma_f32_16x16x32_bf16 v[88:91], a[192:195], a[96:99], v[88:91]
    ds_read_b64_tr_b16 a[216:217], v18 offset:33024
    v_mfma_f32_16x16x32_bf16 v[152:155], a[192:195], a[100:103], v[152:155]
    ds_read_b64_tr_b16 a[218:219], v18 offset:41216
    v_mfma_f32_16x16x32_bf16 v[216:219], a[192:195], a[104:107], v[216:219]
    v_mfma_f32_16x16x32_bf16 v[92:95], a[196:199], a[96:99], v[92:95]
    ds_read_b64_tr_b16 a[220:221], v18 offset:33032
    v_mfma_f32_16x16x32_bf16 v[156:159], a[196:199], a[100:103], v[156:159]
    ds_read_b64_tr_b16 a[222:223], v18 offset:41224
    v_mfma_f32_16x16x32_bf16 v[220:223], a[196:199], a[104:107], v[220:223]
    s_waitcnt lgkmcnt(8)
    v_mfma_f32_16x16x32_bf16 v[96:99], a[200:203], a[96:99], v[96:99]
    ds_read_b64_tr_b16 a[224:225], v19 offset:33024
    v_mfma_f32_16x16x32_bf16 v[160:163], a[200:203], a[100:103], v[160:163]
    ds_read_b64_tr_b16 a[226:227], v19 offset:41216
    v_mfma_f32_16x16x32_bf16 v[224:227], a[200:203], a[104:107], v[224:227]
    v_mfma_f32_16x16x32_bf16 v[100:103], a[204:207], a[96:99], v[100:103]
    ds_read_b64_tr_b16 a[228:229], v19 offset:33032
    v_mfma_f32_16x16x32_bf16 v[164:167], a[204:207], a[100:103], v[164:167]
    ds_read_b64_tr_b16 a[230:231], v19 offset:41224
    v_mfma_f32_16x16x32_bf16 v[228:231], a[204:207], a[104:107], v[228:231]
    s_waitcnt lgkmcnt(8)
    v_mfma_f32_16x16x32_bf16 v[104:107], a[208:211], a[96:99], v[104:107]
    ds_read_b64_tr_b16 a[168:169], v16 offset:49152
    v_mfma_f32_16x16x32_bf16 v[168:171], a[208:211], a[100:103], v[168:171]
    ds_read_b64_tr_b16 a[170:171], v16 offset:57344
    v_mfma_f32_16x16x32_bf16 v[232:235], a[208:211], a[104:107], v[232:235]
    v_mfma_f32_16x16x32_bf16 v[108:111], a[212:215], a[96:99], v[108:111]
    ds_read_b64_tr_b16 a[172:173], v16 offset:49160
    v_mfma_f32_16x16x32_bf16 v[172:175], a[212:215], a[100:103], v[172:175]
    ds_read_b64_tr_b16 a[174:175], v16 offset:57352
    v_mfma_f32_16x16x32_bf16 v[236:239], a[212:215], a[104:107], v[236:239]
    s_waitcnt lgkmcnt(8)
    v_mfma_f32_16x16x32_bf16 v[112:115], a[216:219], a[96:99], v[112:115]
    ds_read_b64_tr_b16 a[176:177], v17 offset:49152
    v_mfma_f32_16x16x32_bf16 v[176:179], a[216:219], a[100:103], v[176:179]
    ds_read_b64_tr_b16 a[178:179], v17 offset:57344
    v_mfma_f32_16x16x32_bf16 v[240:243], a[216:219], a[104:107], v[240:243]
    v_mfma_f32_16x16x32_bf16 v[116:119], a[220:223], a[96:99], v[116:119]
    ds_read_b64_tr_b16 a[180:181], v17 offset:49160
    v_mfma_f32_16x16x32_bf16 v[180:183], a[220:223], a[100:103], v[180:183]
    ds_read_b64_tr_b16 a[182:183], v17 offset:57352
    v_mfma_f32_16x16x32_bf16 v[244:247], a[220:223], a[104:107], v[244:247]
    s_waitcnt lgkmcnt(8)
    v_mfma_f32_16x16x32_bf16 v[120:123], a[224:227], a[96:99], v[120:123]
    ds_read_b64_tr_b16 a[184:185], v18 offset:49152
    v_mfma_f32_16x16x32_bf16 v[184:187], a[224:227], a[100:103], v[184:187]
    ds_read_b64_tr_b16 a[186:187], v18 offset:57344
    v_mfma_f32_16x16x32_bf16 v[248:251], a[224:227], a[104:107], v[248:251]
    v_mfma_f32_16x16x32_bf16 v[124:127], a[228:231], a[96:99], v[124:127]
    ds_read_b64_tr_b16 a[188:189], v18 offset:49160
    v_mfma_f32_16x16x32_bf16 v[188:191], a[228:231], a[100:103], v[188:191]
    ds_read_b64_tr_b16 a[190:191], v18 offset:57352
    v_mfma_f32_16x16x32_bf16 v[252:255], a[228:231], a[104:107], v[252:255]
    s_barrier
    s_waitcnt lgkmcnt(8)
    v_mfma_f32_16x16x32_bf16 v[64:67], a[168:171], a[108:111], v[64:67]
    ds_read_b64_tr_b16 a[192:193], v19 offset:49152
    v_mfma_f32_16x16x32_bf16 v[128:131], a[168:171], a[112:115], v[128:131]
    ds_read_b64_tr_b16 a[194:195], v19 offset:57344
    v_mfma_f32_16x16x32_bf16 v[192:195], a[168:171], a[116:119], v[192:195]
    v_mfma_f32_16x16x32_bf16 v[68:71], a[172:175], a[108:111], v[68:71]
    ds_read_b64_tr_b16 a[196:197], v19 offset:49160
    v_mfma_f32_16x16x32_bf16 v[132:135], a[172:175], a[112:115], v[132:135]
    ds_read_b64_tr_b16 a[198:199], v19 offset:57352
    v_mfma_f32_16x16x32_bf16 v[196:199], a[172:175], a[116:119], v[196:199]
    s_waitcnt lgkmcnt(8)
    v_mfma_f32_16x16x32_bf16 v[72:75], a[176:179], a[108:111], v[72:75]
    ds_read_b64_tr_b16 a[200:201], v16 offset:49408
    v_mfma_f32_16x16x32_bf16 v[136:139], a[176:179], a[112:115], v[136:139]
    ds_read_b64_tr_b16 a[202:203], v16 offset:57600
    v_mfma_f32_16x16x32_bf16 v[200:203], a[176:179], a[116:119], v[200:203]
    v_mfma_f32_16x16x32_bf16 v[76:79], a[180:183], a[108:111], v[76:79]
    ds_read_b64_tr_b16 a[204:205], v16 offset:49416
    v_mfma_f32_16x16x32_bf16 v[140:143], a[180:183], a[112:115], v[140:143]
    ds_read_b64_tr_b16 a[206:207], v16 offset:57608
    v_mfma_f32_16x16x32_bf16 v[204:207], a[180:183], a[116:119], v[204:207]
    s_waitcnt lgkmcnt(8)
    v_mfma_f32_16x16x32_bf16 v[80:83], a[184:187], a[108:111], v[80:83]
    ds_read_b64_tr_b16 a[208:209], v17 offset:49408
    v_mfma_f32_16x16x32_bf16 v[144:147], a[184:187], a[112:115], v[144:147]
    ds_read_b64_tr_b16 a[210:211], v17 offset:57600
    v_mfma_f32_16x16x32_bf16 v[208:211], a[184:187], a[116:119], v[208:211]
    v_mfma_f32_16x16x32_bf16 v[84:87], a[188:191], a[108:111], v[84:87]
    ds_read_b64_tr_b16 a[212:213], v17 offset:49416
    v_mfma_f32_16x16x32_bf16 v[148:151], a[188:191], a[112:115], v[148:151]
    ds_read_b64_tr_b16 a[214:215], v17 offset:57608
    v_mfma_f32_16x16x32_bf16 v[212:215], a[188:191], a[116:119], v[212:215]
    s_waitcnt lgkmcnt(8)
    v_mfma_f32_16x16x32_bf16 v[88:91], a[192:195], a[108:111], v[88:91]
    ds_read_b64_tr_b16 a[216:217], v18 offset:49408
    v_mfma_f32_16x16x32_bf16 v[152:155], a[192:195], a[112:115], v[152:155]
    ds_read_b64_tr_b16 a[218:219], v18 offset:57600
    v_mfma_f32_16x16x32_bf16 v[216:219], a[192:195], a[116:119], v[216:219]
    v_mfma_f32_16x16x32_bf16 v[92:95], a[196:199], a[108:111], v[92:95]
    ds_read_b64_tr_b16 a[220:221], v18 offset:49416
    v_mfma_f32_16x16x32_bf16 v[156:159], a[196:199], a[112:115], v[156:159]
    ds_read_b64_tr_b16 a[222:223], v18 offset:57608
    v_mfma_f32_16x16x32_bf16 v[220:223], a[196:199], a[116:119], v[220:223]
    s_waitcnt lgkmcnt(8)
    v_mfma_f32_16x16x32_bf16 v[96:99], a[200:203], a[108:111], v[96:99]
    ds_read_b64_tr_b16 a[224:225], v19 offset:49408
    v_mfma_f32_16x16x32_bf16 v[160:163], a[200:203], a[112:115], v[160:163]
    ds_read_b64_tr_b16 a[226:227], v19 offset:57600
    v_mfma_f32_16x16x32_bf16 v[224:227], a[200:203], a[116:119], v[224:227]
    v_mfma_f32_16x16x32_bf16 v[100:103], a[204:207], a[108:111], v[100:103]
    ds_read_b64_tr_b16 a[228:229], v19 offset:49416
    v_mfma_f32_16x16x32_bf16 v[164:167], a[204:207], a[112:115], v[164:167]
    ds_read_b64_tr_b16 a[230:231], v19 offset:57608
    v_mfma_f32_16x16x32_bf16 v[228:231], a[204:207], a[116:119], v[228:231]
    s_waitcnt lgkmcnt(8)
    v_mfma_f32_16x16x32_bf16 v[104:107], a[208:211], a[108:111], v[104:107]
    ds_read_b64_tr_b16 a[168:169], v16 offset:0
    v_mfma_f32_16x16x32_bf16 v[168:171], a[208:211], a[112:115], v[168:171]
    ds_read_b64_tr_b16 a[170:171], v16 offset:8192
    v_mfma_f32_16x16x32_bf16 v[232:235], a[208:211], a[116:119], v[232:235]
    v_mfma_f32_16x16x32_bf16 v[108:111], a[212:215], a[108:111], v[108:111]
    ds_read_b64_tr_b16 a[172:173], v16 offset:8
    v_mfma_f32_16x16x32_bf16 v[172:175], a[212:215], a[112:115], v[172:175]
    ds_read_b64_tr_b16 a[174:175], v16 offset:8200
    v_mfma_f32_16x16x32_bf16 v[236:239], a[212:215], a[116:119], v[236:239]
    s_waitcnt lgkmcnt(8)
    v_mfma_f32_16x16x32_bf16 v[112:115], a[216:219], a[108:111], v[112:115]
    ds_read_b64_tr_b16 a[176:177], v17 offset:0
    v_mfma_f32_16x16x32_bf16 v[176:179], a[216:219], a[112:115], v[176:179]
    ds_read_b64_tr_b16 a[178:179], v17 offset:8192
    v_mfma_f32_16x16x32_bf16 v[240:243], a[216:219], a[116:119], v[240:243]
    v_mfma_f32_16x16x32_bf16 v[116:119], a[220:223], a[108:111], v[116:119]
    ds_read_b64_tr_b16 a[180:181], v17 offset:8
    v_mfma_f32_16x16x32_bf16 v[180:183], a[220:223], a[112:115], v[180:183]
    ds_read_b64_tr_b16 a[182:183], v17 offset:8200
    v_mfma_f32_16x16x32_bf16 v[244:247], a[220:223], a[116:119], v[244:247]
    s_waitcnt lgkmcnt(8)
    v_mfma_f32_16x16x32_bf16 v[120:123], a[224:227], a[108:111], v[120:123]
    ds_read_b64_tr_b16 a[184:185], v18 offset:0
    v_mfma_f32_16x16x32_bf16 v[184:187], a[224:227], a[112:115], v[184:187]
    ds_read_b64_tr_b16 a[186:187], v18 offset:8192
    v_mfma_f32_16x16x32_bf16 v[248:251], a[224:227], a[116:119], v[248:251]
    v_mfma_f32_16x16x32_bf16 v[124:127], a[228:231], a[108:111], v[124:127]
    ds_read_b64_tr_b16 a[188:189], v18 offset:8
    v_mfma_f32_16x16x32_bf16 v[188:191], a[228:231], a[112:115], v[188:191]
    ds_read_b64_tr_b16 a[190:191], v18 offset:8200
    v_mfma_f32_16x16x32_bf16 v[252:255], a[228:231], a[116:119], v[252:255]
    s_barrier
    s_waitcnt lgkmcnt(8)
    v_mfma_f32_16x16x32_bf16 v[64:67], a[168:171], a[120:123], v[64:67]
    ds_read_b64_tr_b16 a[192:193], v19 offset:0
    v_mfma_f32_16x16x32_bf16 v[128:131], a[168:171], a[124:127], v[128:131]
    ds_read_b64_tr_b16 a[194:195], v19 offset:8192
    v_mfma_f32_16x16x32_bf16 v[192:195], a[168:171], a[128:131], v[192:195]
    v_mfma_f32_16x16x32_bf16 v[68:71], a[172:175], a[120:123], v[68:71]
    ds_read_b64_tr_b16 a[196:197], v19 offset:8
    v_mfma_f32_16x16x32_bf16 v[132:135], a[172:175], a[124:127], v[132:135]
    ds_read_b64_tr_b16 a[198:199], v19 offset:8200
    v_mfma_f32_16x16x32_bf16 v[196:199], a[172:175], a[128:131], v[196:199]
    s_waitcnt lgkmcnt(8)
    v_mfma_f32_16x16x32_bf16 v[72:75], a[176:179], a[120:123], v[72:75]
    ds_read_b64_tr_b16 a[200:201], v16 offset:256
    v_mfma_f32_16x16x32_bf16 v[136:139], a[176:179], a[124:127], v[136:139]
    ds_read_b64_tr_b16 a[202:203], v16 offset:8448
    v_mfma_f32_16x16x32_bf16 v[200:203], a[176:179], a[128:131], v[200:203]
    v_mfma_f32_16x16x32_bf16 v[76:79], a[180:183], a[120:123], v[76:79]
    ds_read_b64_tr_b16 a[204:205], v16 offset:264
    v_mfma_f32_16x16x32_bf16 v[140:143], a[180:183], a[124:127], v[140:143]
    ds_read_b64_tr_b16 a[206:207], v16 offset:8456
    v_mfma_f32_16x16x32_bf16 v[204:207], a[180:183], a[128:131], v[204:207]
    s_waitcnt lgkmcnt(8)
    v_mfma_f32_16x16x32_bf16 v[80:83], a[184:187], a[120:123], v[80:83]
    ds_read_b64_tr_b16 a[208:209], v17 offset:256
    v_mfma_f32_16x16x32_bf16 v[144:147], a[184:187], a[124:127], v[144:147]
    ds_read_b64_tr_b16 a[210:211], v17 offset:8448
    v_mfma_f32_16x16x32_bf16 v[208:211], a[184:187], a[128:131], v[208:211]
    v_mfma_f32_16x16x32_bf16 v[84:87], a[188:191], a[120:123], v[84:87]
    ds_read_b64_tr_b16 a[212:213], v17 offset:264
    v_mfma_f32_16x16x32_bf16 v[148:151], a[188:191], a[124:127], v[148:151]
    ds_read_b64_tr_b16 a[214:215], v17 offset:8456
    v_mfma_f32_16x16x32_bf16 v[212:215], a[188:191], a[128:131], v[212:215]
    s_waitcnt lgkmcnt(8)
    v_mfma_f32_16x16x32_bf16 v[88:91], a[192:195], a[120:123], v[88:91]
    ds_read_b64_tr_b16 a[216:217], v18 offset:256
    v_mfma_f32_16x16x32_bf16 v[152:155], a[192:195], a[124:127], v[152:155]
    ds_read_b64_tr_b16 a[218:219], v18 offset:8448
    v_mfma_f32_16x16x32_bf16 v[216:219], a[192:195], a[128:131], v[216:219]
    v_mfma_f32_16x16x32_bf16 v[92:95], a[196:199], a[120:123], v[92:95]
    ds_read_b64_tr_b16 a[220:221], v18 offset:264
    v_mfma_f32_16x16x32_bf16 v[156:159], a[196:199], a[124:127], v[156:159]
    ds_read_b64_tr_b16 a[222:223], v18 offset:8456
    v_mfma_f32_16x16x32_bf16 v[220:223], a[196:199], a[128:131], v[220:223]
    s_waitcnt lgkmcnt(8)
    v_mfma_f32_16x16x32_bf16 v[96:99], a[200:203], a[120:123], v[96:99]
    ds_read_b64_tr_b16 a[224:225], v19 offset:256
    v_mfma_f32_16x16x32_bf16 v[160:163], a[200:203], a[124:127], v[160:163]
    ds_read_b64_tr_b16 a[226:227], v19 offset:8448
    v_mfma_f32_16x16x32_bf16 v[224:227], a[200:203], a[128:131], v[224:227]
    v_mfma_f32_16x16x32_bf16 v[100:103], a[204:207], a[120:123], v[100:103]
    ds_read_b64_tr_b16 a[228:229], v19 offset:264
    v_mfma_f32_16x16x32_bf16 v[164:167], a[204:207], a[124:127], v[164:167]
    ds_read_b64_tr_b16 a[230:231], v19 offset:8456
    v_mfma_f32_16x16x32_bf16 v[228:231], a[204:207], a[128:131], v[228:231]
    s_waitcnt lgkmcnt(8)
    v_mfma_f32_16x16x32_bf16 v[104:107], a[208:211], a[120:123], v[104:107]
    ds_read_b64_tr_b16 a[168:169], v16 offset:16384
    v_mfma_f32_16x16x32_bf16 v[168:171], a[208:211], a[124:127], v[168:171]
    ds_read_b64_tr_b16 a[170:171], v16 offset:24576
    v_mfma_f32_16x16x32_bf16 v[232:235], a[208:211], a[128:131], v[232:235]
    v_mfma_f32_16x16x32_bf16 v[108:111], a[212:215], a[120:123], v[108:111]
    ds_read_b64_tr_b16 a[172:173], v16 offset:16392
    v_mfma_f32_16x16x32_bf16 v[172:175], a[212:215], a[124:127], v[172:175]
    ds_read_b64_tr_b16 a[174:175], v16 offset:24584
    v_mfma_f32_16x16x32_bf16 v[236:239], a[212:215], a[128:131], v[236:239]
    s_waitcnt lgkmcnt(8)
    v_mfma_f32_16x16x32_bf16 v[112:115], a[216:219], a[120:123], v[112:115]
    ds_read_b64_tr_b16 a[176:177], v17 offset:16384
    v_mfma_f32_16x16x32_bf16 v[176:179], a[216:219], a[124:127], v[176:179]
    ds_read_b64_tr_b16 a[178:179], v17 offset:24576
    v_mfma_f32_16x16x32_bf16 v[240:243], a[216:219], a[128:131], v[240:243]
    v_mfma_f32_16x16x32_bf16 v[116:119], a[220:223], a[120:123], v[116:119]
    ds_read_b64_tr_b16 a[180:181], v17 offset:16392
    v_mfma_f32_16x16x32_bf16 v[180:183], a[220:223], a[124:127], v[180:183]
    ds_read_b64_tr_b16 a[182:183], v17 offset:24584
    v_mfma_f32_16x16x32_bf16 v[244:247], a[220:223], a[128:131], v[244:247]
    s_waitcnt lgkmcnt(8)
    v_mfma_f32_16x16x32_bf16 v[120:123], a[224:227], a[120:123], v[120:123]
    ds_read_b64_tr_b16 a[184:185], v18 offset:16384
    v_mfma_f32_16x16x32_bf16 v[184:187], a[224:227], a[124:127], v[184:187]
    ds_read_b64_tr_b16 a[186:187], v18 offset:24576
    v_mfma_f32_16x16x32_bf16 v[248:251], a[224:227], a[128:131], v[248:251]
    v_mfma_f32_16x16x32_bf16 v[124:127], a[228:231], a[120:123], v[124:127]
    ds_read_b64_tr_b16 a[188:189], v18 offset:16392
    v_mfma_f32_16x16x32_bf16 v[188:191], a[228:231], a[124:127], v[188:191]
    ds_read_b64_tr_b16 a[190:191], v18 offset:24584
    v_mfma_f32_16x16x32_bf16 v[252:255], a[228:231], a[128:131], v[252:255]
    s_barrier
    s_waitcnt lgkmcnt(8)
    v_mfma_f32_16x16x32_bf16 v[64:67], a[168:171], a[132:135], v[64:67]
    ds_read_b64_tr_b16 a[192:193], v19 offset:16384
    v_mfma_f32_16x16x32_bf16 v[128:131], a[168:171], a[136:139], v[128:131]
    ds_read_b64_tr_b16 a[194:195], v19 offset:24576
    v_mfma_f32_16x16x32_bf16 v[192:195], a[168:171], a[140:143], v[192:195]
    v_mfma_f32_16x16x32_bf16 v[68:71], a[172:175], a[132:135], v[68:71]
    ds_read_b64_tr_b16 a[196:197], v19 offset:16392
    v_mfma_f32_16x16x32_bf16 v[132:135], a[172:175], a[136:139], v[132:135]
    ds_read_b64_tr_b16 a[198:199], v19 offset:24584
    v_mfma_f32_16x16x32_bf16 v[196:199], a[172:175], a[140:143], v[196:199]
    s_waitcnt lgkmcnt(8)
    v_mfma_f32_16x16x32_bf16 v[72:75], a[176:179], a[132:135], v[72:75]
    ds_read_b64_tr_b16 a[200:201], v16 offset:16640
    v_mfma_f32_16x16x32_bf16 v[136:139], a[176:179], a[136:139], v[136:139]
    ds_read_b64_tr_b16 a[202:203], v16 offset:24832
    v_mfma_f32_16x16x32_bf16 v[200:203], a[176:179], a[140:143], v[200:203]
    v_mfma_f32_16x16x32_bf16 v[76:79], a[180:183], a[132:135], v[76:79]
    ds_read_b64_tr_b16 a[204:205], v16 offset:16648
    v_mfma_f32_16x16x32_bf16 v[140:143], a[180:183], a[136:139], v[140:143]
    ds_read_b64_tr_b16 a[206:207], v16 offset:24840
    v_mfma_f32_16x16x32_bf16 v[204:207], a[180:183], a[140:143], v[204:207]
    s_waitcnt lgkmcnt(8)
    v_mfma_f32_16x16x32_bf16 v[80:83], a[184:187], a[132:135], v[80:83]
    ds_read_b64_tr_b16 a[208:209], v17 offset:16640
    v_mfma_f32_16x16x32_bf16 v[144:147], a[184:187], a[136:139], v[144:147]
    ds_read_b64_tr_b16 a[210:211], v17 offset:24832
    v_mfma_f32_16x16x32_bf16 v[208:211], a[184:187], a[140:143], v[208:211]
    v_mfma_f32_16x16x32_bf16 v[84:87], a[188:191], a[132:135], v[84:87]
    ds_read_b64_tr_b16 a[212:213], v17 offset:16648
    v_mfma_f32_16x16x32_bf16 v[148:151], a[188:191], a[136:139], v[148:151]
    ds_read_b64_tr_b16 a[214:215], v17 offset:24840
    v_mfma_f32_16x16x32_bf16 v[212:215], a[188:191], a[140:143], v[212:215]
    s_waitcnt lgkmcnt(8)
    v_mfma_f32_16x16x32_bf16 v[88:91], a[192:195], a[132:135], v[88:91]
    ds_read_b64_tr_b16 a[216:217], v18 offset:16640
    v_mfma_f32_16x16x32_bf16 v[152:155], a[192:195], a[136:139], v[152:155]
    ds_read_b64_tr_b16 a[218:219], v18 offset:24832
    v_mfma_f32_16x16x32_bf16 v[216:219], a[192:195], a[140:143], v[216:219]
    v_mfma_f32_16x16x32_bf16 v[92:95], a[196:199], a[132:135], v[92:95]
    ds_read_b64_tr_b16 a[220:221], v18 offset:16648
    v_mfma_f32_16x16x32_bf16 v[156:159], a[196:199], a[136:139], v[156:159]
    ds_read_b64_tr_b16 a[222:223], v18 offset:24840
    v_mfma_f32_16x16x32_bf16 v[220:223], a[196:199], a[140:143], v[220:223]
    s_waitcnt lgkmcnt(8)
    v_mfma_f32_16x16x32_bf16 v[96:99], a[200:203], a[132:135], v[96:99]
    ds_read_b64_tr_b16 a[224:225], v19 offset:16640
    v_mfma_f32_16x16x32_bf16 v[160:163], a[200:203], a[136:139], v[160:163]
    ds_read_b64_tr_b16 a[226:227], v19 offset:24832
    v_mfma_f32_16x16x32_bf16 v[224:227], a[200:203], a[140:143], v[224:227]
    v_mfma_f32_16x16x32_bf16 v[100:103], a[204:207], a[132:135], v[100:103]
    ds_read_b64_tr_b16 a[228:229], v19 offset:16648
    v_mfma_f32_16x16x32_bf16 v[164:167], a[204:207], a[136:139], v[164:167]
    ds_read_b64_tr_b16 a[230:231], v19 offset:24840
    v_mfma_f32_16x16x32_bf16 v[228:231], a[204:207], a[140:143], v[228:231]
    s_waitcnt lgkmcnt(8)
    v_mfma_f32_16x16x32_bf16 v[104:107], a[208:211], a[132:135], v[104:107]
    ds_read_b64_tr_b16 a[168:169], v16 offset:32768
    v_mfma_f32_16x16x32_bf16 v[168:171], a[208:211], a[136:139], v[168:171]
    ds_read_b64_tr_b16 a[170:171], v16 offset:40960
    v_mfma_f32_16x16x32_bf16 v[232:235], a[208:211], a[140:143], v[232:235]
    v_mfma_f32_16x16x32_bf16 v[108:111], a[212:215], a[132:135], v[108:111]
    ds_read_b64_tr_b16 a[172:173], v16 offset:32776
    v_mfma_f32_16x16x32_bf16 v[172:175], a[212:215], a[136:139], v[172:175]
    ds_read_b64_tr_b16 a[174:175], v16 offset:40968
    v_mfma_f32_16x16x32_bf16 v[236:239], a[212:215], a[140:143], v[236:239]
    s_waitcnt lgkmcnt(8)
    v_mfma_f32_16x16x32_bf16 v[112:115], a[216:219], a[132:135], v[112:115]
    ds_read_b64_tr_b16 a[176:177], v17 offset:32768
    v_mfma_f32_16x16x32_bf16 v[176:179], a[216:219], a[136:139], v[176:179]
    ds_read_b64_tr_b16 a[178:179], v17 offset:40960
    v_mfma_f32_16x16x32_bf16 v[240:243], a[216:219], a[140:143], v[240:243]
    v_mfma_f32_16x16x32_bf16 v[116:119], a[220:223], a[132:135], v[116:119]
    ds_read_b64_tr_b16 a[180:181], v17 offset:32776
    v_mfma_f32_16x16x32_bf16 v[180:183], a[220:223], a[136:139], v[180:183]
    ds_read_b64_tr_b16 a[182:183], v17 offset:40968
    v_mfma_f32_16x16x32_bf16 v[244:247], a[220:223], a[140:143], v[244:247]
    s_waitcnt lgkmcnt(8)
    v_mfma_f32_16x16x32_bf16 v[120:123], a[224:227], a[132:135], v[120:123]
    ds_read_b64_tr_b16 a[184:185], v18 offset:32768
    v_mfma_f32_16x16x32_bf16 v[184:187], a[224:227], a[136:139], v[184:187]
    ds_read_b64_tr_b16 a[186:187], v18 offset:40960
    v_mfma_f32_16x16x32_bf16 v[248:251], a[224:227], a[140:143], v[248:251]
    v_mfma_f32_16x16x32_bf16 v[124:127], a[228:231], a[132:135], v[124:127]
    ds_read_b64_tr_b16 a[188:189], v18 offset:32776
    v_mfma_f32_16x16x32_bf16 v[188:191], a[228:231], a[136:139], v[188:191]
    ds_read_b64_tr_b16 a[190:191], v18 offset:40968
    v_mfma_f32_16x16x32_bf16 v[252:255], a[228:231], a[140:143], v[252:255]
    s_barrier
    s_waitcnt lgkmcnt(8)
    v_mfma_f32_16x16x32_bf16 v[64:67], a[168:171], a[144:147], v[64:67]
    ds_read_b64_tr_b16 a[192:193], v19 offset:32768
    v_mfma_f32_16x16x32_bf16 v[128:131], a[168:171], a[148:151], v[128:131]
    ds_read_b64_tr_b16 a[194:195], v19 offset:40960
    v_mfma_f32_16x16x32_bf16 v[192:195], a[168:171], a[152:155], v[192:195]
    v_mfma_f32_16x16x32_bf16 v[68:71], a[172:175], a[144:147], v[68:71]
    ds_read_b64_tr_b16 a[196:197], v19 offset:32776
    v_mfma_f32_16x16x32_bf16 v[132:135], a[172:175], a[148:151], v[132:135]
    ds_read_b64_tr_b16 a[198:199], v19 offset:40968
    v_mfma_f32_16x16x32_bf16 v[196:199], a[172:175], a[152:155], v[196:199]
    s_waitcnt lgkmcnt(8)
    v_mfma_f32_16x16x32_bf16 v[72:75], a[176:179], a[144:147], v[72:75]
    ds_read_b64_tr_b16 a[200:201], v16 offset:33024
    v_mfma_f32_16x16x32_bf16 v[136:139], a[176:179], a[148:151], v[136:139]
    ds_read_b64_tr_b16 a[202:203], v16 offset:41216
    v_mfma_f32_16x16x32_bf16 v[200:203], a[176:179], a[152:155], v[200:203]
    v_mfma_f32_16x16x32_bf16 v[76:79], a[180:183], a[144:147], v[76:79]
    ds_read_b64_tr_b16 a[204:205], v16 offset:33032
    v_mfma_f32_16x16x32_bf16 v[140:143], a[180:183], a[148:151], v[140:143]
    ds_read_b64_tr_b16 a[206:207], v16 offset:41224
    v_mfma_f32_16x16x32_bf16 v[204:207], a[180:183], a[152:155], v[204:207]
    s_waitcnt lgkmcnt(8)
    v_mfma_f32_16x16x32_bf16 v[80:83], a[184:187], a[144:147], v[80:83]
    ds_read_b64_tr_b16 a[208:209], v17 offset:33024
    v_mfma_f32_16x16x32_bf16 v[144:147], a[184:187], a[148:151], v[144:147]
    ds_read_b64_tr_b16 a[210:211], v17 offset:41216
    v_mfma_f32_16x16x32_bf16 v[208:211], a[184:187], a[152:155], v[208:211]
    v_mfma_f32_16x16x32_bf16 v[84:87], a[188:191], a[144:147], v[84:87]
    ds_read_b64_tr_b16 a[212:213], v17 offset:33032
    v_mfma_f32_16x16x32_bf16 v[148:151], a[188:191], a[148:151], v[148:151]
    ds_read_b64_tr_b16 a[214:215], v17 offset:41224
    v_mfma_f32_16x16x32_bf16 v[212:215], a[188:191], a[152:155], v[212:215]
    s_waitcnt lgkmcnt(8)
    v_mfma_f32_16x16x32_bf16 v[88:91], a[192:195], a[144:147], v[88:91]
    ds_read_b64_tr_b16 a[216:217], v18 offset:33024
    v_mfma_f32_16x16x32_bf16 v[152:155], a[192:195], a[148:151], v[152:155]
    ds_read_b64_tr_b16 a[218:219], v18 offset:41216
    v_mfma_f32_16x16x32_bf16 v[216:219], a[192:195], a[152:155], v[216:219]
    v_mfma_f32_16x16x32_bf16 v[92:95], a[196:199], a[144:147], v[92:95]
    ds_read_b64_tr_b16 a[220:221], v18 offset:33032
    v_mfma_f32_16x16x32_bf16 v[156:159], a[196:199], a[148:151], v[156:159]
    ds_read_b64_tr_b16 a[222:223], v18 offset:41224
    v_mfma_f32_16x16x32_bf16 v[220:223], a[196:199], a[152:155], v[220:223]
    s_waitcnt lgkmcnt(8)
    v_mfma_f32_16x16x32_bf16 v[96:99], a[200:203], a[144:147], v[96:99]
    ds_read_b64_tr_b16 a[224:225], v19 offset:33024
    v_mfma_f32_16x16x32_bf16 v[160:163], a[200:203], a[148:151], v[160:163]
    ds_read_b64_tr_b16 a[226:227], v19 offset:41216
    v_mfma_f32_16x16x32_bf16 v[224:227], a[200:203], a[152:155], v[224:227]
    v_mfma_f32_16x16x32_bf16 v[100:103], a[204:207], a[144:147], v[100:103]
    ds_read_b64_tr_b16 a[228:229], v19 offset:33032
    v_mfma_f32_16x16x32_bf16 v[164:167], a[204:207], a[148:151], v[164:167]
    ds_read_b64_tr_b16 a[230:231], v19 offset:41224
    v_mfma_f32_16x16x32_bf16 v[228:231], a[204:207], a[152:155], v[228:231]
    s_waitcnt lgkmcnt(8)
    v_mfma_f32_16x16x32_bf16 v[104:107], a[208:211], a[144:147], v[104:107]
    ds_read_b64_tr_b16 a[168:169], v16 offset:49152
    v_mfma_f32_16x16x32_bf16 v[168:171], a[208:211], a[148:151], v[168:171]
    ds_read_b64_tr_b16 a[170:171], v16 offset:57344
    v_mfma_f32_16x16x32_bf16 v[232:235], a[208:211], a[152:155], v[232:235]
    v_mfma_f32_16x16x32_bf16 v[108:111], a[212:215], a[144:147], v[108:111]
    ds_read_b64_tr_b16 a[172:173], v16 offset:49160
    v_mfma_f32_16x16x32_bf16 v[172:175], a[212:215], a[148:151], v[172:175]
    ds_read_b64_tr_b16 a[174:175], v16 offset:57352
    v_mfma_f32_16x16x32_bf16 v[236:239], a[212:215], a[152:155], v[236:239]
    s_waitcnt lgkmcnt(8)
    v_mfma_f32_16x16x32_bf16 v[112:115], a[216:219], a[144:147], v[112:115]
    ds_read_b64_tr_b16 a[176:177], v17 offset:49152
    v_mfma_f32_16x16x32_bf16 v[176:179], a[216:219], a[148:151], v[176:179]
    ds_read_b64_tr_b16 a[178:179], v17 offset:57344
    v_mfma_f32_16x16x32_bf16 v[240:243], a[216:219], a[152:155], v[240:243]
    v_mfma_f32_16x16x32_bf16 v[116:119], a[220:223], a[144:147], v[116:119]
    ds_read_b64_tr_b16 a[180:181], v17 offset:49160
    v_mfma_f32_16x16x32_bf16 v[180:183], a[220:223], a[148:151], v[180:183]
    ds_read_b64_tr_b16 a[182:183], v17 offset:57352
    v_mfma_f32_16x16x32_bf16 v[244:247], a[220:223], a[152:155], v[244:247]
    s_waitcnt lgkmcnt(8)
    v_mfma_f32_16x16x32_bf16 v[120:123], a[224:227], a[144:147], v[120:123]
    ds_read_b64_tr_b16 a[184:185], v18 offset:49152
    v_mfma_f32_16x16x32_bf16 v[184:187], a[224:227], a[148:151], v[184:187]
    ds_read_b64_tr_b16 a[186:187], v18 offset:57344
    v_mfma_f32_16x16x32_bf16 v[248:251], a[224:227], a[152:155], v[248:251]
    v_mfma_f32_16x16x32_bf16 v[124:127], a[228:231], a[144:147], v[124:127]
    ds_read_b64_tr_b16 a[188:189], v18 offset:49160
    v_mfma_f32_16x16x32_bf16 v[188:191], a[228:231], a[148:151], v[188:191]
    ds_read_b64_tr_b16 a[190:191], v18 offset:57352
    v_mfma_f32_16x16x32_bf16 v[252:255], a[228:231], a[152:155], v[252:255]
    s_barrier
    s_waitcnt lgkmcnt(8)
    v_mfma_f32_16x16x32_bf16 v[64:67], a[168:171], a[156:159], v[64:67]
    ds_read_b64_tr_b16 a[192:193], v19 offset:49152
    v_mfma_f32_16x16x32_bf16 v[128:131], a[168:171], a[160:163], v[128:131]
    ds_read_b64_tr_b16 a[194:195], v19 offset:57344
    v_mfma_f32_16x16x32_bf16 v[192:195], a[168:171], a[164:167], v[192:195]
    v_mfma_f32_16x16x32_bf16 v[68:71], a[172:175], a[156:159], v[68:71]
    ds_read_b64_tr_b16 a[196:197], v19 offset:49160
    v_mfma_f32_16x16x32_bf16 v[132:135], a[172:175], a[160:163], v[132:135]
    ds_read_b64_tr_b16 a[198:199], v19 offset:57352
    v_mfma_f32_16x16x32_bf16 v[196:199], a[172:175], a[164:167], v[196:199]
    s_waitcnt lgkmcnt(8)
    v_mfma_f32_16x16x32_bf16 v[72:75], a[176:179], a[156:159], v[72:75]
    ds_read_b64_tr_b16 a[200:201], v16 offset:49408
    v_mfma_f32_16x16x32_bf16 v[136:139], a[176:179], a[160:163], v[136:139]
    ds_read_b64_tr_b16 a[202:203], v16 offset:57600
    v_mfma_f32_16x16x32_bf16 v[200:203], a[176:179], a[164:167], v[200:203]
    v_mfma_f32_16x16x32_bf16 v[76:79], a[180:183], a[156:159], v[76:79]
    ds_read_b64_tr_b16 a[204:205], v16 offset:49416
    v_mfma_f32_16x16x32_bf16 v[140:143], a[180:183], a[160:163], v[140:143]
    ds_read_b64_tr_b16 a[206:207], v16 offset:57608
    v_mfma_f32_16x16x32_bf16 v[204:207], a[180:183], a[164:167], v[204:207]
    s_waitcnt lgkmcnt(8)
    v_mfma_f32_16x16x32_bf16 v[80:83], a[184:187], a[156:159], v[80:83]
    ds_read_b64_tr_b16 a[208:209], v17 offset:49408
    v_mfma_f32_16x16x32_bf16 v[144:147], a[184:187], a[160:163], v[144:147]
    ds_read_b64_tr_b16 a[210:211], v17 offset:57600
    v_mfma_f32_16x16x32_bf16 v[208:211], a[184:187], a[164:167], v[208:211]
    v_mfma_f32_16x16x32_bf16 v[84:87], a[188:191], a[156:159], v[84:87]
    ds_read_b64_tr_b16 a[212:213], v17 offset:49416
    v_mfma_f32_16x16x32_bf16 v[148:151], a[188:191], a[160:163], v[148:151]
    ds_read_b64_tr_b16 a[214:215], v17 offset:57608
    v_mfma_f32_16x16x32_bf16 v[212:215], a[188:191], a[164:167], v[212:215]
    s_waitcnt lgkmcnt(8)
    v_mfma_f32_16x16x32_bf16 v[88:91], a[192:195], a[156:159], v[88:91]
    ds_read_b64_tr_b16 a[216:217], v18 offset:49408
    v_mfma_f32_16x16x32_bf16 v[152:155], a[192:195], a[160:163], v[152:155]
    ds_read_b64_tr_b16 a[218:219], v18 offset:57600
    v_mfma_f32_16x16x32_bf16 v[216:219], a[192:195], a[164:167], v[216:219]
    v_mfma_f32_16x16x32_bf16 v[92:95], a[196:199], a[156:159], v[92:95]
    ds_read_b64_tr_b16 a[220:221], v18 offset:49416
    v_mfma_f32_16x16x32_bf16 v[156:159], a[196:199], a[160:163], v[156:159]
    ds_read_b64_tr_b16 a[222:223], v18 offset:57608
    v_mfma_f32_16x16x32_bf16 v[220:223], a[196:199], a[164:167], v[220:223]
    s_waitcnt lgkmcnt(8)
    v_mfma_f32_16x16x32_bf16 v[96:99], a[200:203], a[156:159], v[96:99]
    ds_read_b64_tr_b16 a[224:225], v19 offset:49408
    v_mfma_f32_16x16x32_bf16 v[160:163], a[200:203], a[160:163], v[160:163]
    ds_read_b64_tr_b16 a[226:227], v19 offset:57600
    v_mfma_f32_16x16x32_bf16 v[224:227], a[200:203], a[164:167], v[224:227]
    v_mfma_f32_16x16x32_bf16 v[100:103], a[204:207], a[156:159], v[100:103]
    ds_read_b64_tr_b16 a[228:229], v19 offset:49416
    v_mfma_f32_16x16x32_bf16 v[164:167], a[204:207], a[160:163], v[164:167]
    ds_read_b64_tr_b16 a[230:231], v19 offset:57608
    v_mfma_f32_16x16x32_bf16 v[228:231], a[204:207], a[164:167], v[228:231]
    s_waitcnt lgkmcnt(8)
    v_mfma_f32_16x16x32_bf16 v[104:107], a[208:211], a[156:159], v[104:107]
    v_mfma_f32_16x16x32_bf16 v[168:171], a[208:211], a[160:163], v[168:171]
    v_mfma_f32_16x16x32_bf16 v[232:235], a[208:211], a[164:167], v[232:235]
    v_mfma_f32_16x16x32_bf16 v[108:111], a[212:215], a[156:159], v[108:111]
    v_mfma_f32_16x16x32_bf16 v[172:175], a[212:215], a[160:163], v[172:175]
    v_mfma_f32_16x16x32_bf16 v[236:239], a[212:215], a[164:167], v[236:239]
    s_waitcnt lgkmcnt(4)
    v_mfma_f32_16x16x32_bf16 v[112:115], a[216:219], a[156:159], v[112:115]
    v_mfma_f32_16x16x32_bf16 v[176:179], a[216:219], a[160:163], v[176:179]
    v_mfma_f32_16x16x32_bf16 v[240:243], a[216:219], a[164:167], v[240:243]
    v_mfma_f32_16x16x32_bf16 v[116:119], a[220:223], a[156:159], v[116:119]
    v_mfma_f32_16x16x32_bf16 v[180:183], a[220:223], a[160:163], v[180:183]
    v_mfma_f32_16x16x32_bf16 v[244:247], a[220:223], a[164:167], v[244:247]
    s_waitcnt lgkmcnt(0)
    v_mfma_f32_16x16x32_bf16 v[120:123], a[224:227], a[156:159], v[120:123]
    v_mfma_f32_16x16x32_bf16 v[184:187], a[224:227], a[160:163], v[184:187]
    v_mfma_f32_16x16x32_bf16 v[248:251], a[224:227], a[164:167], v[248:251]
    v_mfma_f32_16x16x32_bf16 v[124:127], a[228:231], a[156:159], v[124:127]
    v_mfma_f32_16x16x32_bf16 v[188:191], a[228:231], a[160:163], v[188:191]
    v_mfma_f32_16x16x32_bf16 v[252:255], a[228:231], a[164:167], v[252:255]
    s_mov_b32 s74, 0x3db8aa3b
    s_mov_b32 s75, 0x3db8aa3b
    v_mov_b32 v2, 0x3f803f80
    v_accvgpr_write_b32 a204, v2
    v_accvgpr_write_b32 a205, v2
    v_accvgpr_write_b32 a206, v2
    v_accvgpr_write_b32 a207, v2
    s_nop 3
    v_pk_mul_f32 v[248:249], v[248:249], s[74:75]
    v_pk_mul_f32 v[250:251], v[250:251], s[74:75]
    v_pk_mul_f32 v[252:253], v[252:253], s[74:75]
    v_pk_mul_f32 v[254:255], v[254:255], s[74:75]
    v_cvt_pk_bf16_f32 v255, v254, v255
    v_cvt_pk_bf16_f32 v254, v252, v253
    v_cvt_pk_bf16_f32 v253, v250, v251
    v_cvt_pk_bf16_f32 v252, v248, v249
    v_pk_mul_f32 v[240:241], v[240:241], s[74:75]
    v_pk_mul_f32 v[242:243], v[242:243], s[74:75]
    v_pk_mul_f32 v[244:245], v[244:245], s[74:75]
    v_pk_mul_f32 v[246:247], v[246:247], s[74:75]
    v_cvt_pk_bf16_f32 v251, v246, v247
    v_cvt_pk_bf16_f32 v250, v244, v245
    v_cvt_pk_bf16_f32 v249, v242, v243
    v_cvt_pk_bf16_f32 v248, v240, v241
    v_pk_mul_f32 v[232:233], v[232:233], s[74:75]
    v_pk_mul_f32 v[234:235], v[234:235], s[74:75]
    v_pk_mul_f32 v[236:237], v[236:237], s[74:75]
    v_pk_mul_f32 v[238:239], v[238:239], s[74:75]
    v_cvt_pk_bf16_f32 v247, v238, v239
    v_cvt_pk_bf16_f32 v246, v236, v237
    v_cvt_pk_bf16_f32 v245, v234, v235
    v_cvt_pk_bf16_f32 v244, v232, v233
    v_pk_mul_f32 v[224:225], v[224:225], s[74:75]
    v_pk_mul_f32 v[226:227], v[226:227], s[74:75]
    v_pk_mul_f32 v[228:229], v[228:229], s[74:75]
    v_pk_mul_f32 v[230:231], v[230:231], s[74:75]
    v_cvt_pk_bf16_f32 v243, v230, v231
    v_cvt_pk_bf16_f32 v242, v228, v229
    v_cvt_pk_bf16_f32 v241, v226, v227
    v_cvt_pk_bf16_f32 v240, v224, v225
    v_pk_mul_f32 v[216:217], v[216:217], s[74:75]
    v_pk_mul_f32 v[218:219], v[218:219], s[74:75]
    v_pk_mul_f32 v[220:221], v[220:221], s[74:75]
    v_pk_mul_f32 v[222:223], v[222:223], s[74:75]
    v_cvt_pk_bf16_f32 v239, v222, v223
    v_cvt_pk_bf16_f32 v238, v220, v221
    v_cvt_pk_bf16_f32 v237, v218, v219
    v_cvt_pk_bf16_f32 v236, v216, v217
    v_pk_mul_f32 v[208:209], v[208:209], s[74:75]
    v_pk_mul_f32 v[210:211], v[210:211], s[74:75]
    v_pk_mul_f32 v[212:213], v[212:213], s[74:75]
    v_pk_mul_f32 v[214:215], v[214:215], s[74:75]
    v_cvt_pk_bf16_f32 v235, v214, v215
    v_cvt_pk_bf16_f32 v234, v212, v213
    v_cvt_pk_bf16_f32 v233, v210, v211
    v_cvt_pk_bf16_f32 v232, v208, v209
    v_pk_mul_f32 v[200:201], v[200:201], s[74:75]
    v_pk_mul_f32 v[202:203], v[202:203], s[74:75]
    v_pk_mul_f32 v[204:205], v[204:205], s[74:75]
    v_pk_mul_f32 v[206:207], v[206:207], s[74:75]
    v_cvt_pk_bf16_f32 v231, v206, v207
    v_cvt_pk_bf16_f32 v230, v204, v205
    v_cvt_pk_bf16_f32 v229, v202, v203
    v_cvt_pk_bf16_f32 v228, v200, v201
    v_pk_mul_f32 v[192:193], v[192:193], s[74:75]
    v_pk_mul_f32 v[194:195], v[194:195], s[74:75]
    v_pk_mul_f32 v[196:197], v[196:197], s[74:75]
    v_pk_mul_f32 v[198:199], v[198:199], s[74:75]
    v_cvt_pk_bf16_f32 v227, v198, v199
    v_cvt_pk_bf16_f32 v226, v196, v197
    v_cvt_pk_bf16_f32 v225, v194, v195
    v_cvt_pk_bf16_f32 v224, v192, v193
    v_pk_mul_f32 v[184:185], v[184:185], s[74:75]
    v_pk_mul_f32 v[186:187], v[186:187], s[74:75]
    v_pk_mul_f32 v[188:189], v[188:189], s[74:75]
    v_pk_mul_f32 v[190:191], v[190:191], s[74:75]
    v_cvt_pk_bf16_f32 v223, v190, v191
    v_cvt_pk_bf16_f32 v222, v188, v189
    v_cvt_pk_bf16_f32 v221, v186, v187
    v_cvt_pk_bf16_f32 v220, v184, v185
    v_pk_mul_f32 v[176:177], v[176:177], s[74:75]
    v_pk_mul_f32 v[178:179], v[178:179], s[74:75]
    v_pk_mul_f32 v[180:181], v[180:181], s[74:75]
    v_pk_mul_f32 v[182:183], v[182:183], s[74:75]
    v_cvt_pk_bf16_f32 v219, v182, v183
    v_cvt_pk_bf16_f32 v218, v180, v181
    v_cvt_pk_bf16_f32 v217, v178, v179
    v_cvt_pk_bf16_f32 v216, v176, v177
    v_pk_mul_f32 v[168:169], v[168:169], s[74:75]
    v_pk_mul_f32 v[170:171], v[170:171], s[74:75]
    v_pk_mul_f32 v[172:173], v[172:173], s[74:75]
    v_pk_mul_f32 v[174:175], v[174:175], s[74:75]
    v_cvt_pk_bf16_f32 v215, v174, v175
    v_cvt_pk_bf16_f32 v214, v172, v173
    v_cvt_pk_bf16_f32 v213, v170, v171
    v_cvt_pk_bf16_f32 v212, v168, v169
    v_pk_mul_f32 v[160:161], v[160:161], s[74:75]
    v_pk_mul_f32 v[162:163], v[162:163], s[74:75]
    v_pk_mul_f32 v[164:165], v[164:165], s[74:75]
    v_pk_mul_f32 v[166:167], v[166:167], s[74:75]
    v_cvt_pk_bf16_f32 v211, v166, v167
    v_cvt_pk_bf16_f32 v210, v164, v165
    v_cvt_pk_bf16_f32 v209, v162, v163
    v_cvt_pk_bf16_f32 v208, v160, v161
    v_pk_mul_f32 v[152:153], v[152:153], s[74:75]
    v_pk_mul_f32 v[154:155], v[154:155], s[74:75]
    v_pk_mul_f32 v[156:157], v[156:157], s[74:75]
    v_pk_mul_f32 v[158:159], v[158:159], s[74:75]
    v_cvt_pk_bf16_f32 v207, v158, v159
    v_cvt_pk_bf16_f32 v206, v156, v157
    v_cvt_pk_bf16_f32 v205, v154, v155
    v_cvt_pk_bf16_f32 v204, v152, v153
    v_pk_mul_f32 v[144:145], v[144:145], s[74:75]
    v_pk_mul_f32 v[146:147], v[146:147], s[74:75]
    v_pk_mul_f32 v[148:149], v[148:149], s[74:75]
    v_pk_mul_f32 v[150:151], v[150:151], s[74:75]
    v_cvt_pk_bf16_f32 v203, v150, v151
    v_cvt_pk_bf16_f32 v202, v148, v149
    v_cvt_pk_bf16_f32 v201, v146, v147
    v_cvt_pk_bf16_f32 v200, v144, v145
    v_pk_mul_f32 v[136:137], v[136:137], s[74:75]
    v_pk_mul_f32 v[138:139], v[138:139], s[74:75]
    v_pk_mul_f32 v[140:141], v[140:141], s[74:75]
    v_pk_mul_f32 v[142:143], v[142:143], s[74:75]
    v_cvt_pk_bf16_f32 v199, v142, v143
    v_cvt_pk_bf16_f32 v198, v140, v141
    v_cvt_pk_bf16_f32 v197, v138, v139
    v_cvt_pk_bf16_f32 v196, v136, v137
    v_pk_mul_f32 v[128:129], v[128:129], s[74:75]
    v_pk_mul_f32 v[130:131], v[130:131], s[74:75]
    v_pk_mul_f32 v[132:133], v[132:133], s[74:75]
    v_pk_mul_f32 v[134:135], v[134:135], s[74:75]
    v_cvt_pk_bf16_f32 v195, v134, v135
    v_cvt_pk_bf16_f32 v194, v132, v133
    v_cvt_pk_bf16_f32 v193, v130, v131
    v_cvt_pk_bf16_f32 v192, v128, v129
    v_pk_mul_f32 v[120:121], v[120:121], s[74:75]
    v_pk_mul_f32 v[122:123], v[122:123], s[74:75]
    v_pk_mul_f32 v[124:125], v[124:125], s[74:75]
    v_pk_mul_f32 v[126:127], v[126:127], s[74:75]
    v_cvt_pk_bf16_f32 v191, v126, v127
    v_cvt_pk_bf16_f32 v190, v124, v125
    v_cvt_pk_bf16_f32 v189, v122, v123
    v_cvt_pk_bf16_f32 v188, v120, v121
    v_pk_mul_f32 v[112:113], v[112:113], s[74:75]
    v_pk_mul_f32 v[114:115], v[114:115], s[74:75]
    v_pk_mul_f32 v[116:117], v[116:117], s[74:75]
    v_pk_mul_f32 v[118:119], v[118:119], s[74:75]
    v_cvt_pk_bf16_f32 v187, v118, v119
    v_cvt_pk_bf16_f32 v186, v116, v117
    v_cvt_pk_bf16_f32 v185, v114, v115
    v_cvt_pk_bf16_f32 v184, v112, v113
    v_pk_mul_f32 v[104:105], v[104:105], s[74:75]
    v_pk_mul_f32 v[106:107], v[106:107], s[74:75]
    v_pk_mul_f32 v[108:109], v[108:109], s[74:75]
    v_pk_mul_f32 v[110:111], v[110:111], s[74:75]
    v_cvt_pk_bf16_f32 v183, v110, v111
    v_cvt_pk_bf16_f32 v182, v108, v109
    v_cvt_pk_bf16_f32 v181, v106, v107
    v_cvt_pk_bf16_f32 v180, v104, v105
    v_pk_mul_f32 v[96:97], v[96:97], s[74:75]
    v_pk_mul_f32 v[98:99], v[98:99], s[74:75]
    v_pk_mul_f32 v[100:101], v[100:101], s[74:75]
    v_pk_mul_f32 v[102:103], v[102:103], s[74:75]
    v_cvt_pk_bf16_f32 v179, v102, v103
    v_cvt_pk_bf16_f32 v178, v100, v101
    v_cvt_pk_bf16_f32 v177, v98, v99
    v_cvt_pk_bf16_f32 v176, v96, v97
    v_pk_mul_f32 v[88:89], v[88:89], s[74:75]
    v_pk_mul_f32 v[90:91], v[90:91], s[74:75]
    v_pk_mul_f32 v[92:93], v[92:93], s[74:75]
    v_pk_mul_f32 v[94:95], v[94:95], s[74:75]
    v_cvt_pk_bf16_f32 v175, v94, v95
    v_cvt_pk_bf16_f32 v174, v92, v93
    v_cvt_pk_bf16_f32 v173, v90, v91
    v_cvt_pk_bf16_f32 v172, v88, v89
    v_pk_mul_f32 v[80:81], v[80:81], s[74:75]
    v_pk_mul_f32 v[82:83], v[82:83], s[74:75]
    v_pk_mul_f32 v[84:85], v[84:85], s[74:75]
    v_pk_mul_f32 v[86:87], v[86:87], s[74:75]
    v_cvt_pk_bf16_f32 v171, v86, v87
    v_cvt_pk_bf16_f32 v170, v84, v85
    v_cvt_pk_bf16_f32 v169, v82, v83
    v_cvt_pk_bf16_f32 v168, v80, v81
    v_pk_mul_f32 v[72:73], v[72:73], s[74:75]
    v_pk_mul_f32 v[74:75], v[74:75], s[74:75]
    v_pk_mul_f32 v[76:77], v[76:77], s[74:75]
    v_pk_mul_f32 v[78:79], v[78:79], s[74:75]
    v_cvt_pk_bf16_f32 v167, v78, v79
    v_cvt_pk_bf16_f32 v166, v76, v77
    v_cvt_pk_bf16_f32 v165, v74, v75
    v_cvt_pk_bf16_f32 v164, v72, v73
    v_pk_mul_f32 v[64:65], v[64:65], s[74:75]
    v_pk_mul_f32 v[66:67], v[66:67], s[74:75]
    v_pk_mul_f32 v[68:69], v[68:69], s[74:75]
    v_pk_mul_f32 v[70:71], v[70:71], s[74:75]
    v_cvt_pk_bf16_f32 v163, v70, v71
    v_cvt_pk_bf16_f32 v162, v68, v69
    v_cvt_pk_bf16_f32 v161, v66, v67
    v_cvt_pk_bf16_f32 v160, v64, v65
    s_barrier
    ds_read_b128 v[96:99], v4 offset:0
    ds_read_b128 v[100:103], v5 offset:0
    ds_read_b128 v[104:107], v6 offset:0
    ds_read_b128 v[108:111], v7 offset:0
    ds_read_b128 v[112:115], v4 offset:256
    ds_read_b128 v[116:119], v5 offset:256
    ds_read_b128 v[120:123], v6 offset:256
    ds_read_b128 v[124:127], v7 offset:256
    s_waitcnt lgkmcnt(6)
    v_mfma_f32_16x16x32_bf16 v[24:27], v[96:99], v[160:163], 0
    v_mfma_f32_16x16x32_bf16 v[32:35], v[96:99], v[192:195], 0
    v_mfma_f32_16x16x32_bf16 v[40:43], v[96:99], v[224:227], 0
    ds_read_b128 v[96:99], v4 offset:8192
    v_mfma_f32_16x16x32_bf16 v[24:27], v[100:103], v[164:167], v[24:27]
    v_mfma_f32_16x16x32_bf16 v[32:35], v[100:103], v[196:199], v[32:35]
    v_mfma_f32_16x16x32_bf16 v[40:43], v[100:103], v[228:231], v[40:43]
    ds_read_b128 v[100:103], v5 offset:8192
    s_waitcnt lgkmcnt(6)
    v_mfma_f32_16x16x32_bf16 v[24:27], v[104:107], v[168:171], v[24:27]
    v_mfma_f32_16x16x32_bf16 v[32:35], v[104:107], v[200:203], v[32:35]
    v_mfma_f32_16x16x32_bf16 v[40:43], v[104:107], v[232:235], v[40:43]
    ds_read_b128 v[104:107], v6 offset:8192
    v_mfma_f32_16x16x32_bf16 v[24:27], v[108:111], v[172:175], v[24:27]
    v_mfma_f32_16x16x32_bf16 v[32:35], v[108:111], v[204:207], v[32:35]
    v_mfma_f32_16x16x32_bf16 v[40:43], v[108:111], v[236:239], v[40:43]
    ds_read_b128 v[108:111], v7 offset:8192
    s_waitcnt lgkmcnt(6)
    v_mfma_f32_16x16x32_bf16 v[24:27], v[112:115], v[176:179], v[24:27]
    v_mfma_f32_16x16x32_bf16 v[32:35], v[112:115], v[208:211], v[32:35]
    v_mfma_f32_16x16x32_bf16 v[40:43], v[112:115], v[240:243], v[40:43]
    ds_read_b128 v[112:115], v4 offset:8448
    v_mfma_f32_16x16x32_bf16 v[24:27], v[116:119], v[180:183], v[24:27]
    v_mfma_f32_16x16x32_bf16 v[32:35], v[116:119], v[212:215], v[32:35]
    v_mfma_f32_16x16x32_bf16 v[40:43], v[116:119], v[244:247], v[40:43]
    ds_read_b128 v[116:119], v5 offset:8448
    s_waitcnt lgkmcnt(6)
    v_mfma_f32_16x16x32_bf16 v[24:27], v[120:123], v[184:187], v[24:27]
    v_mfma_f32_16x16x32_bf16 v[32:35], v[120:123], v[216:219], v[32:35]
    v_mfma_f32_16x16x32_bf16 v[40:43], v[120:123], v[248:251], v[40:43]
    ds_read_b128 v[120:123], v6 offset:8448
    v_mfma_f32_16x16x32_bf16 v[24:27], v[124:127], v[188:191], v[24:27]
    v_mfma_f32_16x16x32_bf16 v[32:35], v[124:127], v[220:223], v[32:35]
    v_mfma_f32_16x16x32_bf16 v[40:43], v[124:127], v[252:255], v[40:43]
    ds_read_b128 v[124:127], v7 offset:8448
    s_waitcnt lgkmcnt(6)
    v_mfma_f32_16x16x32_bf16 v[28:31], v[96:99], v[160:163], 0
    v_mfma_f32_16x16x32_bf16 v[36:39], v[96:99], v[192:195], 0
    v_mfma_f32_16x16x32_bf16 v[44:47], v[96:99], v[224:227], 0
    v_mfma_f32_16x16x32_bf16 v[28:31], v[100:103], v[164:167], v[28:31]
    v_mfma_f32_16x16x32_bf16 v[36:39], v[100:103], v[196:199], v[36:39]
    v_mfma_f32_16x16x32_bf16 v[44:47], v[100:103], v[228:231], v[44:47]
    s_waitcnt lgkmcnt(4)
    v_mfma_f32_16x16x32_bf16 v[28:31], v[104:107], v[168:171], v[28:31]
    v_mfma_f32_16x16x32_bf16 v[36:39], v[104:107], v[200:203], v[36:39]
    v_mfma_f32_16x16x32_bf16 v[44:47], v[104:107], v[232:235], v[44:47]
    v_mfma_f32_16x16x32_bf16 v[28:31], v[108:111], v[172:175], v[28:31]
    v_mfma_f32_16x16x32_bf16 v[36:39], v[108:111], v[204:207], v[36:39]
    v_mfma_f32_16x16x32_bf16 v[44:47], v[108:111], v[236:239], v[44:47]
    s_waitcnt lgkmcnt(2)
    v_mfma_f32_16x16x32_bf16 v[28:31], v[112:115], v[176:179], v[28:31]
    v_mfma_f32_16x16x32_bf16 v[36:39], v[112:115], v[208:211], v[36:39]
    v_mfma_f32_16x16x32_bf16 v[44:47], v[112:115], v[240:243], v[44:47]
    v_mfma_f32_16x16x32_bf16 v[28:31], v[116:119], v[180:183], v[28:31]
    v_mfma_f32_16x16x32_bf16 v[36:39], v[116:119], v[212:215], v[36:39]
    v_mfma_f32_16x16x32_bf16 v[44:47], v[116:119], v[244:247], v[44:47]
    s_waitcnt lgkmcnt(0)
    v_mfma_f32_16x16x32_bf16 v[28:31], v[120:123], v[184:187], v[28:31]
    v_mfma_f32_16x16x32_bf16 v[36:39], v[120:123], v[216:219], v[36:39]
    v_mfma_f32_16x16x32_bf16 v[44:47], v[120:123], v[248:251], v[44:47]
    v_mfma_f32_16x16x32_bf16 v[28:31], v[124:127], v[188:191], v[28:31]
    v_mfma_f32_16x16x32_bf16 v[36:39], v[124:127], v[220:223], v[36:39]
    v_mfma_f32_16x16x32_bf16 v[44:47], v[124:127], v[252:255], v[44:47]
    ds_read_b128 v[96:99], v4 offset:16384
    ds_read_b128 v[100:103], v5 offset:16384
    ds_read_b128 v[104:107], v6 offset:16384
    ds_read_b128 v[108:111], v7 offset:16384
    ds_read_b128 v[112:115], v4 offset:16640
    ds_read_b128 v[116:119], v5 offset:16640
    ds_read_b128 v[120:123], v6 offset:16640
    ds_read_b128 v[124:127], v7 offset:16640
    s_nop 1
    v_max3_f32 v16, v24, v25, v26
    v_max3_f32 v16, v16, v27, v28
    v_max3_f32 v16, v16, v29, v30
    v_max_f32 v16, v16, v31
    v_max3_f32 v17, v32, v33, v34
    v_max3_f32 v17, v17, v35, v36
    v_max3_f32 v17, v17, v37, v38
    v_max_f32 v17, v17, v39
    v_max3_f32 v18, v40, v41, v42
    v_max3_f32 v18, v18, v43, v44
    v_max3_f32 v18, v18, v45, v46
    v_max_f32 v18, v18, v47
    v_mov_b32 v20, v16
    v_mov_b32 v21, v17
    v_mov_b32 v22, v18
    s_nop 0
    v_permlane32_swap_b32 v16, v20
    v_permlane32_swap_b32 v17, v21
    v_permlane32_swap_b32 v18, v22
    s_nop 0
    v_max_f32 v16, v16, v20
    v_max_f32 v17, v17, v21
    v_max_f32 v18, v18, v22
    v_mov_b32 v20, v16
    v_mov_b32 v21, v17
    v_mov_b32 v22, v18
    s_nop 0
    v_permlane16_swap_b32 v16, v20
    v_permlane16_swap_b32 v17, v21
    v_permlane16_swap_b32 v18, v22
    s_nop 0
    v_max_f32 v16, v16, v20
    v_max_f32 v17, v17, v21
    v_max_f32 v18, v18, v22
    v_sub_f32 v24, v24, v16
    v_sub_f32 v25, v25, v16
    v_sub_f32 v26, v26, v16
    v_sub_f32 v27, v27, v16
    v_sub_f32 v28, v28, v16
    v_sub_f32 v29, v29, v16
    v_sub_f32 v30, v30, v16
    v_sub_f32 v31, v31, v16
    v_sub_f32 v84, 0, v16
    v_sub_f32 v85, 0, v16
    v_sub_f32 v86, 0, v16
    v_sub_f32 v87, 0, v16
    v_sub_f32 v32, v32, v17
    v_sub_f32 v33, v33, v17
    v_sub_f32 v34, v34, v17
    v_sub_f32 v35, v35, v17
    v_sub_f32 v36, v36, v17
    v_sub_f32 v37, v37, v17
    v_sub_f32 v38, v38, v17
    v_sub_f32 v39, v39, v17
    v_sub_f32 v88, 0, v17
    v_sub_f32 v89, 0, v17
    v_sub_f32 v90, 0, v17
    v_sub_f32 v91, 0, v17
    v_sub_f32 v40, v40, v18
    v_sub_f32 v41, v41, v18
    v_sub_f32 v42, v42, v18
    v_sub_f32 v43, v43, v18
    v_sub_f32 v44, v44, v18
    v_sub_f32 v45, v45, v18
    v_sub_f32 v46, v46, v18
    v_sub_f32 v47, v47, v18
    v_sub_f32 v92, 0, v18
    v_sub_f32 v93, 0, v18
    v_sub_f32 v94, 0, v18
    v_sub_f32 v95, 0, v18
    s_barrier
    s_waitcnt lgkmcnt(6)
    v_mfma_f32_16x16x32_bf16 v[48:51], v[96:99], v[160:163], v[84:87]
    v_exp_f32 v24, v24
    v_mfma_f32_16x16x32_bf16 v[56:59], v[96:99], v[192:195], v[88:91]
    v_exp_f32 v25, v25
    v_mfma_f32_16x16x32_bf16 v[64:67], v[96:99], v[224:227], v[92:95]
    v_cvt_pk_bf16_f32 v72, v24, v25
    ds_read_b128 v[96:99], v4 offset:24576
    v_mfma_f32_16x16x32_bf16 v[48:51], v[100:103], v[164:167], v[48:51]
    v_mfma_f32_16x16x32_bf16 v[56:59], v[100:103], v[196:199], v[56:59]
    v_exp_f32 v26, v26
    v_mfma_f32_16x16x32_bf16 v[64:67], v[100:103], v[228:231], v[64:67]
    v_exp_f32 v27, v27
    s_waitcnt lgkmcnt(5)
    v_mfma_f32_16x16x32_bf16 v[48:51], v[104:107], v[168:171], v[48:51]
    v_cvt_pk_bf16_f32 v73, v26, v27
    ds_read_b128 v[100:103], v5 offset:24576
    v_mfma_f32_16x16x32_bf16 v[56:59], v[104:107], v[200:203], v[56:59]
    v_mfma_f32_16x16x32_bf16 v[64:67], v[104:107], v[232:235], v[64:67]
    v_exp_f32 v28, v28
    v_mfma_f32_16x16x32_bf16 v[48:51], v[108:111], v[172:175], v[48:51]
    v_exp_f32 v29, v29
    v_mfma_f32_16x16x32_bf16 v[56:59], v[108:111], v[204:207], v[56:59]
    v_cvt_pk_bf16_f32 v74, v28, v29
    ds_read_b128 v[104:107], v6 offset:24576
    v_mfma_f32_16x16x32_bf16 v[64:67], v[108:111], v[236:239], v[64:67]
    ds_read_b128 v[108:111], v7 offset:24576
    s_waitcnt lgkmcnt(6)
    v_mfma_f32_16x16x32_bf16 v[48:51], v[112:115], v[176:179], v[48:51]
    v_exp_f32 v30, v30
    v_mfma_f32_16x16x32_bf16 v[56:59], v[112:115], v[208:211], v[56:59]
    v_exp_f32 v31, v31
    v_mfma_f32_16x16x32_bf16 v[64:67], v[112:115], v[240:243], v[64:67]
    v_cvt_pk_bf16_f32 v75, v30, v31
    ds_read_b128 v[112:115], v4 offset:24832
    v_mfma_f32_16x16x32_bf16 v[48:51], v[116:119], v[180:183], v[48:51]
    v_mfma_f32_16x16x32_bf16 v[56:59], v[116:119], v[212:215], v[56:59]
    v_exp_f32 v32, v32
    v_mfma_f32_16x16x32_bf16 v[64:67], v[116:119], v[244:247], v[64:67]
    v_exp_f32 v33, v33
    s_waitcnt lgkmcnt(5)
    v_mfma_f32_16x16x32_bf16 v[48:51], v[120:123], v[184:187], v[48:51]
    v_cvt_pk_bf16_f32 v76, v32, v33
    ds_read_b128 v[116:119], v5 offset:24832
    v_mfma_f32_16x16x32_bf16 v[56:59], v[120:123], v[216:219], v[56:59]
    v_mfma_f32_16x16x32_bf16 v[64:67], v[120:123], v[248:251], v[64:67]
    v_exp_f32 v34, v34
    v_mfma_f32_16x16x32_bf16 v[48:51], v[124:127], v[188:191], v[48:51]
    v_exp_f32 v35, v35
    v_mfma_f32_16x16x32_bf16 v[56:59], v[124:127], v[220:223], v[56:59]
    v_cvt_pk_bf16_f32 v77, v34, v35
    ds_read_b128 v[120:123], v6 offset:24832
    v_mfma_f32_16x16x32_bf16 v[64:67], v[124:127], v[252:255], v[64:67]
    ds_read_b128 v[124:127], v7 offset:24832
    s_waitcnt lgkmcnt(6)
    v_mfma_f32_16x16x32_bf16 v[52:55], v[96:99], v[160:163], v[84:87]
    v_exp_f32 v36, v36
    v_mfma_f32_16x16x32_bf16 v[60:63], v[96:99], v[192:195], v[88:91]
    v_exp_f32 v37, v37
    v_mfma_f32_16x16x32_bf16 v[68:71], v[96:99], v[224:227], v[92:95]
    v_cvt_pk_bf16_f32 v78, v36, v37
    ds_read_b64_tr_b16 v[128:129], v8 offset:0
    v_mfma_f32_16x16x32_bf16 v[52:55], v[100:103], v[164:167], v[52:55]
    ds_read_b64_tr_b16 v[130:131], v8 offset:8192
    v_mfma_f32_16x16x32_bf16 v[60:63], v[100:103], v[196:199], v[60:63]
    v_exp_f32 v38, v38
    v_mfma_f32_16x16x32_bf16 v[68:71], v[100:103], v[228:231], v[68:71]
    v_exp_f32 v39, v39
    s_waitcnt lgkmcnt(6)
    v_mfma_f32_16x16x32_bf16 v[52:55], v[104:107], v[168:171], v[52:55]
    v_cvt_pk_bf16_f32 v79, v38, v39
    ds_read_b64_tr_b16 v[132:133], v9 offset:0
    v_mfma_f32_16x16x32_bf16 v[60:63], v[104:107], v[200:203], v[60:63]
    ds_read_b64_tr_b16 v[134:135], v9 offset:8192
    v_mfma_f32_16x16x32_bf16 v[68:71], v[104:107], v[232:235], v[68:71]
    v_exp_f32 v40, v40
    v_mfma_f32_16x16x32_bf16 v[52:55], v[108:111], v[172:175], v[52:55]
    v_exp_f32 v41, v41
    v_mfma_f32_16x16x32_bf16 v[60:63], v[108:111], v[204:207], v[60:63]
    v_cvt_pk_bf16_f32 v80, v40, v41
    ds_read_b64_tr_b16 v[136:137], v10 offset:0
    v_mfma_f32_16x16x32_bf16 v[68:71], v[108:111], v[236:239], v[68:71]
    ds_read_b64_tr_b16 v[138:139], v10 offset:8192
    s_waitcnt lgkmcnt(8)
    v_mfma_f32_16x16x32_bf16 v[52:55], v[112:115], v[176:179], v[52:55]
    v_exp_f32 v42, v42
    v_mfma_f32_16x16x32_bf16 v[60:63], v[112:115], v[208:211], v[60:63]
    v_exp_f32 v43, v43
    v_mfma_f32_16x16x32_bf16 v[68:71], v[112:115], v[240:243], v[68:71]
    v_cvt_pk_bf16_f32 v81, v42, v43
    ds_read_b64_tr_b16 v[140:141], v11 offset:0
    v_mfma_f32_16x16x32_bf16 v[52:55], v[116:119], v[180:183], v[52:55]
    ds_read_b64_tr_b16 v[142:143], v11 offset:8192
    v_mfma_f32_16x16x32_bf16 v[60:63], v[116:119], v[212:215], v[60:63]
    v_exp_f32 v44, v44
    v_mfma_f32_16x16x32_bf16 v[68:71], v[116:119], v[244:247], v[68:71]
    v_exp_f32 v45, v45
    s_waitcnt lgkmcnt(8)
    v_mfma_f32_16x16x32_bf16 v[52:55], v[120:123], v[184:187], v[52:55]
    v_cvt_pk_bf16_f32 v82, v44, v45
    v_mfma_f32_16x16x32_bf16 v[60:63], v[120:123], v[216:219], v[60:63]
    v_mfma_f32_16x16x32_bf16 v[68:71], v[120:123], v[248:251], v[68:71]
    v_exp_f32 v46, v46
    v_mfma_f32_16x16x32_bf16 v[52:55], v[124:127], v[188:191], v[52:55]
    v_exp_f32 v47, v47
    v_mfma_f32_16x16x32_bf16 v[60:63], v[124:127], v[220:223], v[60:63]
    v_cvt_pk_bf16_f32 v83, v46, v47
    v_mfma_f32_16x16x32_bf16 v[68:71], v[124:127], v[252:255], v[68:71]
    s_nop 1
    v_mfma_f32_16x16x32_bf16 a[192:195], a[204:207], v[72:75], 0
    ds_read_b64_tr_b16 v[144:145], v12 offset:0
    v_mfma_f32_16x16x32_bf16 a[196:199], a[204:207], v[76:79], 0
    ds_read_b64_tr_b16 v[146:147], v12 offset:8192
    v_mfma_f32_16x16x32_bf16 a[200:203], a[204:207], v[80:83], 0
    s_waitcnt lgkmcnt(6)
    v_mfma_f32_16x16x32_bf16 a[0:3], v[128:131], v[72:75], 0
    ds_read_b64_tr_b16 v[148:149], v13 offset:0
    v_mfma_f32_16x16x32_bf16 a[4:7], v[128:131], v[76:79], 0
    ds_read_b64_tr_b16 v[150:151], v13 offset:8192
    v_mfma_f32_16x16x32_bf16 a[8:11], v[128:131], v[80:83], 0
    v_mfma_f32_16x16x32_bf16 a[12:15], v[132:135], v[72:75], 0
    ds_read_b64_tr_b16 v[152:153], v14 offset:0
    v_max3_f32 v16, v48, v49, v50
    v_mfma_f32_16x16x32_bf16 a[16:19], v[132:135], v[76:79], 0
    ds_read_b64_tr_b16 v[154:155], v14 offset:8192
    v_mfma_f32_16x16x32_bf16 a[20:23], v[132:135], v[80:83], 0
    v_max3_f32 v16, v16, v51, v52
    s_waitcnt lgkmcnt(6)
    v_mfma_f32_16x16x32_bf16 a[24:27], v[136:139], v[72:75], 0
    ds_read_b64_tr_b16 v[156:157], v15 offset:0
    v_mfma_f32_16x16x32_bf16 a[28:31], v[136:139], v[76:79], 0
    ds_read_b64_tr_b16 v[158:159], v15 offset:8192
    v_max3_f32 v16, v16, v53, v54
    v_mfma_f32_16x16x32_bf16 a[32:35], v[136:139], v[80:83], 0
    v_mfma_f32_16x16x32_bf16 a[36:39], v[140:143], v[72:75], 0
    ds_read_b64_tr_b16 v[128:129], v8 offset:256
    v_max3_f32 v16, v16, v55, v56
    v_mfma_f32_16x16x32_bf16 a[40:43], v[140:143], v[76:79], 0
    ds_read_b64_tr_b16 v[130:131], v8 offset:8448
    v_mfma_f32_16x16x32_bf16 a[44:47], v[140:143], v[80:83], 0
    v_max3_f32 v16, v16, v57, v58
    s_waitcnt lgkmcnt(6)
    v_mfma_f32_16x16x32_bf16 a[48:51], v[144:147], v[72:75], 0
    ds_read_b64_tr_b16 v[132:133], v9 offset:256
    v_mfma_f32_16x16x32_bf16 a[52:55], v[144:147], v[76:79], 0
    ds_read_b64_tr_b16 v[134:135], v9 offset:8448
    v_max3_f32 v16, v16, v59, v60
    v_mfma_f32_16x16x32_bf16 a[56:59], v[144:147], v[80:83], 0
    v_mfma_f32_16x16x32_bf16 a[60:63], v[148:151], v[72:75], 0
    ds_read_b64_tr_b16 v[136:137], v10 offset:256
    v_max3_f32 v16, v16, v61, v62
    v_mfma_f32_16x16x32_bf16 a[64:67], v[148:151], v[76:79], 0
    ds_read_b64_tr_b16 v[138:139], v10 offset:8448
    v_mfma_f32_16x16x32_bf16 a[68:71], v[148:151], v[80:83], 0
    v_max3_f32 v16, v16, v63, v64
    s_waitcnt lgkmcnt(6)
    v_mfma_f32_16x16x32_bf16 a[72:75], v[152:155], v[72:75], 0
    ds_read_b64_tr_b16 v[140:141], v11 offset:256
    v_mfma_f32_16x16x32_bf16 a[76:79], v[152:155], v[76:79], 0
    ds_read_b64_tr_b16 v[142:143], v11 offset:8448
    v_max3_f32 v16, v16, v65, v66
    v_mfma_f32_16x16x32_bf16 a[80:83], v[152:155], v[80:83], 0
    v_mfma_f32_16x16x32_bf16 a[84:87], v[156:159], v[72:75], 0
    ds_read_b64_tr_b16 v[144:145], v12 offset:256
    v_max3_f32 v16, v16, v67, v68
    v_mfma_f32_16x16x32_bf16 a[88:91], v[156:159], v[76:79], 0
    ds_read_b64_tr_b16 v[146:147], v12 offset:8448
    v_mfma_f32_16x16x32_bf16 a[92:95], v[156:159], v[80:83], 0
    v_max3_f32 v16, v16, v69, v70
    s_waitcnt lgkmcnt(6)
    v_mfma_f32_16x16x32_bf16 a[96:99], v[128:131], v[72:75], 0
    ds_read_b64_tr_b16 v[148:149], v13 offset:256
    v_mfma_f32_16x16x32_bf16 a[100:103], v[128:131], v[76:79], 0
    ds_read_b64_tr_b16 v[150:151], v13 offset:8448
    v_max_f32 v16, v16, v71
    v_mfma_f32_16x16x32_bf16 a[104:107], v[128:131], v[80:83], 0
    v_mfma_f32_16x16x32_bf16 a[108:111], v[132:135], v[72:75], 0
    ds_read_b64_tr_b16 v[152:153], v14 offset:256
    v_cmp_lt_f32 vcc, s31, v16
    v_mfma_f32_16x16x32_bf16 a[112:115], v[132:135], v[76:79], 0
    ds_read_b64_tr_b16 v[154:155], v14 offset:8448
    v_mfma_f32_16x16x32_bf16 a[116:119], v[132:135], v[80:83], 0
    ds_read_b128 v[96:99], v4 offset:32768
    s_waitcnt lgkmcnt(7)
    v_mfma_f32_16x16x32_bf16 a[120:123], v[136:139], v[72:75], 0
    ds_read_b64_tr_b16 v[156:157], v15 offset:256
    v_mfma_f32_16x16x32_bf16 a[124:127], v[136:139], v[76:79], 0
    ds_read_b64_tr_b16 v[158:159], v15 offset:8448
    v_mfma_f32_16x16x32_bf16 a[128:131], v[136:139], v[80:83], 0
    ds_read_b128 v[100:103], v5 offset:32768
    v_mfma_f32_16x16x32_bf16 a[132:135], v[140:143], v[72:75], 0
    ds_read_b128 v[104:107], v6 offset:32768
    v_mfma_f32_16x16x32_bf16 a[136:139], v[140:143], v[76:79], 0
    ds_read_b128 v[108:111], v7 offset:32768
    v_mfma_f32_16x16x32_bf16 a[140:143], v[140:143], v[80:83], 0
    ds_read_b128 v[112:115], v4 offset:33024
    s_waitcnt lgkmcnt(9)
    v_mfma_f32_16x16x32_bf16 a[144:147], v[144:147], v[72:75], 0
    v_mfma_f32_16x16x32_bf16 a[148:151], v[144:147], v[76:79], 0
    ds_read_b128 v[116:119], v5 offset:33024
    v_mfma_f32_16x16x32_bf16 a[152:155], v[144:147], v[80:83], 0
    v_mfma_f32_16x16x32_bf16 a[156:159], v[148:151], v[72:75], 0
    ds_read_b128 v[120:123], v6 offset:33024
    v_mfma_f32_16x16x32_bf16 a[160:163], v[148:151], v[76:79], 0
    v_mfma_f32_16x16x32_bf16 a[164:167], v[148:151], v[80:83], 0
    ds_read_b128 v[124:127], v7 offset:33024
    s_waitcnt lgkmcnt(7)
    v_mfma_f32_16x16x32_bf16 a[168:171], v[152:155], v[72:75], 0
    v_mfma_f32_16x16x32_bf16 a[172:175], v[152:155], v[76:79], 0
    v_mfma_f32_16x16x32_bf16 a[176:179], v[152:155], v[80:83], 0
    v_mfma_f32_16x16x32_bf16 a[180:183], v[156:159], v[72:75], 0
    v_mfma_f32_16x16x32_bf16 a[184:187], v[156:159], v[76:79], 0
    v_mfma_f32_16x16x32_bf16 a[188:191], v[156:159], v[80:83], 0
    s_cbranch_vccnz L_rare_p0
L_back_p0:
    s_mov_b32 s34, 3
L_loop:
    s_barrier
    s_waitcnt lgkmcnt(6)
    v_mfma_f32_16x16x32_bf16 v[24:27], v[96:99], v[160:163], v[84:87]
    v_exp_f32 v48, v48
    v_mfma_f32_16x16x32_bf16 v[32:35], v[96:99], v[192:195], v[88:91]
    v_exp_f32 v49, v49
    v_mfma_f32_16x16x32_bf16 v[40:43], v[96:99], v[224:227], v[92:95]
    v_cvt_pk_bf16_f32 v72, v48, v49
    ds_read_b128 v[96:99], v4 offset:40960
    v_mfma_f32_16x16x32_bf16 v[24:27], v[100:103], v[164:167], v[24:27]
    v_mfma_f32_16x16x32_bf16 v[32:35], v[100:103], v[196:199], v[32:35]
    v_exp_f32 v50, v50
    v_mfma_f32_16x16x32_bf16 v[40:43], v[100:103], v[228:231], v[40:43]
    v_exp_f32 v51, v51
    s_waitcnt lgkmcnt(5)
    v_mfma_f32_16x16x32_bf16 v[24:27], v[104:107], v[168:171], v[24:27]
    v_cvt_pk_bf16_f32 v73, v50, v51
    ds_read_b128 v[100:103], v5 offset:40960
    v_mfma_f32_16x16x32_bf16 v[32:35], v[104:107], v[200:203], v[32:35]
    v_mfma_f32_16x16x32_bf16 v[40:43], v[104:107], v[232:235], v[40:43]
    v_exp_f32 v52, v52
    v_mfma_f32_16x16x32_bf16 v[24:27], v[108:111], v[172:175], v[24:27]
    v_exp_f32 v53, v53
    v_mfma_f32_16x16x32_bf16 v[32:35], v[108:111], v[204:207], v[32:35]
    v_cvt_pk_bf16_f32 v74, v52, v53
    ds_read_b128 v[104:107], v6 offset:40960
    v_mfma_f32_16x16x32_bf16 v[40:43], v[108:111], v[236:239], v[40:43]
    ds_read_b128 v[108:111], v7 offset:40960
    s_waitcnt lgkmcnt(6)
    v_mfma_f32_16x16x32_bf16 v[24:27], v[112:115], v[176:179], v[24:27]
    v_exp_f32 v54, v54
    v_mfma_f32_16x16x32_bf16 v[32:35], v[112:115], v[208:211], v[32:35]
    v_exp_f32 v55, v55
    v_mfma_f32_16x16x32_bf16 v[40:43], v[112:115], v[240:243], v[40:43]
    v_cvt_pk_bf16_f32 v75, v54, v55
    ds_read_b128 v[112:115], v4 offset:41216
    v_mfma_f32_16x16x32_bf16 v[24:27], v[116:119], v[180:183], v[24:27]
    v_mfma_f32_16x16x32_bf16 v[32:35], v[116:119], v[212:215], v[32:35]
    v_exp_f32 v56, v56
    v_mfma_f32_16x16x32_bf16 v[40:43], v[116:119], v[244:247], v[40:43]
    v_exp_f32 v57, v57
    s_waitcnt lgkmcnt(5)
    v_mfma_f32_16x16x32_bf16 v[24:27], v[120:123], v[184:187], v[24:27]
    v_cvt_pk_bf16_f32 v76, v56, v57
    ds_read_b128 v[116:119], v5 offset:41216
    v_mfma_f32_16x16x32_bf16 v[32:35], v[120:123], v[216:219], v[32:35]
    v_mfma_f32_16x16x32_bf16 v[40:43], v[120:123], v[248:251], v[40:43]
    v_exp_f32 v58, v58
    v_mfma_f32_16x16x32_bf16 v[24:27], v[124:127], v[188:191], v[24:27]
    v_exp_f32 v59, v59
    v_mfma_f32_16x16x32_bf16 v[32:35], v[124:127], v[220:223], v[32:35]
    v_cvt_pk_bf16_f32 v77, v58, v59
    ds_read_b128 v[120:123], v6 offset:41216
    v_mfma_f32_16x16x32_bf16 v[40:43], v[124:127], v[252:255], v[40:43]
    ds_read_b128 v[124:127], v7 offset:41216
    s_waitcnt lgkmcnt(6)
    v_mfma_f32_16x16x32_bf16 v[28:31], v[96:99], v[160:163], v[84:87]
    v_exp_f32 v60, v60
    v_mfma_f32_16x16x32_bf16 v[36:39], v[96:99], v[192:195], v[88:91]
    v_exp_f32 v61, v61
    v_mfma_f32_16x16x32_bf16 v[44:47], v[96:99], v[224:227], v[92:95]
    v_cvt_pk_bf16_f32 v78, v60, v61
    ds_read_b64_tr_b16 v[128:129], v8 offset:16384
    v_mfma_f32_16x16x32_bf16 v[28:31], v[100:103], v[164:167], v[28:31]
    ds_read_b64_tr_b16 v[130:131], v8 offset:24576
    v_mfma_f32_16x16x32_bf16 v[36:39], v[100:103], v[196:199], v[36:39]
    v_exp_f32 v62, v62
    v_mfma_f32_16x16x32_bf16 v[44:47], v[100:103], v[228:231], v[44:47]
    v_exp_f32 v63, v63
    s_waitcnt lgkmcnt(6)
    v_mfma_f32_16x16x32_bf16 v[28:31], v[104:107], v[168:171], v[28:31]
    v_cvt_pk_bf16_f32 v79, v62, v63
    ds_read_b64_tr_b16 v[132:133], v9 offset:16384
    v_mfma_f32_16x16x32_bf16 v[36:39], v[104:107], v[200:203], v[36:39]
    ds_read_b64_tr_b16 v[134:135], v9 offset:24576
    v_mfma_f32_16x16x32_bf16 v[44:47], v[104:107], v[232:235], v[44:47]
    v_exp_f32 v64, v64
    v_mfma_f32_16x16x32_bf16 v[28:31], v[108:111], v[172:175], v[28:31]
    v_exp_f32 v65, v65
    v_mfma_f32_16x16x32_bf16 v[36:39], v[108:111], v[204:207], v[36:39]
    v_cvt_pk_bf16_f32 v80, v64, v65
    ds_read_b64_tr_b16 v[136:137], v10 offset:16384
    v_mfma_f32_16x16x32_bf16 v[44:47], v[108:111], v[236:239], v[44:47]
    ds_read_b64_tr_b16 v[138:139], v10 offset:24576
    s_waitcnt lgkmcnt(8)
    v_mfma_f32_16x16x32_bf16 v[28:31], v[112:115], v[176:179], v[28:31]
    v_exp_f32 v66, v66
    v_mfma_f32_16x16x32_bf16 v[36:39], v[112:115], v[208:211], v[36:39]
    v_exp_f32 v67, v67
    v_mfma_f32_16x16x32_bf16 v[44:47], v[112:115], v[240:243], v[44:47]
    v_cvt_pk_bf16_f32 v81, v66, v67
    ds_read_b64_tr_b16 v[140:141], v11 offset:16384
    v_mfma_f32_16x16x32_bf16 v[28:31], v[116:119], v[180:183], v[28:31]
    ds_read_b64_tr_b16 v[142:143], v11 offset:24576
    v_mfma_f32_16x16x32_bf16 v[36:39], v[116:119], v[212:215], v[36:39]
    v_exp_f32 v68, v68
    v_mfma_f32_16x16x32_bf16 v[44:47], v[116:119], v[244:247], v[44:47]
    v_exp_f32 v69, v69
    s_waitcnt lgkmcnt(8)
    v_mfma_f32_16x16x32_bf16 v[28:31], v[120:123], v[184:187], v[28:31]
    v_cvt_pk_bf16_f32 v82, v68, v69
    v_mfma_f32_16x16x32_bf16 v[36:39], v[120:123], v[216:219], v[36:39]
    v_mfma_f32_16x16x32_bf16 v[44:47], v[120:123], v[248:251], v[44:47]
    v_exp_f32 v70, v70
    v_mfma_f32_16x16x32_bf16 v[28:31], v[124:127], v[188:191], v[28:31]
    v_exp_f32 v71, v71
    v_mfma_f32_16x16x32_bf16 v[36:39], v[124:127], v[220:223], v[36:39]
    v_cvt_pk_bf16_f32 v83, v70, v71
    v_mfma_f32_16x16x32_bf16 v[44:47], v[124:127], v[252:255], v[44:47]
    s_nop 1
    v_mfma_f32_16x16x32_bf16 a[192:195], a[204:207], v[72:75], a[192:195]
    ds_read_b64_tr_b16 v[144:145], v12 offset:16384
    v_mfma_f32_16x16x32_bf16 a[196:199], a[204:207], v[76:79], a[196:199]
    ds_read_b64_tr_b16 v[146:147], v12 offset:24576
    v_mfma_f32_16x16x32_bf16 a[200:203], a[204:207], v[80:83], a[200:203]
    s_waitcnt lgkmcnt(6)
    v_mfma_f32_16x16x32_bf16 a[0:3], v[128:131], v[72:75], a[0:3]
    ds_read_b64_tr_b16 v[148:149], v13 offset:16384
    v_mfma_f32_16x16x32_bf16 a[4:7], v[128:131], v[76:79], a[4:7]
    ds_read_b64_tr_b16 v[150:151], v13 offset:24576
    v_mfma_f32_16x16x32_bf16 a[8:11], v[128:131], v[80:83], a[8:11]
    v_mfma_f32_16x16x32_bf16 a[12:15], v[132:135], v[72:75], a[12:15]
    ds_read_b64_tr_b16 v[152:153], v14 offset:16384
    v_max3_f32 v16, v24, v25, v26
    v_mfma_f32_16x16x32_bf16 a[16:19], v[132:135], v[76:79], a[16:19]
    ds_read_b64_tr_b16 v[154:155], v14 offset:24576
    v_mfma_f32_16x16x32_bf16 a[20:23], v[132:135], v[80:83], a[20:23]
    v_max3_f32 v16, v16, v27, v28
    s_waitcnt lgkmcnt(6)
    v_mfma_f32_16x16x32_bf16 a[24:27], v[136:139], v[72:75], a[24:27]
    ds_read_b64_tr_b16 v[156:157], v15 offset:16384
    v_mfma_f32_16x16x32_bf16 a[28:31], v[136:139], v[76:79], a[28:31]
    ds_read_b64_tr_b16 v[158:159], v15 offset:24576
    v_max3_f32 v16, v16, v29, v30
    v_mfma_f32_16x16x32_bf16 a[32:35], v[136:139], v[80:83], a[32:35]
    v_mfma_f32_16x16x32_bf16 a[36:39], v[140:143], v[72:75], a[36:39]
    ds_read_b64_tr_b16 v[128:129], v8 offset:16640
    v_max3_f32 v16, v16, v31, v32
    v_mfma_f32_16x16x32_bf16 a[40:43], v[140:143], v[76:79], a[40:43]
    ds_read_b64_tr_b16 v[130:131], v8 offset:24832
    v_mfma_f32_16x16x32_bf16 a[44:47], v[140:143], v[80:83], a[44:47]
    v_max3_f32 v16, v16, v33, v34
    s_waitcnt lgkmcnt(6)
    v_mfma_f32_16x16x32_bf16 a[48:51], v[144:147], v[72:75], a[48:51]
    ds_read_b64_tr_b16 v[132:133], v9 offset:16640
    v_mfma_f32_16x16x32_bf16 a[52:55], v[144:147], v[76:79], a[52:55]
    ds_read_b64_tr_b16 v[134:135], v9 offset:24832
    v_max3_f32 v16, v16, v35, v36
    v_mfma_f32_16x16x32_bf16 a[56:59], v[144:147], v[80:83], a[56:59]
    v_mfma_f32_16x16x32_bf16 a[60:63], v[148:151], v[72:75], a[60:63]
    ds_read_b64_tr_b16 v[136:137], v10 offset:16640
    v_max3_f32 v16, v16, v37, v38
    v_mfma_f32_16x16x32_bf16 a[64:67], v[148:151], v[76:79], a[64:67]
    ds_read_b64_tr_b16 v[138:139], v10 offset:24832
    v_mfma_f32_16x16x32_bf16 a[68:71], v[148:151], v[80:83], a[68:71]
    v_max3_f32 v16, v16, v39, v40
    s_waitcnt lgkmcnt(6)
    v_mfma_f32_16x16x32_bf16 a[72:75], v[152:155], v[72:75], a[72:75]
    ds_read_b64_tr_b16 v[140:141], v11 offset:16640
    v_mfma_f32_16x16x32_bf16 a[76:79], v[152:155], v[76:79], a[76:79]
    ds_read_b64_tr_b16 v[142:143], v11 offset:24832
    v_max3_f32 v16, v16, v41, v42
    v_mfma_f32_16x16x32_bf16 a[80:83], v[152:155], v[80:83], a[80:83]
    v_mfma_f32_16x16x32_bf16 a[84:87], v[156:159], v[72:75], a[84:87]
    ds_read_b64_tr_b16 v[144:145], v12 offset:16640
    v_max3_f32 v16, v16, v43, v44
    v_mfma_f32_16x16x32_bf16 a[88:91], v[156:159], v[76:79], a[88:91]
    ds_read_b64_tr_b16 v[146:147], v12 offset:24832
    v_mfma_f32_16x16x32_bf16 a[92:95], v[156:159], v[80:83], a[92:95]
    v_max3_f32 v16, v16, v45, v46
    s_waitcnt lgkmcnt(6)
    v_mfma_f32_16x16x32_bf16 a[96:99], v[128:131], v[72:75], a[96:99]
    ds_read_b64_tr_b16 v[148:149], v13 offset:16640
    v_mfma_f32_16x16x32_bf16 a[100:103], v[128:131], v[76:79], a[100:103]
    ds_read_b64_tr_b16 v[150:151], v13 offset:24832
    v_max_f32 v16, v16, v47
    v_mfma_f32_16x16x32_bf16 a[104:107], v[128:131], v[80:83], a[104:107]
    v_mfma_f32_16x16x32_bf16 a[108:111], v[132:135], v[72:75], a[108:111]
    ds_read_b64_tr_b16 v[152:153], v14 offset:16640
    v_cmp_lt_f32 vcc, s31, v16
    v_mfma_f32_16x16x32_bf16 a[112:115], v[132:135], v[76:79], a[112:115]
    ds_read_b64_tr_b16 v[154:155], v14 offset:24832
    v_mfma_f32_16x16x32_bf16 a[116:119], v[132:135], v[80:83], a[116:119]
    ds_read_b128 v[96:99], v4 offset:49152
    s_waitcnt lgkmcnt(7)
    v_mfma_f32_16x16x32_bf16 a[120:123], v[136:139], v[72:75], a[120:123]
    ds_read_b64_tr_b16 v[156:157], v15 offset:16640
    v_mfma_f32_16x16x32_bf16 a[124:127], v[136:139], v[76:79], a[124:127]
    ds_read_b64_tr_b16 v[158:159], v15 offset:24832
    v_mfma_f32_16x16x32_bf16 a[128:131], v[136:139], v[80:83], a[128:131]
    ds_read_b128 v[100:103], v5 offset:49152
    v_mfma_f32_16x16x32_bf16 a[132:135], v[140:143], v[72:75], a[132:135]
    ds_read_b128 v[104:107], v6 offset:49152
    v_mfma_f32_16x16x32_bf16 a[136:139], v[140:143], v[76:79], a[136:139]
    ds_read_b128 v[108:111], v7 offset:49152
    v_mfma_f32_16x16x32_bf16 a[140:143], v[140:143], v[80:83], a[140:143]
    ds_read_b128 v[112:115], v4 offset:49408
    s_waitcnt lgkmcnt(9)
    v_mfma_f32_16x16x32_bf16 a[144:147], v[144:147], v[72:75], a[144:147]
    v_mfma_f32_16x16x32_bf16 a[148:151], v[144:147], v[76:79], a[148:151]
    ds_read_b128 v[116:119], v5 offset:49408
    v_mfma_f32_16x16x32_bf16 a[152:155], v[144:147], v[80:83], a[152:155]
    v_mfma_f32_16x16x32_bf16 a[156:159], v[148:151], v[72:75], a[156:159]
    ds_read_b128 v[120:123], v6 offset:49408
    v_mfma_f32_16x16x32_bf16 a[160:163], v[148:151], v[76:79], a[160:163]
    v_mfma_f32_16x16x32_bf16 a[164:167], v[148:151], v[80:83], a[164:167]
    ds_read_b128 v[124:127], v7 offset:49408
    s_waitcnt lgkmcnt(7)
    v_mfma_f32_16x16x32_bf16 a[168:171], v[152:155], v[72:75], a[168:171]
    v_mfma_f32_16x16x32_bf16 a[172:175], v[152:155], v[76:79], a[172:175]
    v_mfma_f32_16x16x32_bf16 a[176:179], v[152:155], v[80:83], a[176:179]
    v_mfma_f32_16x16x32_bf16 a[180:183], v[156:159], v[72:75], a[180:183]
    v_mfma_f32_16x16x32_bf16 a[184:187], v[156:159], v[76:79], a[184:187]
    v_mfma_f32_16x16x32_bf16 a[188:191], v[156:159], v[80:83], a[188:191]
    s_cbranch_vccnz L_rare_L_loop_1
L_back_L_loop_1:
    s_barrier
    s_waitcnt lgkmcnt(6)
    v_mfma_f32_16x16x32_bf16 v[48:51], v[96:99], v[160:163], v[84:87]
    v_exp_f32 v24, v24
    v_mfma_f32_16x16x32_bf16 v[56:59], v[96:99], v[192:195], v[88:91]
    v_exp_f32 v25, v25
    v_mfma_f32_16x16x32_bf16 v[64:67], v[96:99], v[224:227], v[92:95]
    v_cvt_pk_bf16_f32 v72, v24, v25
    ds_read_b128 v[96:99], v4 offset:57344
    v_mfma_f32_16x16x32_bf16 v[48:51], v[100:103], v[164:167], v[48:51]
    v_mfma_f32_16x16x32_bf16 v[56:59], v[100:103], v[196:199], v[56:59]
    v_exp_f32 v26, v26
    v_mfma_f32_16x16x32_bf16 v[64:67], v[100:103], v[228:231], v[64:67]
    v_exp_f32 v27, v27
    s_waitcnt lgkmcnt(5)
    v_mfma_f32_16x16x32_bf16 v[48:51], v[104:107], v[168:171], v[48:51]
    v_cvt_pk_bf16_f32 v73, v26, v27
    ds_read_b128 v[100:103], v5 offset:57344
    v_mfma_f32_16x16x32_bf16 v[56:59], v[104:107], v[200:203], v[56:59]
    v_mfma_f32_16x16x32_bf16 v[64:67], v[104:107], v[232:235], v[64:67]
    v_exp_f32 v28, v28
    v_mfma_f32_16x16x32_bf16 v[48:51], v[108:111], v[172:175], v[48:51]
    v_exp_f32 v29, v29
    v_mfma_f32_16x16x32_bf16 v[56:59], v[108:111], v[204:207], v[56:59]
    v_cvt_pk_bf16_f32 v74, v28, v29
    ds_read_b128 v[104:107], v6 offset:57344
    v_mfma_f32_16x16x32_bf16 v[64:67], v[108:111], v[236:239], v[64:67]
    ds_read_b128 v[108:111], v7 offset:57344
    s_waitcnt lgkmcnt(6)
    v_mfma_f32_16x16x32_bf16 v[48:51], v[112:115], v[176:179], v[48:51]
    v_exp_f32 v30, v30
    v_mfma_f32_16x16x32_bf16 v[56:59], v[112:115], v[208:211], v[56:59]
    v_exp_f32 v31, v31
    v_mfma_f32_16x16x32_bf16 v[64:67], v[112:115], v[240:243], v[64:67]
    v_cvt_pk_bf16_f32 v75, v30, v31
    ds_read_b128 v[112:115], v4 offset:57600
    v_mfma_f32_16x16x32_bf16 v[48:51], v[116:119], v[180:183], v[48:51]
    v_mfma_f32_16x16x32_bf16 v[56:59], v[116:119], v[212:215], v[56:59]
    v_exp_f32 v32, v32
    v_mfma_f32_16x16x32_bf16 v[64:67], v[116:119], v[244:247], v[64:67]
    v_exp_f32 v33, v33
    s_waitcnt lgkmcnt(5)
    v_mfma_f32_16x16x32_bf16 v[48:51], v[120:123], v[184:187], v[48:51]
    v_cvt_pk_bf16_f32 v76, v32, v33
    ds_read_b128 v[116:119], v5 offset:57600
    v_mfma_f32_16x16x32_bf16 v[56:59], v[120:123], v[216:219], v[56:59]
    v_mfma_f32_16x16x32_bf16 v[64:67], v[120:123], v[248:251], v[64:67]
    v_exp_f32 v34, v34
    v_mfma_f32_16x16x32_bf16 v[48:51], v[124:127], v[188:191], v[48:51]
    v_exp_f32 v35, v35
    v_mfma_f32_16x16x32_bf16 v[56:59], v[124:127], v[220:223], v[56:59]
    v_cvt_pk_bf16_f32 v77, v34, v35
    ds_read_b128 v[120:123], v6 offset:57600
    v_mfma_f32_16x16x32_bf16 v[64:67], v[124:127], v[252:255], v[64:67]
    ds_read_b128 v[124:127], v7 offset:57600
    s_waitcnt lgkmcnt(6)
    v_mfma_f32_16x16x32_bf16 v[52:55], v[96:99], v[160:163], v[84:87]
    v_exp_f32 v36, v36
    v_mfma_f32_16x16x32_bf16 v[60:63], v[96:99], v[192:195], v[88:91]
    v_exp_f32 v37, v37
    v_mfma_f32_16x16x32_bf16 v[68:71], v[96:99], v[224:227], v[92:95]
    v_cvt_pk_bf16_f32 v78, v36, v37
    ds_read_b64_tr_b16 v[128:129], v8 offset:32768
    v_mfma_f32_16x16x32_bf16 v[52:55], v[100:103], v[164:167], v[52:55]
    ds_read_b64_tr_b16 v[130:131], v8 offset:40960
    v_mfma_f32_16x16x32_bf16 v[60:63], v[100:103], v[196:199], v[60:63]
    v_exp_f32 v38, v38
    v_mfma_f32_16x16x32_bf16 v[68:71], v[100:103], v[228:231], v[68:71]
    v_exp_f32 v39, v39
    s_waitcnt lgkmcnt(6)
    v_mfma_f32_16x16x32_bf16 v[52:55], v[104:107], v[168:171], v[52:55]
    v_cvt_pk_bf16_f32 v79, v38, v39
    ds_read_b64_tr_b16 v[132:133], v9 offset:32768
    v_mfma_f32_16x16x32_bf16 v[60:63], v[104:107], v[200:203], v[60:63]
    ds_read_b64_tr_b16 v[134:135], v9 offset:40960
    v_mfma_f32_16x16x32_bf16 v[68:71], v[104:107], v[232:235], v[68:71]
    v_exp_f32 v40, v40
    v_mfma_f32_16x16x32_bf16 v[52:55], v[108:111], v[172:175], v[52:55]
    v_exp_f32 v41, v41
    v_mfma_f32_16x16x32_bf16 v[60:63], v[108:111], v[204:207], v[60:63]
    v_cvt_pk_bf16_f32 v80, v40, v41
    ds_read_b64_tr_b16 v[136:137], v10 offset:32768
    v_mfma_f32_16x16x32_bf16 v[68:71], v[108:111], v[236:239], v[68:71]
    ds_read_b64_tr_b16 v[138:139], v10 offset:40960
    s_waitcnt lgkmcnt(8)
    v_mfma_f32_16x16x32_bf16 v[52:55], v[112:115], v[176:179], v[52:55]
    v_exp_f32 v42, v42
    v_mfma_f32_16x16x32_bf16 v[60:63], v[112:115], v[208:211], v[60:63]
    v_exp_f32 v43, v43
    v_mfma_f32_16x16x32_bf16 v[68:71], v[112:115], v[240:243], v[68:71]
    v_cvt_pk_bf16_f32 v81, v42, v43
    ds_read_b64_tr_b16 v[140:141], v11 offset:32768
    v_mfma_f32_16x16x32_bf16 v[52:55], v[116:119], v[180:183], v[52:55]
    ds_read_b64_tr_b16 v[142:143], v11 offset:40960
    v_mfma_f32_16x16x32_bf16 v[60:63], v[116:119], v[212:215], v[60:63]
    v_exp_f32 v44, v44
    v_mfma_f32_16x16x32_bf16 v[68:71], v[116:119], v[244:247], v[68:71]
    v_exp_f32 v45, v45
    s_waitcnt lgkmcnt(8)
    v_mfma_f32_16x16x32_bf16 v[52:55], v[120:123], v[184:187], v[52:55]
    v_cvt_pk_bf16_f32 v82, v44, v45
    v_mfma_f32_16x16x32_bf16 v[60:63], v[120:123], v[216:219], v[60:63]
    v_mfma_f32_16x16x32_bf16 v[68:71], v[120:123], v[248:251], v[68:71]
    v_exp_f32 v46, v46
    v_mfma_f32_16x16x32_bf16 v[52:55], v[124:127], v[188:191], v[52:55]
    v_exp_f32 v47, v47
    v_mfma_f32_16x16x32_bf16 v[60:63], v[124:127], v[220:223], v[60:63]
    v_cvt_pk_bf16_f32 v83, v46, v47
    v_mfma_f32_16x16x32_bf16 v[68:71], v[124:127], v[252:255], v[68:71]
    s_nop 1
    v_mfma_f32_16x16x32_bf16 a[192:195], a[204:207], v[72:75], a[192:195]
    ds_read_b64_tr_b16 v[144:145], v12 offset:32768
    v_mfma_f32_16x16x32_bf16 a[196:199], a[204:207], v[76:79], a[196:199]
    ds_read_b64_tr_b16 v[146:147], v12 offset:40960
    v_mfma_f32_16x16x32_bf16 a[200:203], a[204:207], v[80:83], a[200:203]
    s_waitcnt lgkmcnt(6)
    v_mfma_f32_16x16x32_bf16 a[0:3], v[128:131], v[72:75], a[0:3]
    ds_read_b64_tr_b16 v[148:149], v13 offset:32768
    v_mfma_f32_16x16x32_bf16 a[4:7], v[128:131], v[76:79], a[4:7]
    ds_read_b64_tr_b16 v[150:151], v13 offset:40960
    v_mfma_f32_16x16x32_bf16 a[8:11], v[128:131], v[80:83], a[8:11]
    v_mfma_f32_16x16x32_bf16 a[12:15], v[132:135], v[72:75], a[12:15]
    ds_read_b64_tr_b16 v[152:153], v14 offset:32768
    v_max3_f32 v16, v48, v49, v50
    v_mfma_f32_16x16x32_bf16 a[16:19], v[132:135], v[76:79], a[16:19]
    ds_read_b64_tr_b16 v[154:155], v14 offset:40960
    v_mfma_f32_16x16x32_bf16 a[20:23], v[132:135], v[80:83], a[20:23]
    v_max3_f32 v16, v16, v51, v52
    s_waitcnt lgkmcnt(6)
    v_mfma_f32_16x16x32_bf16 a[24:27], v[136:139], v[72:75], a[24:27]
    ds_read_b64_tr_b16 v[156:157], v15 offset:32768
    v_mfma_f32_16x16x32_bf16 a[28:31], v[136:139], v[76:79], a[28:31]
    ds_read_b64_tr_b16 v[158:159], v15 offset:40960
    v_max3_f32 v16, v16, v53, v54
    v_mfma_f32_16x16x32_bf16 a[32:35], v[136:139], v[80:83], a[32:35]
    v_mfma_f32_16x16x32_bf16 a[36:39], v[140:143], v[72:75], a[36:39]
    ds_read_b64_tr_b16 v[128:129], v8 offset:33024
    v_max3_f32 v16, v16, v55, v56
    v_mfma_f32_16x16x32_bf16 a[40:43], v[140:143], v[76:79], a[40:43]
    ds_read_b64_tr_b16 v[130:131], v8 offset:41216
    v_mfma_f32_16x16x32_bf16 a[44:47], v[140:143], v[80:83], a[44:47]
    v_max3_f32 v16, v16, v57, v58
    s_waitcnt lgkmcnt(6)
    v_mfma_f32_16x16x32_bf16 a[48:51], v[144:147], v[72:75], a[48:51]
    ds_read_b64_tr_b16 v[132:133], v9 offset:33024
    v_mfma_f32_16x16x32_bf16 a[52:55], v[144:147], v[76:79], a[52:55]
    ds_read_b64_tr_b16 v[134:135], v9 offset:41216
    v_max3_f32 v16, v16, v59, v60
    v_mfma_f32_16x16x32_bf16 a[56:59], v[144:147], v[80:83], a[56:59]
    v_mfma_f32_16x16x32_bf16 a[60:63], v[148:151], v[72:75], a[60:63]
    ds_read_b64_tr_b16 v[136:137], v10 offset:33024
    v_max3_f32 v16, v16, v61, v62
    v_mfma_f32_16x16x32_bf16 a[64:67], v[148:151], v[76:79], a[64:67]
    ds_read_b64_tr_b16 v[138:139], v10 offset:41216
    v_mfma_f32_16x16x32_bf16 a[68:71], v[148:151], v[80:83], a[68:71]
    v_max3_f32 v16, v16, v63, v64
    s_waitcnt lgkmcnt(6)
    v_mfma_f32_16x16x32_bf16 a[72:75], v[152:155], v[72:75], a[72:75]
    ds_read_b64_tr_b16 v[140:141], v11 offset:33024
    v_mfma_f32_16x16x32_bf16 a[76:79], v[152:155], v[76:79], a[76:79]
    ds_read_b64_tr_b16 v[142:143], v11 offset:41216
    v_max3_f32 v16, v16, v65, v66
    v_mfma_f32_16x16x32_bf16 a[80:83], v[152:155], v[80:83], a[80:83]
    v_mfma_f32_16x16x32_bf16 a[84:87], v[156:159], v[72:75], a[84:87]
    ds_read_b64_tr_b16 v[144:145], v12 offset:33024
    v_max3_f32 v16, v16, v67, v68
    v_mfma_f32_16x16x32_bf16 a[88:91], v[156:159], v[76:79], a[88:91]
    ds_read_b64_tr_b16 v[146:147], v12 offset:41216
    v_mfma_f32_16x16x32_bf16 a[92:95], v[156:159], v[80:83], a[92:95]
    v_max3_f32 v16, v16, v69, v70
    s_waitcnt lgkmcnt(6)
    v_mfma_f32_16x16x32_bf16 a[96:99], v[128:131], v[72:75], a[96:99]
    ds_read_b64_tr_b16 v[148:149], v13 offset:33024
    v_mfma_f32_16x16x32_bf16 a[100:103], v[128:131], v[76:79], a[100:103]
    ds_read_b64_tr_b16 v[150:151], v13 offset:41216
    v_max_f32 v16, v16, v71
    v_mfma_f32_16x16x32_bf16 a[104:107], v[128:131], v[80:83], a[104:107]
    v_mfma_f32_16x16x32_bf16 a[108:111], v[132:135], v[72:75], a[108:111]
    ds_read_b64_tr_b16 v[152:153], v14 offset:33024
    v_cmp_lt_f32 vcc, s31, v16
    v_mfma_f32_16x16x32_bf16 a[112:115], v[132:135], v[76:79], a[112:115]
    ds_read_b64_tr_b16 v[154:155], v14 offset:41216
    v_mfma_f32_16x16x32_bf16 a[116:119], v[132:135], v[80:83], a[116:119]
    ds_read_b128 v[96:99], v4 offset:0
    s_waitcnt lgkmcnt(7)
    v_mfma_f32_16x16x32_bf16 a[120:123], v[136:139], v[72:75], a[120:123]
    ds_read_b64_tr_b16 v[156:157], v15 offset:33024
    v_mfma_f32_16x16x32_bf16 a[124:127], v[136:139], v[76:79], a[124:127]
    ds_read_b64_tr_b16 v[158:159], v15 offset:41216
    v_mfma_f32_16x16x32_bf16 a[128:131], v[136:139], v[80:83], a[128:131]
    ds_read_b128 v[100:103], v5 offset:0
    v_mfma_f32_16x16x32_bf16 a[132:135], v[140:143], v[72:75], a[132:135]
    ds_read_b128 v[104:107], v6 offset:0
    v_mfma_f32_16x16x32_bf16 a[136:139], v[140:143], v[76:79], a[136:139]
    ds_read_b128 v[108:111], v7 offset:0
    v_mfma_f32_16x16x32_bf16 a[140:143], v[140:143], v[80:83], a[140:143]
    ds_read_b128 v[112:115], v4 offset:256
    s_waitcnt lgkmcnt(9)
    v_mfma_f32_16x16x32_bf16 a[144:147], v[144:147], v[72:75], a[144:147]
    v_mfma_f32_16x16x32_bf16 a[148:151], v[144:147], v[76:79], a[148:151]
    ds_read_b128 v[116:119], v5 offset:256
    v_mfma_f32_16x16x32_bf16 a[152:155], v[144:147], v[80:83], a[152:155]
    v_mfma_f32_16x16x32_bf16 a[156:159], v[148:151], v[72:75], a[156:159]
    ds_read_b128 v[120:123], v6 offset:256
    v_mfma_f32_16x16x32_bf16 a[160:163], v[148:151], v[76:79], a[160:163]
    v_mfma_f32_16x16x32_bf16 a[164:167], v[148:151], v[80:83], a[164:167]
    ds_read_b128 v[124:127], v7 offset:256
    s_waitcnt lgkmcnt(7)
    v_mfma_f32_16x16x32_bf16 a[168:171], v[152:155], v[72:75], a[168:171]
    v_mfma_f32_16x16x32_bf16 a[172:175], v[152:155], v[76:79], a[172:175]
    v_mfma_f32_16x16x32_bf16 a[176:179], v[152:155], v[80:83], a[176:179]
    v_mfma_f32_16x16x32_bf16 a[180:183], v[156:159], v[72:75], a[180:183]
    v_mfma_f32_16x16x32_bf16 a[184:187], v[156:159], v[76:79], a[184:187]
    v_mfma_f32_16x16x32_bf16 a[188:191], v[156:159], v[80:83], a[188:191]
    s_cbranch_vccnz L_rare_L_loop_2
L_back_L_loop_2:
    s_barrier
    s_waitcnt lgkmcnt(6)
    v_mfma_f32_16x16x32_bf16 v[24:27], v[96:99], v[160:163], v[84:87]
    v_exp_f32 v48, v48
    v_mfma_f32_16x16x32_bf16 v[32:35], v[96:99], v[192:195], v[88:91]
    v_exp_f32 v49, v49
    v_mfma_f32_16x16x32_bf16 v[40:43], v[96:99], v[224:227], v[92:95]
    v_cvt_pk_bf16_f32 v72, v48, v49
    ds_read_b128 v[96:99], v4 offset:8192
    v_mfma_f32_16x16x32_bf16 v[24:27], v[100:103], v[164:167], v[24:27]
    v_mfma_f32_16x16x32_bf16 v[32:35], v[100:103], v[196:199], v[32:35]
    v_exp_f32 v50, v50
    v_mfma_f32_16x16x32_bf16 v[40:43], v[100:103], v[228:231], v[40:43]
    v_exp_f32 v51, v51
    s_waitcnt lgkmcnt(5)
    v_mfma_f32_16x16x32_bf16 v[24:27], v[104:107], v[168:171], v[24:27]
    v_cvt_pk_bf16_f32 v73, v50, v51
    ds_read_b128 v[100:103], v5 offset:8192
    v_mfma_f32_16x16x32_bf16 v[32:35], v[104:107], v[200:203], v[32:35]
    v_mfma_f32_16x16x32_bf16 v[40:43], v[104:107], v[232:235], v[40:43]
    v_exp_f32 v52, v52
    v_mfma_f32_16x16x32_bf16 v[24:27], v[108:111], v[172:175], v[24:27]
    v_exp_f32 v53, v53
    v_mfma_f32_16x16x32_bf16 v[32:35], v[108:111], v[204:207], v[32:35]
    v_cvt_pk_bf16_f32 v74, v52, v53
    ds_read_b128 v[104:107], v6 offset:8192
    v_mfma_f32_16x16x32_bf16 v[40:43], v[108:111], v[236:239], v[40:43]
    ds_read_b128 v[108:111], v7 offset:8192
    s_waitcnt lgkmcnt(6)
    v_mfma_f32_16x16x32_bf16 v[24:27], v[112:115], v[176:179], v[24:27]
    v_exp_f32 v54, v54
    v_mfma_f32_16x16x32_bf16 v[32:35], v[112:115], v[208:211], v[32:35]
    v_exp_f32 v55, v55
    v_mfma_f32_16x16x32_bf16 v[40:43], v[112:115], v[240:243], v[40:43]
    v_cvt_pk_bf16_f32 v75, v54, v55
    ds_read_b128 v[112:115], v4 offset:8448
    v_mfma_f32_16x16x32_bf16 v[24:27], v[116:119], v[180:183], v[24:27]
    v_mfma_f32_16x16x32_bf16 v[32:35], v[116:119], v[212:215], v[32:35]
    v_exp_f32 v56, v56
    v_mfma_f32_16x16x32_bf16 v[40:43], v[116:119], v[244:247], v[40:43]
    v_exp_f32 v57, v57
    s_waitcnt lgkmcnt(5)
    v_mfma_f32_16x16x32_bf16 v[24:27], v[120:123], v[184:187], v[24:27]
    v_cvt_pk_bf16_f32 v76, v56, v57
    ds_read_b128 v[116:119], v5 offset:8448
    v_mfma_f32_16x16x32_bf16 v[32:35], v[120:123], v[216:219], v[32:35]
    v_mfma_f32_16x16x32_bf16 v[40:43], v[120:123], v[248:251], v[40:43]
    v_exp_f32 v58, v58
    v_mfma_f32_16x16x32_bf16 v[24:27], v[124:127], v[188:191], v[24:27]
    v_exp_f32 v59, v59
    v_mfma_f32_16x16x32_bf16 v[32:35], v[124:127], v[220:223], v[32:35]
    v_cvt_pk_bf16_f32 v77, v58, v59
    ds_read_b128 v[120:123], v6 offset:8448
    v_mfma_f32_16x16x32_bf16 v[40:43], v[124:127], v[252:255], v[40:43]
    ds_read_b128 v[124:127], v7 offset:8448
    s_waitcnt lgkmcnt(6)
    v_mfma_f32_16x16x32_bf16 v[28:31], v[96:99], v[160:163], v[84:87]
    v_exp_f32 v60, v60
    v_mfma_f32_16x16x32_bf16 v[36:39], v[96:99], v[192:195], v[88:91]
    v_exp_f32 v61, v61
    v_mfma_f32_16x16x32_bf16 v[44:47], v[96:99], v[224:227], v[92:95]
    v_cvt_pk_bf16_f32 v78, v60, v61
    ds_read_b64_tr_b16 v[128:129], v8 offset:49152
    v_mfma_f32_16x16x32_bf16 v[28:31], v[100:103], v[164:167], v[28:31]
    ds_read_b64_tr_b16 v[130:131], v8 offset:57344
    v_mfma_f32_16x16x32_bf16 v[36:39], v[100:103], v[196:199], v[36:39]
    v_exp_f32 v62, v62
    v_mfma_f32_16x16x32_bf16 v[44:47], v[100:103], v[228:231], v[44:47]
    v_exp_f32 v63, v63
    s_waitcnt lgkmcnt(6)
    v_mfma_f32_16x16x32_bf16 v[28:31], v[104:107], v[168:171], v[28:31]
    v_cvt_pk_bf16_f32 v79, v62, v63
    ds_read_b64_tr_b16 v[132:133], v9 offset:49152
    v_mfma_f32_16x16x32_bf16 v[36:39], v[104:107], v[200:203], v[36:39]
    ds_read_b64_tr_b16 v[134:135], v9 offset:57344
    v_mfma_f32_16x16x32_bf16 v[44:47], v[104:107], v[232:235], v[44:47]
    v_exp_f32 v64, v64
    v_mfma_f32_16x16x32_bf16 v[28:31], v[108:111], v[172:175], v[28:31]
    v_exp_f32 v65, v65
    v_mfma_f32_16x16x32_bf16 v[36:39], v[108:111], v[204:207], v[36:39]
    v_cvt_pk_bf16_f32 v80, v64, v65
    ds_read_b64_tr_b16 v[136:137], v10 offset:49152
    v_mfma_f32_16x16x32_bf16 v[44:47], v[108:111], v[236:239], v[44:47]
    ds_read_b64_tr_b16 v[138:139], v10 offset:57344
    s_waitcnt lgkmcnt(8)
    v_mfma_f32_16x16x32_bf16 v[28:31], v[112:115], v[176:179], v[28:31]
    v_exp_f32 v66, v66
    v_mfma_f32_16x16x32_bf16 v[36:39], v[112:115], v[208:211], v[36:39]
    v_exp_f32 v67, v67
    v_mfma_f32_16x16x32_bf16 v[44:47], v[112:115], v[240:243], v[44:47]
    v_cvt_pk_bf16_f32 v81, v66, v67
    ds_read_b64_tr_b16 v[140:141], v11 offset:49152
    v_mfma_f32_16x16x32_bf16 v[28:31], v[116:119], v[180:183], v[28:31]
    ds_read_b64_tr_b16 v[142:143], v11 offset:57344
    v_mfma_f32_16x16x32_bf16 v[36:39], v[116:119], v[212:215], v[36:39]
    v_exp_f32 v68, v68
    v_mfma_f32_16x16x32_bf16 v[44:47], v[116:119], v[244:247], v[44:47]
    v_exp_f32 v69, v69
    s_waitcnt lgkmcnt(8)
    v_mfma_f32_16x16x32_bf16 v[28:31], v[120:123], v[184:187], v[28:31]
    v_cvt_pk_bf16_f32 v82, v68, v69
    v_mfma_f32_16x16x32_bf16 v[36:39], v[120:123], v[216:219], v[36:39]
    v_mfma_f32_16x16x32_bf16 v[44:47], v[120:123], v[248:251], v[44:47]
    v_exp_f32 v70, v70
    v_mfma_f32_16x16x32_bf16 v[28:31], v[124:127], v[188:191], v[28:31]
    v_exp_f32 v71, v71
    v_mfma_f32_16x16x32_bf16 v[36:39], v[124:127], v[220:223], v[36:39]
    v_cvt_pk_bf16_f32 v83, v70, v71
    v_mfma_f32_16x16x32_bf16 v[44:47], v[124:127], v[252:255], v[44:47]
    s_nop 1
    v_mfma_f32_16x16x32_bf16 a[192:195], a[204:207], v[72:75], a[192:195]
    ds_read_b64_tr_b16 v[144:145], v12 offset:49152
    v_mfma_f32_16x16x32_bf16 a[196:199], a[204:207], v[76:79], a[196:199]
    ds_read_b64_tr_b16 v[146:147], v12 offset:57344
    v_mfma_f32_16x16x32_bf16 a[200:203], a[204:207], v[80:83], a[200:203]
    s_waitcnt lgkmcnt(6)
    v_mfma_f32_16x16x32_bf16 a[0:3], v[128:131], v[72:75], a[0:3]
    ds_read_b64_tr_b16 v[148:149], v13 offset:49152
    v_mfma_f32_16x16x32_bf16 a[4:7], v[128:131], v[76:79], a[4:7]
    ds_read_b64_tr_b16 v[150:151], v13 offset:57344
    v_mfma_f32_16x16x32_bf16 a[8:11], v[128:131], v[80:83], a[8:11]
    v_mfma_f32_16x16x32_bf16 a[12:15], v[132:135], v[72:75], a[12:15]
    ds_read_b64_tr_b16 v[152:153], v14 offset:49152
    v_max3_f32 v16, v24, v25, v26
    v_mfma_f32_16x16x32_bf16 a[16:19], v[132:135], v[76:79], a[16:19]
    ds_read_b64_tr_b16 v[154:155], v14 offset:57344
    v_mfma_f32_16x16x32_bf16 a[20:23], v[132:135], v[80:83], a[20:23]
    v_max3_f32 v16, v16, v27, v28
    s_waitcnt lgkmcnt(6)
    v_mfma_f32_16x16x32_bf16 a[24:27], v[136:139], v[72:75], a[24:27]
    ds_read_b64_tr_b16 v[156:157], v15 offset:49152
    v_mfma_f32_16x16x32_bf16 a[28:31], v[136:139], v[76:79], a[28:31]
    ds_read_b64_tr_b16 v[158:159], v15 offset:57344
    v_max3_f32 v16, v16, v29, v30
    v_mfma_f32_16x16x32_bf16 a[32:35], v[136:139], v[80:83], a[32:35]
    v_mfma_f32_16x16x32_bf16 a[36:39], v[140:143], v[72:75], a[36:39]
    ds_read_b64_tr_b16 v[128:129], v8 offset:49408
    v_max3_f32 v16, v16, v31, v32
    v_mfma_f32_16x16x32_bf16 a[40:43], v[140:143], v[76:79], a[40:43]
    ds_read_b64_tr_b16 v[130:131], v8 offset:57600
    v_mfma_f32_16x16x32_bf16 a[44:47], v[140:143], v[80:83], a[44:47]
    v_max3_f32 v16, v16, v33, v34
    s_waitcnt lgkmcnt(6)
    v_mfma_f32_16x16x32_bf16 a[48:51], v[144:147], v[72:75], a[48:51]
    ds_read_b64_tr_b16 v[132:133], v9 offset:49408
    v_mfma_f32_16x16x32_bf16 a[52:55], v[144:147], v[76:79], a[52:55]
    ds_read_b64_tr_b16 v[134:135], v9 offset:57600
    v_max3_f32 v16, v16, v35, v36
    v_mfma_f32_16x16x32_bf16 a[56:59], v[144:147], v[80:83], a[56:59]
    v_mfma_f32_16x16x32_bf16 a[60:63], v[148:151], v[72:75], a[60:63]
    ds_read_b64_tr_b16 v[136:137], v10 offset:49408
    v_max3_f32 v16, v16, v37, v38
    v_mfma_f32_16x16x32_bf16 a[64:67], v[148:151], v[76:79], a[64:67]
    ds_read_b64_tr_b16 v[138:139], v10 offset:57600
    v_mfma_f32_16x16x32_bf16 a[68:71], v[148:151], v[80:83], a[68:71]
    v_max3_f32 v16, v16, v39, v40
    s_waitcnt lgkmcnt(6)
    v_mfma_f32_16x16x32_bf16 a[72:75], v[152:155], v[72:75], a[72:75]
    ds_read_b64_tr_b16 v[140:141], v11 offset:49408
    v_mfma_f32_16x16x32_bf16 a[76:79], v[152:155], v[76:79], a[76:79]
    ds_read_b64_tr_b16 v[142:143], v11 offset:57600
    v_max3_f32 v16, v16, v41, v42
    v_mfma_f32_16x16x32_bf16 a[80:83], v[152:155], v[80:83], a[80:83]
    v_mfma_f32_16x16x32_bf16 a[84:87], v[156:159], v[72:75], a[84:87]
    ds_read_b64_tr_b16 v[144:145], v12 offset:49408
    v_max3_f32 v16, v16, v43, v44
    v_mfma_f32_16x16x32_bf16 a[88:91], v[156:159], v[76:79], a[88:91]
    ds_read_b64_tr_b16 v[146:147], v12 offset:57600
    v_mfma_f32_16x16x32_bf16 a[92:95], v[156:159], v[80:83], a[92:95]
    v_max3_f32 v16, v16, v45, v46
    s_waitcnt lgkmcnt(6)
    v_mfma_f32_16x16x32_bf16 a[96:99], v[128:131], v[72:75], a[96:99]
    ds_read_b64_tr_b16 v[148:149], v13 offset:49408
    v_mfma_f32_16x16x32_bf16 a[100:103], v[128:131], v[76:79], a[100:103]
    ds_read_b64_tr_b16 v[150:151], v13 offset:57600
    v_max_f32 v16, v16, v47
    v_mfma_f32_16x16x32_bf16 a[104:107], v[128:131], v[80:83], a[104:107]
    v_mfma_f32_16x16x32_bf16 a[108:111], v[132:135], v[72:75], a[108:111]
    ds_read_b64_tr_b16 v[152:153], v14 offset:49408
    v_cmp_lt_f32 vcc, s31, v16
    v_mfma_f32_16x16x32_bf16 a[112:115], v[132:135], v[76:79], a[112:115]
    ds_read_b64_tr_b16 v[154:155], v14 offset:57600
    v_mfma_f32_16x16x32_bf16 a[116:119], v[132:135], v[80:83], a[116:119]
    ds_read_b128 v[96:99], v4 offset:16384
    s_waitcnt lgkmcnt(7)
    v_mfma_f32_16x16x32_bf16 a[120:123], v[136:139], v[72:75], a[120:123]
    ds_read_b64_tr_b16 v[156:157], v15 offset:49408
    v_mfma_f32_16x16x32_bf16 a[124:127], v[136:139], v[76:79], a[124:127]
    ds_read_b64_tr_b16 v[158:159], v15 offset:57600
    v_mfma_f32_16x16x32_bf16 a[128:131], v[136:139], v[80:83], a[128:131]
    ds_read_b128 v[100:103], v5 offset:16384
    v_mfma_f32_16x16x32_bf16 a[132:135], v[140:143], v[72:75], a[132:135]
    ds_read_b128 v[104:107], v6 offset:16384
    v_mfma_f32_16x16x32_bf16 a[136:139], v[140:143], v[76:79], a[136:139]
    ds_read_b128 v[108:111], v7 offset:16384
    v_mfma_f32_16x16x32_bf16 a[140:143], v[140:143], v[80:83], a[140:143]
    ds_read_b128 v[112:115], v4 offset:16640
    s_waitcnt lgkmcnt(9)
    v_mfma_f32_16x16x32_bf16 a[144:147], v[144:147], v[72:75], a[144:147]
    v_mfma_f32_16x16x32_bf16 a[148:151], v[144:147], v[76:79], a[148:151]
    ds_read_b128 v[116:119], v5 offset:16640
    v_mfma_f32_16x16x32_bf16 a[152:155], v[144:147], v[80:83], a[152:155]
    v_mfma_f32_16x16x32_bf16 a[156:159], v[148:151], v[72:75], a[156:159]
    ds_read_b128 v[120:123], v6 offset:16640
    v_mfma_f32_16x16x32_bf16 a[160:163], v[148:151], v[76:79], a[160:163]
    v_mfma_f32_16x16x32_bf16 a[164:167], v[148:151], v[80:83], a[164:167]
    ds_read_b128 v[124:127], v7 offset:16640
    s_waitcnt lgkmcnt(7)
    v_mfma_f32_16x16x32_bf16 a[168:171], v[152:155], v[72:75], a[168:171]
    v_mfma_f32_16x16x32_bf16 a[172:175], v[152:155], v[76:79], a[172:175]
    v_mfma_f32_16x16x32_bf16 a[176:179], v[152:155], v[80:83], a[176:179]
    v_mfma_f32_16x16x32_bf16 a[180:183], v[156:159], v[72:75], a[180:183]
    v_mfma_f32_16x16x32_bf16 a[184:187], v[156:159], v[76:79], a[184:187]
    v_mfma_f32_16x16x32_bf16 a[188:191], v[156:159], v[80:83], a[188:191]
    s_cbranch_vccnz L_rare_L_loop_3
L_back_L_loop_3:
    s_barrier
    s_waitcnt lgkmcnt(6)
    v_mfma_f32_16x16x32_bf16 v[48:51], v[96:99], v[160:163], v[84:87]
    v_exp_f32 v24, v24
    v_mfma_f32_16x16x32_bf16 v[56:59], v[96:99], v[192:195], v[88:91]
    v_exp_f32 v25, v25
    v_mfma_f32_16x16x32_bf16 v[64:67], v[96:99], v[224:227], v[92:95]
    v_cvt_pk_bf16_f32 v72, v24, v25
    ds_read_b128 v[96:99], v4 offset:24576
    v_mfma_f32_16x16x32_bf16 v[48:51], v[100:103], v[164:167], v[48:51]
    v_mfma_f32_16x16x32_bf16 v[56:59], v[100:103], v[196:199], v[56:59]
    v_exp_f32 v26, v26
    v_mfma_f32_16x16x32_bf16 v[64:67], v[100:103], v[228:231], v[64:67]
    v_exp_f32 v27, v27
    s_waitcnt lgkmcnt(5)
    v_mfma_f32_16x16x32_bf16 v[48:51], v[104:107], v[168:171], v[48:51]
    v_cvt_pk_bf16_f32 v73, v26, v27
    ds_read_b128 v[100:103], v5 offset:24576
    v_mfma_f32_16x16x32_bf16 v[56:59], v[104:107], v[200:203], v[56:59]
    v_mfma_f32_16x16x32_bf16 v[64:67], v[104:107], v[232:235], v[64:67]
    v_exp_f32 v28, v28
    v_mfma_f32_16x16x32_bf16 v[48:51], v[108:111], v[172:175], v[48:51]
    v_exp_f32 v29, v29
    v_mfma_f32_16x16x32_bf16 v[56:59], v[108:111], v[204:207], v[56:59]
    v_cvt_pk_bf16_f32 v74, v28, v29
    ds_read_b128 v[104:107], v6 offset:24576
    v_mfma_f32_16x16x32_bf16 v[64:67], v[108:111], v[236:239], v[64:67]
    ds_read_b128 v[108:111], v7 offset:24576
    s_waitcnt lgkmcnt(6)
    v_mfma_f32_16x16x32_bf16 v[48:51], v[112:115], v[176:179], v[48:51]
    v_exp_f32 v30, v30
    v_mfma_f32_16x16x32_bf16 v[56:59], v[112:115], v[208:211], v[56:59]
    v_exp_f32 v31, v31
    v_mfma_f32_16x16x32_bf16 v[64:67], v[112:115], v[240:243], v[64:67]
    v_cvt_pk_bf16_f32 v75, v30, v31
    ds_read_b128 v[112:115], v4 offset:24832
    v_mfma_f32_16x16x32_bf16 v[48:51], v[116:119], v[180:183], v[48:51]
    v_mfma_f32_16x16x32_bf16 v[56:59], v[116:119], v[212:215], v[56:59]
    v_exp_f32 v32, v32
    v_mfma_f32_16x16x32_bf16 v[64:67], v[116:119], v[244:247], v[64:67]
    v_exp_f32 v33, v33
    s_waitcnt lgkmcnt(5)
    v_mfma_f32_16x16x32_bf16 v[48:51], v[120:123], v[184:187], v[48:51]
    v_cvt_pk_bf16_f32 v76, v32, v33
    ds_read_b128 v[116:119], v5 offset:24832
    v_mfma_f32_16x16x32_bf16 v[56:59], v[120:123], v[216:219], v[56:59]
    v_mfma_f32_16x16x32_bf16 v[64:67], v[120:123], v[248:251], v[64:67]
    v_exp_f32 v34, v34
    v_mfma_f32_16x16x32_bf16 v[48:51], v[124:127], v[188:191], v[48:51]
    v_exp_f32 v35, v35
    v_mfma_f32_16x16x32_bf16 v[56:59], v[124:127], v[220:223], v[56:59]
    v_cvt_pk_bf16_f32 v77, v34, v35
    ds_read_b128 v[120:123], v6 offset:24832
    v_mfma_f32_16x16x32_bf16 v[64:67], v[124:127], v[252:255], v[64:67]
    ds_read_b128 v[124:127], v7 offset:24832
    s_waitcnt lgkmcnt(6)
    v_mfma_f32_16x16x32_bf16 v[52:55], v[96:99], v[160:163], v[84:87]
    v_exp_f32 v36, v36
    v_mfma_f32_16x16x32_bf16 v[60:63], v[96:99], v[192:195], v[88:91]
    v_exp_f32 v37, v37
    v_mfma_f32_16x16x32_bf16 v[68:71], v[96:99], v[224:227], v[92:95]
    v_cvt_pk_bf16_f32 v78, v36, v37
    ds_read_b64_tr_b16 v[128:129], v8 offset:0
    v_mfma_f32_16x16x32_bf16 v[52:55], v[100:103], v[164:167], v[52:55]
    ds_read_b64_tr_b16 v[130:131], v8 offset:8192
    v_mfma_f32_16x16x32_bf16 v[60:63], v[100:103], v[196:199], v[60:63]
    v_exp_f32 v38, v38
    v_mfma_f32_16x16x32_bf16 v[68:71], v[100:103], v[228:231], v[68:71]
    v_exp_f32 v39, v39
    s_waitcnt lgkmcnt(6)
    v_mfma_f32_16x16x32_bf16 v[52:55], v[104:107], v[168:171], v[52:55]
    v_cvt_pk_bf16_f32 v79, v38, v39
    ds_read_b64_tr_b16 v[132:133], v9 offset:0
    v_mfma_f32_16x16x32_bf16 v[60:63], v[104:107], v[200:203], v[60:63]
    ds_read_b64_tr_b16 v[134:135], v9 offset:8192
    v_mfma_f32_16x16x32_bf16 v[68:71], v[104:107], v[232:235], v[68:71]
    v_exp_f32 v40, v40
    v_mfma_f32_16x16x32_bf16 v[52:55], v[108:111], v[172:175], v[52:55]
    v_exp_f32 v41, v41
    v_mfma_f32_16x16x32_bf16 v[60:63], v[108:111], v[204:207], v[60:63]
    v_cvt_pk_bf16_f32 v80, v40, v41
    ds_read_b64_tr_b16 v[136:137], v10 offset:0
    v_mfma_f32_16x16x32_bf16 v[68:71], v[108:111], v[236:239], v[68:71]
    ds_read_b64_tr_b16 v[138:139], v10 offset:8192
    s_waitcnt lgkmcnt(8)
    v_mfma_f32_16x16x32_bf16 v[52:55], v[112:115], v[176:179], v[52:55]
    v_exp_f32 v42, v42
    v_mfma_f32_16x16x32_bf16 v[60:63], v[112:115], v[208:211], v[60:63]
    v_exp_f32 v43, v43
    v_mfma_f32_16x16x32_bf16 v[68:71], v[112:115], v[240:243], v[68:71]
    v_cvt_pk_bf16_f32 v81, v42, v43
    ds_read_b64_tr_b16 v[140:141], v11 offset:0
    v_mfma_f32_16x16x32_bf16 v[52:55], v[116:119], v[180:183], v[52:55]
    ds_read_b64_tr_b16 v[142:143], v11 offset:8192
    v_mfma_f32_16x16x32_bf16 v[60:63], v[116:119], v[212:215], v[60:63]
    v_exp_f32 v44, v44
    v_mfma_f32_16x16x32_bf16 v[68:71], v[116:119], v[244:247], v[68:71]
    v_exp_f32 v45, v45
    s_waitcnt lgkmcnt(8)
    v_mfma_f32_16x16x32_bf16 v[52:55], v[120:123], v[184:187], v[52:55]
    v_cvt_pk_bf16_f32 v82, v44, v45
    v_mfma_f32_16x16x32_bf16 v[60:63], v[120:123], v[216:219], v[60:63]
    v_mfma_f32_16x16x32_bf16 v[68:71], v[120:123], v[248:251], v[68:71]
    v_exp_f32 v46, v46
    v_mfma_f32_16x16x32_bf16 v[52:55], v[124:127], v[188:191], v[52:55]
    v_exp_f32 v47, v47
    v_mfma_f32_16x16x32_bf16 v[60:63], v[124:127], v[220:223], v[60:63]
    v_cvt_pk_bf16_f32 v83, v46, v47
    v_mfma_f32_16x16x32_bf16 v[68:71], v[124:127], v[252:255], v[68:71]
    s_nop 1
    v_mfma_f32_16x16x32_bf16 a[192:195], a[204:207], v[72:75], a[192:195]
    ds_read_b64_tr_b16 v[144:145], v12 offset:0
    v_mfma_f32_16x16x32_bf16 a[196:199], a[204:207], v[76:79], a[196:199]
    ds_read_b64_tr_b16 v[146:147], v12 offset:8192
    v_mfma_f32_16x16x32_bf16 a[200:203], a[204:207], v[80:83], a[200:203]
    s_waitcnt lgkmcnt(6)
    v_mfma_f32_16x16x32_bf16 a[0:3], v[128:131], v[72:75], a[0:3]
    ds_read_b64_tr_b16 v[148:149], v13 offset:0
    v_mfma_f32_16x16x32_bf16 a[4:7], v[128:131], v[76:79], a[4:7]
    ds_read_b64_tr_b16 v[150:151], v13 offset:8192
    v_mfma_f32_16x16x32_bf16 a[8:11], v[128:131], v[80:83], a[8:11]
    v_mfma_f32_16x16x32_bf16 a[12:15], v[132:135], v[72:75], a[12:15]
    ds_read_b64_tr_b16 v[152:153], v14 offset:0
    v_max3_f32 v16, v48, v49, v50
    v_mfma_f32_16x16x32_bf16 a[16:19], v[132:135], v[76:79], a[16:19]
    ds_read_b64_tr_b16 v[154:155], v14 offset:8192
    v_mfma_f32_16x16x32_bf16 a[20:23], v[132:135], v[80:83], a[20:23]
    v_max3_f32 v16, v16, v51, v52
    s_waitcnt lgkmcnt(6)
    v_mfma_f32_16x16x32_bf16 a[24:27], v[136:139], v[72:75], a[24:27]
    ds_read_b64_tr_b16 v[156:157], v15 offset:0
    v_mfma_f32_16x16x32_bf16 a[28:31], v[136:139], v[76:79], a[28:31]
    ds_read_b64_tr_b16 v[158:159], v15 offset:8192
    v_max3_f32 v16, v16, v53, v54
    v_mfma_f32_16x16x32_bf16 a[32:35], v[136:139], v[80:83], a[32:35]
    v_mfma_f32_16x16x32_bf16 a[36:39], v[140:143], v[72:75], a[36:39]
    ds_read_b64_tr_b16 v[128:129], v8 offset:256
    v_max3_f32 v16, v16, v55, v56
    v_mfma_f32_16x16x32_bf16 a[40:43], v[140:143], v[76:79], a[40:43]
    ds_read_b64_tr_b16 v[130:131], v8 offset:8448
    v_mfma_f32_16x16x32_bf16 a[44:47], v[140:143], v[80:83], a[44:47]
    v_max3_f32 v16, v16, v57, v58
    s_waitcnt lgkmcnt(6)
    v_mfma_f32_16x16x32_bf16 a[48:51], v[144:147], v[72:75], a[48:51]
    ds_read_b64_tr_b16 v[132:133], v9 offset:256
    v_mfma_f32_16x16x32_bf16 a[52:55], v[144:147], v[76:79], a[52:55]
    ds_read_b64_tr_b16 v[134:135], v9 offset:8448
    v_max3_f32 v16, v16, v59, v60
    v_mfma_f32_16x16x32_bf16 a[56:59], v[144:147], v[80:83], a[56:59]
    v_mfma_f32_16x16x32_bf16 a[60:63], v[148:151], v[72:75], a[60:63]
    ds_read_b64_tr_b16 v[136:137], v10 offset:256
    v_max3_f32 v16, v16, v61, v62
    v_mfma_f32_16x16x32_bf16 a[64:67], v[148:151], v[76:79], a[64:67]
    ds_read_b64_tr_b16 v[138:139], v10 offset:8448
    v_mfma_f32_16x16x32_bf16 a[68:71], v[148:151], v[80:83], a[68:71]
    v_max3_f32 v16, v16, v63, v64
    s_waitcnt lgkmcnt(6)
    v_mfma_f32_16x16x32_bf16 a[72:75], v[152:155], v[72:75], a[72:75]
    ds_read_b64_tr_b16 v[140:141], v11 offset:256
    v_mfma_f32_16x16x32_bf16 a[76:79], v[152:155], v[76:79], a[76:79]
    ds_read_b64_tr_b16 v[142:143], v11 offset:8448
    v_max3_f32 v16, v16, v65, v66
    v_mfma_f32_16x16x32_bf16 a[80:83], v[152:155], v[80:83], a[80:83]
    v_mfma_f32_16x16x32_bf16 a[84:87], v[156:159], v[72:75], a[84:87]
    ds_read_b64_tr_b16 v[144:145], v12 offset:256
    v_max3_f32 v16, v16, v67, v68
    v_mfma_f32_16x16x32_bf16 a[88:91], v[156:159], v[76:79], a[88:91]
    ds_read_b64_tr_b16 v[146:147], v12 offset:8448
    v_mfma_f32_16x16x32_bf16 a[92:95], v[156:159], v[80:83], a[92:95]
    v_max3_f32 v16, v16, v69, v70
    s_waitcnt lgkmcnt(6)
    v_mfma_f32_16x16x32_bf16 a[96:99], v[128:131], v[72:75], a[96:99]
    ds_read_b64_tr_b16 v[148:149], v13 offset:256
    v_mfma_f32_16x16x32_bf16 a[100:103], v[128:131], v[76:79], a[100:103]
    ds_read_b64_tr_b16 v[150:151], v13 offset:8448
    v_max_f32 v16, v16, v71
    v_mfma_f32_16x16x32_bf16 a[104:107], v[128:131], v[80:83], a[104:107]
    v_mfma_f32_16x16x32_bf16 a[108:111], v[132:135], v[72:75], a[108:111]
    ds_read_b64_tr_b16 v[152:153], v14 offset:256
    v_cmp_lt_f32 vcc, s31, v16
    v_mfma_f32_16x16x32_bf16 a[112:115], v[132:135], v[76:79], a[112:115]
    ds_read_b64_tr_b16 v[154:155], v14 offset:8448
    v_mfma_f32_16x16x32_bf16 a[116:119], v[132:135], v[80:83], a[116:119]
    ds_read_b128 v[96:99], v4 offset:32768
    s_waitcnt lgkmcnt(7)
    v_mfma_f32_16x16x32_bf16 a[120:123], v[136:139], v[72:75], a[120:123]
    ds_read_b64_tr_b16 v[156:157], v15 offset:256
    v_mfma_f32_16x16x32_bf16 a[124:127], v[136:139], v[76:79], a[124:127]
    ds_read_b64_tr_b16 v[158:159], v15 offset:8448
    v_mfma_f32_16x16x32_bf16 a[128:131], v[136:139], v[80:83], a[128:131]
    ds_read_b128 v[100:103], v5 offset:32768
    v_mfma_f32_16x16x32_bf16 a[132:135], v[140:143], v[72:75], a[132:135]
    ds_read_b128 v[104:107], v6 offset:32768
    v_mfma_f32_16x16x32_bf16 a[136:139], v[140:143], v[76:79], a[136:139]
    ds_read_b128 v[108:111], v7 offset:32768
    v_mfma_f32_16x16x32_bf16 a[140:143], v[140:143], v[80:83], a[140:143]
    ds_read_b128 v[112:115], v4 offset:33024
    s_waitcnt lgkmcnt(9)
    v_mfma_f32_16x16x32_bf16 a[144:147], v[144:147], v[72:75], a[144:147]
    v_mfma_f32_16x16x32_bf16 a[148:151], v[144:147], v[76:79], a[148:151]
    ds_read_b128 v[116:119], v5 offset:33024
    v_mfma_f32_16x16x32_bf16 a[152:155], v[144:147], v[80:83], a[152:155]
    v_mfma_f32_16x16x32_bf16 a[156:159], v[148:151], v[72:75], a[156:159]
    ds_read_b128 v[120:123], v6 offset:33024
    v_mfma_f32_16x16x32_bf16 a[160:163], v[148:151], v[76:79], a[160:163]
    v_mfma_f32_16x16x32_bf16 a[164:167], v[148:151], v[80:83], a[164:167]
    ds_read_b128 v[124:127], v7 offset:33024
    s_waitcnt lgkmcnt(7)
    v_mfma_f32_16x16x32_bf16 a[168:171], v[152:155], v[72:75], a[168:171]
    v_mfma_f32_16x16x32_bf16 a[172:175], v[152:155], v[76:79], a[172:175]
    v_mfma_f32_16x16x32_bf16 a[176:179], v[152:155], v[80:83], a[176:179]
    v_mfma_f32_16x16x32_bf16 a[180:183], v[156:159], v[72:75], a[180:183]
    v_mfma_f32_16x16x32_bf16 a[184:187], v[156:159], v[76:79], a[184:187]
    v_mfma_f32_16x16x32_bf16 a[188:191], v[156:159], v[80:83], a[188:191]
    s_cbranch_vccnz L_rare_L_loop_4
L_back_L_loop_4:
    s_sub_u32 s34, s34, 1
    s_cmp_lg_u32 s34, 0
    s_cbranch_scc1 L_loop
    s_mov_b32 s34, 4
L_loopm:
    s_waitcnt lgkmcnt(6)
    v_mfma_f32_16x16x32_bf16 v[24:27], v[96:99], v[160:163], v[84:87]
    v_exp_f32 v48, v48
    v_mfma_f32_16x16x32_bf16 v[32:35], v[96:99], v[192:195], v[88:91]
    v_exp_f32 v49, v49
    v_mfma_f32_16x16x32_bf16 v[40:43], v[96:99], v[224:227], v[92:95]
    v_cvt_pk_bf16_f32 v72, v48, v49
    ds_read_b128 v[96:99], v4 offset:40960
    v_mfma_f32_16x16x32_bf16 v[24:27], v[100:103], v[164:167], v[24:27]
    v_mfma_f32_16x16x32_bf16 v[32:35], v[100:103], v[196:199], v[32:35]
    v_exp_f32 v50, v50
    v_mfma_f32_16x16x32_bf16 v[40:43], v[100:103], v[228:231], v[40:43]
    v_exp_f32 v51, v51
    s_waitcnt lgkmcnt(5)
    v_mfma_f32_16x16x32_bf16 v[24:27], v[104:107], v[168:171], v[24:27]
    v_cvt_pk_bf16_f32 v73, v50, v51
    ds_read_b128 v[100:103], v5 offset:40960
    v_mfma_f32_16x16x32_bf16 v[32:35], v[104:107], v[200:203], v[32:35]
    v_mfma_f32_16x16x32_bf16 v[40:43], v[104:107], v[232:235], v[40:43]
    v_exp_f32 v52, v52
    v_mfma_f32_16x16x32_bf16 v[24:27], v[108:111], v[172:175], v[24:27]
    v_exp_f32 v53, v53
    v_mfma_f32_16x16x32_bf16 v[32:35], v[108:111], v[204:207], v[32:35]
    v_cvt_pk_bf16_f32 v74, v52, v53
    ds_read_b128 v[104:107], v6 offset:40960
    v_mfma_f32_16x16x32_bf16 v[40:43], v[108:111], v[236:239], v[40:43]
    ds_read_b128 v[108:111], v7 offset:40960
    s_waitcnt lgkmcnt(6)
    v_mfma_f32_16x16x32_bf16 v[24:27], v[112:115], v[176:179], v[24:27]
    v_exp_f32 v54, v54
    v_mfma_f32_16x16x32_bf16 v[32:35], v[112:115], v[208:211], v[32:35]
    v_exp_f32 v55, v55
    v_mfma_f32_16x16x32_bf16 v[40:43], v[112:115], v[240:243], v[40:43]
    v_cvt_pk_bf16_f32 v75, v54, v55
    ds_read_b128 v[112:115], v4 offset:41216
    v_mfma_f32_16x16x32_bf16 v[24:27], v[116:119], v[180:183], v[24:27]
    v_mfma_f32_16x16x32_bf16 v[32:35], v[116:119], v[212:215], v[32:35]
    v_exp_f32 v56, v56
    v_mfma_f32_16x16x32_bf16 v[40:43], v[116:119], v[244:247], v[40:43]
    v_exp_f32 v57, v57
    s_waitcnt lgkmcnt(5)
    v_mfma_f32_16x16x32_bf16 v[24:27], v[120:123], v[184:187], v[24:27]
    v_cvt_pk_bf16_f32 v76, v56, v57
    ds_read_b128 v[116:119], v5 offset:41216
    v_mfma_f32_16x16x32_bf16 v[32:35], v[120:123], v[216:219], v[32:35]
    v_mfma_f32_16x16x32_bf16 v[40:43], v[120:123], v[248:251], v[40:43]
    v_exp_f32 v58, v58
    v_mfma_f32_16x16x32_bf16 v[24:27], v[124:127], v[188:191], v[24:27]
    v_exp_f32 v59, v59
    v_mfma_f32_16x16x32_bf16 v[32:35], v[124:127], v[220:223], v[32:35]
    v_cvt_pk_bf16_f32 v77, v58, v59
    ds_read_b128 v[120:123], v6 offset:41216
    v_mfma_f32_16x16x32_bf16 v[40:43], v[124:127], v[252:255], v[40:43]
    ds_read_b128 v[124:127], v7 offset:41216
    s_waitcnt lgkmcnt(6)
    v_mfma_f32_16x16x32_bf16 v[28:31], v[96:99], v[160:163], v[84:87]
    v_exp_f32 v60, v60
    v_mfma_f32_16x16x32_bf16 v[36:39], v[96:99], v[192:195], v[88:91]
    v_exp_f32 v61, v61
    v_mfma_f32_16x16x32_bf16 v[44:47], v[96:99], v[224:227], v[92:95]
    s_barrier
    v_cvt_pk_bf16_f32 v78, v60, v61
    v_mfma_f32_16x16x32_bf16 v[28:31], v[100:103], v[164:167], v[28:31]
    ds_read_b64_tr_b16 v[128:129], v8 offset:16384
    v_mfma_f32_16x16x32_bf16 v[36:39], v[100:103], v[196:199], v[36:39]
    v_exp_f32 v62, v62
    v_mfma_f32_16x16x32_bf16 v[44:47], v[100:103], v[228:231], v[44:47]
    v_exp_f32 v63, v63
    s_waitcnt lgkmcnt(5)
    v_mfma_f32_16x16x32_bf16 v[28:31], v[104:107], v[168:171], v[28:31]
    v_cvt_pk_bf16_f32 v79, v62, v63
    ds_read_b64_tr_b16 v[130:131], v8 offset:24576
    v_mfma_f32_16x16x32_bf16 v[36:39], v[104:107], v[200:203], v[36:39]
    ds_read_b64_tr_b16 v[132:133], v9 offset:16384
    v_mfma_f32_16x16x32_bf16 v[44:47], v[104:107], v[232:235], v[44:47]
    v_exp_f32 v64, v64
    v_mfma_f32_16x16x32_bf16 v[28:31], v[108:111], v[172:175], v[28:31]
    v_exp_f32 v65, v65
    v_mfma_f32_16x16x32_bf16 v[36:39], v[108:111], v[204:207], v[36:39]
    v_cvt_pk_bf16_f32 v80, v64, v65
    ds_read_b64_tr_b16 v[134:135], v9 offset:24576
    v_mfma_f32_16x16x32_bf16 v[44:47], v[108:111], v[236:239], v[44:47]
    ds_read_b64_tr_b16 v[136:137], v10 offset:16384
    s_waitcnt lgkmcnt(7)
    v_mfma_f32_16x16x32_bf16 v[28:31], v[112:115], v[176:179], v[28:31]
    v_exp_f32 v66, v66
    v_mfma_f32_16x16x32_bf16 v[36:39], v[112:115], v[208:211], v[36:39]
    v_exp_f32 v67, v67
    v_mfma_f32_16x16x32_bf16 v[44:47], v[112:115], v[240:243], v[44:47]
    v_cvt_pk_bf16_f32 v81, v66, v67
    ds_read_b64_tr_b16 v[138:139], v10 offset:24576
    v_mfma_f32_16x16x32_bf16 v[28:31], v[116:119], v[180:183], v[28:31]
    ds_read_b64_tr_b16 v[140:141], v11 offset:16384
    v_mfma_f32_16x16x32_bf16 v[36:39], v[116:119], v[212:215], v[36:39]
    v_exp_f32 v68, v68
    v_mfma_f32_16x16x32_bf16 v[44:47], v[116:119], v[244:247], v[44:47]
    v_exp_f32 v69, v69
    s_waitcnt lgkmcnt(7)
    v_mfma_f32_16x16x32_bf16 v[28:31], v[120:123], v[184:187], v[28:31]
    v_cvt_pk_bf16_f32 v82, v68, v69
    ds_read_b64_tr_b16 v[142:143], v11 offset:24576
    v_mfma_f32_16x16x32_bf16 v[36:39], v[120:123], v[216:219], v[36:39]
    v_mfma_f32_16x16x32_bf16 v[44:47], v[120:123], v[248:251], v[44:47]
    v_exp_f32 v70, v70
    v_mfma_f32_16x16x32_bf16 v[28:31], v[124:127], v[188:191], v[28:31]
    v_exp_f32 v71, v71
    v_mfma_f32_16x16x32_bf16 v[36:39], v[124:127], v[220:223], v[36:39]
    v_cvt_pk_bf16_f32 v83, v70, v71
    v_mfma_f32_16x16x32_bf16 v[44:47], v[124:127], v[252:255], v[44:47]
    s_nop 1
    v_mfma_f32_16x16x32_bf16 a[192:195], a[204:207], v[72:75], a[192:195]
    ds_read_b64_tr_b16 v[144:145], v12 offset:16384
    v_mfma_f32_16x16x32_bf16 a[196:199], a[204:207], v[76:79], a[196:199]
    ds_read_b64_tr_b16 v[146:147], v12 offset:24576
    v_mfma_f32_16x16x32_bf16 a[200:203], a[204:207], v[80:83], a[200:203]
    s_waitcnt lgkmcnt(6)
    v_mfma_f32_16x16x32_bf16 a[0:3], v[128:131], v[72:75], a[0:3]
    ds_read_b64_tr_b16 v[148:149], v13 offset:16384
    v_mfma_f32_16x16x32_bf16 a[4:7], v[128:131], v[76:79], a[4:7]
    ds_read_b64_tr_b16 v[150:151], v13 offset:24576
    v_mfma_f32_16x16x32_bf16 a[8:11], v[128:131], v[80:83], a[8:11]
    v_mfma_f32_16x16x32_bf16 a[12:15], v[132:135], v[72:75], a[12:15]
    ds_read_b64_tr_b16 v[152:153], v14 offset:16384
    v_max3_f32 v16, v24, v25, v26
    v_mfma_f32_16x16x32_bf16 a[16:19], v[132:135], v[76:79], a[16:19]
    ds_read_b64_tr_b16 v[154:155], v14 offset:24576
    v_mfma_f32_16x16x32_bf16 a[20:23], v[132:135], v[80:83], a[20:23]
    v_max3_f32 v16, v16, v27, v28
    s_waitcnt lgkmcnt(6)
    v_mfma_f32_16x16x32_bf16 a[24:27], v[136:139], v[72:75], a[24:27]
    ds_read_b64_tr_b16 v[156:157], v15 offset:16384
    v_mfma_f32_16x16x32_bf16 a[28:31], v[136:139], v[76:79], a[28:31]
    ds_read_b64_tr_b16 v[158:159], v15 offset:24576
    v_max3_f32 v16, v16, v29, v30
    v_mfma_f32_16x16x32_bf16 a[32:35], v[136:139], v[80:83], a[32:35]
    v_mfma_f32_16x16x32_bf16 a[36:39], v[140:143], v[72:75], a[36:39]
    ds_read_b64_tr_b16 v[128:129], v8 offset:16640
    v_max3_f32 v16, v16, v31, v32
    v_mfma_f32_16x16x32_bf16 a[40:43], v[140:143], v[76:79], a[40:43]
    ds_read_b64_tr_b16 v[130:131], v8 offset:24832
    v_mfma_f32_16x16x32_bf16 a[44:47], v[140:143], v[80:83], a[44:47]
    v_max3_f32 v16, v16, v33, v34
    s_waitcnt lgkmcnt(6)
    v_mfma_f32_16x16x32_bf16 a[48:51], v[144:147], v[72:75], a[48:51]
    ds_read_b64_tr_b16 v[132:133], v9 offset:16640
    v_mfma_f32_16x16x32_bf16 a[52:55], v[144:147], v[76:79], a[52:55]
    ds_read_b64_tr_b16 v[134:135], v9 offset:24832
    v_max3_f32 v16, v16, v35, v36
    v_mfma_f32_16x16x32_bf16 a[56:59], v[144:147], v[80:83], a[56:59]
    v_mfma_f32_16x16x32_bf16 a[60:63], v[148:151], v[72:75], a[60:63]
    ds_read_b64_tr_b16 v[136:137], v10 offset:16640
    v_max3_f32 v16, v16, v37, v38
    v_mfma_f32_16x16x32_bf16 a[64:67], v[148:151], v[76:79], a[64:67]
    ds_read_b64_tr_b16 v[138:139], v10 offset:24832
    v_mfma_f32_16x16x32_bf16 a[68:71], v[148:151], v[80:83], a[68:71]
    v_max3_f32 v16, v16, v39, v40
    s_waitcnt lgkmcnt(6)
    v_mfma_f32_16x16x32_bf16 a[72:75], v[152:155], v[72:75], a[72:75]
    ds_read_b64_tr_b16 v[140:141], v11 offset:16640
    v_mfma_f32_16x16x32_bf16 a[76:79], v[152:155], v[76:79], a[76:79]
    ds_read_b64_tr_b16 v[142:143], v11 offset:24832
    v_max3_f32 v16, v16, v41, v42
    v_mfma_f32_16x16x32_bf16 a[80:83], v[152:155], v[80:83], a[80:83]
    v_mfma_f32_16x16x32_bf16 a[84:87], v[156:159], v[72:75], a[84:87]
    ds_read_b64_tr_b16 v[144:145], v12 offset:16640
    v_max3_f32 v16, v16, v43, v44
    v_mfma_f32_16x16x32_bf16 a[88:91], v[156:159], v[76:79], a[88:91]
    ds_read_b64_tr_b16 v[146:147], v12 offset:24832
    v_mfma_f32_16x16x32_bf16 a[92:95], v[156:159], v[80:83], a[92:95]
    v_max3_f32 v16, v16, v45, v46
    s_waitcnt lgkmcnt(6)
    v_mfma_f32_16x16x32_bf16 a[96:99], v[128:131], v[72:75], a[96:99]
    ds_read_b64_tr_b16 v[148:149], v13 offset:16640
    v_mfma_f32_16x16x32_bf16 a[100:103], v[128:131], v[76:79], a[100:103]
    ds_read_b64_tr_b16 v[150:151], v13 offset:24832
    v_max_f32 v16, v16, v47
    v_mfma_f32_16x16x32_bf16 a[104:107], v[128:131], v[80:83], a[104:107]
    v_mfma_f32_16x16x32_bf16 a[108:111], v[132:135], v[72:75], a[108:111]
    s_barrier
    ds_read_b64_tr_b16 v[152:153], v14 offset:16640
    v_mfma_f32_16x16x32_bf16 a[112:115], v[132:135], v[76:79], a[112:115]
    ds_read_b64_tr_b16 v[154:155], v14 offset:24832
    v_cmp_lt_f32 vcc, s31, v16
    v_mfma_f32_16x16x32_bf16 a[116:119], v[132:135], v[80:83], a[116:119]
    ds_read_b128 v[96:99], v4 offset:49152
    s_waitcnt lgkmcnt(7)
    v_mfma_f32_16x16x32_bf16 a[120:123], v[136:139], v[72:75], a[120:123]
    ds_read_b64_tr_b16 v[156:157], v15 offset:16640
    v_mfma_f32_16x16x32_bf16 a[124:127], v[136:139], v[76:79], a[124:127]
    ds_read_b64_tr_b16 v[158:159], v15 offset:24832
    v_mfma_f32_16x16x32_bf16 a[128:131], v[136:139], v[80:83], a[128:131]
    ds_read_b128 v[100:103], v5 offset:49152
    v_mfma_f32_16x16x32_bf16 a[132:135], v[140:143], v[72:75], a[132:135]
    ds_read_b128 v[104:107], v6 offset:49152
    v_mfma_f32_16x16x32_bf16 a[136:139], v[140:143], v[76:79], a[136:139]
    ds_read_b128 v[108:111], v7 offset:49152
    v_mfma_f32_16x16x32_bf16 a[140:143], v[140:143], v[80:83], a[140:143]
    s_waitcnt lgkmcnt(8)
    v_mfma_f32_16x16x32_bf16 a[144:147], v[144:147], v[72:75], a[144:147]
    ds_read_b128 v[112:115], v4 offset:49408
    v_mfma_f32_16x16x32_bf16 a[148:151], v[144:147], v[76:79], a[148:151]
    v_mfma_f32_16x16x32_bf16 a[152:155], v[144:147], v[80:83], a[152:155]
    ds_read_b128 v[116:119], v5 offset:49408
    v_mfma_f32_16x16x32_bf16 a[156:159], v[148:151], v[72:75], a[156:159]
    v_mfma_f32_16x16x32_bf16 a[160:163], v[148:151], v[76:79], a[160:163]
    ds_read_b128 v[120:123], v6 offset:49408
    v_mfma_f32_16x16x32_bf16 a[164:167], v[148:151], v[80:83], a[164:167]
    s_waitcnt lgkmcnt(6)
    v_mfma_f32_16x16x32_bf16 a[168:171], v[152:155], v[72:75], a[168:171]
    ds_read_b128 v[124:127], v7 offset:49408
    v_mfma_f32_16x16x32_bf16 a[172:175], v[152:155], v[76:79], a[172:175]
    v_mfma_f32_16x16x32_bf16 a[176:179], v[152:155], v[80:83], a[176:179]
    v_mfma_f32_16x16x32_bf16 a[180:183], v[156:159], v[72:75], a[180:183]
    v_mfma_f32_16x16x32_bf16 a[184:187], v[156:159], v[76:79], a[184:187]
    v_mfma_f32_16x16x32_bf16 a[188:191], v[156:159], v[80:83], a[188:191]
    s_cbranch_vccnz L_rare_L_loopm_13
L_back_L_loopm_13:
    s_waitcnt lgkmcnt(6)
    v_mfma_f32_16x16x32_bf16 v[48:51], v[96:99], v[160:163], v[84:87]
    v_exp_f32 v24, v24
    v_mfma_f32_16x16x32_bf16 v[56:59], v[96:99], v[192:195], v[88:91]
    v_exp_f32 v25, v25
    v_mfma_f32_16x16x32_bf16 v[64:67], v[96:99], v[224:227], v[92:95]
    v_cvt_pk_bf16_f32 v72, v24, v25
    ds_read_b128 v[96:99], v4 offset:57344
    v_mfma_f32_16x16x32_bf16 v[48:51], v[100:103], v[164:167], v[48:51]
    v_mfma_f32_16x16x32_bf16 v[56:59], v[100:103], v[196:199], v[56:59]
    v_exp_f32 v26, v26
    v_mfma_f32_16x16x32_bf16 v[64:67], v[100:103], v[228:231], v[64:67]
    v_exp_f32 v27, v27
    s_waitcnt lgkmcnt(5)
    v_mfma_f32_16x16x32_bf16 v[48:51], v[104:107], v[168:171], v[48:51]
    v_cvt_pk_bf16_f32 v73, v26, v27
    ds_read_b128 v[100:103], v5 offset:57344
    v_mfma_f32_16x16x32_bf16 v[56:59], v[104:107], v[200:203], v[56:59]
    v_mfma_f32_16x16x32_bf16 v[64:67], v[104:107], v[232:235], v[64:67]
    v_exp_f32 v28, v28
    v_mfma_f32_16x16x32_bf16 v[48:51], v[108:111], v[172:175], v[48:51]
    v_exp_f32 v29, v29
    v_mfma_f32_16x16x32_bf16 v[56:59], v[108:111], v[204:207], v[56:59]
    v_cvt_pk_bf16_f32 v74, v28, v29
    ds_read_b128 v[104:107], v6 offset:57344
    v_mfma_f32_16x16x32_bf16 v[64:67], v[108:111], v[236:239], v[64:67]
    ds_read_b128 v[108:111], v7 offset:57344
    s_waitcnt lgkmcnt(6)
    v_mfma_f32_16x16x32_bf16 v[48:51], v[112:115], v[176:179], v[48:51]
    v_exp_f32 v30, v30
    v_mfma_f32_16x16x32_bf16 v[56:59], v[112:115], v[208:211], v[56:59]
    v_exp_f32 v31, v31
    v_mfma_f32_16x16x32_bf16 v[64:67], v[112:115], v[240:243], v[64:67]
    v_cvt_pk_bf16_f32 v75, v30, v31
    ds_read_b128 v[112:115], v4 offset:57600
    v_mfma_f32_16x16x32_bf16 v[48:51], v[116:119], v[180:183], v[48:51]
    v_mfma_f32_16x16x32_bf16 v[56:59], v[116:119], v[212:215], v[56:59]
    v_exp_f32 v32, v32
    v_mfma_f32_16x16x32_bf16 v[64:67], v[116:119], v[244:247], v[64:67]
    v_exp_f32 v33, v33
    s_waitcnt lgkmcnt(5)
    v_mfma_f32_16x16x32_bf16 v[48:51], v[120:123], v[184:187], v[48:51]
    v_cvt_pk_bf16_f32 v76, v32, v33
    ds_read_b128 v[116:119], v5 offset:57600
    v_mfma_f32_16x16x32_bf16 v[56:59], v[120:123], v[216:219], v[56:59]
    v_mfma_f32_16x16x32_bf16 v[64:67], v[120:123], v[248:251], v[64:67]
    v_exp_f32 v34, v34
    v_mfma_f32_16x16x32_bf16 v[48:51], v[124:127], v[188:191], v[48:51]
    v_exp_f32 v35, v35
    v_mfma_f32_16x16x32_bf16 v[56:59], v[124:127], v[220:223], v[56:59]
    v_cvt_pk_bf16_f32 v77, v34, v35
    ds_read_b128 v[120:123], v6 offset:57600
    v_mfma_f32_16x16x32_bf16 v[64:67], v[124:127], v[252:255], v[64:67]
    ds_read_b128 v[124:127], v7 offset:57600
    s_waitcnt lgkmcnt(6)
    v_mfma_f32_16x16x32_bf16 v[52:55], v[96:99], v[160:163], v[84:87]
    v_exp_f32 v36, v36
    v_mfma_f32_16x16x32_bf16 v[60:63], v[96:99], v[192:195], v[88:91]
    v_exp_f32 v37, v37
    v_mfma_f32_16x16x32_bf16 v[68:71], v[96:99], v[224:227], v[92:95]
    s_barrier
    v_cvt_pk_bf16_f32 v78, v36, v37
    v_mfma_f32_16x16x32_bf16 v[52:55], v[100:103], v[164:167], v[52:55]
    ds_read_b64_tr_b16 v[128:129], v8 offset:32768
    v_mfma_f32_16x16x32_bf16 v[60:63], v[100:103], v[196:199], v[60:63]
    v_exp_f32 v38, v38
    v_mfma_f32_16x16x32_bf16 v[68:71], v[100:103], v[228:231], v[68:71]
    v_exp_f32 v39, v39
    s_waitcnt lgkmcnt(5)
    v_mfma_f32_16x16x32_bf16 v[52:55], v[104:107], v[168:171], v[52:55]
    v_cvt_pk_bf16_f32 v79, v38, v39
    ds_read_b64_tr_b16 v[130:131], v8 offset:40960
    v_mfma_f32_16x16x32_bf16 v[60:63], v[104:107], v[200:203], v[60:63]
    ds_read_b64_tr_b16 v[132:133], v9 offset:32768
    v_mfma_f32_16x16x32_bf16 v[68:71], v[104:107], v[232:235], v[68:71]
    v_exp_f32 v40, v40
    v_mfma_f32_16x16x32_bf16 v[52:55], v[108:111], v[172:175], v[52:55]
    v_exp_f32 v41, v41
    v_mfma_f32_16x16x32_bf16 v[60:63], v[108:111], v[204:207], v[60:63]
    v_cvt_pk_bf16_f32 v80, v40, v41
    ds_read_b64_tr_b16 v[134:135], v9 offset:40960
    v_mfma_f32_16x16x32_bf16 v[68:71], v[108:111], v[236:239], v[68:71]
    ds_read_b64_tr_b16 v[136:137], v10 offset:32768
    s_waitcnt lgkmcnt(7)
    v_mfma_f32_16x16x32_bf16 v[52:55], v[112:115], v[176:179], v[52:55]
    v_exp_f32 v42, v42
    v_mfma_f32_16x16x32_bf16 v[60:63], v[112:115], v[208:211], v[60:63]
    v_exp_f32 v43, v43
    v_mfma_f32_16x16x32_bf16 v[68:71], v[112:115], v[240:243], v[68:71]
    v_cvt_pk_bf16_f32 v81, v42, v43
    ds_read_b64_tr_b16 v[138:139], v10 offset:40960
    v_mfma_f32_16x16x32_bf16 v[52:55], v[116:119], v[180:183], v[52:55]
    ds_read_b64_tr_b16 v[140:141], v11 offset:32768
    v_mfma_f32_16x16x32_bf16 v[60:63], v[116:119], v[212:215], v[60:63]
    v_exp_f32 v44, v44
    v_mfma_f32_16x16x32_bf16 v[68:71], v[116:119], v[244:247], v[68:71]
    v_exp_f32 v45, v45
    s_waitcnt lgkmcnt(7)
    v_mfma_f32_16x16x32_bf16 v[52:55], v[120:123], v[184:187], v[52:55]
    v_cvt_pk_bf16_f32 v82, v44, v45
    ds_read_b64_tr_b16 v[142:143], v11 offset:40960
    v_mfma_f32_16x16x32_bf16 v[60:63], v[120:123], v[216:219], v[60:63]
    v_mfma_f32_16x16x32_bf16 v[68:71], v[120:123], v[248:251], v[68:71]
    v_exp_f32 v46, v46
    v_mfma_f32_16x16x32_bf16 v[52:55], v[124:127], v[188:191], v[52:55]
    v_exp_f32 v47, v47
    v_mfma_f32_16x16x32_bf16 v[60:63], v[124:127], v[220:223], v[60:63]
    v_cvt_pk_bf16_f32 v83, v46, v47
    v_mfma_f32_16x16x32_bf16 v[68:71], v[124:127], v[252:255], v[68:71]
    s_nop 1
    v_mfma_f32_16x16x32_bf16 a[192:195], a[204:207], v[72:75], a[192:195]
    ds_read_b64_tr_b16 v[144:145], v12 offset:32768
    v_mfma_f32_16x16x32_bf16 a[196:199], a[204:207], v[76:79], a[196:199]
    ds_read_b64_tr_b16 v[146:147], v12 offset:40960
    v_mfma_f32_16x16x32_bf16 a[200:203], a[204:207], v[80:83], a[200:203]
    s_waitcnt lgkmcnt(6)
    v_mfma_f32_16x16x32_bf16 a[0:3], v[128:131], v[72:75], a[0:3]
    ds_read_b64_tr_b16 v[148:149], v13 offset:32768
    v_mfma_f32_16x16x32_bf16 a[4:7], v[128:131], v[76:79], a[4:7]
    ds_read_b64_tr_b16 v[150:151], v13 offset:40960
    v_mfma_f32_16x16x32_bf16 a[8:11], v[128:131], v[80:83], a[8:11]
    v_mfma_f32_16x16x32_bf16 a[12:15], v[132:135], v[72:75], a[12:15]
    ds_read_b64_tr_b16 v[152:153], v14 offset:32768
    v_max3_f32 v16, v48, v49, v50
    v_mfma_f32_16x16x32_bf16 a[16:19], v[132:135], v[76:79], a[16:19]
    ds_read_b64_tr_b16 v[154:155], v14 offset:40960
    v_mfma_f32_16x16x32_bf16 a[20:23], v[132:135], v[80:83], a[20:23]
    v_max3_f32 v16, v16, v51, v52
    s_waitcnt lgkmcnt(6)
    v_mfma_f32_16x16x32_bf16 a[24:27], v[136:139], v[72:75], a[24:27]
    ds_read_b64_tr_b16 v[156:157], v15 offset:32768
    v_mfma_f32_16x16x32_bf16 a[28:31], v[136:139], v[76:79], a[28:31]
    ds_read_b64_tr_b16 v[158:159], v15 offset:40960
    v_max3_f32 v16, v16, v53, v54
    v_mfma_f32_16x16x32_bf16 a[32:35], v[136:139], v[80:83], a[32:35]
    v_mfma_f32_16x16x32_bf16 a[36:39], v[140:143], v[72:75], a[36:39]
    ds_read_b64_tr_b16 v[128:129], v8 offset:33024
    v_max3_f32 v16, v16, v55, v56
    v_mfma_f32_16x16x32_bf16 a[40:43], v[140:143], v[76:79], a[40:43]
    ds_read_b64_tr_b16 v[130:131], v8 offset:41216
    v_mfma_f32_16x16x32_bf16 a[44:47], v[140:143], v[80:83], a[44:47]
    v_max3_f32 v16, v16, v57, v58
    s_waitcnt lgkmcnt(6)
    v_mfma_f32_16x16x32_bf16 a[48:51], v[144:147], v[72:75], a[48:51]
    ds_read_b64_tr_b16 v[132:133], v9 offset:33024
    v_mfma_f32_16x16x32_bf16 a[52:55], v[144:147], v[76:79], a[52:55]
    ds_read_b64_tr_b16 v[134:135], v9 offset:41216
    v_max3_f32 v16, v16, v59, v60
    v_mfma_f32_16x16x32_bf16 a[56:59], v[144:147], v[80:83], a[56:59]
    v_mfma_f32_16x16x32_bf16 a[60:63], v[148:151], v[72:75], a[60:63]
    ds_read_b64_tr_b16 v[136:137], v10 offset:33024
    v_max3_f32 v16, v16, v61, v62
    v_mfma_f32_16x16x32_bf16 a[64:67], v[148:151], v[76:79], a[64:67]
    ds_read_b64_tr_b16 v[138:139], v10 offset:41216
    v_mfma_f32_16x16x32_bf16 a[68:71], v[148:151], v[80:83], a[68:71]
    v_max3_f32 v16, v16, v63, v64
    s_waitcnt lgkmcnt(6)
    v_mfma_f32_16x16x32_bf16 a[72:75], v[152:155], v[72:75], a[72:75]
    ds_read_b64_tr_b16 v[140:141], v11 offset:33024
    v_mfma_f32_16x16x32_bf16 a[76:79], v[152:155], v[76:79], a[76:79]
    ds_read_b64_tr_b16 v[142:143], v11 offset:41216
    v_max3_f32 v16, v16, v65, v66
    v_mfma_f32_16x16x32_bf16 a[80:83], v[152:155], v[80:83], a[80:83]
    v_mfma_f32_16x16x32_bf16 a[84:87], v[156:159], v[72:75], a[84:87]
    ds_read_b64_tr_b16 v[144:145], v12 offset:33024
    v_max3_f32 v16, v16, v67, v68
    v_mfma_f32_16x16x32_bf16 a[88:91], v[156:159], v[76:79], a[88:91]
    ds_read_b64_tr_b16 v[146:147], v12 offset:41216
    v_mfma_f32_16x16x32_bf16 a[92:95], v[156:159], v[80:83], a[92:95]
    v_max3_f32 v16, v16, v69, v70
    s_waitcnt lgkmcnt(6)
    v_mfma_f32_16x16x32_bf16 a[96:99], v[128:131], v[72:75], a[96:99]
    ds_read_b64_tr_b16 v[148:149], v13 offset:33024
    v_mfma_f32_16x16x32_bf16 a[100:103], v[128:131], v[76:79], a[100:103]
    ds_read_b64_tr_b16 v[150:151], v13 offset:41216
    v_max_f32 v16, v16, v71
    v_mfma_f32_16x16x32_bf16 a[104:107], v[128:131], v[80:83], a[104:107]
    v_mfma_f32_16x16x32_bf16 a[108:111], v[132:135], v[72:75], a[108:111]
    s_barrier
    ds_read_b64_tr_b16 v[152:153], v14 offset:33024
    v_mfma_f32_16x16x32_bf16 a[112:115], v[132:135], v[76:79], a[112:115]
    ds_read_b64_tr_b16 v[154:155], v14 offset:41216
    v_cmp_lt_f32 vcc, s31, v16
    v_mfma_f32_16x16x32_bf16 a[116:119], v[132:135], v[80:83], a[116:119]
    ds_read_b128 v[96:99], v4 offset:0
    s_waitcnt lgkmcnt(7)
    v_mfma_f32_16x16x32_bf16 a[120:123], v[136:139], v[72:75], a[120:123]
    ds_read_b64_tr_b16 v[156:157], v15 offset:33024
    v_mfma_f32_16x16x32_bf16 a[124:127], v[136:139], v[76:79], a[124:127]
    ds_read_b64_tr_b16 v[158:159], v15 offset:41216
    v_mfma_f32_16x16x32_bf16 a[128:131], v[136:139], v[80:83], a[128:131]
    ds_read_b128 v[100:103], v5 offset:0
    v_mfma_f32_16x16x32_bf16 a[132:135], v[140:143], v[72:75], a[132:135]
    ds_read_b128 v[104:107], v6 offset:0
    v_mfma_f32_16x16x32_bf16 a[136:139], v[140:143], v[76:79], a[136:139]
    ds_read_b128 v[108:111], v7 offset:0
    v_mfma_f32_16x16x32_bf16 a[140:143], v[140:143], v[80:83], a[140:143]
    s_waitcnt lgkmcnt(8)
    v_mfma_f32_16x16x32_bf16 a[144:147], v[144:147], v[72:75], a[144:147]
    ds_read_b128 v[112:115], v4 offset:256
    v_mfma_f32_16x16x32_bf16 a[148:151], v[144:147], v[76:79], a[148:151]
    v_mfma_f32_16x16x32_bf16 a[152:155], v[144:147], v[80:83], a[152:155]
    ds_read_b128 v[116:119], v5 offset:256
    v_mfma_f32_16x16x32_bf16 a[156:159], v[148:151], v[72:75], a[156:159]
    v_mfma_f32_16x16x32_bf16 a[160:163], v[148:151], v[76:79], a[160:163]
    ds_read_b128 v[120:123], v6 offset:256
    v_mfma_f32_16x16x32_bf16 a[164:167], v[148:151], v[80:83], a[164:167]
    s_waitcnt lgkmcnt(6)
    v_mfma_f32_16x16x32_bf16 a[168:171], v[152:155], v[72:75], a[168:171]
    ds_read_b128 v[124:127], v7 offset:256
    v_mfma_f32_16x16x32_bf16 a[172:175], v[152:155], v[76:79], a[172:175]
    v_mfma_f32_16x16x32_bf16 a[176:179], v[152:155], v[80:83], a[176:179]
    v_mfma_f32_16x16x32_bf16 a[180:183], v[156:159], v[72:75], a[180:183]
    v_mfma_f32_16x16x32_bf16 a[184:187], v[156:159], v[76:79], a[184:187]
    v_mfma_f32_16x16x32_bf16 a[188:191], v[156:159], v[80:83], a[188:191]
    s_cbranch_vccnz L_rare_L_loopm_14
L_back_L_loopm_14:
    s_waitcnt lgkmcnt(6)
    v_mfma_f32_16x16x32_bf16 v[24:27], v[96:99], v[160:163], v[84:87]
    v_exp_f32 v48, v48
    v_mfma_f32_16x16x32_bf16 v[32:35], v[96:99], v[192:195], v[88:91]
    v_exp_f32 v49, v49
    v_mfma_f32_16x16x32_bf16 v[40:43], v[96:99], v[224:227], v[92:95]
    v_cvt_pk_bf16_f32 v72, v48, v49
    ds_read_b128 v[96:99], v4 offset:8192
    v_mfma_f32_16x16x32_bf16 v[24:27], v[100:103], v[164:167], v[24:27]
    v_mfma_f32_16x16x32_bf16 v[32:35], v[100:103], v[196:199], v[32:35]
    v_exp_f32 v50, v50
    v_mfma_f32_16x16x32_bf16 v[40:43], v[100:103], v[228:231], v[40:43]
    v_exp_f32 v51, v51
    s_waitcnt lgkmcnt(5)
    v_mfma_f32_16x16x32_bf16 v[24:27], v[104:107], v[168:171], v[24:27]
    v_cvt_pk_bf16_f32 v73, v50, v51
    ds_read_b128 v[100:103], v5 offset:8192
    v_mfma_f32_16x16x32_bf16 v[32:35], v[104:107], v[200:203], v[32:35]
    v_mfma_f32_16x16x32_bf16 v[40:43], v[104:107], v[232:235], v[40:43]
    v_exp_f32 v52, v52
    v_mfma_f32_16x16x32_bf16 v[24:27], v[108:111], v[172:175], v[24:27]
    v_exp_f32 v53, v53
    v_mfma_f32_16x16x32_bf16 v[32:35], v[108:111], v[204:207], v[32:35]
    v_cvt_pk_bf16_f32 v74, v52, v53
    ds_read_b128 v[104:107], v6 offset:8192
    v_mfma_f32_16x16x32_bf16 v[40:43], v[108:111], v[236:239], v[40:43]
    ds_read_b128 v[108:111], v7 offset:8192
    s_waitcnt lgkmcnt(6)
    v_mfma_f32_16x16x32_bf16 v[24:27], v[112:115], v[176:179], v[24:27]
    v_exp_f32 v54, v54
    v_mfma_f32_16x16x32_bf16 v[32:35], v[112:115], v[208:211], v[32:35]
    v_exp_f32 v55, v55
    v_mfma_f32_16x16x32_bf16 v[40:43], v[112:115], v[240:243], v[40:43]
    v_cvt_pk_bf16_f32 v75, v54, v55
    ds_read_b128 v[112:115], v4 offset:8448
    v_mfma_f32_16x16x32_bf16 v[24:27], v[116:119], v[180:183], v[24:27]
    v_mfma_f32_16x16x32_bf16 v[32:35], v[116:119], v[212:215], v[32:35]
    v_exp_f32 v56, v56
    v_mfma_f32_16x16x32_bf16 v[40:43], v[116:119], v[244:247], v[40:43]
    v_exp_f32 v57, v57
    s_waitcnt lgkmcnt(5)
    v_mfma_f32_16x16x32_bf16 v[24:27], v[120:123], v[184:187], v[24:27]
    v_cvt_pk_bf16_f32 v76, v56, v57
    ds_read_b128 v[116:119], v5 offset:8448
    v_mfma_f32_16x16x32_bf16 v[32:35], v[120:123], v[216:219], v[32:35]
    v_mfma_f32_16x16x32_bf16 v[40:43], v[120:123], v[248:251], v[40:43]
    v_exp_f32 v58, v58
    v_mfma_f32_16x16x32_bf16 v[24:27], v[124:127], v[188:191], v[24:27]
    v_exp_f32 v59, v59
    v_mfma_f32_16x16x32_bf16 v[32:35], v[124:127], v[220:223], v[32:35]
    v_cvt_pk_bf16_f32 v77, v58, v59
    ds_read_b128 v[120:123], v6 offset:8448
    v_mfma_f32_16x16x32_bf16 v[40:43], v[124:127], v[252:255], v[40:43]
    ds_read_b128 v[124:127], v7 offset:8448
    s_waitcnt lgkmcnt(6)
    v_mfma_f32_16x16x32_bf16 v[28:31], v[96:99], v[160:163], v[84:87]
    v_exp_f32 v60, v60
    v_mfma_f32_16x16x32_bf16 v[36:39], v[96:99], v[192:195], v[88:91]
    v_exp_f32 v61, v61
    v_mfma_f32_16x16x32_bf16 v[44:47], v[96:99], v[224:227], v[92:95]
    s_barrier
    v_cvt_pk_bf16_f32 v78, v60, v61
    v_mfma_f32_16x16x32_bf16 v[28:31], v[100:103], v[164:167], v[28:31]
    ds_read_b64_tr_b16 v[128:129], v8 offset:49152
    v_mfma_f32_16x16x32_bf16 v[36:39], v[100:103], v[196:199], v[36:39]
    v_exp_f32 v62, v62
    v_mfma_f32_16x16x32_bf16 v[44:47], v[100:103], v[228:231], v[44:47]
    v_exp_f32 v63, v63
    s_waitcnt lgkmcnt(5)
    v_mfma_f32_16x16x32_bf16 v[28:31], v[104:107], v[168:171], v[28:31]
    v_cvt_pk_bf16_f32 v79, v62, v63
    ds_read_b64_tr_b16 v[130:131], v8 offset:57344
    v_mfma_f32_16x16x32_bf16 v[36:39], v[104:107], v[200:203], v[36:39]
    ds_read_b64_tr_b16 v[132:133], v9 offset:49152
    v_mfma_f32_16x16x32_bf16 v[44:47], v[104:107], v[232:235], v[44:47]
    v_exp_f32 v64, v64
    v_mfma_f32_16x16x32_bf16 v[28:31], v[108:111], v[172:175], v[28:31]
    v_exp_f32 v65, v65
    v_mfma_f32_16x16x32_bf16 v[36:39], v[108:111], v[204:207], v[36:39]
    v_cvt_pk_bf16_f32 v80, v64, v65
    ds_read_b64_tr_b16 v[134:135], v9 offset:57344
    v_mfma_f32_16x16x32_bf16 v[44:47], v[108:111], v[236:239], v[44:47]
    ds_read_b64_tr_b16 v[136:137], v10 offset:49152
    s_waitcnt lgkmcnt(7)
    v_mfma_f32_16x16x32_bf16 v[28:31], v[112:115], v[176:179], v[28:31]
    v_exp_f32 v66, v66
    v_mfma_f32_16x16x32_bf16 v[36:39], v[112:115], v[208:211], v[36:39]
    v_exp_f32 v67, v67
    v_mfma_f32_16x16x32_bf16 v[44:47], v[112:115], v[240:243], v[44:47]
    v_cvt_pk_bf16_f32 v81, v66, v67
    ds_read_b64_tr_b16 v[138:139], v10 offset:57344
    v_mfma_f32_16x16x32_bf16 v[28:31], v[116:119], v[180:183], v[28:31]
    ds_read_b64_tr_b16 v[140:141], v11 offset:49152
    v_mfma_f32_16x16x32_bf16 v[36:39], v[116:119], v[212:215], v[36:39]
    v_exp_f32 v68, v68
    v_mfma_f32_16x16x32_bf16 v[44:47], v[116:119], v[244:247], v[44:47]
    v_exp_f32 v69, v69
    s_waitcnt lgkmcnt(7)
    v_mfma_f32_16x16x32_bf16 v[28:31], v[120:123], v[184:187], v[28:31]
    v_cvt_pk_bf16_f32 v82, v68, v69
    ds_read_b64_tr_b16 v[142:143], v11 offset:57344
    v_mfma_f32_16x16x32_bf16 v[36:39], v[120:123], v[216:219], v[36:39]
    v_mfma_f32_16x16x32_bf16 v[44:47], v[120:123], v[248:251], v[44:47]
    v_exp_f32 v70, v70
    v_mfma_f32_16x16x32_bf16 v[28:31], v[124:127], v[188:191], v[28:31]
    v_exp_f32 v71, v71
    v_mfma_f32_16x16x32_bf16 v[36:39], v[124:127], v[220:223], v[36:39]
    v_cvt_pk_bf16_f32 v83, v70, v71
    v_mfma_f32_16x16x32_bf16 v[44:47], v[124:127], v[252:255], v[44:47]
    s_nop 1
    v_mfma_f32_16x16x32_bf16 a[192:195], a[204:207], v[72:75], a[192:195]
    ds_read_b64_tr_b16 v[144:145], v12 offset:49152
    v_mfma_f32_16x16x32_bf16 a[196:199], a[204:207], v[76:79], a[196:199]
    ds_read_b64_tr_b16 v[146:147], v12 offset:57344
    v_mfma_f32_16x16x32_bf16 a[200:203], a[204:207], v[80:83], a[200:203]
    s_waitcnt lgkmcnt(6)
    v_mfma_f32_16x16x32_bf16 a[0:3], v[128:131], v[72:75], a[0:3]
    ds_read_b64_tr_b16 v[148:149], v13 offset:49152
    v_mfma_f32_16x16x32_bf16 a[4:7], v[128:131], v[76:79], a[4:7]
    ds_read_b64_tr_b16 v[150:151], v13 offset:57344
    v_mfma_f32_16x16x32_bf16 a[8:11], v[128:131], v[80:83], a[8:11]
    v_mfma_f32_16x16x32_bf16 a[12:15], v[132:135], v[72:75], a[12:15]
    ds_read_b64_tr_b16 v[152:153], v14 offset:49152
    v_max3_f32 v16, v24, v25, v26
    v_mfma_f32_16x16x32_bf16 a[16:19], v[132:135], v[76:79], a[16:19]
    ds_read_b64_tr_b16 v[154:155], v14 offset:57344
    v_mfma_f32_16x16x32_bf16 a[20:23], v[132:135], v[80:83], a[20:23]
    v_max3_f32 v16, v16, v27, v28
    s_waitcnt lgkmcnt(6)
    v_mfma_f32_16x16x32_bf16 a[24:27], v[136:139], v[72:75], a[24:27]
    ds_read_b64_tr_b16 v[156:157], v15 offset:49152
    v_mfma_f32_16x16x32_bf16 a[28:31], v[136:139], v[76:79], a[28:31]
    ds_read_b64_tr_b16 v[158:159], v15 offset:57344
    v_max3_f32 v16, v16, v29, v30
    v_mfma_f32_16x16x32_bf16 a[32:35], v[136:139], v[80:83], a[32:35]
    v_mfma_f32_16x16x32_bf16 a[36:39], v[140:143], v[72:75], a[36:39]
    ds_read_b64_tr_b16 v[128:129], v8 offset:49408
    v_max3_f32 v16, v16, v31, v32
    v_mfma_f32_16x16x32_bf16 a[40:43], v[140:143], v[76:79], a[40:43]
    ds_read_b64_tr_b16 v[130:131], v8 offset:57600
    v_mfma_f32_16x16x32_bf16 a[44:47], v[140:143], v[80:83], a[44:47]
    v_max3_f32 v16, v16, v33, v34
    s_waitcnt lgkmcnt(6)
    v_mfma_f32_16x16x32_bf16 a[48:51], v[144:147], v[72:75], a[48:51]
    ds_read_b64_tr_b16 v[132:133], v9 offset:49408
    v_mfma_f32_16x16x32_bf16 a[52:55], v[144:147], v[76:79], a[52:55]
    ds_read_b64_tr_b16 v[134:135], v9 offset:57600
    v_max3_f32 v16, v16, v35, v36
    v_mfma_f32_16x16x32_bf16 a[56:59], v[144:147], v[80:83], a[56:59]
    v_mfma_f32_16x16x32_bf16 a[60:63], v[148:151], v[72:75], a[60:63]
    ds_read_b64_tr_b16 v[136:137], v10 offset:49408
    v_max3_f32 v16, v16, v37, v38
    v_mfma_f32_16x16x32_bf16 a[64:67], v[148:151], v[76:79], a[64:67]
    ds_read_b64_tr_b16 v[138:139], v10 offset:57600
    v_mfma_f32_16x16x32_bf16 a[68:71], v[148:151], v[80:83], a[68:71]
    v_max3_f32 v16, v16, v39, v40
    s_waitcnt lgkmcnt(6)
    v_mfma_f32_16x16x32_bf16 a[72:75], v[152:155], v[72:75], a[72:75]
    ds_read_b64_tr_b16 v[140:141], v11 offset:49408
    v_mfma_f32_16x16x32_bf16 a[76:79], v[152:155], v[76:79], a[76:79]
    ds_read_b64_tr_b16 v[142:143], v11 offset:57600
    v_max3_f32 v16, v16, v41, v42
    v_mfma_f32_16x16x32_bf16 a[80:83], v[152:155], v[80:83], a[80:83]
    v_mfma_f32_16x16x32_bf16 a[84:87], v[156:159], v[72:75], a[84:87]
    ds_read_b64_tr_b16 v[144:145], v12 offset:49408
    v_max3_f32 v16, v16, v43, v44
    v_mfma_f32_16x16x32_bf16 a[88:91], v[156:159], v[76:79], a[88:91]
    ds_read_b64_tr_b16 v[146:147], v12 offset:57600
    v_mfma_f32_16x16x32_bf16 a[92:95], v[156:159], v[80:83], a[92:95]
    v_max3_f32 v16, v16, v45, v46
    s_waitcnt lgkmcnt(6)
    v_mfma_f32_16x16x32_bf16 a[96:99], v[128:131], v[72:75], a[96:99]
    ds_read_b64_tr_b16 v[148:149], v13 offset:49408
    v_mfma_f32_16x16x32_bf16 a[100:103], v[128:131], v[76:79], a[100:103]
    ds_read_b64_tr_b16 v[150:151], v13 offset:57600
    v_max_f32 v16, v16, v47
    v_mfma_f32_16x16x32_bf16 a[104:107], v[128:131], v[80:83], a[104:107]
    v_mfma_f32_16x16x32_bf16 a[108:111], v[132:135], v[72:75], a[108:111]
    s_barrier
    ds_read_b64_tr_b16 v[152:153], v14 offset:49408
    v_mfma_f32_16x16x32_bf16 a[112:115], v[132:135], v[76:79], a[112:115]
    ds_read_b64_tr_b16 v[154:155], v14 offset:57600
    v_cmp_lt_f32 vcc, s31, v16
    v_mfma_f32_16x16x32_bf16 a[116:119], v[132:135], v[80:83], a[116:119]
    ds_read_b128 v[96:99], v4 offset:16384
    s_waitcnt lgkmcnt(7)
    v_mfma_f32_16x16x32_bf16 a[120:123], v[136:139], v[72:75], a[120:123]
    ds_read_b64_tr_b16 v[156:157], v15 offset:49408
    v_mfma_f32_16x16x32_bf16 a[124:127], v[136:139], v[76:79], a[124:127]
    ds_read_b64_tr_b16 v[158:159], v15 offset:57600
    v_mfma_f32_16x16x32_bf16 a[128:131], v[136:139], v[80:83], a[128:131]
    ds_read_b128 v[100:103], v5 offset:16384
    v_mfma_f32_16x16x32_bf16 a[132:135], v[140:143], v[72:75], a[132:135]
    ds_read_b128 v[104:107], v6 offset:16384
    v_mfma_f32_16x16x32_bf16 a[136:139], v[140:143], v[76:79], a[136:139]
    ds_read_b128 v[108:111], v7 offset:16384
    v_mfma_f32_16x16x32_bf16 a[140:143], v[140:143], v[80:83], a[140:143]
    s_waitcnt lgkmcnt(8)
    v_mfma_f32_16x16x32_bf16 a[144:147], v[144:147], v[72:75], a[144:147]
    ds_read_b128 v[112:115], v4 offset:16640
    v_mfma_f32_16x16x32_bf16 a[148:151], v[144:147], v[76:79], a[148:151]
    v_mfma_f32_16x16x32_bf16 a[152:155], v[144:147], v[80:83], a[152:155]
    ds_read_b128 v[116:119], v5 offset:16640
    v_mfma_f32_16x16x32_bf16 a[156:159], v[148:151], v[72:75], a[156:159]
    v_mfma_f32_16x16x32_bf16 a[160:163], v[148:151], v[76:79], a[160:163]
    ds_read_b128 v[120:123], v6 offset:16640
    v_mfma_f32_16x16x32_bf16 a[164:167], v[148:151], v[80:83], a[164:167]
    s_waitcnt lgkmcnt(6)
    v_mfma_f32_16x16x32_bf16 a[168:171], v[152:155], v[72:75], a[168:171]
    ds_read_b128 v[124:127], v7 offset:16640
    v_mfma_f32_16x16x32_bf16 a[172:175], v[152:155], v[76:79], a[172:175]
    v_mfma_f32_16x16x32_bf16 a[176:179], v[152:155], v[80:83], a[176:179]
    v_mfma_f32_16x16x32_bf16 a[180:183], v[156:159], v[72:75], a[180:183]
    v_mfma_f32_16x16x32_bf16 a[184:187], v[156:159], v[76:79], a[184:187]
    v_mfma_f32_16x16x32_bf16 a[188:191], v[156:159], v[80:83], a[188:191]
    s_cbranch_vccnz L_rare_L_loopm_15
L_back_L_loopm_15:
    s_waitcnt lgkmcnt(6)
    v_mfma_f32_16x16x32_bf16 v[48:51], v[96:99], v[160:163], v[84:87]
    v_exp_f32 v24, v24
    v_mfma_f32_16x16x32_bf16 v[56:59], v[96:99], v[192:195], v[88:91]
    v_exp_f32 v25, v25
    v_mfma_f32_16x16x32_bf16 v[64:67], v[96:99], v[224:227], v[92:95]
    v_cvt_pk_bf16_f32 v72, v24, v25
    ds_read_b128 v[96:99], v4 offset:24576
    v_mfma_f32_16x16x32_bf16 v[48:51], v[100:103], v[164:167], v[48:51]
    v_mfma_f32_16x16x32_bf16 v[56:59], v[100:103], v[196:199], v[56:59]
    v_exp_f32 v26, v26
    v_mfma_f32_16x16x32_bf16 v[64:67], v[100:103], v[228:231], v[64:67]
    v_exp_f32 v27, v27
    s_waitcnt lgkmcnt(5)
    v_mfma_f32_16x16x32_bf16 v[48:51], v[104:107], v[168:171], v[48:51]
    v_cvt_pk_bf16_f32 v73, v26, v27
    ds_read_b128 v[100:103], v5 offset:24576
    v_mfma_f32_16x16x32_bf16 v[56:59], v[104:107], v[200:203], v[56:59]
    v_mfma_f32_16x16x32_bf16 v[64:67], v[104:107], v[232:235], v[64:67]
    v_exp_f32 v28, v28
    v_mfma_f32_16x16x32_bf16 v[48:51], v[108:111], v[172:175], v[48:51]
    v_exp_f32 v29, v29
    v_mfma_f32_16x16x32_bf16 v[56:59], v[108:111], v[204:207], v[56:59]
    v_cvt_pk_bf16_f32 v74, v28, v29
    ds_read_b128 v[104:107], v6 offset:24576
    v_mfma_f32_16x16x32_bf16 v[64:67], v[108:111], v[236:239], v[64:67]
    ds_read_b128 v[108:111], v7 offset:24576
    s_waitcnt lgkmcnt(6)
    v_mfma_f32_16x16x32_bf16 v[48:51], v[112:115], v[176:179], v[48:51]
    v_exp_f32 v30, v30
    v_mfma_f32_16x16x32_bf16 v[56:59], v[112:115], v[208:211], v[56:59]
    v_exp_f32 v31, v31
    v_mfma_f32_16x16x32_bf16 v[64:67], v[112:115], v[240:243], v[64:67]
    v_cvt_pk_bf16_f32 v75, v30, v31
    ds_read_b128 v[112:115], v4 offset:24832
    v_mfma_f32_16x16x32_bf16 v[48:51], v[116:119], v[180:183], v[48:51]
    v_mfma_f32_16x16x32_bf16 v[56:59], v[116:119], v[212:215], v[56:59]
    v_exp_f32 v32, v32
    v_mfma_f32_16x16x32_bf16 v[64:67], v[116:119], v[244:247], v[64:67]
    v_exp_f32 v33, v33
    s_waitcnt lgkmcnt(5)
    v_mfma_f32_16x16x32_bf16 v[48:51], v[120:123], v[184:187], v[48:51]
    v_cvt_pk_bf16_f32 v76, v32, v33
    ds_read_b128 v[116:119], v5 offset:24832
    v_mfma_f32_16x16x32_bf16 v[56:59], v[120:123], v[216:219], v[56:59]
    v_mfma_f32_16x16x32_bf16 v[64:67], v[120:123], v[248:251], v[64:67]
    v_exp_f32 v34, v34
    v_mfma_f32_16x16x32_bf16 v[48:51], v[124:127], v[188:191], v[48:51]
    v_exp_f32 v35, v35
    v_mfma_f32_16x16x32_bf16 v[56:59], v[124:127], v[220:223], v[56:59]
    v_cvt_pk_bf16_f32 v77, v34, v35
    ds_read_b128 v[120:123], v6 offset:24832
    v_mfma_f32_16x16x32_bf16 v[64:67], v[124:127], v[252:255], v[64:67]
    ds_read_b128 v[124:127], v7 offset:24832
    s_waitcnt lgkmcnt(6)
    v_mfma_f32_16x16x32_bf16 v[52:55], v[96:99], v[160:163], v[84:87]
    v_exp_f32 v36, v36
    v_mfma_f32_16x16x32_bf16 v[60:63], v[96:99], v[192:195], v[88:91]
    v_exp_f32 v37, v37
    v_mfma_f32_16x16x32_bf16 v[68:71], v[96:99], v[224:227], v[92:95]
    s_barrier
    v_cvt_pk_bf16_f32 v78, v36, v37
    v_mfma_f32_16x16x32_bf16 v[52:55], v[100:103], v[164:167], v[52:55]
    ds_read_b64_tr_b16 v[128:129], v8 offset:0
    v_mfma_f32_16x16x32_bf16 v[60:63], v[100:103], v[196:199], v[60:63]
    v_exp_f32 v38, v38
    v_mfma_f32_16x16x32_bf16 v[68:71], v[100:103], v[228:231], v[68:71]
    v_exp_f32 v39, v39
    s_waitcnt lgkmcnt(5)
    v_mfma_f32_16x16x32_bf16 v[52:55], v[104:107], v[168:171], v[52:55]
    v_cvt_pk_bf16_f32 v79, v38, v39
    ds_read_b64_tr_b16 v[130:131], v8 offset:8192
    v_mfma_f32_16x16x32_bf16 v[60:63], v[104:107], v[200:203], v[60:63]
    ds_read_b64_tr_b16 v[132:133], v9 offset:0
    v_mfma_f32_16x16x32_bf16 v[68:71], v[104:107], v[232:235], v[68:71]
    v_exp_f32 v40, v40
    v_mfma_f32_16x16x32_bf16 v[52:55], v[108:111], v[172:175], v[52:55]
    v_exp_f32 v41, v41
    v_mfma_f32_16x16x32_bf16 v[60:63], v[108:111], v[204:207], v[60:63]
    v_cvt_pk_bf16_f32 v80, v40, v41
    ds_read_b64_tr_b16 v[134:135], v9 offset:8192
    v_mfma_f32_16x16x32_bf16 v[68:71], v[108:111], v[236:239], v[68:71]
    ds_read_b64_tr_b16 v[136:137], v10 offset:0
    s_waitcnt lgkmcnt(7)
    v_mfma_f32_16x16x32_bf16 v[52:55], v[112:115], v[176:179], v[52:55]
    v_exp_f32 v42, v42
    v_mfma_f32_16x16x32_bf16 v[60:63], v[112:115], v[208:211], v[60:63]
    v_exp_f32 v43, v43
    v_mfma_f32_16x16x32_bf16 v[68:71], v[112:115], v[240:243], v[68:71]
    v_cvt_pk_bf16_f32 v81, v42, v43
    ds_read_b64_tr_b16 v[138:139], v10 offset:8192
    v_mfma_f32_16x16x32_bf16 v[52:55], v[116:119], v[180:183], v[52:55]
    ds_read_b64_tr_b16 v[140:141], v11 offset:0
    v_mfma_f32_16x16x32_bf16 v[60:63], v[116:119], v[212:215], v[60:63]
    v_exp_f32 v44, v44
    v_mfma_f32_16x16x32_bf16 v[68:71], v[116:119], v[244:247], v[68:71]
    v_exp_f32 v45, v45
    s_waitcnt lgkmcnt(7)
    v_mfma_f32_16x16x32_bf16 v[52:55], v[120:123], v[184:187], v[52:55]
    v_cvt_pk_bf16_f32 v82, v44, v45
    ds_read_b64_tr_b16 v[142:143], v11 offset:8192
    v_mfma_f32_16x16x32_bf16 v[60:63], v[120:123], v[216:219], v[60:63]
    v_mfma_f32_16x16x32_bf16 v[68:71], v[120:123], v[248:251], v[68:71]
    v_exp_f32 v46, v46
    v_mfma_f32_16x16x32_bf16 v[52:55], v[124:127], v[188:191], v[52:55]
    v_exp_f32 v47, v47
    v_mfma_f32_16x16x32_bf16 v[60:63], v[124:127], v[220:223], v[60:63]
    v_cvt_pk_bf16_f32 v83, v46, v47
    v_mfma_f32_16x16x32_bf16 v[68:71], v[124:127], v[252:255], v[68:71]
    s_nop 1
    v_mfma_f32_16x16x32_bf16 a[192:195], a[204:207], v[72:75], a[192:195]
    ds_read_b64_tr_b16 v[144:145], v12 offset:0
    v_mfma_f32_16x16x32_bf16 a[196:199], a[204:207], v[76:79], a[196:199]
    ds_read_b64_tr_b16 v[146:147], v12 offset:8192
    v_mfma_f32_16x16x32_bf16 a[200:203], a[204:207], v[80:83], a[200:203]
    s_waitcnt lgkmcnt(6)
    v_mfma_f32_16x16x32_bf16 a[0:3], v[128:131], v[72:75], a[0:3]
    ds_read_b64_tr_b16 v[148:149], v13 offset:0
    v_mfma_f32_16x16x32_bf16 a[4:7], v[128:131], v[76:79], a[4:7]
    ds_read_b64_tr_b16 v[150:151], v13 offset:8192
    v_mfma_f32_16x16x32_bf16 a[8:11], v[128:131], v[80:83], a[8:11]
    v_mfma_f32_16x16x32_bf16 a[12:15], v[132:135], v[72:75], a[12:15]
    ds_read_b64_tr_b16 v[152:153], v14 offset:0
    v_max3_f32 v16, v48, v49, v50
    v_mfma_f32_16x16x32_bf16 a[16:19], v[132:135], v[76:79], a[16:19]
    ds_read_b64_tr_b16 v[154:155], v14 offset:8192
    v_mfma_f32_16x16x32_bf16 a[20:23], v[132:135], v[80:83], a[20:23]
    v_max3_f32 v16, v16, v51, v52
    s_waitcnt lgkmcnt(6)
    v_mfma_f32_16x16x32_bf16 a[24:27], v[136:139], v[72:75], a[24:27]
    ds_read_b64_tr_b16 v[156:157], v15 offset:0
    v_mfma_f32_16x16x32_bf16 a[28:31], v[136:139], v[76:79], a[28:31]
    ds_read_b64_tr_b16 v[158:159], v15 offset:8192
    v_max3_f32 v16, v16, v53, v54
    v_mfma_f32_16x16x32_bf16 a[32:35], v[136:139], v[80:83], a[32:35]
    v_mfma_f32_16x16x32_bf16 a[36:39], v[140:143], v[72:75], a[36:39]
    ds_read_b64_tr_b16 v[128:129], v8 offset:256
    v_max3_f32 v16, v16, v55, v56
    v_mfma_f32_16x16x32_bf16 a[40:43], v[140:143], v[76:79], a[40:43]
    ds_read_b64_tr_b16 v[130:131], v8 offset:8448
    v_mfma_f32_16x16x32_bf16 a[44:47], v[140:143], v[80:83], a[44:47]
    v_max3_f32 v16, v16, v57, v58
    s_waitcnt lgkmcnt(6)
    v_mfma_f32_16x16x32_bf16 a[48:51], v[144:147], v[72:75], a[48:51]
    ds_read_b64_tr_b16 v[132:133], v9 offset:256
    v_mfma_f32_16x16x32_bf16 a[52:55], v[144:147], v[76:79], a[52:55]
    ds_read_b64_tr_b16 v[134:135], v9 offset:8448
    v_max3_f32 v16, v16, v59, v60
    v_mfma_f32_16x16x32_bf16 a[56:59], v[144:147], v[80:83], a[56:59]
    v_mfma_f32_16x16x32_bf16 a[60:63], v[148:151], v[72:75], a[60:63]
    ds_read_b64_tr_b16 v[136:137], v10 offset:256
    v_max3_f32 v16, v16, v61, v62
    v_mfma_f32_16x16x32_bf16 a[64:67], v[148:151], v[76:79], a[64:67]
    ds_read_b64_tr_b16 v[138:139], v10 offset:8448
    v_mfma_f32_16x16x32_bf16 a[68:71], v[148:151], v[80:83], a[68:71]
    v_max3_f32 v16, v16, v63, v64
    s_waitcnt lgkmcnt(6)
    v_mfma_f32_16x16x32_bf16 a[72:75], v[152:155], v[72:75], a[72:75]
    ds_read_b64_tr_b16 v[140:141], v11 offset:256
    v_mfma_f32_16x16x32_bf16 a[76:79], v[152:155], v[76:79], a[76:79]
    ds_read_b64_tr_b16 v[142:143], v11 offset:8448
    v_max3_f32 v16, v16, v65, v66
    v_mfma_f32_16x16x32_bf16 a[80:83], v[152:155], v[80:83], a[80:83]
    v_mfma_f32_16x16x32_bf16 a[84:87], v[156:159], v[72:75], a[84:87]
    ds_read_b64_tr_b16 v[144:145], v12 offset:256
    v_max3_f32 v16, v16, v67, v68
    v_mfma_f32_16x16x32_bf16 a[88:91], v[156:159], v[76:79], a[88:91]
    ds_read_b64_tr_b16 v[146:147], v12 offset:8448
    v_mfma_f32_16x16x32_bf16 a[92:95], v[156:159], v[80:83], a[92:95]
    v_max3_f32 v16, v16, v69, v70
    s_waitcnt lgkmcnt(6)
    v_mfma_f32_16x16x32_bf16 a[96:99], v[128:131], v[72:75], a[96:99]
    ds_read_b64_tr_b16 v[148:149], v13 offset:256
    v_mfma_f32_16x16x32_bf16 a[100:103], v[128:131], v[76:79], a[100:103]
    ds_read_b64_tr_b16 v[150:151], v13 offset:8448
    v_max_f32 v16, v16, v71
    v_mfma_f32_16x16x32_bf16 a[104:107], v[128:131], v[80:83], a[104:107]
    v_mfma_f32_16x16x32_bf16 a[108:111], v[132:135], v[72:75], a[108:111]
    s_barrier
    ds_read_b64_tr_b16 v[152:153], v14 offset:256
    v_mfma_f32_16x16x32_bf16 a[112:115], v[132:135], v[76:79], a[112:115]
    ds_read_b64_tr_b16 v[154:155], v14 offset:8448
    v_cmp_lt_f32 vcc, s31, v16
    v_mfma_f32_16x16x32_bf16 a[116:119], v[132:135], v[80:83], a[116:119]
    ds_read_b128 v[96:99], v4 offset:32768
    s_waitcnt lgkmcnt(7)
    v_mfma_f32_16x16x32_bf16 a[120:123], v[136:139], v[72:75], a[120:123]
    ds_read_b64_tr_b16 v[156:157], v15 offset:256
    v_mfma_f32_16x16x32_bf16 a[124:127], v[136:139], v[76:79], a[124:127]
    ds_read_b64_tr_b16 v[158:159], v15 offset:8448
    v_mfma_f32_16x16x32_bf16 a[128:131], v[136:139], v[80:83], a[128:131]
    ds_read_b128 v[100:103], v5 offset:32768
    v_mfma_f32_16x16x32_bf16 a[132:135], v[140:143], v[72:75], a[132:135]
    ds_read_b128 v[104:107], v6 offset:32768
    v_mfma_f32_16x16x32_bf16 a[136:139], v[140:143], v[76:79], a[136:139]
    ds_read_b128 v[108:111], v7 offset:32768
    v_mfma_f32_16x16x32_bf16 a[140:143], v[140:143], v[80:83], a[140:143]
    s_waitcnt lgkmcnt(8)
    v_mfma_f32_16x16x32_bf16 a[144:147], v[144:147], v[72:75], a[144:147]
    ds_read_b128 v[112:115], v4 offset:33024
    v_mfma_f32_16x16x32_bf16 a[148:151], v[144:147], v[76:79], a[148:151]
    v_mfma_f32_16x16x32_bf16 a[152:155], v[144:147], v[80:83], a[152:155]
    ds_read_b128 v[116:119], v5 offset:33024
    v_mfma_f32_16x16x32_bf16 a[156:159], v[148:151], v[72:75], a[156:159]
    v_mfma_f32_16x16x32_bf16 a[160:163], v[148:151], v[76:79], a[160:163]
    ds_read_b128 v[120:123], v6 offset:33024
    v_mfma_f32_16x16x32_bf16 a[164:167], v[148:151], v[80:83], a[164:167]
    s_waitcnt lgkmcnt(6)
    v_mfma_f32_16x16x32_bf16 a[168:171], v[152:155], v[72:75], a[168:171]
    ds_read_b128 v[124:127], v7 offset:33024
    v_mfma_f32_16x16x32_bf16 a[172:175], v[152:155], v[76:79], a[172:175]
    v_mfma_f32_16x16x32_bf16 a[176:179], v[152:155], v[80:83], a[176:179]
    v_mfma_f32_16x16x32_bf16 a[180:183], v[156:159], v[72:75], a[180:183]
    v_mfma_f32_16x16x32_bf16 a[184:187], v[156:159], v[76:79], a[184:187]
    v_mfma_f32_16x16x32_bf16 a[188:191], v[156:159], v[80:83], a[188:191]
    s_cbranch_vccnz L_rare_L_loopm_16
L_back_L_loopm_16:
    s_sub_u32 s34, s34, 1
    s_cmp_lg_u32 s34, 0
    s_cbranch_scc1 L_loopm
L_tail_code:
    s_waitcnt lgkmcnt(6)
    v_mfma_f32_16x16x32_bf16 v[24:27], v[96:99], v[160:163], v[84:87]
    v_exp_f32 v48, v48
    v_mfma_f32_16x16x32_bf16 v[32:35], v[96:99], v[192:195], v[88:91]
    v_exp_f32 v49, v49
    v_mfma_f32_16x16x32_bf16 v[40:43], v[96:99], v[224:227], v[92:95]
    v_cvt_pk_bf16_f32 v72, v48, v49
    ds_read_b128 v[96:99], v4 offset:40960
    v_mfma_f32_16x16x32_bf16 v[24:27], v[100:103], v[164:167], v[24:27]
    v_mfma_f32_16x16x32_bf16 v[32:35], v[100:103], v[196:199], v[32:35]
    v_exp_f32 v50, v50
    v_mfma_f32_16x16x32_bf16 v[40:43], v[100:103], v[228:231], v[40:43]
    v_exp_f32 v51, v51
    s_waitcnt lgkmcnt(5)
    v_mfma_f32_16x16x32_bf16 v[24:27], v[104:107], v[168:171], v[24:27]
    v_cvt_pk_bf16_f32 v73, v50, v51
    ds_read_b128 v[100:103], v5 offset:40960
    v_mfma_f32_16x16x32_bf16 v[32:35], v[104:107], v[200:203], v[32:35]
    v_mfma_f32_16x16x32_bf16 v[40:43], v[104:107], v[232:235], v[40:43]
    v_exp_f32 v52, v52
    v_mfma_f32_16x16x32_bf16 v[24:27], v[108:111], v[172:175], v[24:27]
    v_exp_f32 v53, v53
    v_mfma_f32_16x16x32_bf16 v[32:35], v[108:111], v[204:207], v[32:35]
    v_cvt_pk_bf16_f32 v74, v52, v53
    ds_read_b128 v[104:107], v6 offset:40960
    v_mfma_f32_16x16x32_bf16 v[40:43], v[108:111], v[236:239], v[40:43]
    ds_read_b128 v[108:111], v7 offset:40960
    s_waitcnt lgkmcnt(6)
    v_mfma_f32_16x16x32_bf16 v[24:27], v[112:115], v[176:179], v[24:27]
    v_exp_f32 v54, v54
    v_mfma_f32_16x16x32_bf16 v[32:35], v[112:115], v[208:211], v[32:35]
    v_exp_f32 v55, v55
    v_mfma_f32_16x16x32_bf16 v[40:43], v[112:115], v[240:243], v[40:43]
    v_cvt_pk_bf16_f32 v75, v54, v55
    ds_read_b128 v[112:115], v4 offset:41216
    v_mfma_f32_16x16x32_bf16 v[24:27], v[116:119], v[180:183], v[24:27]
    v_mfma_f32_16x16x32_bf16 v[32:35], v[116:119], v[212:215], v[32:35]
    v_exp_f32 v56, v56
    v_mfma_f32_16x16x32_bf16 v[40:43], v[116:119], v[244:247], v[40:43]
    v_exp_f32 v57, v57
    s_waitcnt lgkmcnt(5)
    v_mfma_f32_16x16x32_bf16 v[24:27], v[120:123], v[184:187], v[24:27]
    v_cvt_pk_bf16_f32 v76, v56, v57
    ds_read_b128 v[116:119], v5 offset:41216
    v_mfma_f32_16x16x32_bf16 v[32:35], v[120:123], v[216:219], v[32:35]
    v_mfma_f32_16x16x32_bf16 v[40:43], v[120:123], v[248:251], v[40:43]
    v_exp_f32 v58, v58
    v_mfma_f32_16x16x32_bf16 v[24:27], v[124:127], v[188:191], v[24:27]
    v_exp_f32 v59, v59
    v_mfma_f32_16x16x32_bf16 v[32:35], v[124:127], v[220:223], v[32:35]
    v_cvt_pk_bf16_f32 v77, v58, v59
    ds_read_b128 v[120:123], v6 offset:41216
    v_mfma_f32_16x16x32_bf16 v[40:43], v[124:127], v[252:255], v[40:43]
    ds_read_b128 v[124:127], v7 offset:41216
    s_waitcnt lgkmcnt(6)
    v_mfma_f32_16x16x32_bf16 v[28:31], v[96:99], v[160:163], v[84:87]
    v_exp_f32 v60, v60
    v_mfma_f32_16x16x32_bf16 v[36:39], v[96:99], v[192:195], v[88:91]
    v_exp_f32 v61, v61
    v_mfma_f32_16x16x32_bf16 v[44:47], v[96:99], v[224:227], v[92:95]
    s_barrier
    v_cvt_pk_bf16_f32 v78, v60, v61
    v_mfma_f32_16x16x32_bf16 v[28:31], v[100:103], v[164:167], v[28:31]
    ds_read_b64_tr_b16 v[128:129], v8 offset:16384
    v_mfma_f32_16x16x32_bf16 v[36:39], v[100:103], v[196:199], v[36:39]
    v_exp_f32 v62, v62
    v_mfma_f32_16x16x32_bf16 v[44:47], v[100:103], v[228:231], v[44:47]
    v_exp_f32 v63, v63
    s_waitcnt lgkmcnt(5)
    v_mfma_f32_16x16x32_bf16 v[28:31], v[104:107], v[168:171], v[28:31]
    v_cvt_pk_bf16_f32 v79, v62, v63
    ds_read_b64_tr_b16 v[130:131], v8 offset:24576
    v_mfma_f32_16x16x32_bf16 v[36:39], v[104:107], v[200:203], v[36:39]
    ds_read_b64_tr_b16 v[132:133], v9 offset:16384
    v_mfma_f32_16x16x32_bf16 v[44:47], v[104:107], v[232:235], v[44:47]
    v_exp_f32 v64, v64
    v_mfma_f32_16x16x32_bf16 v[28:31], v[108:111], v[172:175], v[28:31]
    v_exp_f32 v65, v65
    v_mfma_f32_16x16x32_bf16 v[36:39], v[108:111], v[204:207], v[36:39]
    v_cvt_pk_bf16_f32 v80, v64, v65
    ds_read_b64_tr_b16 v[134:135], v9 offset:24576
    v_mfma_f32_16x16x32_bf16 v[44:47], v[108:111], v[236:239], v[44:47]
    ds_read_b64_tr_b16 v[136:137], v10 offset:16384
    s_waitcnt lgkmcnt(7)
    v_mfma_f32_16x16x32_bf16 v[28:31], v[112:115], v[176:179], v[28:31]
    v_exp_f32 v66, v66
    v_mfma_f32_16x16x32_bf16 v[36:39], v[112:115], v[208:211], v[36:39]
    v_exp_f32 v67, v67
    v_mfma_f32_16x16x32_bf16 v[44:47], v[112:115], v[240:243], v[44:47]
    v_cvt_pk_bf16_f32 v81, v66, v67
    ds_read_b64_tr_b16 v[138:139], v10 offset:24576
    v_mfma_f32_16x16x32_bf16 v[28:31], v[116:119], v[180:183], v[28:31]
    ds_read_b64_tr_b16 v[140:141], v11 offset:16384
    v_mfma_f32_16x16x32_bf16 v[36:39], v[116:119], v[212:215], v[36:39]
    v_exp_f32 v68, v68
    v_mfma_f32_16x16x32_bf16 v[44:47], v[116:119], v[244:247], v[44:47]
    v_exp_f32 v69, v69
    s_waitcnt lgkmcnt(7)
    v_mfma_f32_16x16x32_bf16 v[28:31], v[120:123], v[184:187], v[28:31]
    v_cvt_pk_bf16_f32 v82, v68, v69
    ds_read_b64_tr_b16 v[142:143], v11 offset:24576
    v_mfma_f32_16x16x32_bf16 v[36:39], v[120:123], v[216:219], v[36:39]
    v_mfma_f32_16x16x32_bf16 v[44:47], v[120:123], v[248:251], v[44:47]
    v_exp_f32 v70, v70
    v_mfma_f32_16x16x32_bf16 v[28:31], v[124:127], v[188:191], v[28:31]
    v_exp_f32 v71, v71
    v_mfma_f32_16x16x32_bf16 v[36:39], v[124:127], v[220:223], v[36:39]
    v_cvt_pk_bf16_f32 v83, v70, v71
    v_mfma_f32_16x16x32_bf16 v[44:47], v[124:127], v[252:255], v[44:47]
    s_nop 1
    v_mfma_f32_16x16x32_bf16 a[192:195], a[204:207], v[72:75], a[192:195]
    ds_read_b64_tr_b16 v[144:145], v12 offset:16384
    v_mfma_f32_16x16x32_bf16 a[196:199], a[204:207], v[76:79], a[196:199]
    ds_read_b64_tr_b16 v[146:147], v12 offset:24576
    v_mfma_f32_16x16x32_bf16 a[200:203], a[204:207], v[80:83], a[200:203]
    s_waitcnt lgkmcnt(6)
    v_mfma_f32_16x16x32_bf16 a[0:3], v[128:131], v[72:75], a[0:3]
    ds_read_b64_tr_b16 v[148:149], v13 offset:16384
    v_mfma_f32_16x16x32_bf16 a[4:7], v[128:131], v[76:79], a[4:7]
    ds_read_b64_tr_b16 v[150:151], v13 offset:24576
    v_mfma_f32_16x16x32_bf16 a[8:11], v[128:131], v[80:83], a[8:11]
    v_mfma_f32_16x16x32_bf16 a[12:15], v[132:135], v[72:75], a[12:15]
    ds_read_b64_tr_b16 v[152:153], v14 offset:16384
    v_max3_f32 v16, v24, v25, v26
    v_mfma_f32_16x16x32_bf16 a[16:19], v[132:135], v[76:79], a[16:19]
    ds_read_b64_tr_b16 v[154:155], v14 offset:24576
    v_mfma_f32_16x16x32_bf16 a[20:23], v[132:135], v[80:83], a[20:23]
    v_max3_f32 v16, v16, v27, v28
    s_waitcnt lgkmcnt(6)
    v_mfma_f32_16x16x32_bf16 a[24:27], v[136:139], v[72:75], a[24:27]
    ds_read_b64_tr_b16 v[156:157], v15 offset:16384
    v_mfma_f32_16x16x32_bf16 a[28:31], v[136:139], v[76:79], a[28:31]
    ds_read_b64_tr_b16 v[158:159], v15 offset:24576
    v_max3_f32 v16, v16, v29, v30
    v_mfma_f32_16x16x32_bf16 a[32:35], v[136:139], v[80:83], a[32:35]
    v_mfma_f32_16x16x32_bf16 a[36:39], v[140:143], v[72:75], a[36:39]
    ds_read_b64_tr_b16 v[128:129], v8 offset:16640
    v_max3_f32 v16, v16, v31, v32
    v_mfma_f32_16x16x32_bf16 a[40:43], v[140:143], v[76:79], a[40:43]
    ds_read_b64_tr_b16 v[130:131], v8 offset:24832
    v_mfma_f32_16x16x32_bf16 a[44:47], v[140:143], v[80:83], a[44:47]
    v_max3_f32 v16, v16, v33, v34
    s_waitcnt lgkmcnt(6)
    v_mfma_f32_16x16x32_bf16 a[48:51], v[144:147], v[72:75], a[48:51]
    ds_read_b64_tr_b16 v[132:133], v9 offset:16640
    v_mfma_f32_16x16x32_bf16 a[52:55], v[144:147], v[76:79], a[52:55]
    ds_read_b64_tr_b16 v[134:135], v9 offset:24832
    v_max3_f32 v16, v16, v35, v36
    v_mfma_f32_16x16x32_bf16 a[56:59], v[144:147], v[80:83], a[56:59]
    v_mfma_f32_16x16x32_bf16 a[60:63], v[148:151], v[72:75], a[60:63]
    ds_read_b64_tr_b16 v[136:137], v10 offset:16640
    v_max3_f32 v16, v16, v37, v38
    v_mfma_f32_16x16x32_bf16 a[64:67], v[148:151], v[76:79], a[64:67]
    ds_read_b64_tr_b16 v[138:139], v10 offset:24832
    v_mfma_f32_16x16x32_bf16 a[68:71], v[148:151], v[80:83], a[68:71]
    v_max3_f32 v16, v16, v39, v40
    s_waitcnt lgkmcnt(6)
    v_mfma_f32_16x16x32_bf16 a[72:75], v[152:155], v[72:75], a[72:75]
    ds_read_b64_tr_b16 v[140:141], v11 offset:16640
    v_mfma_f32_16x16x32_bf16 a[76:79], v[152:155], v[76:79], a[76:79]
    ds_read_b64_tr_b16 v[142:143], v11 offset:24832
    v_max3_f32 v16, v16, v41, v42
    v_mfma_f32_16x16x32_bf16 a[80:83], v[152:155], v[80:83], a[80:83]
    v_mfma_f32_16x16x32_bf16 a[84:87], v[156:159], v[72:75], a[84:87]
    ds_read_b64_tr_b16 v[144:145], v12 offset:16640
    v_max3_f32 v16, v16, v43, v44
    v_mfma_f32_16x16x32_bf16 a[88:91], v[156:159], v[76:79], a[88:91]
    ds_read_b64_tr_b16 v[146:147], v12 offset:24832
    v_mfma_f32_16x16x32_bf16 a[92:95], v[156:159], v[80:83], a[92:95]
    v_max3_f32 v16, v16, v45, v46
    s_waitcnt lgkmcnt(6)
    v_mfma_f32_16x16x32_bf16 a[96:99], v[128:131], v[72:75], a[96:99]
    ds_read_b64_tr_b16 v[148:149], v13 offset:16640
    v_mfma_f32_16x16x32_bf16 a[100:103], v[128:131], v[76:79], a[100:103]
    ds_read_b64_tr_b16 v[150:151], v13 offset:24832
    v_max_f32 v16, v16, v47
    v_mfma_f32_16x16x32_bf16 a[104:107], v[128:131], v[80:83], a[104:107]
    v_mfma_f32_16x16x32_bf16 a[108:111], v[132:135], v[72:75], a[108:111]
    s_barrier
    ds_read_b64_tr_b16 v[152:153], v14 offset:16640
    v_mfma_f32_16x16x32_bf16 a[112:115], v[132:135], v[76:79], a[112:115]
    ds_read_b64_tr_b16 v[154:155], v14 offset:24832
    v_cmp_lt_f32 vcc, s31, v16
    v_mfma_f32_16x16x32_bf16 a[116:119], v[132:135], v[80:83], a[116:119]
    ds_read_b128 v[96:99], v4 offset:49152
    s_waitcnt lgkmcnt(7)
    v_mfma_f32_16x16x32_bf16 a[120:123], v[136:139], v[72:75], a[120:123]
    ds_read_b64_tr_b16 v[156:157], v15 offset:16640
    v_mfma_f32_16x16x32_bf16 a[124:127], v[136:139], v[76:79], a[124:127]
    ds_read_b64_tr_b16 v[158:159], v15 offset:24832
    v_mfma_f32_16x16x32_bf16 a[128:131], v[136:139], v[80:83], a[128:131]
    ds_read_b128 v[100:103], v5 offset:49152
    v_mfma_f32_16x16x32_bf16 a[132:135], v[140:143], v[72:75], a[132:135]
    ds_read_b128 v[104:107], v6 offset:49152
    v_mfma_f32_16x16x32_bf16 a[136:139], v[140:143], v[76:79], a[136:139]
    ds_read_b128 v[108:111], v7 offset:49152
    v_mfma_f32_16x16x32_bf16 a[140:143], v[140:143], v[80:83], a[140:143]
    s_waitcnt lgkmcnt(8)
    v_mfma_f32_16x16x32_bf16 a[144:147], v[144:147], v[72:75], a[144:147]
    ds_read_b128 v[112:115], v4 offset:49408
    v_mfma_f32_16x16x32_bf16 a[148:151], v[144:147], v[76:79], a[148:151]
    v_mfma_f32_16x16x32_bf16 a[152:155], v[144:147], v[80:83], a[152:155]
    ds_read_b128 v[116:119], v5 offset:49408
    v_mfma_f32_16x16x32_bf16 a[156:159], v[148:151], v[72:75], a[156:159]
    v_mfma_f32_16x16x32_bf16 a[160:163], v[148:151], v[76:79], a[160:163]
    ds_read_b128 v[120:123], v6 offset:49408
    v_mfma_f32_16x16x32_bf16 a[164:167], v[148:151], v[80:83], a[164:167]
    s_waitcnt lgkmcnt(6)
    v_mfma_f32_16x16x32_bf16 a[168:171], v[152:155], v[72:75], a[168:171]
    ds_read_b128 v[124:127], v7 offset:49408
    v_mfma_f32_16x16x32_bf16 a[172:175], v[152:155], v[76:79], a[172:175]
    v_mfma_f32_16x16x32_bf16 a[176:179], v[152:155], v[80:83], a[176:179]
    v_mfma_f32_16x16x32_bf16 a[180:183], v[156:159], v[72:75], a[180:183]
    v_mfma_f32_16x16x32_bf16 a[184:187], v[156:159], v[76:79], a[184:187]
    v_mfma_f32_16x16x32_bf16 a[188:191], v[156:159], v[80:83], a[188:191]
    s_cbranch_vccnz L_rare_e29
L_back_e29:
    s_waitcnt lgkmcnt(6)
    v_mfma_f32_16x16x32_bf16 v[48:51], v[96:99], v[160:163], v[84:87]
    v_exp_f32 v24, v24
    v_mfma_f32_16x16x32_bf16 v[56:59], v[96:99], v[192:195], v[88:91]
    v_exp_f32 v25, v25
    v_mfma_f32_16x16x32_bf16 v[64:67], v[96:99], v[224:227], v[92:95]
    v_cvt_pk_bf16_f32 v72, v24, v25
    ds_read_b128 v[96:99], v4 offset:57344
    v_mfma_f32_16x16x32_bf16 v[48:51], v[100:103], v[164:167], v[48:51]
    v_mfma_f32_16x16x32_bf16 v[56:59], v[100:103], v[196:199], v[56:59]
    v_exp_f32 v26, v26
    v_mfma_f32_16x16x32_bf16 v[64:67], v[100:103], v[228:231], v[64:67]
    v_exp_f32 v27, v27
    s_waitcnt lgkmcnt(5)
    v_mfma_f32_16x16x32_bf16 v[48:51], v[104:107], v[168:171], v[48:51]
    v_cvt_pk_bf16_f32 v73, v26, v27
    ds_read_b128 v[100:103], v5 offset:57344
    v_mfma_f32_16x16x32_bf16 v[56:59], v[104:107], v[200:203], v[56:59]
    v_mfma_f32_16x16x32_bf16 v[64:67], v[104:107], v[232:235], v[64:67]
    v_exp_f32 v28, v28
    v_mfma_f32_16x16x32_bf16 v[48:51], v[108:111], v[172:175], v[48:51]
    v_exp_f32 v29, v29
    v_mfma_f32_16x16x32_bf16 v[56:59], v[108:111], v[204:207], v[56:59]
    v_cvt_pk_bf16_f32 v74, v28, v29
    ds_read_b128 v[104:107], v6 offset:57344
    v_mfma_f32_16x16x32_bf16 v[64:67], v[108:111], v[236:239], v[64:67]
    ds_read_b128 v[108:111], v7 offset:57344
    s_waitcnt lgkmcnt(6)
    v_mfma_f32_16x16x32_bf16 v[48:51], v[112:115], v[176:179], v[48:51]
    v_exp_f32 v30, v30
    v_mfma_f32_16x16x32_bf16 v[56:59], v[112:115], v[208:211], v[56:59]
    v_exp_f32 v31, v31
    v_mfma_f32_16x16x32_bf16 v[64:67], v[112:115], v[240:243], v[64:67]
    v_cvt_pk_bf16_f32 v75, v30, v31
    ds_read_b128 v[112:115], v4 offset:57600
    v_mfma_f32_16x16x32_bf16 v[48:51], v[116:119], v[180:183], v[48:51]
    v_mfma_f32_16x16x32_bf16 v[56:59], v[116:119], v[212:215], v[56:59]
    v_exp_f32 v32, v32
    v_mfma_f32_16x16x32_bf16 v[64:67], v[116:119], v[244:247], v[64:67]
    v_exp_f32 v33, v33
    s_waitcnt lgkmcnt(5)
    v_mfma_f32_16x16x32_bf16 v[48:51], v[120:123], v[184:187], v[48:51]
    v_cvt_pk_bf16_f32 v76, v32, v33
    ds_read_b128 v[116:119], v5 offset:57600
    v_mfma_f32_16x16x32_bf16 v[56:59], v[120:123], v[216:219], v[56:59]
    v_mfma_f32_16x16x32_bf16 v[64:67], v[120:123], v[248:251], v[64:67]
    v_exp_f32 v34, v34
    v_mfma_f32_16x16x32_bf16 v[48:51], v[124:127], v[188:191], v[48:51]
    v_exp_f32 v35, v35
    v_mfma_f32_16x16x32_bf16 v[56:59], v[124:127], v[220:223], v[56:59]
    v_cvt_pk_bf16_f32 v77, v34, v35
    ds_read_b128 v[120:123], v6 offset:57600
    v_mfma_f32_16x16x32_bf16 v[64:67], v[124:127], v[252:255], v[64:67]
    ds_read_b128 v[124:127], v7 offset:57600
    s_waitcnt lgkmcnt(6)
    v_mfma_f32_16x16x32_bf16 v[52:55], v[96:99], v[160:163], v[84:87]
    v_exp_f32 v36, v36
    v_mfma_f32_16x16x32_bf16 v[60:63], v[96:99], v[192:195], v[88:91]
    v_exp_f32 v37, v37
    v_mfma_f32_16x16x32_bf16 v[68:71], v[96:99], v[224:227], v[92:95]
    s_barrier
    v_cvt_pk_bf16_f32 v78, v36, v37
    v_mfma_f32_16x16x32_bf16 v[52:55], v[100:103], v[164:167], v[52:55]
    ds_read_b64_tr_b16 v[128:129], v8 offset:32768
    v_mfma_f32_16x16x32_bf16 v[60:63], v[100:103], v[196:199], v[60:63]
    v_exp_f32 v38, v38
    v_mfma_f32_16x16x32_bf16 v[68:71], v[100:103], v[228:231], v[68:71]
    v_exp_f32 v39, v39
    s_waitcnt lgkmcnt(5)
    v_mfma_f32_16x16x32_bf16 v[52:55], v[104:107], v[168:171], v[52:55]
    v_cvt_pk_bf16_f32 v79, v38, v39
    ds_read_b64_tr_b16 v[130:131], v8 offset:40960
    v_mfma_f32_16x16x32_bf16 v[60:63], v[104:107], v[200:203], v[60:63]
    ds_read_b64_tr_b16 v[132:133], v9 offset:32768
    v_mfma_f32_16x16x32_bf16 v[68:71], v[104:107], v[232:235], v[68:71]
    v_exp_f32 v40, v40
    v_mfma_f32_16x16x32_bf16 v[52:55], v[108:111], v[172:175], v[52:55]
    v_exp_f32 v41, v41
    v_mfma_f32_16x16x32_bf16 v[60:63], v[108:111], v[204:207], v[60:63]
    v_cvt_pk_bf16_f32 v80, v40, v41
    ds_read_b64_tr_b16 v[134:135], v9 offset:40960
    v_mfma_f32_16x16x32_bf16 v[68:71], v[108:111], v[236:239], v[68:71]
    ds_read_b64_tr_b16 v[136:137], v10 offset:32768
    s_waitcnt lgkmcnt(7)
    v_mfma_f32_16x16x32_bf16 v[52:55], v[112:115], v[176:179], v[52:55]
    v_exp_f32 v42, v42
    v_mfma_f32_16x16x32_bf16 v[60:63], v[112:115], v[208:211], v[60:63]
    v_exp_f32 v43, v43
    v_mfma_f32_16x16x32_bf16 v[68:71], v[112:115], v[240:243], v[68:71]
    v_cvt_pk_bf16_f32 v81, v42, v43
    ds_read_b64_tr_b16 v[138:139], v10 offset:40960
    v_mfma_f32_16x16x32_bf16 v[52:55], v[116:119], v[180:183], v[52:55]
    ds_read_b64_tr_b16 v[140:141], v11 offset:32768
    v_mfma_f32_16x16x32_bf16 v[60:63], v[116:119], v[212:215], v[60:63]
    v_exp_f32 v44, v44
    v_mfma_f32_16x16x32_bf16 v[68:71], v[116:119], v[244:247], v[68:71]
    v_exp_f32 v45, v45
    s_waitcnt lgkmcnt(7)
    v_mfma_f32_16x16x32_bf16 v[52:55], v[120:123], v[184:187], v[52:55]
    v_cvt_pk_bf16_f32 v82, v44, v45
    ds_read_b64_tr_b16 v[142:143], v11 offset:40960
    v_mfma_f32_16x16x32_bf16 v[60:63], v[120:123], v[216:219], v[60:63]
    v_mfma_f32_16x16x32_bf16 v[68:71], v[120:123], v[248:251], v[68:71]
    v_exp_f32 v46, v46
    v_mfma_f32_16x16x32_bf16 v[52:55], v[124:127], v[188:191], v[52:55]
    v_exp_f32 v47, v47
    v_mfma_f32_16x16x32_bf16 v[60:63], v[124:127], v[220:223], v[60:63]
    v_cvt_pk_bf16_f32 v83, v46, v47
    v_mfma_f32_16x16x32_bf16 v[68:71], v[124:127], v[252:255], v[68:71]
    s_nop 1
    v_mfma_f32_16x16x32_bf16 a[192:195], a[204:207], v[72:75], a[192:195]
    ds_read_b64_tr_b16 v[144:145], v12 offset:32768
    v_mfma_f32_16x16x32_bf16 a[196:199], a[204:207], v[76:79], a[196:199]
    ds_read_b64_tr_b16 v[146:147], v12 offset:40960
    v_mfma_f32_16x16x32_bf16 a[200:203], a[204:207], v[80:83], a[200:203]
    s_waitcnt lgkmcnt(6)
    v_mfma_f32_16x16x32_bf16 a[0:3], v[128:131], v[72:75], a[0:3]
    ds_read_b64_tr_b16 v[148:149], v13 offset:32768
    v_mfma_f32_16x16x32_bf16 a[4:7], v[128:131], v[76:79], a[4:7]
    ds_read_b64_tr_b16 v[150:151], v13 offset:40960
    v_mfma_f32_16x16x32_bf16 a[8:11], v[128:131], v[80:83], a[8:11]
    v_mfma_f32_16x16x32_bf16 a[12:15], v[132:135], v[72:75], a[12:15]
    ds_read_b64_tr_b16 v[152:153], v14 offset:32768
    v_max3_f32 v16, v48, v49, v50
    v_mfma_f32_16x16x32_bf16 a[16:19], v[132:135], v[76:79], a[16:19]
    ds_read_b64_tr_b16 v[154:155], v14 offset:40960
    v_mfma_f32_16x16x32_bf16 a[20:23], v[132:135], v[80:83], a[20:23]
    v_max3_f32 v16, v16, v51, v52
    s_waitcnt lgkmcnt(6)
    v_mfma_f32_16x16x32_bf16 a[24:27], v[136:139], v[72:75], a[24:27]
    ds_read_b64_tr_b16 v[156:157], v15 offset:32768
    v_mfma_f32_16x16x32_bf16 a[28:31], v[136:139], v[76:79], a[28:31]
    ds_read_b64_tr_b16 v[158:159], v15 offset:40960
    v_max3_f32 v16, v16, v53, v54
    v_mfma_f32_16x16x32_bf16 a[32:35], v[136:139], v[80:83], a[32:35]
    v_mfma_f32_16x16x32_bf16 a[36:39], v[140:143], v[72:75], a[36:39]
    ds_read_b64_tr_b16 v[128:129], v8 offset:33024
    v_max3_f32 v16, v16, v55, v56
    v_mfma_f32_16x16x32_bf16 a[40:43], v[140:143], v[76:79], a[40:43]
    ds_read_b64_tr_b16 v[130:131], v8 offset:41216
    v_mfma_f32_16x16x32_bf16 a[44:47], v[140:143], v[80:83], a[44:47]
    v_max3_f32 v16, v16, v57, v58
    s_waitcnt lgkmcnt(6)
    v_mfma_f32_16x16x32_bf16 a[48:51], v[144:147], v[72:75], a[48:51]
    ds_read_b64_tr_b16 v[132:133], v9 offset:33024
    v_mfma_f32_16x16x32_bf16 a[52:55], v[144:147], v[76:79], a[52:55]
    ds_read_b64_tr_b16 v[134:135], v9 offset:41216
    v_max3_f32 v16, v16, v59, v60
    v_mfma_f32_16x16x32_bf16 a[56:59], v[144:147], v[80:83], a[56:59]
    v_mfma_f32_16x16x32_bf16 a[60:63], v[148:151], v[72:75], a[60:63]
    ds_read_b64_tr_b16 v[136:137], v10 offset:33024
    v_max3_f32 v16, v16, v61, v62
    v_mfma_f32_16x16x32_bf16 a[64:67], v[148:151], v[76:79], a[64:67]
    ds_read_b64_tr_b16 v[138:139], v10 offset:41216
    v_mfma_f32_16x16x32_bf16 a[68:71], v[148:151], v[80:83], a[68:71]
    v_max3_f32 v16, v16, v63, v64
    s_waitcnt lgkmcnt(6)
    v_mfma_f32_16x16x32_bf16 a[72:75], v[152:155], v[72:75], a[72:75]
    ds_read_b64_tr_b16 v[140:141], v11 offset:33024
    v_mfma_f32_16x16x32_bf16 a[76:79], v[152:155], v[76:79], a[76:79]
    ds_read_b64_tr_b16 v[142:143], v11 offset:41216
    v_max3_f32 v16, v16, v65, v66
    v_mfma_f32_16x16x32_bf16 a[80:83], v[152:155], v[80:83], a[80:83]
    v_mfma_f32_16x16x32_bf16 a[84:87], v[156:159], v[72:75], a[84:87]
    ds_read_b64_tr_b16 v[144:145], v12 offset:33024
    v_max3_f32 v16, v16, v67, v68
    v_mfma_f32_16x16x32_bf16 a[88:91], v[156:159], v[76:79], a[88:91]
    ds_read_b64_tr_b16 v[146:147], v12 offset:41216
    v_mfma_f32_16x16x32_bf16 a[92:95], v[156:159], v[80:83], a[92:95]
    v_max3_f32 v16, v16, v69, v70
    s_waitcnt lgkmcnt(6)
    v_mfma_f32_16x16x32_bf16 a[96:99], v[128:131], v[72:75], a[96:99]
    ds_read_b64_tr_b16 v[148:149], v13 offset:33024
    v_mfma_f32_16x16x32_bf16 a[100:103], v[128:131], v[76:79], a[100:103]
    ds_read_b64_tr_b16 v[150:151], v13 offset:41216
    v_max_f32 v16, v16, v71
    v_mfma_f32_16x16x32_bf16 a[104:107], v[128:131], v[80:83], a[104:107]
    v_mfma_f32_16x16x32_bf16 a[108:111], v[132:135], v[72:75], a[108:111]
    ds_read_b64_tr_b16 v[152:153], v14 offset:33024
    v_cmp_lt_f32 vcc, s31, v16
    v_mfma_f32_16x16x32_bf16 a[112:115], v[132:135], v[76:79], a[112:115]
    ds_read_b64_tr_b16 v[154:155], v14 offset:41216
    v_mfma_f32_16x16x32_bf16 a[116:119], v[132:135], v[80:83], a[116:119]
    s_waitcnt lgkmcnt(6)
    v_mfma_f32_16x16x32_bf16 a[120:123], v[136:139], v[72:75], a[120:123]
    ds_read_b64_tr_b16 v[156:157], v15 offset:33024
    v_mfma_f32_16x16x32_bf16 a[124:127], v[136:139], v[76:79], a[124:127]
    ds_read_b64_tr_b16 v[158:159], v15 offset:41216
    v_mfma_f32_16x16x32_bf16 a[128:131], v[136:139], v[80:83], a[128:131]
    v_mfma_f32_16x16x32_bf16 a[132:135], v[140:143], v[72:75], a[132:135]
    v_mfma_f32_16x16x32_bf16 a[136:139], v[140:143], v[76:79], a[136:139]
    v_mfma_f32_16x16x32_bf16 a[140:143], v[140:143], v[80:83], a[140:143]
    s_waitcnt lgkmcnt(4)
    v_mfma_f32_16x16x32_bf16 a[144:147], v[144:147], v[72:75], a[144:147]
    v_mfma_f32_16x16x32_bf16 a[148:151], v[144:147], v[76:79], a[148:151]
    v_mfma_f32_16x16x32_bf16 a[152:155], v[144:147], v[80:83], a[152:155]
    v_mfma_f32_16x16x32_bf16 a[156:159], v[148:151], v[72:75], a[156:159]
    v_mfma_f32_16x16x32_bf16 a[160:163], v[148:151], v[76:79], a[160:163]
    v_mfma_f32_16x16x32_bf16 a[164:167], v[148:151], v[80:83], a[164:167]
    s_waitcnt lgkmcnt(0)
    v_mfma_f32_16x16x32_bf16 a[168:171], v[152:155], v[72:75], a[168:171]
    v_mfma_f32_16x16x32_bf16 a[172:175], v[152:155], v[76:79], a[172:175]
    v_mfma_f32_16x16x32_bf16 a[176:179], v[152:155], v[80:83], a[176:179]
    v_mfma_f32_16x16x32_bf16 a[180:183], v[156:159], v[72:75], a[180:183]
    v_mfma_f32_16x16x32_bf16 a[184:187], v[156:159], v[76:79], a[184:187]
    v_mfma_f32_16x16x32_bf16 a[188:191], v[156:159], v[80:83], a[188:191]
    s_cbranch_vccnz L_rare_e30
L_back_e30:
    v_exp_f32 v48, v48
    v_exp_f32 v49, v49
    v_exp_f32 v50, v50
    v_exp_f32 v51, v51
    v_cvt_pk_bf16_f32 v72, v48, v49
    v_exp_f32 v52, v52
    v_exp_f32 v53, v53
    v_cvt_pk_bf16_f32 v73, v50, v51
    v_exp_f32 v54, v54
    v_exp_f32 v55, v55
    v_cvt_pk_bf16_f32 v74, v52, v53
    v_exp_f32 v56, v56
    v_exp_f32 v57, v57
    v_cvt_pk_bf16_f32 v75, v54, v55
    v_exp_f32 v58, v58
    v_exp_f32 v59, v59
    v_cvt_pk_bf16_f32 v76, v56, v57
    v_exp_f32 v60, v60
    v_exp_f32 v61, v61
    v_cvt_pk_bf16_f32 v77, v58, v59
    v_exp_f32 v62, v62
    v_exp_f32 v63, v63
    v_cvt_pk_bf16_f32 v78, v60, v61
    v_exp_f32 v64, v64
    v_exp_f32 v65, v65
    v_cvt_pk_bf16_f32 v79, v62, v63
    v_exp_f32 v66, v66
    v_exp_f32 v67, v67
    v_cvt_pk_bf16_f32 v80, v64, v65
    v_exp_f32 v68, v68
    v_exp_f32 v69, v69
    v_cvt_pk_bf16_f32 v81, v66, v67
    v_exp_f32 v70, v70
    v_exp_f32 v71, v71
    v_cvt_pk_bf16_f32 v82, v68, v69
    s_barrier
    ds_read_b64_tr_b16 v[128:129], v8 offset:49152
    ds_read_b64_tr_b16 v[130:131], v8 offset:57344
    ds_read_b64_tr_b16 v[132:133], v9 offset:49152
    ds_read_b64_tr_b16 v[134:135], v9 offset:57344
    ds_read_b64_tr_b16 v[136:137], v10 offset:49152
    ds_read_b64_tr_b16 v[138:139], v10 offset:57344
    ds_read_b64_tr_b16 v[140:141], v11 offset:49152
    ds_read_b64_tr_b16 v[142:143], v11 offset:57344
    v_cvt_pk_bf16_f32 v83, v70, v71
    s_nop 1
    v_mfma_f32_16x16x32_bf16 a[192:195], a[204:207], v[72:75], a[192:195]
    ds_read_b64_tr_b16 v[144:145], v12 offset:49152
    v_subrev_u32 v24, 65536, v8
    v_mfma_f32_16x16x32_bf16 a[196:199], a[204:207], v[76:79], a[196:199]
    ds_read_b64_tr_b16 v[146:147], v12 offset:57344
    v_add_u32 v32, 65536, v8
    v_mfma_f32_16x16x32_bf16 a[200:203], a[204:207], v[80:83], a[200:203]
    v_subrev_u32 v25, 65536, v9
    s_waitcnt lgkmcnt(6)
    v_mfma_f32_16x16x32_bf16 a[0:3], v[128:131], v[72:75], a[0:3]
    ds_read_b64_tr_b16 v[148:149], v13 offset:49152
    v_add_u32 v33, 65536, v9
    v_mfma_f32_16x16x32_bf16 a[4:7], v[128:131], v[76:79], a[4:7]
    ds_read_b64_tr_b16 v[150:151], v13 offset:57344
    v_subrev_u32 v26, 65536, v10
    v_mfma_f32_16x16x32_bf16 a[8:11], v[128:131], v[80:83], a[8:11]
    v_add_u32 v34, 65536, v10
    v_subrev_u32 v27, 65536, v11
    v_mfma_f32_16x16x32_bf16 a[12:15], v[132:135], v[72:75], a[12:15]
    ds_read_b64_tr_b16 v[152:153], v14 offset:49152
    v_add_u32 v35, 65536, v11
    v_mfma_f32_16x16x32_bf16 a[16:19], v[132:135], v[76:79], a[16:19]
    ds_read_b64_tr_b16 v[154:155], v14 offset:57344
    v_subrev_u32 v28, 65536, v12
    v_mfma_f32_16x16x32_bf16 a[20:23], v[132:135], v[80:83], a[20:23]
    v_add_u32 v36, 65536, v12
    s_waitcnt lgkmcnt(6)
    v_mfma_f32_16x16x32_bf16 a[24:27], v[136:139], v[72:75], a[24:27]
    ds_read_b64_tr_b16 v[156:157], v15 offset:49152
    v_subrev_u32 v29, 65536, v13
    v_mfma_f32_16x16x32_bf16 a[28:31], v[136:139], v[76:79], a[28:31]
    ds_read_b64_tr_b16 v[158:159], v15 offset:57344
    v_add_u32 v37, 65536, v13
    v_mfma_f32_16x16x32_bf16 a[32:35], v[136:139], v[80:83], a[32:35]
    v_subrev_u32 v30, 65536, v14
    v_add_u32 v38, 65536, v14
    v_mfma_f32_16x16x32_bf16 a[36:39], v[140:143], v[72:75], a[36:39]
    ds_read_b64_tr_b16 v[128:129], v8 offset:49408
    v_subrev_u32 v31, 65536, v15
    v_mfma_f32_16x16x32_bf16 a[40:43], v[140:143], v[76:79], a[40:43]
    ds_read_b64_tr_b16 v[130:131], v8 offset:57600
    v_add_u32 v39, 65536, v15
    v_mfma_f32_16x16x32_bf16 a[44:47], v[140:143], v[80:83], a[44:47]
    s_waitcnt lgkmcnt(6)
    v_mfma_f32_16x16x32_bf16 a[48:51], v[144:147], v[72:75], a[48:51]
    ds_read_b64_tr_b16 v[132:133], v9 offset:49408
    v_mfma_f32_16x16x32_bf16 a[52:55], v[144:147], v[76:79], a[52:55]
    ds_read_b64_tr_b16 v[134:135], v9 offset:57600
    v_accvgpr_read_b32 v40, a0
    v_mfma_f32_16x16x32_bf16 a[56:59], v[144:147], v[80:83], a[56:59]
    v_accvgpr_read_b32 v41, a1
    v_accvgpr_read_b32 v42, a2
    v_mfma_f32_16x16x32_bf16 a[60:63], v[148:151], v[72:75], a[60:63]
    ds_read_b64_tr_b16 v[136:137], v10 offset:49408
    v_accvgpr_read_b32 v43, a3
    v_mfma_f32_16x16x32_bf16 a[64:67], v[148:151], v[76:79], a[64:67]
    ds_read_b64_tr_b16 v[138:139], v10 offset:57600
    v_accvgpr_read_b32 v44, a12
    v_mfma_f32_16x16x32_bf16 a[68:71], v[148:151], v[80:83], a[68:71]
    v_accvgpr_read_b32 v45, a13
    s_waitcnt lgkmcnt(6)
    v_mfma_f32_16x16x32_bf16 a[72:75], v[152:155], v[72:75], a[72:75]
    ds_read_b64_tr_b16 v[140:141], v11 offset:49408
    v_accvgpr_read_b32 v46, a14
    v_mfma_f32_16x16x32_bf16 a[76:79], v[152:155], v[76:79], a[76:79]
    ds_read_b64_tr_b16 v[142:143], v11 offset:57600
    v_accvgpr_read_b32 v47, a15
    v_mfma_f32_16x16x32_bf16 a[80:83], v[152:155], v[80:83], a[80:83]
    v_cvt_pk_bf16_f32 v160, v40, v41
    v_cvt_pk_bf16_f32 v161, v42, v43
    v_mfma_f32_16x16x32_bf16 a[84:87], v[156:159], v[72:75], a[84:87]
    ds_read_b64_tr_b16 v[144:145], v12 offset:49408
    v_cvt_pk_bf16_f32 v162, v44, v45
    v_mfma_f32_16x16x32_bf16 a[88:91], v[156:159], v[76:79], a[88:91]
    ds_read_b64_tr_b16 v[146:147], v12 offset:57600
    v_cvt_pk_bf16_f32 v163, v46, v47
    v_mfma_f32_16x16x32_bf16 a[92:95], v[156:159], v[80:83], a[92:95]
    v_accvgpr_read_b32 v48, a4
    s_waitcnt lgkmcnt(6)
    v_mfma_f32_16x16x32_bf16 a[96:99], v[128:131], v[72:75], a[96:99]
    ds_read_b64_tr_b16 v[148:149], v13 offset:49408
    v_accvgpr_read_b32 v49, a5
    v_mfma_f32_16x16x32_bf16 a[100:103], v[128:131], v[76:79], a[100:103]
    ds_read_b64_tr_b16 v[150:151], v13 offset:57600
    v_accvgpr_read_b32 v50, a6
    v_mfma_f32_16x16x32_bf16 a[104:107], v[128:131], v[80:83], a[104:107]
    v_accvgpr_read_b32 v51, a7
    v_accvgpr_read_b32 v52, a16
    v_mfma_f32_16x16x32_bf16 a[108:111], v[132:135], v[72:75], a[108:111]
    ds_read_b64_tr_b16 v[152:153], v14 offset:49408
    v_accvgpr_read_b32 v53, a17
    v_mfma_f32_16x16x32_bf16 a[112:115], v[132:135], v[76:79], a[112:115]
    ds_read_b64_tr_b16 v[154:155], v14 offset:57600
    v_accvgpr_read_b32 v54, a18
    v_mfma_f32_16x16x32_bf16 a[116:119], v[132:135], v[80:83], a[116:119]
    v_accvgpr_read_b32 v55, a19
    s_waitcnt lgkmcnt(6)
    v_mfma_f32_16x16x32_bf16 a[120:123], v[136:139], v[72:75], a[120:123]
    ds_read_b64_tr_b16 v[156:157], v15 offset:49408
    v_cvt_pk_bf16_f32 v192, v48, v49
    v_mfma_f32_16x16x32_bf16 a[124:127], v[136:139], v[76:79], a[124:127]
    ds_read_b64_tr_b16 v[158:159], v15 offset:57600
    v_cvt_pk_bf16_f32 v193, v50, v51
    v_mfma_f32_16x16x32_bf16 a[128:131], v[136:139], v[80:83], a[128:131]
    v_cvt_pk_bf16_f32 v194, v52, v53
    v_cvt_pk_bf16_f32 v195, v54, v55
    v_mfma_f32_16x16x32_bf16 a[132:135], v[140:143], v[72:75], a[132:135]
    v_accvgpr_read_b32 v56, a8
    v_accvgpr_read_b32 v57, a9
    v_mfma_f32_16x16x32_bf16 a[136:139], v[140:143], v[76:79], a[136:139]
    v_accvgpr_read_b32 v58, a10
    v_accvgpr_read_b32 v59, a11
    v_mfma_f32_16x16x32_bf16 a[140:143], v[140:143], v[80:83], a[140:143]
    v_accvgpr_read_b32 v60, a20
    s_waitcnt lgkmcnt(4)
    v_mfma_f32_16x16x32_bf16 a[144:147], v[144:147], v[72:75], a[144:147]
    v_accvgpr_read_b32 v61, a21
    v_accvgpr_read_b32 v62, a22
    v_mfma_f32_16x16x32_bf16 a[148:151], v[144:147], v[76:79], a[148:151]
    v_accvgpr_read_b32 v63, a23
    v_cvt_pk_bf16_f32 v224, v56, v57
    v_mfma_f32_16x16x32_bf16 a[152:155], v[144:147], v[80:83], a[152:155]
    v_cvt_pk_bf16_f32 v225, v58, v59
    v_cvt_pk_bf16_f32 v226, v60, v61
    v_mfma_f32_16x16x32_bf16 a[156:159], v[148:151], v[72:75], a[156:159]
    v_cvt_pk_bf16_f32 v227, v62, v63
    v_accvgpr_read_b32 v40, a24
    v_mfma_f32_16x16x32_bf16 a[160:163], v[148:151], v[76:79], a[160:163]
    v_accvgpr_read_b32 v41, a25
    v_accvgpr_read_b32 v42, a26
    v_mfma_f32_16x16x32_bf16 a[164:167], v[148:151], v[80:83], a[164:167]
    v_accvgpr_read_b32 v43, a27
    s_waitcnt lgkmcnt(0)
    v_mfma_f32_16x16x32_bf16 a[168:171], v[152:155], v[72:75], a[168:171]
    v_accvgpr_read_b32 v44, a36
    v_accvgpr_read_b32 v45, a37
    v_mfma_f32_16x16x32_bf16 a[172:175], v[152:155], v[76:79], a[172:175]
    v_accvgpr_read_b32 v46, a38
    v_accvgpr_read_b32 v47, a39
    v_mfma_f32_16x16x32_bf16 a[176:179], v[152:155], v[80:83], a[176:179]
    v_cvt_pk_bf16_f32 v164, v40, v41
    v_cvt_pk_bf16_f32 v165, v42, v43
    v_mfma_f32_16x16x32_bf16 a[180:183], v[156:159], v[72:75], a[180:183]
    v_cvt_pk_bf16_f32 v166, v44, v45
    v_cvt_pk_bf16_f32 v167, v46, v47
    v_mfma_f32_16x16x32_bf16 a[184:187], v[156:159], v[76:79], a[184:187]
    v_accvgpr_read_b32 v48, a28
    v_accvgpr_read_b32 v49, a29
    v_mfma_f32_16x16x32_bf16 a[188:191], v[156:159], v[80:83], a[188:191]
    v_accvgpr_read_b32 v50, a30
    v_accvgpr_read_b32 v51, a31
    v_accvgpr_read_b32 v52, a40
    ds_read_b64_tr_b16 a[208:209], v32 offset:0
    v_accvgpr_read_b32 v53, a41
    ds_read_b64_tr_b16 a[210:211], v32 offset:8192
    v_accvgpr_read_b32 v54, a42
    ds_read_b64_tr_b16 a[212:213], v33 offset:0
    v_accvgpr_read_b32 v55, a43
    ds_read_b64_tr_b16 a[214:215], v33 offset:8192
    v_cvt_pk_bf16_f32 v196, v48, v49
    ds_read_b64_tr_b16 a[216:217], v34 offset:0
    v_cvt_pk_bf16_f32 v197, v50, v51
    ds_read_b64_tr_b16 a[218:219], v34 offset:8192
    v_cvt_pk_bf16_f32 v198, v52, v53
    ds_read_b64_tr_b16 a[220:221], v35 offset:0
    v_cvt_pk_bf16_f32 v199, v54, v55
    ds_read_b64_tr_b16 a[222:223], v35 offset:8192
    v_accvgpr_read_b32 v56, a32
    ds_read_b64_tr_b16 a[224:225], v36 offset:0
    v_accvgpr_read_b32 v57, a33
    ds_read_b64_tr_b16 a[226:227], v36 offset:8192
    v_accvgpr_read_b32 v58, a34
    ds_read_b64_tr_b16 a[228:229], v37 offset:0
    v_accvgpr_read_b32 v59, a35
    ds_read_b64_tr_b16 a[230:231], v37 offset:8192
    v_accvgpr_read_b32 v60, a44
    v_accvgpr_read_b32 v61, a45
    v_accvgpr_read_b32 v62, a46
    v_accvgpr_read_b32 v63, a47
    v_cvt_pk_bf16_f32 v228, v56, v57
    v_cvt_pk_bf16_f32 v229, v58, v59
    v_cvt_pk_bf16_f32 v230, v60, v61
    v_cvt_pk_bf16_f32 v231, v62, v63
    v_lshlrev_b32 v22, 4, v1
    s_mul_i32 s40, s3, 43008
    v_accvgpr_read_b32 v16, a192
    v_accvgpr_read_b32 v18, a196
    v_accvgpr_read_b32 v20, a200
    v_rcp_f32 v16, v16
    v_rcp_f32 v18, v18
    v_rcp_f32 v20, v20
    s_nop 0
    v_mov_b32 v17, v16
    v_mov_b32 v19, v18
    v_mov_b32 v21, v20
    v_mov_b32 v4, 65536
    v_mov_b32 v5, 1
    s_lshl_b32 s84, s30, 3
    s_add_u32 s84, s84, s28
    s_lshl_b32 s84, s84, 14
    s_add_u32 s84, s84, 34603008
    s_add_u32 s84, s72, s84
    s_addc_u32 s85, s73, 0
    s_mov_b32 s86, 16384
    s_mov_b32 s87, 0x20000
    s_lshl_b32 s88, s30, 3
    s_add_u32 s88, s88, s28
    s_mul_i32 s45, s88, 2064384
    s_add_u32 s44, s72, s45
    s_addc_u32 s45, s73, 0
    s_mov_b32 s46, 2064384
    s_mov_b32 s47, 0x20000
    s_mov_b32 s92, s80
    s_mov_b32 s93, s81
    s_mov_b32 s94, 2064384
    s_mov_b32 s95, 0x20000
    s_mul_i32 s64, s88, 9216
    s_add_u32 s64, s64, 35651584
    s_add_u32 s64, s72, s64
    s_addc_u32 s65, s73, 0
    s_mov_b32 s66, 9216
    s_mov_b32 s67, 0x20000
    v_and_b32 v6, 15, v1
    v_lshlrev_b32 v6, 6, v6
    s_mul_i32 s90, s3, 3072
    s_lshl_b32 s91, s29, 2
    s_add_u32 s90, s90, s91
    s_mov_b64 exec, 0xffff
    buffer_store_dword v16, v6, s[64:67], s90 offen offset:0 sc0 sc1
    buffer_store_dword v18, v6, s[64:67], s90 offen offset:1024 sc0 sc1
    buffer_store_dword v20, v6, s[64:67], s90 offen offset:2048 sc0 sc1
    s_mov_b64 exec, -1
    s_barrier
    s_waitcnt lgkmcnt(8)
    v_mfma_f32_16x16x32_bf16 v[64:67], a[208:211], v[160:163], 0
    ds_read_b64_tr_b16 a[232:233], v38 offset:0
    v_accvgpr_read_b32 v40, a48
    v_mfma_f32_16x16x32_bf16 v[68:71], a[208:211], v[192:195], 0
    ds_read_b64_tr_b16 a[234:235], v38 offset:8192
    v_accvgpr_read_b32 v41, a49
    v_mfma_f32_16x16x32_bf16 v[72:75], a[208:211], v[224:227], 0
    ds_read_b64_tr_b16 a[236:237], v39 offset:0
    v_accvgpr_read_b32 v42, a50
    v_mfma_f32_16x16x32_bf16 v[76:79], a[212:215], v[160:163], 0
    ds_read_b64_tr_b16 a[238:239], v39 offset:8192
    v_accvgpr_read_b32 v43, a51
    v_mfma_f32_16x16x32_bf16 v[80:83], a[212:215], v[192:195], 0
    ds_read_b64_tr_b16 a[240:241], v32 offset:256
    v_accvgpr_read_b32 v44, a60
    v_mfma_f32_16x16x32_bf16 v[84:87], a[212:215], v[224:227], 0
    ds_read_b64_tr_b16 a[242:243], v32 offset:8448
    s_waitcnt lgkmcnt(10)
    v_mfma_f32_16x16x32_bf16 v[88:91], a[216:219], v[160:163], 0
    ds_read_b64_tr_b16 a[244:245], v33 offset:256
    v_accvgpr_read_b32 v45, a61
    v_mfma_f32_16x16x32_bf16 v[92:95], a[216:219], v[192:195], 0
    ds_read_b64_tr_b16 a[246:247], v33 offset:8448
    v_accvgpr_read_b32 v46, a62
    v_mfma_f32_16x16x32_bf16 v[96:99], a[216:219], v[224:227], 0
    v_accvgpr_read_b32 v47, a63
    v_cvt_pk_bf16_f32 v168, v40, v41
    v_mfma_f32_16x16x32_bf16 v[100:103], a[220:223], v[160:163], 0
    ds_read_b64_tr_b16 a[248:249], v34 offset:256
    v_cvt_pk_bf16_f32 v169, v42, v43
    v_mfma_f32_16x16x32_bf16 v[104:107], a[220:223], v[192:195], 0
    ds_read_b64_tr_b16 a[250:251], v34 offset:8448
    v_cvt_pk_bf16_f32 v170, v44, v45
    v_mfma_f32_16x16x32_bf16 v[108:111], a[220:223], v[224:227], 0
    v_cvt_pk_bf16_f32 v171, v46, v47
    s_waitcnt lgkmcnt(10)
    v_mfma_f32_16x16x32_bf16 v[112:115], a[224:227], v[160:163], 0
    ds_read_b64_tr_b16 a[252:253], v35 offset:256
    v_accvgpr_read_b32 v48, a52
    v_mfma_f32_16x16x32_bf16 v[116:119], a[224:227], v[192:195], 0
    ds_read_b64_tr_b16 a[254:255], v35 offset:8448
    v_accvgpr_read_b32 v49, a53
    v_mfma_f32_16x16x32_bf16 v[120:123], a[224:227], v[224:227], 0
    v_accvgpr_read_b32 v50, a54
    v_accvgpr_read_b32 v51, a55
    v_mfma_f32_16x16x32_bf16 v[124:127], a[228:231], v[160:163], 0
    ds_read_b64_tr_b16 a[208:209], v36 offset:256
    v_accvgpr_read_b32 v52, a64
    v_mfma_f32_16x16x32_bf16 v[128:131], a[228:231], v[192:195], 0
    ds_read_b64_tr_b16 a[210:211], v36 offset:8448
    v_accvgpr_read_b32 v53, a65
    v_mfma_f32_16x16x32_bf16 v[132:135], a[228:231], v[224:227], 0
    v_accvgpr_read_b32 v54, a66
    s_waitcnt lgkmcnt(10)
    v_mfma_f32_16x16x32_bf16 v[136:139], a[232:235], v[160:163], 0
    ds_read_b64_tr_b16 a[212:213], v37 offset:256
    v_accvgpr_read_b32 v55, a67
    v_mfma_f32_16x16x32_bf16 v[140:143], a[232:235], v[192:195], 0
    ds_read_b64_tr_b16 a[214:215], v37 offset:8448
    v_cvt_pk_bf16_f32 v200, v48, v49
    v_mfma_f32_16x16x32_bf16 v[144:147], a[232:235], v[224:227], 0
    v_cvt_pk_bf16_f32 v201, v50, v51
    v_cvt_pk_bf16_f32 v202, v52, v53
    v_mfma_f32_16x16x32_bf16 v[148:151], a[236:239], v[160:163], 0
    v_cvt_pk_bf16_f32 v203, v54, v55
    v_accvgpr_read_b32 v56, a56
    v_mfma_f32_16x16x32_bf16 v[152:155], a[236:239], v[192:195], 0
    v_accvgpr_read_b32 v57, a57
    v_accvgpr_read_b32 v58, a58
    v_mfma_f32_16x16x32_bf16 v[156:159], a[236:239], v[224:227], 0
    v_accvgpr_read_b32 v59, a59
    v_accvgpr_read_b32 v60, a68
    v_accvgpr_read_b32 v61, a69
    v_accvgpr_read_b32 v62, a70
    v_accvgpr_read_b32 v63, a71
    v_cvt_pk_bf16_f32 v232, v56, v57
    v_cvt_pk_bf16_f32 v233, v58, v59
    v_cvt_pk_bf16_f32 v234, v60, v61
    v_cvt_pk_bf16_f32 v235, v62, v63
    s_waitcnt lgkmcnt(8)
    v_mfma_f32_16x16x32_bf16 v[64:67], a[240:243], v[164:167], v[64:67]
    ds_read_b64_tr_b16 a[216:217], v38 offset:256
    v_accvgpr_read_b32 v40, a72
    v_mfma_f32_16x16x32_bf16 v[68:71], a[240:243], v[196:199], v[68:71]
    ds_read_b64_tr_b16 a[218:219], v38 offset:8448
    v_accvgpr_read_b32 v41, a73
    v_mfma_f32_16x16x32_bf16 v[72:75], a[240:243], v[228:231], v[72:75]
    ds_read_b64_tr_b16 a[220:221], v39 offset:256
    v_accvgpr_read_b32 v42, a74
    v_mfma_f32_16x16x32_bf16 v[76:79], a[244:247], v[164:167], v[76:79]
    ds_read_b64_tr_b16 a[222:223], v39 offset:8448
    v_accvgpr_read_b32 v43, a75
    v_mfma_f32_16x16x32_bf16 v[80:83], a[244:247], v[196:199], v[80:83]
    ds_read_b64_tr_b16 a[224:225], v32 offset:16384
    v_accvgpr_read_b32 v44, a84
    v_mfma_f32_16x16x32_bf16 v[84:87], a[244:247], v[228:231], v[84:87]
    ds_read_b64_tr_b16 a[226:227], v32 offset:24576
    s_waitcnt lgkmcnt(10)
    v_mfma_f32_16x16x32_bf16 v[88:91], a[248:251], v[164:167], v[88:91]
    ds_read_b64_tr_b16 a[228:229], v33 offset:16384
    v_accvgpr_read_b32 v45, a85
    v_mfma_f32_16x16x32_bf16 v[92:95], a[248:251], v[196:199], v[92:95]
    ds_read_b64_tr_b16 a[230:231], v33 offset:24576
    v_accvgpr_read_b32 v46, a86
    v_mfma_f32_16x16x32_bf16 v[96:99], a[248:251], v[228:231], v[96:99]
    v_accvgpr_read_b32 v47, a87
    v_cvt_pk_bf16_f32 v172, v40, v41
    v_mfma_f32_16x16x32_bf16 v[100:103], a[252:255], v[164:167], v[100:103]
    ds_read_b64_tr_b16 a[232:233], v34 offset:16384
    v_cvt_pk_bf16_f32 v173, v42, v43
    v_mfma_f32_16x16x32_bf16 v[104:107], a[252:255], v[196:199], v[104:107]
    ds_read_b64_tr_b16 a[234:235], v34 offset:24576
    v_cvt_pk_bf16_f32 v174, v44, v45
    v_mfma_f32_16x16x32_bf16 v[108:111], a[252:255], v[228:231], v[108:111]
    v_cvt_pk_bf16_f32 v175, v46, v47
    s_waitcnt lgkmcnt(10)
    v_mfma_f32_16x16x32_bf16 v[112:115], a[208:211], v[164:167], v[112:115]
    ds_read_b64_tr_b16 a[236:237], v35 offset:16384
    v_accvgpr_read_b32 v48, a76
    v_mfma_f32_16x16x32_bf16 v[116:119], a[208:211], v[196:199], v[116:119]
    ds_read_b64_tr_b16 a[238:239], v35 offset:24576
    v_accvgpr_read_b32 v49, a77
    v_mfma_f32_16x16x32_bf16 v[120:123], a[208:211], v[228:231], v[120:123]
    v_accvgpr_read_b32 v50, a78
    v_accvgpr_read_b32 v51, a79
    v_mfma_f32_16x16x32_bf16 v[124:127], a[212:215], v[164:167], v[124:127]
    ds_read_b64_tr_b16 a[240:241], v36 offset:16384
    v_accvgpr_read_b32 v52, a88
    v_mfma_f32_16x16x32_bf16 v[128:131], a[212:215], v[196:199], v[128:131]
    ds_read_b64_tr_b16 a[242:243], v36 offset:24576
    v_accvgpr_read_b32 v53, a89
    v_mfma_f32_16x16x32_bf16 v[132:135], a[212:215], v[228:231], v[132:135]
    v_accvgpr_read_b32 v54, a90
    s_waitcnt lgkmcnt(10)
    v_mfma_f32_16x16x32_bf16 v[136:139], a[216:219], v[164:167], v[136:139]
    ds_read_b64_tr_b16 a[244:245], v37 offset:16384
    v_accvgpr_read_b32 v55, a91
    v_mfma_f32_16x16x32_bf16 v[140:143], a[216:219], v[196:199], v[140:143]
    ds_read_b64_tr_b16 a[246:247], v37 offset:24576
    v_cvt_pk_bf16_f32 v204, v48, v49
    v_mfma_f32_16x16x32_bf16 v[144:147], a[216:219], v[228:231], v[144:147]
    v_cvt_pk_bf16_f32 v205, v50, v51
    v_cvt_pk_bf16_f32 v206, v52, v53
    v_mfma_f32_16x16x32_bf16 v[148:151], a[220:223], v[164:167], v[148:151]
    v_cvt_pk_bf16_f32 v207, v54, v55
    v_accvgpr_read_b32 v56, a80
    v_mfma_f32_16x16x32_bf16 v[152:155], a[220:223], v[196:199], v[152:155]
    v_accvgpr_read_b32 v57, a81
    v_accvgpr_read_b32 v58, a82
    v_mfma_f32_16x16x32_bf16 v[156:159], a[220:223], v[228:231], v[156:159]
    v_accvgpr_read_b32 v59, a83
    v_accvgpr_read_b32 v60, a92
    v_accvgpr_read_b32 v61, a93
    v_accvgpr_read_b32 v62, a94
    v_accvgpr_read_b32 v63, a95
    v_cvt_pk_bf16_f32 v236, v56, v57
    v_cvt_pk_bf16_f32 v237, v58, v59
    v_cvt_pk_bf16_f32 v238, v60, v61
    v_cvt_pk_bf16_f32 v239, v62, v63
    s_barrier
    s_waitcnt lgkmcnt(8)
    v_mfma_f32_16x16x32_bf16 v[64:67], a[224:227], v[168:171], v[64:67]
    ds_read_b64_tr_b16 a[248:249], v38 offset:16384
    v_accvgpr_read_b32 v40, a96
    v_mfma_f32_16x16x32_bf16 v[68:71], a[224:227], v[200:203], v[68:71]
    ds_read_b64_tr_b16 a[250:251], v38 offset:24576
    v_accvgpr_read_b32 v41, a97
    v_mfma_f32_16x16x32_bf16 v[72:75], a[224:227], v[232:235], v[72:75]
    ds_read_b64_tr_b16 a[252:253], v39 offset:16384
    v_accvgpr_read_b32 v42, a98
    v_mfma_f32_16x16x32_bf16 v[76:79], a[228:231], v[168:171], v[76:79]
    ds_read_b64_tr_b16 a[254:255], v39 offset:24576
    v_accvgpr_read_b32 v43, a99
    v_mfma_f32_16x16x32_bf16 v[80:83], a[228:231], v[200:203], v[80:83]
    ds_read_b64_tr_b16 a[208:209], v32 offset:16640
    v_accvgpr_read_b32 v44, a108
    v_mfma_f32_16x16x32_bf16 v[84:87], a[228:231], v[232:235], v[84:87]
    ds_read_b64_tr_b16 a[210:211], v32 offset:24832
    s_waitcnt lgkmcnt(10)
    v_mfma_f32_16x16x32_bf16 v[88:91], a[232:235], v[168:171], v[88:91]
    ds_read_b64_tr_b16 a[212:213], v33 offset:16640
    v_accvgpr_read_b32 v45, a109
    v_mfma_f32_16x16x32_bf16 v[92:95], a[232:235], v[200:203], v[92:95]
    ds_read_b64_tr_b16 a[214:215], v33 offset:24832
    v_accvgpr_read_b32 v46, a110
    v_mfma_f32_16x16x32_bf16 v[96:99], a[232:235], v[232:235], v[96:99]
    v_accvgpr_read_b32 v47, a111
    v_cvt_pk_bf16_f32 v176, v40, v41
    v_mfma_f32_16x16x32_bf16 v[100:103], a[236:239], v[168:171], v[100:103]
    ds_read_b64_tr_b16 a[216:217], v34 offset:16640
    v_cvt_pk_bf16_f32 v177, v42, v43
    v_mfma_f32_16x16x32_bf16 v[104:107], a[236:239], v[200:203], v[104:107]
    ds_read_b64_tr_b16 a[218:219], v34 offset:24832
    v_cvt_pk_bf16_f32 v178, v44, v45
    v_mfma_f32_16x16x32_bf16 v[108:111], a[236:239], v[232:235], v[108:111]
    v_cvt_pk_bf16_f32 v179, v46, v47
    s_waitcnt lgkmcnt(10)
    v_mfma_f32_16x16x32_bf16 v[112:115], a[240:243], v[168:171], v[112:115]
    ds_read_b64_tr_b16 a[220:221], v35 offset:16640
    v_accvgpr_read_b32 v48, a100
    v_mfma_f32_16x16x32_bf16 v[116:119], a[240:243], v[200:203], v[116:119]
    ds_read_b64_tr_b16 a[222:223], v35 offset:24832
    v_accvgpr_read_b32 v49, a101
    v_mfma_f32_16x16x32_bf16 v[120:123], a[240:243], v[232:235], v[120:123]
    v_accvgpr_read_b32 v50, a102
    v_accvgpr_read_b32 v51, a103
    v_mfma_f32_16x16x32_bf16 v[124:127], a[244:247], v[168:171], v[124:127]
    ds_read_b64_tr_b16 a[224:225], v36 offset:16640
    v_accvgpr_read_b32 v52, a112
    v_mfma_f32_16x16x32_bf16 v[128:131], a[244:247], v[200:203], v[128:131]
    ds_read_b64_tr_b16 a[226:227], v36 offset:24832
    v_accvgpr_read_b32 v53, a113
    v_mfma_f32_16x16x32_bf16 v[132:135], a[244:247], v[232:235], v[132:135]
    v_accvgpr_read_b32 v54, a114
    s_waitcnt lgkmcnt(10)
    v_mfma_f32_16x16x32_bf16 v[136:139], a[248:251], v[168:171], v[136:139]
    ds_read_b64_tr_b16 a[228:229], v37 offset:16640
    v_accvgpr_read_b32 v55, a115
    v_mfma_f32_16x16x32_bf16 v[140:143], a[248:251], v[200:203], v[140:143]
    ds_read_b64_tr_b16 a[230:231], v37 offset:24832
    v_cvt_pk_bf16_f32 v208, v48, v49
    v_mfma_f32_16x16x32_bf16 v[144:147], a[248:251], v[232:235], v[144:147]
    v_cvt_pk_bf16_f32 v209, v50, v51
    v_cvt_pk_bf16_f32 v210, v52, v53
    v_mfma_f32_16x16x32_bf16 v[148:151], a[252:255], v[168:171], v[148:151]
    v_cvt_pk_bf16_f32 v211, v54, v55
    v_accvgpr_read_b32 v56, a104
    v_mfma_f32_16x16x32_bf16 v[152:155], a[252:255], v[200:203], v[152:155]
    v_accvgpr_read_b32 v57, a105
    v_accvgpr_read_b32 v58, a106
    v_mfma_f32_16x16x32_bf16 v[156:159], a[252:255], v[232:235], v[156:159]
    v_accvgpr_read_b32 v59, a107
    v_accvgpr_read_b32 v60, a116
    v_accvgpr_read_b32 v61, a117
    v_accvgpr_read_b32 v62, a118
    v_accvgpr_read_b32 v63, a119
    v_cvt_pk_bf16_f32 v240, v56, v57
    v_cvt_pk_bf16_f32 v241, v58, v59
    v_cvt_pk_bf16_f32 v242, v60, v61
    v_cvt_pk_bf16_f32 v243, v62, v63
    s_waitcnt lgkmcnt(8)
    v_mfma_f32_16x16x32_bf16 v[64:67], a[208:211], v[172:175], v[64:67]
    ds_read_b64_tr_b16 a[232:233], v38 offset:16640
    v_accvgpr_read_b32 v40, a120
    v_mfma_f32_16x16x32_bf16 v[68:71], a[208:211], v[204:207], v[68:71]
    ds_read_b64_tr_b16 a[234:235], v38 offset:24832
    v_accvgpr_read_b32 v41, a121
    v_mfma_f32_16x16x32_bf16 v[72:75], a[208:211], v[236:239], v[72:75]
    ds_read_b64_tr_b16 a[236:237], v39 offset:16640
    v_accvgpr_read_b32 v42, a122
    v_mfma_f32_16x16x32_bf16 v[76:79], a[212:215], v[172:175], v[76:79]
    ds_read_b64_tr_b16 a[238:239], v39 offset:24832
    v_accvgpr_read_b32 v43, a123
    v_mfma_f32_16x16x32_bf16 v[80:83], a[212:215], v[204:207], v[80:83]
    ds_read_b64_tr_b16 a[240:241], v24 offset:0
    v_accvgpr_read_b32 v44, a132
    v_mfma_f32_16x16x32_bf16 v[84:87], a[212:215], v[236:239], v[84:87]
    ds_read_b64_tr_b16 a[242:243], v24 offset:8192
    s_waitcnt lgkmcnt(10)
    v_mfma_f32_16x16x32_bf16 v[88:91], a[216:219], v[172:175], v[88:91]
    ds_read_b64_tr_b16 a[244:245], v25 offset:0
    v_accvgpr_read_b32 v45, a133
    v_mfma_f32_16x16x32_bf16 v[92:95], a[216:219], v[204:207], v[92:95]
    ds_read_b64_tr_b16 a[246:247], v25 offset:8192
    v_accvgpr_read_b32 v46, a134
    v_mfma_f32_16x16x32_bf16 v[96:99], a[216:219], v[236:239], v[96:99]
    v_accvgpr_read_b32 v47, a135
    v_cvt_pk_bf16_f32 v180, v40, v41
    v_mfma_f32_16x16x32_bf16 v[100:103], a[220:223], v[172:175], v[100:103]
    ds_read_b64_tr_b16 a[248:249], v26 offset:0
    v_cvt_pk_bf16_f32 v181, v42, v43
    v_mfma_f32_16x16x32_bf16 v[104:107], a[220:223], v[204:207], v[104:107]
    ds_read_b64_tr_b16 a[250:251], v26 offset:8192
    v_cvt_pk_bf16_f32 v182, v44, v45
    v_mfma_f32_16x16x32_bf16 v[108:111], a[220:223], v[236:239], v[108:111]
    v_cvt_pk_bf16_f32 v183, v46, v47
    s_waitcnt lgkmcnt(10)
    v_mfma_f32_16x16x32_bf16 v[112:115], a[224:227], v[172:175], v[112:115]
    ds_read_b64_tr_b16 a[252:253], v27 offset:0
    v_accvgpr_read_b32 v48, a124
    v_mfma_f32_16x16x32_bf16 v[116:119], a[224:227], v[204:207], v[116:119]
    ds_read_b64_tr_b16 a[254:255], v27 offset:8192
    v_accvgpr_read_b32 v49, a125
    v_mfma_f32_16x16x32_bf16 v[120:123], a[224:227], v[236:239], v[120:123]
    v_accvgpr_read_b32 v50, a126
    v_accvgpr_read_b32 v51, a127
    v_mfma_f32_16x16x32_bf16 v[124:127], a[228:231], v[172:175], v[124:127]
    ds_read_b64_tr_b16 a[208:209], v28 offset:0
    v_accvgpr_read_b32 v52, a136
    v_mfma_f32_16x16x32_bf16 v[128:131], a[228:231], v[204:207], v[128:131]
    ds_read_b64_tr_b16 a[210:211], v28 offset:8192
    v_accvgpr_read_b32 v53, a137
    v_mfma_f32_16x16x32_bf16 v[132:135], a[228:231], v[236:239], v[132:135]
    v_accvgpr_read_b32 v54, a138
    s_waitcnt lgkmcnt(10)
    v_mfma_f32_16x16x32_bf16 v[136:139], a[232:235], v[172:175], v[136:139]
    ds_read_b64_tr_b16 a[212:213], v29 offset:0
    v_accvgpr_read_b32 v55, a139
    v_mfma_f32_16x16x32_bf16 v[140:143], a[232:235], v[204:207], v[140:143]
    ds_read_b64_tr_b16 a[214:215], v29 offset:8192
    v_cvt_pk_bf16_f32 v212, v48, v49
    v_mfma_f32_16x16x32_bf16 v[144:147], a[232:235], v[236:239], v[144:147]
    v_cvt_pk_bf16_f32 v213, v50, v51
    v_cvt_pk_bf16_f32 v214, v52, v53
    v_mfma_f32_16x16x32_bf16 v[148:151], a[236:239], v[172:175], v[148:151]
    v_cvt_pk_bf16_f32 v215, v54, v55
    v_accvgpr_read_b32 v56, a128
    v_mfma_f32_16x16x32_bf16 v[152:155], a[236:239], v[204:207], v[152:155]
    v_accvgpr_read_b32 v57, a129
    v_accvgpr_read_b32 v58, a130
    v_mfma_f32_16x16x32_bf16 v[156:159], a[236:239], v[236:239], v[156:159]
    v_accvgpr_read_b32 v59, a131
    v_accvgpr_read_b32 v60, a140
    v_accvgpr_read_b32 v61, a141
    v_accvgpr_read_b32 v62, a142
    v_accvgpr_read_b32 v63, a143
    v_cvt_pk_bf16_f32 v244, v56, v57
    v_cvt_pk_bf16_f32 v245, v58, v59
    v_cvt_pk_bf16_f32 v246, v60, v61
    v_cvt_pk_bf16_f32 v247, v62, v63
    s_barrier
    s_waitcnt lgkmcnt(8)
    v_mfma_f32_16x16x32_bf16 v[64:67], a[240:243], v[176:179], v[64:67]
    ds_read_b64_tr_b16 a[216:217], v30 offset:0
    v_accvgpr_read_b32 v40, a144
    v_mfma_f32_16x16x32_bf16 v[68:71], a[240:243], v[208:211], v[68:71]
    ds_read_b64_tr_b16 a[218:219], v30 offset:8192
    v_accvgpr_read_b32 v41, a145
    v_mfma_f32_16x16x32_bf16 v[72:75], a[240:243], v[240:243], v[72:75]
    ds_read_b64_tr_b16 a[220:221], v31 offset:0
    v_accvgpr_read_b32 v42, a146
    v_mfma_f32_16x16x32_bf16 v[76:79], a[244:247], v[176:179], v[76:79]
    ds_read_b64_tr_b16 a[222:223], v31 offset:8192
    v_accvgpr_read_b32 v43, a147
    v_mfma_f32_16x16x32_bf16 v[80:83], a[244:247], v[208:211], v[80:83]
    ds_read_b64_tr_b16 a[224:225], v24 offset:256
    v_accvgpr_read_b32 v44, a156
    v_mfma_f32_16x16x32_bf16 v[84:87], a[244:247], v[240:243], v[84:87]
    ds_read_b64_tr_b16 a[226:227], v24 offset:8448
    s_waitcnt lgkmcnt(10)
    v_mfma_f32_16x16x32_bf16 v[88:91], a[248:251], v[176:179], v[88:91]
    ds_read_b64_tr_b16 a[228:229], v25 offset:256
    v_accvgpr_read_b32 v45, a157
    v_mfma_f32_16x16x32_bf16 v[92:95], a[248:251], v[208:211], v[92:95]
    ds_read_b64_tr_b16 a[230:231], v25 offset:8448
    v_accvgpr_read_b32 v46, a158
    v_mfma_f32_16x16x32_bf16 v[96:99], a[248:251], v[240:243], v[96:99]
    v_accvgpr_read_b32 v47, a159
    v_cvt_pk_bf16_f32 v184, v40, v41
    v_mfma_f32_16x16x32_bf16 v[100:103], a[252:255], v[176:179], v[100:103]
    ds_read_b64_tr_b16 a[232:233], v26 offset:256
    v_cvt_pk_bf16_f32 v185, v42, v43
    v_mfma_f32_16x16x32_bf16 v[104:107], a[252:255], v[208:211], v[104:107]
    ds_read_b64_tr_b16 a[234:235], v26 offset:8448
    v_cvt_pk_bf16_f32 v186, v44, v45
    v_mfma_f32_16x16x32_bf16 v[108:111], a[252:255], v[240:243], v[108:111]
    v_cvt_pk_bf16_f32 v187, v46, v47
    s_waitcnt lgkmcnt(10)
    v_mfma_f32_16x16x32_bf16 v[112:115], a[208:211], v[176:179], v[112:115]
    ds_read_b64_tr_b16 a[236:237], v27 offset:256
    v_accvgpr_read_b32 v48, a148
    v_mfma_f32_16x16x32_bf16 v[116:119], a[208:211], v[208:211], v[116:119]
    ds_read_b64_tr_b16 a[238:239], v27 offset:8448
    v_accvgpr_read_b32 v49, a149
    v_mfma_f32_16x16x32_bf16 v[120:123], a[208:211], v[240:243], v[120:123]
    v_accvgpr_read_b32 v50, a150
    v_accvgpr_read_b32 v51, a151
    v_mfma_f32_16x16x32_bf16 v[124:127], a[212:215], v[176:179], v[124:127]
    ds_read_b64_tr_b16 a[240:241], v28 offset:256
    v_accvgpr_read_b32 v52, a160
    v_mfma_f32_16x16x32_bf16 v[128:131], a[212:215], v[208:211], v[128:131]
    ds_read_b64_tr_b16 a[242:243], v28 offset:8448
    v_accvgpr_read_b32 v53, a161
    v_mfma_f32_16x16x32_bf16 v[132:135], a[212:215], v[240:243], v[132:135]
    v_accvgpr_read_b32 v54, a162
    s_waitcnt lgkmcnt(10)
    v_mfma_f32_16x16x32_bf16 v[136:139], a[216:219], v[176:179], v[136:139]
    ds_read_b64_tr_b16 a[244:245], v29 offset:256
    v_accvgpr_read_b32 v55, a163
    v_mfma_f32_16x16x32_bf16 v[140:143], a[216:219], v[208:211], v[140:143]
    ds_read_b64_tr_b16 a[246:247], v29 offset:8448
    v_cvt_pk_bf16_f32 v216, v48, v49
    v_mfma_f32_16x16x32_bf16 v[144:147], a[216:219], v[240:243], v[144:147]
    v_cvt_pk_bf16_f32 v217, v50, v51
    v_cvt_pk_bf16_f32 v218, v52, v53
    v_mfma_f32_16x16x32_bf16 v[148:151], a[220:223], v[176:179], v[148:151]
    v_cvt_pk_bf16_f32 v219, v54, v55
    v_accvgpr_read_b32 v56, a152
    v_mfma_f32_16x16x32_bf16 v[152:155], a[220:223], v[208:211], v[152:155]
    v_accvgpr_read_b32 v57, a153
    v_accvgpr_read_b32 v58, a154
    v_mfma_f32_16x16x32_bf16 v[156:159], a[220:223], v[240:243], v[156:159]
    v_accvgpr_read_b32 v59, a155
    v_accvgpr_read_b32 v60, a164
    v_accvgpr_read_b32 v61, a165
    v_accvgpr_read_b32 v62, a166
    v_accvgpr_read_b32 v63, a167
    v_cvt_pk_bf16_f32 v248, v56, v57
    v_cvt_pk_bf16_f32 v249, v58, v59
    v_cvt_pk_bf16_f32 v250, v60, v61
    v_cvt_pk_bf16_f32 v251, v62, v63
    s_waitcnt lgkmcnt(8)
    v_mfma_f32_16x16x32_bf16 v[64:67], a[224:227], v[180:183], v[64:67]
    ds_read_b64_tr_b16 a[248:249], v30 offset:256
    v_accvgpr_read_b32 v40, a168
    v_mfma_f32_16x16x32_bf16 v[68:71], a[224:227], v[212:215], v[68:71]
    ds_read_b64_tr_b16 a[250:251], v30 offset:8448
    v_accvgpr_read_b32 v41, a169
    v_mfma_f32_16x16x32_bf16 v[72:75], a[224:227], v[244:247], v[72:75]
    ds_read_b64_tr_b16 a[252:253], v31 offset:256
    v_accvgpr_read_b32 v42, a170
    v_mfma_f32_16x16x32_bf16 v[76:79], a[228:231], v[180:183], v[76:79]
    ds_read_b64_tr_b16 a[254:255], v31 offset:8448
    v_accvgpr_read_b32 v43, a171
    v_mfma_f32_16x16x32_bf16 v[80:83], a[228:231], v[212:215], v[80:83]
    ds_read_b64_tr_b16 a[208:209], v24 offset:16384
    v_accvgpr_read_b32 v44, a180
    v_mfma_f32_16x16x32_bf16 v[84:87], a[228:231], v[244:247], v[84:87]
    ds_read_b64_tr_b16 a[210:211], v24 offset:24576
    s_waitcnt lgkmcnt(10)
    v_mfma_f32_16x16x32_bf16 v[88:91], a[232:235], v[180:183], v[88:91]
    ds_read_b64_tr_b16 a[212:213], v25 offset:16384
    v_accvgpr_read_b32 v45, a181
    v_mfma_f32_16x16x32_bf16 v[92:95], a[232:235], v[212:215], v[92:95]
    ds_read_b64_tr_b16 a[214:215], v25 offset:24576
    v_accvgpr_read_b32 v46, a182
    v_mfma_f32_16x16x32_bf16 v[96:99], a[232:235], v[244:247], v[96:99]
    v_accvgpr_read_b32 v47, a183
    v_cvt_pk_bf16_f32 v188, v40, v41
    v_mfma_f32_16x16x32_bf16 v[100:103], a[236:239], v[180:183], v[100:103]
    ds_read_b64_tr_b16 a[216:217], v26 offset:16384
    v_cvt_pk_bf16_f32 v189, v42, v43
    v_mfma_f32_16x16x32_bf16 v[104:107], a[236:239], v[212:215], v[104:107]
    ds_read_b64_tr_b16 a[218:219], v26 offset:24576
    v_cvt_pk_bf16_f32 v190, v44, v45
    v_mfma_f32_16x16x32_bf16 v[108:111], a[236:239], v[244:247], v[108:111]
    v_cvt_pk_bf16_f32 v191, v46, v47
    s_waitcnt lgkmcnt(10)
    v_mfma_f32_16x16x32_bf16 v[112:115], a[240:243], v[180:183], v[112:115]
    ds_read_b64_tr_b16 a[220:221], v27 offset:16384
    v_accvgpr_read_b32 v48, a172
    v_mfma_f32_16x16x32_bf16 v[116:119], a[240:243], v[212:215], v[116:119]
    ds_read_b64_tr_b16 a[222:223], v27 offset:24576
    v_accvgpr_read_b32 v49, a173
    v_mfma_f32_16x16x32_bf16 v[120:123], a[240:243], v[244:247], v[120:123]
    v_accvgpr_read_b32 v50, a174
    v_accvgpr_read_b32 v51, a175
    v_mfma_f32_16x16x32_bf16 v[124:127], a[244:247], v[180:183], v[124:127]
    ds_read_b64_tr_b16 a[224:225], v28 offset:16384
    v_accvgpr_read_b32 v52, a184
    v_mfma_f32_16x16x32_bf16 v[128:131], a[244:247], v[212:215], v[128:131]
    ds_read_b64_tr_b16 a[226:227], v28 offset:24576
    v_accvgpr_read_b32 v53, a185
    v_mfma_f32_16x16x32_bf16 v[132:135], a[244:247], v[244:247], v[132:135]
    v_accvgpr_read_b32 v54, a186
    s_waitcnt lgkmcnt(10)
    v_mfma_f32_16x16x32_bf16 v[136:139], a[248:251], v[180:183], v[136:139]
    ds_read_b64_tr_b16 a[228:229], v29 offset:16384
    v_accvgpr_read_b32 v55, a187
    v_mfma_f32_16x16x32_bf16 v[140:143], a[248:251], v[212:215], v[140:143]
    ds_read_b64_tr_b16 a[230:231], v29 offset:24576
    v_cvt_pk_bf16_f32 v220, v48, v49
    v_mfma_f32_16x16x32_bf16 v[144:147], a[248:251], v[244:247], v[144:147]
    v_cvt_pk_bf16_f32 v221, v50, v51
    v_cvt_pk_bf16_f32 v222, v52, v53
    v_mfma_f32_16x16x32_bf16 v[148:151], a[252:255], v[180:183], v[148:151]
    v_cvt_pk_bf16_f32 v223, v54, v55
    v_accvgpr_read_b32 v56, a176
    v_mfma_f32_16x16x32_bf16 v[152:155], a[252:255], v[212:215], v[152:155]
    v_accvgpr_read_b32 v57, a177
    v_accvgpr_read_b32 v58, a178
    v_mfma_f32_16x16x32_bf16 v[156:159], a[252:255], v[244:247], v[156:159]
    v_accvgpr_read_b32 v59, a179
    v_accvgpr_read_b32 v60, a188
    v_accvgpr_read_b32 v61, a189
    v_accvgpr_read_b32 v62, a190
    v_accvgpr_read_b32 v63, a191
    v_cvt_pk_bf16_f32 v252, v56, v57
    v_cvt_pk_bf16_f32 v253, v58, v59
    v_cvt_pk_bf16_f32 v254, v60, v61
    v_cvt_pk_bf16_f32 v255, v62, v63
    s_barrier
    s_waitcnt lgkmcnt(8)
    v_mfma_f32_16x16x32_bf16 v[64:67], a[208:211], v[184:187], v[64:67]
    ds_read_b64_tr_b16 a[232:233], v30 offset:16384
    v_mfma_f32_16x16x32_bf16 v[68:71], a[208:211], v[216:219], v[68:71]
    ds_read_b64_tr_b16 a[234:235], v30 offset:24576
    v_mfma_f32_16x16x32_bf16 v[72:75], a[208:211], v[248:251], v[72:75]
    ds_read_b64_tr_b16 a[236:237], v31 offset:16384
    v_mfma_f32_16x16x32_bf16 v[76:79], a[212:215], v[184:187], v[76:79]
    ds_read_b64_tr_b16 a[238:239], v31 offset:24576
    v_mfma_f32_16x16x32_bf16 v[80:83], a[212:215], v[216:219], v[80:83]
    ds_read_b64_tr_b16 a[240:241], v24 offset:16640
    v_mfma_f32_16x16x32_bf16 v[84:87], a[212:215], v[248:251], v[84:87]
    ds_read_b64_tr_b16 a[242:243], v24 offset:24832
    s_waitcnt lgkmcnt(10)
    v_mfma_f32_16x16x32_bf16 v[88:91], a[216:219], v[184:187], v[88:91]
    ds_read_b64_tr_b16 a[244:245], v25 offset:16640
    v_mfma_f32_16x16x32_bf16 v[92:95], a[216:219], v[216:219], v[92:95]
    ds_read_b64_tr_b16 a[246:247], v25 offset:24832
    v_mfma_f32_16x16x32_bf16 v[96:99], a[216:219], v[248:251], v[96:99]
    v_mfma_f32_16x16x32_bf16 v[100:103], a[220:223], v[184:187], v[100:103]
    ds_read_b64_tr_b16 a[248:249], v26 offset:16640
    v_mfma_f32_16x16x32_bf16 v[104:107], a[220:223], v[216:219], v[104:107]
    ds_read_b64_tr_b16 a[250:251], v26 offset:24832
    v_mfma_f32_16x16x32_bf16 v[108:111], a[220:223], v[248:251], v[108:111]
    s_waitcnt lgkmcnt(10)
    v_mfma_f32_16x16x32_bf16 v[112:115], a[224:227], v[184:187], v[112:115]
    ds_read_b64_tr_b16 a[252:253], v27 offset:16640
    v_mfma_f32_16x16x32_bf16 v[116:119], a[224:227], v[216:219], v[116:119]
    ds_read_b64_tr_b16 a[254:255], v27 offset:24832
    v_mfma_f32_16x16x32_bf16 v[120:123], a[224:227], v[248:251], v[120:123]
    v_mfma_f32_16x16x32_bf16 v[124:127], a[228:231], v[184:187], v[124:127]
    ds_read_b64_tr_b16 a[208:209], v28 offset:16640
    v_mfma_f32_16x16x32_bf16 v[128:131], a[228:231], v[216:219], v[128:131]
    ds_read_b64_tr_b16 a[210:211], v28 offset:24832
    v_mfma_f32_16x16x32_bf16 v[132:135], a[228:231], v[248:251], v[132:135]
    s_waitcnt lgkmcnt(10)
    v_mfma_f32_16x16x32_bf16 v[136:139], a[232:235], v[184:187], v[136:139]
    ds_read_b64_tr_b16 a[212:213], v29 offset:16640
    v_mfma_f32_16x16x32_bf16 v[140:143], a[232:235], v[216:219], v[140:143]
    ds_read_b64_tr_b16 a[214:215], v29 offset:24832
    v_mfma_f32_16x16x32_bf16 v[144:147], a[232:235], v[248:251], v[144:147]
    v_mfma_f32_16x16x32_bf16 v[148:151], a[236:239], v[184:187], v[148:151]
    v_mfma_f32_16x16x32_bf16 v[152:155], a[236:239], v[216:219], v[152:155]
    v_mfma_f32_16x16x32_bf16 v[156:159], a[236:239], v[248:251], v[156:159]
    s_waitcnt lgkmcnt(8)
    v_mfma_f32_16x16x32_bf16 v[64:67], a[240:243], v[188:191], v[64:67]
    ds_read_b64_tr_b16 a[216:217], v30 offset:16640
    v_mfma_f32_16x16x32_bf16 v[68:71], a[240:243], v[220:223], v[68:71]
    ds_read_b64_tr_b16 a[218:219], v30 offset:24832
    v_mfma_f32_16x16x32_bf16 v[72:75], a[240:243], v[252:255], v[72:75]
    ds_read_b64_tr_b16 a[220:221], v31 offset:16640
    v_mfma_f32_16x16x32_bf16 v[76:79], a[244:247], v[188:191], v[76:79]
    ds_read_b64_tr_b16 a[222:223], v31 offset:24832
    v_mfma_f32_16x16x32_bf16 v[80:83], a[244:247], v[220:223], v[80:83]
    ds_read_b64_tr_b16 a[224:225], v8 offset:0
    v_mfma_f32_16x16x32_bf16 v[84:87], a[244:247], v[252:255], v[84:87]
    ds_read_b64_tr_b16 a[226:227], v8 offset:8192
    s_waitcnt lgkmcnt(10)
    v_mfma_f32_16x16x32_bf16 v[88:91], a[248:251], v[188:191], v[88:91]
    ds_read_b64_tr_b16 a[228:229], v9 offset:0
    v_mfma_f32_16x16x32_bf16 v[92:95], a[248:251], v[220:223], v[92:95]
    ds_read_b64_tr_b16 a[230:231], v9 offset:8192
    v_mfma_f32_16x16x32_bf16 v[96:99], a[248:251], v[252:255], v[96:99]
    v_mfma_f32_16x16x32_bf16 v[100:103], a[252:255], v[188:191], v[100:103]
    ds_read_b64_tr_b16 a[232:233], v10 offset:0
    v_mfma_f32_16x16x32_bf16 v[104:107], a[252:255], v[220:223], v[104:107]
    ds_read_b64_tr_b16 a[234:235], v10 offset:8192
    v_mfma_f32_16x16x32_bf16 v[108:111], a[252:255], v[252:255], v[108:111]
    s_waitcnt lgkmcnt(10)
    v_mfma_f32_16x16x32_bf16 v[112:115], a[208:211], v[188:191], v[112:115]
    ds_read_b64_tr_b16 a[236:237], v11 offset:0
    v_mfma_f32_16x16x32_bf16 v[116:119], a[208:211], v[220:223], v[116:119]
    ds_read_b64_tr_b16 a[238:239], v11 offset:8192
    v_mfma_f32_16x16x32_bf16 v[120:123], a[208:211], v[252:255], v[120:123]
    v_mfma_f32_16x16x32_bf16 v[124:127], a[212:215], v[188:191], v[124:127]
    ds_read_b64_tr_b16 a[240:241], v12 offset:0
    v_mfma_f32_16x16x32_bf16 v[128:131], a[212:215], v[220:223], v[128:131]
    ds_read_b64_tr_b16 a[242:243], v12 offset:8192
    v_mfma_f32_16x16x32_bf16 v[132:135], a[212:215], v[252:255], v[132:135]
    s_waitcnt lgkmcnt(10)
    v_mfma_f32_16x16x32_bf16 v[136:139], a[216:219], v[188:191], v[136:139]
    ds_read_b64_tr_b16 a[244:245], v13 offset:0
    v_mfma_f32_16x16x32_bf16 v[140:143], a[216:219], v[220:223], v[140:143]
    ds_read_b64_tr_b16 a[246:247], v13 offset:8192
    v_mfma_f32_16x16x32_bf16 v[144:147], a[216:219], v[252:255], v[144:147]
    v_mfma_f32_16x16x32_bf16 v[148:151], a[220:223], v[188:191], v[148:151]
    v_mfma_f32_16x16x32_bf16 v[152:155], a[220:223], v[220:223], v[152:155]
    v_mfma_f32_16x16x32_bf16 v[156:159], a[220:223], v[252:255], v[156:159]
    s_barrier
    s_waitcnt lgkmcnt(8)
    v_mfma_f32_16x16x32_bf16 a[0:3], a[224:227], v[160:163], 0
    ds_read_b64_tr_b16 a[248:249], v14 offset:0
    v_mfma_f32_16x16x32_bf16 a[4:7], a[224:227], v[192:195], 0
    ds_read_b64_tr_b16 a[250:251], v14 offset:8192
    v_mfma_f32_16x16x32_bf16 a[8:11], a[224:227], v[224:227], 0
    ds_read_b64_tr_b16 a[252:253], v15 offset:0
    v_mfma_f32_16x16x32_bf16 a[12:15], a[228:231], v[160:163], 0
    ds_read_b64_tr_b16 a[254:255], v15 offset:8192
    v_mfma_f32_16x16x32_bf16 a[16:19], a[228:231], v[192:195], 0
    ds_read_b64_tr_b16 a[208:209], v8 offset:256
    v_cvt_pk_bf16_f32 v48, v64, v65
    v_mfma_f32_16x16x32_bf16 a[20:23], a[228:231], v[224:227], 0
    ds_read_b64_tr_b16 a[210:211], v8 offset:8448
    s_waitcnt lgkmcnt(10)
    v_mfma_f32_16x16x32_bf16 a[24:27], a[232:235], v[160:163], 0
    ds_read_b64_tr_b16 a[212:213], v9 offset:256
    v_cvt_pk_bf16_f32 v49, v66, v67
    v_mfma_f32_16x16x32_bf16 a[28:31], a[232:235], v[192:195], 0
    ds_read_b64_tr_b16 a[214:215], v9 offset:8448
    v_cvt_pk_bf16_f32 v50, v76, v77
    v_mfma_f32_16x16x32_bf16 a[32:35], a[232:235], v[224:227], 0
    v_cvt_pk_bf16_f32 v51, v78, v79
    s_add_u32 s32, s40, 0
    v_mfma_f32_16x16x32_bf16 a[36:39], a[236:239], v[160:163], 0
    buffer_store_dwordx4 v[48:51], v22, s[24:27], s32 offen sc0 sc1
    v_cvt_pk_bf16_f32 v60, v68, v69
    v_mfma_f32_16x16x32_bf16 a[40:43], a[236:239], v[192:195], 0
    v_cvt_pk_bf16_f32 v61, v70, v71
    v_cvt_pk_bf16_f32 v62, v80, v81
    v_mfma_f32_16x16x32_bf16 a[44:47], a[236:239], v[224:227], 0
    v_cvt_pk_bf16_f32 v63, v82, v83
    s_add_u32 s32, s40, 14336
    s_waitcnt lgkmcnt(8)
    v_mfma_f32_16x16x32_bf16 a[0:3], a[240:243], v[164:167], a[0:3]
    ds_read_b64_tr_b16 a[216:217], v10 offset:256
    buffer_store_dwordx4 v[60:63], v22, s[24:27], s32 offen sc0 sc1
    v_mfma_f32_16x16x32_bf16 a[4:7], a[240:243], v[196:199], a[4:7]
    ds_read_b64_tr_b16 a[218:219], v10 offset:8448
    v_cvt_pk_bf16_f32 v48, v72, v73
    v_mfma_f32_16x16x32_bf16 a[8:11], a[240:243], v[228:231], a[8:11]
    ds_read_b64_tr_b16 a[220:221], v11 offset:256
    v_cvt_pk_bf16_f32 v49, v74, v75
    v_mfma_f32_16x16x32_bf16 a[12:15], a[244:247], v[164:167], a[12:15]
    ds_read_b64_tr_b16 a[222:223], v11 offset:8448
    v_cvt_pk_bf16_f32 v50, v84, v85
    v_mfma_f32_16x16x32_bf16 a[16:19], a[244:247], v[196:199], a[16:19]
    ds_read_b64_tr_b16 a[224:225], v12 offset:256
    v_cvt_pk_bf16_f32 v51, v86, v87
    v_mfma_f32_16x16x32_bf16 a[20:23], a[244:247], v[228:231], a[20:23]
    ds_read_b64_tr_b16 a[226:227], v12 offset:8448
    s_waitcnt lgkmcnt(10)
    v_mfma_f32_16x16x32_bf16 a[24:27], a[248:251], v[164:167], a[24:27]
    ds_read_b64_tr_b16 a[228:229], v13 offset:256
    s_add_u32 s32, s40, 28672
    v_mfma_f32_16x16x32_bf16 a[28:31], a[248:251], v[196:199], a[28:31]
    ds_read_b64_tr_b16 a[230:231], v13 offset:8448
    buffer_store_dwordx4 v[48:51], v22, s[24:27], s32 offen sc0 sc1
    v_mfma_f32_16x16x32_bf16 a[32:35], a[248:251], v[228:231], a[32:35]
    v_cvt_pk_bf16_f32 v60, v88, v89
    v_cvt_pk_bf16_f32 v61, v90, v91
    v_mfma_f32_16x16x32_bf16 a[36:39], a[252:255], v[164:167], a[36:39]
    v_cvt_pk_bf16_f32 v62, v100, v101
    v_cvt_pk_bf16_f32 v63, v102, v103
    v_mfma_f32_16x16x32_bf16 a[40:43], a[252:255], v[196:199], a[40:43]
    s_add_u32 s32, s40, 1024
    buffer_store_dwordx4 v[60:63], v22, s[24:27], s32 offen sc0 sc1
    v_mfma_f32_16x16x32_bf16 a[44:47], a[252:255], v[228:231], a[44:47]
    v_cvt_pk_bf16_f32 v48, v92, v93
    v_cvt_pk_bf16_f32 v49, v94, v95
    s_waitcnt lgkmcnt(8)
    v_mfma_f32_16x16x32_bf16 a[0:3], a[208:211], v[168:171], a[0:3]
    ds_read_b64_tr_b16 a[232:233], v14 offset:256
    v_cvt_pk_bf16_f32 v50, v104, v105
    v_mfma_f32_16x16x32_bf16 a[4:7], a[208:211], v[200:203], a[4:7]
    ds_read_b64_tr_b16 a[234:235], v14 offset:8448
    v_cvt_pk_bf16_f32 v51, v106, v107
    v_mfma_f32_16x16x32_bf16 a[8:11], a[208:211], v[232:235], a[8:11]
    ds_read_b64_tr_b16 a[236:237], v15 offset:256
    s_add_u32 s32, s40, 15360
    v_mfma_f32_16x16x32_bf16 a[12:15], a[212:215], v[168:171], a[12:15]
    ds_read_b64_tr_b16 a[238:239], v15 offset:8448
    buffer_store_dwordx4 v[48:51], v22, s[24:27], s32 offen sc0 sc1
    v_mfma_f32_16x16x32_bf16 a[16:19], a[212:215], v[200:203], a[16:19]
    ds_read_b64_tr_b16 a[240:241], v24 offset:32768
    v_cvt_pk_bf16_f32 v60, v96, v97
    v_mfma_f32_16x16x32_bf16 a[20:23], a[212:215], v[232:235], a[20:23]
    ds_read_b64_tr_b16 a[242:243], v24 offset:40960
    s_waitcnt lgkmcnt(10)
    v_mfma_f32_16x16x32_bf16 a[24:27], a[216:219], v[168:171], a[24:27]
    ds_read_b64_tr_b16 a[244:245], v25 offset:32768
    v_cvt_pk_bf16_f32 v61, v98, v99
    v_mfma_f32_16x16x32_bf16 a[28:31], a[216:219], v[200:203], a[28:31]
    ds_read_b64_tr_b16 a[246:247], v25 offset:40960
    v_cvt_pk_bf16_f32 v62, v108, v109
    v_mfma_f32_16x16x32_bf16 a[32:35], a[216:219], v[232:235], a[32:35]
    v_cvt_pk_bf16_f32 v63, v110, v111
    s_add_u32 s32, s40, 29696
    v_mfma_f32_16x16x32_bf16 a[36:39], a[220:223], v[168:171], a[36:39]
    buffer_store_dwordx4 v[60:63], v22, s[24:27], s32 offen sc0 sc1
    v_cvt_pk_bf16_f32 v48, v112, v113
    v_mfma_f32_16x16x32_bf16 a[40:43], a[220:223], v[200:203], a[40:43]
    v_cvt_pk_bf16_f32 v49, v114, v115
    v_cvt_pk_bf16_f32 v50, v124, v125
    v_mfma_f32_16x16x32_bf16 a[44:47], a[220:223], v[232:235], a[44:47]
    v_cvt_pk_bf16_f32 v51, v126, v127
    s_add_u32 s32, s40, 2048
    s_waitcnt lgkmcnt(8)
    v_mfma_f32_16x16x32_bf16 a[0:3], a[224:227], v[172:175], a[0:3]
    ds_read_b64_tr_b16 a[248:249], v26 offset:32768
    buffer_store_dwordx4 v[48:51], v22, s[24:27], s32 offen sc0 sc1
    v_mfma_f32_16x16x32_bf16 a[4:7], a[224:227], v[204:207], a[4:7]
    ds_read_b64_tr_b16 a[250:251], v26 offset:40960
    v_cvt_pk_bf16_f32 v60, v116, v117
    v_mfma_f32_16x16x32_bf16 a[8:11], a[224:227], v[236:239], a[8:11]
    ds_read_b64_tr_b16 a[252:253], v27 offset:32768
    v_cvt_pk_bf16_f32 v61, v118, v119
    v_mfma_f32_16x16x32_bf16 a[12:15], a[228:231], v[172:175], a[12:15]
    ds_read_b64_tr_b16 a[254:255], v27 offset:40960
    v_cvt_pk_bf16_f32 v62, v128, v129
    v_mfma_f32_16x16x32_bf16 a[16:19], a[228:231], v[204:207], a[16:19]
    ds_read_b64_tr_b16 a[208:209], v28 offset:32768
    v_cvt_pk_bf16_f32 v63, v130, v131
    v_mfma_f32_16x16x32_bf16 a[20:23], a[228:231], v[236:239], a[20:23]
    ds_read_b64_tr_b16 a[210:211], v28 offset:40960
    s_waitcnt lgkmcnt(10)
    v_mfma_f32_16x16x32_bf16 a[24:27], a[232:235], v[172:175], a[24:27]
    ds_read_b64_tr_b16 a[212:213], v29 offset:32768
    s_add_u32 s32, s40, 16384
    v_mfma_f32_16x16x32_bf16 a[28:31], a[232:235], v[204:207], a[28:31]
    ds_read_b64_tr_b16 a[214:215], v29 offset:40960
    buffer_store_dwordx4 v[60:63], v22, s[24:27], s32 offen sc0 sc1
    v_mfma_f32_16x16x32_bf16 a[32:35], a[232:235], v[236:239], a[32:35]
    v_cvt_pk_bf16_f32 v48, v120, v121
    v_cvt_pk_bf16_f32 v49, v122, v123
    v_mfma_f32_16x16x32_bf16 a[36:39], a[236:239], v[172:175], a[36:39]
    v_cvt_pk_bf16_f32 v50, v132, v133
    v_cvt_pk_bf16_f32 v51, v134, v135
    v_mfma_f32_16x16x32_bf16 a[40:43], a[236:239], v[204:207], a[40:43]
    s_add_u32 s32, s40, 30720
    buffer_store_dwordx4 v[48:51], v22, s[24:27], s32 offen sc0 sc1
    v_mfma_f32_16x16x32_bf16 a[44:47], a[236:239], v[236:239], a[44:47]
    v_cvt_pk_bf16_f32 v60, v136, v137
    v_cvt_pk_bf16_f32 v61, v138, v139
    s_barrier
    s_waitcnt lgkmcnt(8)
    v_mfma_f32_16x16x32_bf16 a[0:3], a[240:243], v[176:179], a[0:3]
    ds_read_b64_tr_b16 a[216:217], v30 offset:32768
    v_cvt_pk_bf16_f32 v62, v148, v149
    v_mfma_f32_16x16x32_bf16 a[4:7], a[240:243], v[208:211], a[4:7]
    ds_read_b64_tr_b16 a[218:219], v30 offset:40960
    v_cvt_pk_bf16_f32 v63, v150, v151
    v_mfma_f32_16x16x32_bf16 a[8:11], a[240:243], v[240:243], a[8:11]
    ds_read_b64_tr_b16 a[220:221], v31 offset:32768
    s_add_u32 s32, s40, 3072
    v_mfma_f32_16x16x32_bf16 a[12:15], a[244:247], v[176:179], a[12:15]
    ds_read_b64_tr_b16 a[222:223], v31 offset:40960
    buffer_store_dwordx4 v[60:63], v22, s[24:27], s32 offen sc0 sc1
    v_mfma_f32_16x16x32_bf16 a[16:19], a[244:247], v[208:211], a[16:19]
    ds_read_b64_tr_b16 a[224:225], v24 offset:33024
    v_cvt_pk_bf16_f32 v48, v140, v141
    v_mfma_f32_16x16x32_bf16 a[20:23], a[244:247], v[240:243], a[20:23]
    ds_read_b64_tr_b16 a[226:227], v24 offset:41216
    s_waitcnt lgkmcnt(10)
    v_mfma_f32_16x16x32_bf16 a[24:27], a[248:251], v[176:179], a[24:27]
    ds_read_b64_tr_b16 a[228:229], v25 offset:33024
    v_cvt_pk_bf16_f32 v49, v142, v143
    v_mfma_f32_16x16x32_bf16 a[28:31], a[248:251], v[208:211], a[28:31]
    ds_read_b64_tr_b16 a[230:231], v25 offset:41216
    v_cvt_pk_bf16_f32 v50, v152, v153
    v_mfma_f32_16x16x32_bf16 a[32:35], a[248:251], v[240:243], a[32:35]
    v_cvt_pk_bf16_f32 v51, v154, v155
    s_add_u32 s32, s40, 17408
    v_mfma_f32_16x16x32_bf16 a[36:39], a[252:255], v[176:179], a[36:39]
    buffer_store_dwordx4 v[48:51], v22, s[24:27], s32 offen sc0 sc1
    v_cvt_pk_bf16_f32 v60, v144, v145
    v_mfma_f32_16x16x32_bf16 a[40:43], a[252:255], v[208:211], a[40:43]
    v_cvt_pk_bf16_f32 v61, v146, v147
    v_cvt_pk_bf16_f32 v62, v156, v157
    v_mfma_f32_16x16x32_bf16 a[44:47], a[252:255], v[240:243], a[44:47]
    v_cvt_pk_bf16_f32 v63, v158, v159
    s_add_u32 s32, s40, 31744
    s_waitcnt lgkmcnt(8)
    v_mfma_f32_16x16x32_bf16 a[0:3], a[208:211], v[180:183], a[0:3]
    ds_read_b64_tr_b16 a[232:233], v26 offset:33024
    buffer_store_dwordx4 v[60:63], v22, s[24:27], s32 offen sc0 sc1
    v_mfma_f32_16x16x32_bf16 a[4:7], a[208:211], v[212:215], a[4:7]
    ds_read_b64_tr_b16 a[234:235], v26 offset:41216
    v_mfma_f32_16x16x32_bf16 a[8:11], a[208:211], v[244:247], a[8:11]
    ds_read_b64_tr_b16 a[236:237], v27 offset:33024
    v_mfma_f32_16x16x32_bf16 a[12:15], a[212:215], v[180:183], a[12:15]
    ds_read_b64_tr_b16 a[238:239], v27 offset:41216
    v_mfma_f32_16x16x32_bf16 a[16:19], a[212:215], v[212:215], a[16:19]
    ds_read_b64_tr_b16 a[240:241], v28 offset:33024
    v_mfma_f32_16x16x32_bf16 a[20:23], a[212:215], v[244:247], a[20:23]
    ds_read_b64_tr_b16 a[242:243], v28 offset:41216
    s_waitcnt lgkmcnt(10)
    v_mfma_f32_16x16x32_bf16 a[24:27], a[216:219], v[180:183], a[24:27]
    ds_read_b64_tr_b16 a[244:245], v29 offset:33024
    v_mfma_f32_16x16x32_bf16 a[28:31], a[216:219], v[212:215], a[28:31]
    ds_read_b64_tr_b16 a[246:247], v29 offset:41216
    v_mfma_f32_16x16x32_bf16 a[32:35], a[216:219], v[244:247], a[32:35]
    v_mfma_f32_16x16x32_bf16 a[36:39], a[220:223], v[180:183], a[36:39]
    v_mfma_f32_16x16x32_bf16 a[40:43], a[220:223], v[212:215], a[40:43]
    v_mfma_f32_16x16x32_bf16 a[44:47], a[220:223], v[244:247], a[44:47]
    s_waitcnt lgkmcnt(8)
    v_mfma_f32_16x16x32_bf16 a[0:3], a[224:227], v[184:187], a[0:3]
    ds_read_b64_tr_b16 a[248:249], v30 offset:33024
    v_mfma_f32_16x16x32_bf16 a[4:7], a[224:227], v[216:219], a[4:7]
    ds_read_b64_tr_b16 a[250:251], v30 offset:41216
    v_mfma_f32_16x16x32_bf16 a[8:11], a[224:227], v[248:251], a[8:11]
    ds_read_b64_tr_b16 a[252:253], v31 offset:33024
    v_mfma_f32_16x16x32_bf16 a[12:15], a[228:231], v[184:187], a[12:15]
    ds_read_b64_tr_b16 a[254:255], v31 offset:41216
    v_mfma_f32_16x16x32_bf16 a[16:19], a[228:231], v[216:219], a[16:19]
    ds_read_b64_tr_b16 a[208:209], v8 offset:16384
    v_mfma_f32_16x16x32_bf16 a[20:23], a[228:231], v[248:251], a[20:23]
    ds_read_b64_tr_b16 a[210:211], v8 offset:24576
    s_waitcnt lgkmcnt(10)
    v_mfma_f32_16x16x32_bf16 a[24:27], a[232:235], v[184:187], a[24:27]
    ds_read_b64_tr_b16 a[212:213], v9 offset:16384
    v_mfma_f32_16x16x32_bf16 a[28:31], a[232:235], v[216:219], a[28:31]
    ds_read_b64_tr_b16 a[214:215], v9 offset:24576
    v_mfma_f32_16x16x32_bf16 a[32:35], a[232:235], v[248:251], a[32:35]
    v_mfma_f32_16x16x32_bf16 a[36:39], a[236:239], v[184:187], a[36:39]
    v_mfma_f32_16x16x32_bf16 a[40:43], a[236:239], v[216:219], a[40:43]
    v_mfma_f32_16x16x32_bf16 a[44:47], a[236:239], v[248:251], a[44:47]
    s_waitcnt lgkmcnt(8)
    v_mfma_f32_16x16x32_bf16 a[0:3], a[240:243], v[188:191], a[0:3]
    ds_read_b64_tr_b16 a[216:217], v10 offset:16384
    v_mfma_f32_16x16x32_bf16 a[4:7], a[240:243], v[220:223], a[4:7]
    ds_read_b64_tr_b16 a[218:219], v10 offset:24576
    v_mfma_f32_16x16x32_bf16 a[8:11], a[240:243], v[252:255], a[8:11]
    ds_read_b64_tr_b16 a[220:221], v11 offset:16384
    v_mfma_f32_16x16x32_bf16 a[12:15], a[244:247], v[188:191], a[12:15]
    ds_read_b64_tr_b16 a[222:223], v11 offset:24576
    v_mfma_f32_16x16x32_bf16 a[16:19], a[244:247], v[220:223], a[16:19]
    ds_read_b64_tr_b16 a[224:225], v12 offset:16384
    v_mfma_f32_16x16x32_bf16 a[20:23], a[244:247], v[252:255], a[20:23]
    ds_read_b64_tr_b16 a[226:227], v12 offset:24576
    s_waitcnt lgkmcnt(10)
    v_mfma_f32_16x16x32_bf16 a[24:27], a[248:251], v[188:191], a[24:27]
    ds_read_b64_tr_b16 a[228:229], v13 offset:16384
    v_mfma_f32_16x16x32_bf16 a[28:31], a[248:251], v[220:223], a[28:31]
    ds_read_b64_tr_b16 a[230:231], v13 offset:24576
    v_mfma_f32_16x16x32_bf16 a[32:35], a[248:251], v[252:255], a[32:35]
    v_mfma_f32_16x16x32_bf16 a[36:39], a[252:255], v[188:191], a[36:39]
    v_mfma_f32_16x16x32_bf16 a[40:43], a[252:255], v[220:223], a[40:43]
    v_mfma_f32_16x16x32_bf16 a[44:47], a[252:255], v[252:255], a[44:47]
    s_barrier
    s_waitcnt lgkmcnt(8)
    v_mfma_f32_16x16x32_bf16 v[64:67], a[208:211], v[160:163], 0
    ds_read_b64_tr_b16 a[232:233], v14 offset:16384
    v_mfma_f32_16x16x32_bf16 v[68:71], a[208:211], v[192:195], 0
    ds_read_b64_tr_b16 a[234:235], v14 offset:24576
    v_mfma_f32_16x16x32_bf16 v[72:75], a[208:211], v[224:227], 0
    ds_read_b64_tr_b16 a[236:237], v15 offset:16384
    v_mfma_f32_16x16x32_bf16 v[76:79], a[212:215], v[160:163], 0
    ds_read_b64_tr_b16 a[238:239], v15 offset:24576
    v_mfma_f32_16x16x32_bf16 v[80:83], a[212:215], v[192:195], 0
    ds_read_b64_tr_b16 a[240:241], v8 offset:16640
    v_accvgpr_read_b32 v40, a0
    v_mfma_f32_16x16x32_bf16 v[84:87], a[212:215], v[224:227], 0
    ds_read_b64_tr_b16 a[242:243], v8 offset:24832
    s_waitcnt lgkmcnt(10)
    v_mfma_f32_16x16x32_bf16 v[88:91], a[216:219], v[160:163], 0
    ds_read_b64_tr_b16 a[244:245], v9 offset:16640
    v_accvgpr_read_b32 v41, a1
    v_mfma_f32_16x16x32_bf16 v[92:95], a[216:219], v[192:195], 0
    ds_read_b64_tr_b16 a[246:247], v9 offset:24832
    v_accvgpr_read_b32 v42, a2
    v_mfma_f32_16x16x32_bf16 v[96:99], a[216:219], v[224:227], 0
    v_accvgpr_read_b32 v43, a3
    v_accvgpr_read_b32 v44, a12
    v_mfma_f32_16x16x32_bf16 v[100:103], a[220:223], v[160:163], 0
    v_accvgpr_read_b32 v45, a13
    v_accvgpr_read_b32 v46, a14
    v_mfma_f32_16x16x32_bf16 v[104:107], a[220:223], v[192:195], 0
    v_accvgpr_read_b32 v47, a15
    v_cvt_pk_bf16_f32 v48, v40, v41
    v_mfma_f32_16x16x32_bf16 v[108:111], a[220:223], v[224:227], 0
    v_cvt_pk_bf16_f32 v49, v42, v43
    v_cvt_pk_bf16_f32 v50, v44, v45
    s_waitcnt lgkmcnt(8)
    v_mfma_f32_16x16x32_bf16 v[64:67], a[224:227], v[164:167], v[64:67]
    ds_read_b64_tr_b16 a[248:249], v10 offset:16640
    v_cvt_pk_bf16_f32 v51, v46, v47
    v_mfma_f32_16x16x32_bf16 v[68:71], a[224:227], v[196:199], v[68:71]
    ds_read_b64_tr_b16 a[250:251], v10 offset:24832
    s_add_u32 s32, s40, 4096
    v_mfma_f32_16x16x32_bf16 v[72:75], a[224:227], v[228:231], v[72:75]
    ds_read_b64_tr_b16 a[252:253], v11 offset:16640
    buffer_store_dwordx4 v[48:51], v22, s[24:27], s32 offen sc0 sc1
    v_mfma_f32_16x16x32_bf16 v[76:79], a[228:231], v[164:167], v[76:79]
    ds_read_b64_tr_b16 a[254:255], v11 offset:24832
    v_accvgpr_read_b32 v52, a4
    v_mfma_f32_16x16x32_bf16 v[80:83], a[228:231], v[196:199], v[80:83]
    ds_read_b64_tr_b16 a[208:209], v12 offset:16640
    v_accvgpr_read_b32 v53, a5
    v_mfma_f32_16x16x32_bf16 v[84:87], a[228:231], v[228:231], v[84:87]
    ds_read_b64_tr_b16 a[210:211], v12 offset:24832
    s_waitcnt lgkmcnt(10)
    v_mfma_f32_16x16x32_bf16 v[88:91], a[232:235], v[164:167], v[88:91]
    ds_read_b64_tr_b16 a[212:213], v13 offset:16640
    v_accvgpr_read_b32 v54, a6
    v_mfma_f32_16x16x32_bf16 v[92:95], a[232:235], v[196:199], v[92:95]
    ds_read_b64_tr_b16 a[214:215], v13 offset:24832
    v_accvgpr_read_b32 v55, a7
    v_mfma_f32_16x16x32_bf16 v[96:99], a[232:235], v[228:231], v[96:99]
    v_accvgpr_read_b32 v56, a16
    v_accvgpr_read_b32 v57, a17
    v_mfma_f32_16x16x32_bf16 v[100:103], a[236:239], v[164:167], v[100:103]
    v_accvgpr_read_b32 v58, a18
    v_accvgpr_read_b32 v59, a19
    v_mfma_f32_16x16x32_bf16 v[104:107], a[236:239], v[196:199], v[104:107]
    v_cvt_pk_bf16_f32 v60, v52, v53
    v_cvt_pk_bf16_f32 v61, v54, v55
    v_mfma_f32_16x16x32_bf16 v[108:111], a[236:239], v[228:231], v[108:111]
    v_cvt_pk_bf16_f32 v62, v56, v57
    v_cvt_pk_bf16_f32 v63, v58, v59
    s_waitcnt lgkmcnt(8)
    v_mfma_f32_16x16x32_bf16 v[64:67], a[240:243], v[168:171], v[64:67]
    ds_read_b64_tr_b16 a[216:217], v14 offset:16640
    s_add_u32 s32, s40, 18432
    v_mfma_f32_16x16x32_bf16 v[68:71], a[240:243], v[200:203], v[68:71]
    ds_read_b64_tr_b16 a[218:219], v14 offset:24832
    buffer_store_dwordx4 v[60:63], v22, s[24:27], s32 offen sc0 sc1
    v_mfma_f32_16x16x32_bf16 v[72:75], a[240:243], v[232:235], v[72:75]
    ds_read_b64_tr_b16 a[220:221], v15 offset:16640
    v_accvgpr_read_b32 v40, a8
    v_mfma_f32_16x16x32_bf16 v[76:79], a[244:247], v[168:171], v[76:79]
    ds_read_b64_tr_b16 a[222:223], v15 offset:24832
    v_accvgpr_read_b32 v41, a9
    v_mfma_f32_16x16x32_bf16 v[80:83], a[244:247], v[200:203], v[80:83]
    ds_read_b64_tr_b16 a[224:225], v24 offset:49152
    v_accvgpr_read_b32 v42, a10
    v_mfma_f32_16x16x32_bf16 v[84:87], a[244:247], v[232:235], v[84:87]
    ds_read_b64_tr_b16 a[226:227], v24 offset:57344
    s_waitcnt lgkmcnt(10)
    v_mfma_f32_16x16x32_bf16 v[88:91], a[248:251], v[168:171], v[88:91]
    ds_read_b64_tr_b16 a[228:229], v25 offset:49152
    v_accvgpr_read_b32 v43, a11
    v_mfma_f32_16x16x32_bf16 v[92:95], a[248:251], v[200:203], v[92:95]
    ds_read_b64_tr_b16 a[230:231], v25 offset:57344
    v_accvgpr_read_b32 v44, a20
    v_mfma_f32_16x16x32_bf16 v[96:99], a[248:251], v[232:235], v[96:99]
    v_accvgpr_read_b32 v45, a21
    v_accvgpr_read_b32 v46, a22
    v_mfma_f32_16x16x32_bf16 v[100:103], a[252:255], v[168:171], v[100:103]
    v_accvgpr_read_b32 v47, a23
    v_cvt_pk_bf16_f32 v48, v40, v41
    v_mfma_f32_16x16x32_bf16 v[104:107], a[252:255], v[200:203], v[104:107]
    v_cvt_pk_bf16_f32 v49, v42, v43
    v_cvt_pk_bf16_f32 v50, v44, v45
    v_mfma_f32_16x16x32_bf16 v[108:111], a[252:255], v[232:235], v[108:111]
    v_cvt_pk_bf16_f32 v51, v46, v47
    s_add_u32 s32, s40, 32768
    s_waitcnt lgkmcnt(8)
    v_mfma_f32_16x16x32_bf16 v[64:67], a[208:211], v[172:175], v[64:67]
    ds_read_b64_tr_b16 a[232:233], v26 offset:49152
    buffer_store_dwordx4 v[48:51], v22, s[24:27], s32 offen sc0 sc1
    v_mfma_f32_16x16x32_bf16 v[68:71], a[208:211], v[204:207], v[68:71]
    ds_read_b64_tr_b16 a[234:235], v26 offset:57344
    v_accvgpr_read_b32 v52, a24
    v_mfma_f32_16x16x32_bf16 v[72:75], a[208:211], v[236:239], v[72:75]
    ds_read_b64_tr_b16 a[236:237], v27 offset:49152
    v_accvgpr_read_b32 v53, a25
    v_mfma_f32_16x16x32_bf16 v[76:79], a[212:215], v[172:175], v[76:79]
    ds_read_b64_tr_b16 a[238:239], v27 offset:57344
    v_accvgpr_read_b32 v54, a26
    v_mfma_f32_16x16x32_bf16 v[80:83], a[212:215], v[204:207], v[80:83]
    ds_read_b64_tr_b16 a[240:241], v28 offset:49152
    v_accvgpr_read_b32 v55, a27
    v_mfma_f32_16x16x32_bf16 v[84:87], a[212:215], v[236:239], v[84:87]
    ds_read_b64_tr_b16 a[242:243], v28 offset:57344
    s_waitcnt lgkmcnt(10)
    v_mfma_f32_16x16x32_bf16 v[88:91], a[216:219], v[172:175], v[88:91]
    ds_read_b64_tr_b16 a[244:245], v29 offset:49152
    v_accvgpr_read_b32 v56, a36
    v_mfma_f32_16x16x32_bf16 v[92:95], a[216:219], v[204:207], v[92:95]
    ds_read_b64_tr_b16 a[246:247], v29 offset:57344
    v_accvgpr_read_b32 v57, a37
    v_mfma_f32_16x16x32_bf16 v[96:99], a[216:219], v[236:239], v[96:99]
    v_accvgpr_read_b32 v58, a38
    v_accvgpr_read_b32 v59, a39
    v_mfma_f32_16x16x32_bf16 v[100:103], a[220:223], v[172:175], v[100:103]
    v_cvt_pk_bf16_f32 v60, v52, v53
    v_cvt_pk_bf16_f32 v61, v54, v55
    v_mfma_f32_16x16x32_bf16 v[104:107], a[220:223], v[204:207], v[104:107]
    v_cvt_pk_bf16_f32 v62, v56, v57
    v_cvt_pk_bf16_f32 v63, v58, v59
    v_mfma_f32_16x16x32_bf16 v[108:111], a[220:223], v[236:239], v[108:111]
    s_add_u32 s32, s40, 5120
    buffer_store_dwordx4 v[60:63], v22, s[24:27], s32 offen sc0 sc1
    s_barrier
    s_waitcnt vmcnt(4)
    s_mov_b64 exec, 1
    ds_add_rtn_u32 v6, v4, v5 offset:0
    s_mov_b64 exec, -1
    s_waitcnt lgkmcnt(9)
    v_mfma_f32_16x16x32_bf16 v[64:67], a[224:227], v[176:179], v[64:67]
    ds_read_b64_tr_b16 a[248:249], v30 offset:49152
    v_accvgpr_read_b32 v40, a28
    v_mfma_f32_16x16x32_bf16 v[68:71], a[224:227], v[208:211], v[68:71]
    ds_read_b64_tr_b16 a[250:251], v30 offset:57344
    v_accvgpr_read_b32 v41, a29
    v_mfma_f32_16x16x32_bf16 v[72:75], a[224:227], v[240:243], v[72:75]
    ds_read_b64_tr_b16 a[252:253], v31 offset:49152
    v_accvgpr_read_b32 v42, a30
    v_mfma_f32_16x16x32_bf16 v[76:79], a[228:231], v[176:179], v[76:79]
    ds_read_b64_tr_b16 a[254:255], v31 offset:57344
    v_accvgpr_read_b32 v43, a31
    v_mfma_f32_16x16x32_bf16 v[80:83], a[228:231], v[208:211], v[80:83]
    ds_read_b64_tr_b16 a[208:209], v24 offset:49408
    v_accvgpr_read_b32 v44, a40
    v_mfma_f32_16x16x32_bf16 v[84:87], a[228:231], v[240:243], v[84:87]
    ds_read_b64_tr_b16 a[210:211], v24 offset:57600
    s_waitcnt lgkmcnt(11)
    v_mfma_f32_16x16x32_bf16 v[88:91], a[232:235], v[176:179], v[88:91]
    ds_read_b64_tr_b16 a[212:213], v25 offset:49408
    v_accvgpr_read_b32 v45, a41
    v_mfma_f32_16x16x32_bf16 v[92:95], a[232:235], v[208:211], v[92:95]
    ds_read_b64_tr_b16 a[214:215], v25 offset:57600
    v_accvgpr_read_b32 v46, a42
    v_mfma_f32_16x16x32_bf16 v[96:99], a[232:235], v[240:243], v[96:99]
    v_accvgpr_read_b32 v47, a43
    v_cvt_pk_bf16_f32 v48, v40, v41
    v_mfma_f32_16x16x32_bf16 v[100:103], a[236:239], v[176:179], v[100:103]
    v_cvt_pk_bf16_f32 v49, v42, v43
    v_cvt_pk_bf16_f32 v50, v44, v45
    v_mfma_f32_16x16x32_bf16 v[104:107], a[236:239], v[208:211], v[104:107]
    v_cvt_pk_bf16_f32 v51, v46, v47
    s_add_u32 s32, s40, 19456
    v_mfma_f32_16x16x32_bf16 v[108:111], a[236:239], v[240:243], v[108:111]
    buffer_store_dwordx4 v[48:51], v22, s[24:27], s32 offen sc0 sc1
    v_accvgpr_read_b32 v52, a32
    s_waitcnt lgkmcnt(8)
    v_readfirstlane_b32 s90, v6
    s_nop 3
    s_cmp_eq_u32 s90, 2
    s_cbranch_scc0 L_nosig0
    s_mov_b64 exec, 1
    s_mov_b32 s88, 0
    buffer_atomic_add v5, off, s[84:87], s88
    s_mov_b64 exec, -1
L_nosig0:
    v_mfma_f32_16x16x32_bf16 v[64:67], a[240:243], v[180:183], v[64:67]
    ds_read_b64_tr_b16 a[216:217], v26 offset:49408
    v_accvgpr_read_b32 v53, a33
    v_mfma_f32_16x16x32_bf16 v[68:71], a[240:243], v[212:215], v[68:71]
    ds_read_b64_tr_b16 a[218:219], v26 offset:57600
    v_accvgpr_read_b32 v54, a34
    v_mfma_f32_16x16x32_bf16 v[72:75], a[240:243], v[244:247], v[72:75]
    ds_read_b64_tr_b16 a[220:221], v27 offset:49408
    v_accvgpr_read_b32 v55, a35
    v_mfma_f32_16x16x32_bf16 v[76:79], a[244:247], v[180:183], v[76:79]
    ds_read_b64_tr_b16 a[222:223], v27 offset:57600
    v_accvgpr_read_b32 v56, a44
    v_mfma_f32_16x16x32_bf16 v[80:83], a[244:247], v[212:215], v[80:83]
    ds_read_b64_tr_b16 a[224:225], v28 offset:49408
    v_accvgpr_read_b32 v57, a45
    v_mfma_f32_16x16x32_bf16 v[84:87], a[244:247], v[244:247], v[84:87]
    ds_read_b64_tr_b16 a[226:227], v28 offset:57600
    s_waitcnt lgkmcnt(10)
    v_mfma_f32_16x16x32_bf16 v[88:91], a[248:251], v[180:183], v[88:91]
    ds_read_b64_tr_b16 a[228:229], v29 offset:49408
    v_accvgpr_read_b32 v58, a46
    v_mfma_f32_16x16x32_bf16 v[92:95], a[248:251], v[212:215], v[92:95]
    ds_read_b64_tr_b16 a[230:231], v29 offset:57600
    v_accvgpr_read_b32 v59, a47
    v_mfma_f32_16x16x32_bf16 v[96:99], a[248:251], v[244:247], v[96:99]
    v_cvt_pk_bf16_f32 v60, v52, v53
    v_cvt_pk_bf16_f32 v61, v54, v55
    v_mfma_f32_16x16x32_bf16 v[100:103], a[252:255], v[180:183], v[100:103]
    v_cvt_pk_bf16_f32 v62, v56, v57
    v_cvt_pk_bf16_f32 v63, v58, v59
    v_mfma_f32_16x16x32_bf16 v[104:107], a[252:255], v[212:215], v[104:107]
    s_add_u32 s32, s40, 33792
    buffer_store_dwordx4 v[60:63], v22, s[24:27], s32 offen sc0 sc1
    v_mfma_f32_16x16x32_bf16 v[108:111], a[252:255], v[244:247], v[108:111]
    s_waitcnt lgkmcnt(8)
    v_mfma_f32_16x16x32_bf16 v[64:67], a[208:211], v[184:187], v[64:67]
    ds_read_b64_tr_b16 a[232:233], v30 offset:49408
    v_mfma_f32_16x16x32_bf16 v[68:71], a[208:211], v[216:219], v[68:71]
    ds_read_b64_tr_b16 a[234:235], v30 offset:57600
    v_mfma_f32_16x16x32_bf16 v[72:75], a[208:211], v[248:251], v[72:75]
    ds_read_b64_tr_b16 a[236:237], v31 offset:49408
    v_mfma_f32_16x16x32_bf16 v[76:79], a[212:215], v[184:187], v[76:79]
    ds_read_b64_tr_b16 a[238:239], v31 offset:57600
    v_mfma_f32_16x16x32_bf16 v[80:83], a[212:215], v[216:219], v[80:83]
    ds_read_b64_tr_b16 a[240:241], v8 offset:32768
    v_mfma_f32_16x16x32_bf16 v[84:87], a[212:215], v[248:251], v[84:87]
    ds_read_b64_tr_b16 a[242:243], v8 offset:40960
    s_waitcnt lgkmcnt(10)
    v_mfma_f32_16x16x32_bf16 v[88:91], a[216:219], v[184:187], v[88:91]
    ds_read_b64_tr_b16 a[244:245], v9 offset:32768
    v_mfma_f32_16x16x32_bf16 v[92:95], a[216:219], v[216:219], v[92:95]
    ds_read_b64_tr_b16 a[246:247], v9 offset:40960
    v_mfma_f32_16x16x32_bf16 v[96:99], a[216:219], v[248:251], v[96:99]
    v_mfma_f32_16x16x32_bf16 v[100:103], a[220:223], v[184:187], v[100:103]
    v_mfma_f32_16x16x32_bf16 v[104:107], a[220:223], v[216:219], v[104:107]
    v_mfma_f32_16x16x32_bf16 v[108:111], a[220:223], v[248:251], v[108:111]
    s_waitcnt lgkmcnt(8)
    v_mfma_f32_16x16x32_bf16 v[64:67], a[224:227], v[188:191], v[64:67]
    ds_read_b64_tr_b16 a[248:249], v10 offset:32768
    v_mfma_f32_16x16x32_bf16 v[68:71], a[224:227], v[220:223], v[68:71]
    ds_read_b64_tr_b16 a[250:251], v10 offset:40960
    v_mfma_f32_16x16x32_bf16 v[72:75], a[224:227], v[252:255], v[72:75]
    ds_read_b64_tr_b16 a[252:253], v11 offset:32768
    v_mfma_f32_16x16x32_bf16 v[76:79], a[228:231], v[188:191], v[76:79]
    ds_read_b64_tr_b16 a[254:255], v11 offset:40960
    v_mfma_f32_16x16x32_bf16 v[80:83], a[228:231], v[220:223], v[80:83]
    ds_read_b64_tr_b16 a[208:209], v12 offset:32768
    v_mfma_f32_16x16x32_bf16 v[84:87], a[228:231], v[252:255], v[84:87]
    ds_read_b64_tr_b16 a[210:211], v12 offset:40960
    s_waitcnt lgkmcnt(10)
    v_mfma_f32_16x16x32_bf16 v[88:91], a[232:235], v[188:191], v[88:91]
    ds_read_b64_tr_b16 a[212:213], v13 offset:32768
    v_mfma_f32_16x16x32_bf16 v[92:95], a[232:235], v[220:223], v[92:95]
    ds_read_b64_tr_b16 a[214:215], v13 offset:40960
    v_mfma_f32_16x16x32_bf16 v[96:99], a[232:235], v[252:255], v[96:99]
    v_mfma_f32_16x16x32_bf16 v[100:103], a[236:239], v[188:191], v[100:103]
    v_mfma_f32_16x16x32_bf16 v[104:107], a[236:239], v[220:223], v[104:107]
    v_mfma_f32_16x16x32_bf16 v[108:111], a[236:239], v[252:255], v[108:111]
    s_barrier
    s_waitcnt lgkmcnt(8)
    v_mfma_f32_16x16x32_bf16 v[112:115], a[240:243], v[160:163], 0
    ds_read_b64_tr_b16 a[216:217], v14 offset:32768
    v_mfma_f32_16x16x32_bf16 v[116:119], a[240:243], v[192:195], 0
    ds_read_b64_tr_b16 a[218:219], v14 offset:40960
    v_mfma_f32_16x16x32_bf16 v[120:123], a[240:243], v[224:227], 0
    ds_read_b64_tr_b16 a[220:221], v15 offset:32768
    v_mfma_f32_16x16x32_bf16 v[124:127], a[244:247], v[160:163], 0
    ds_read_b64_tr_b16 a[222:223], v15 offset:40960
    v_mfma_f32_16x16x32_bf16 v[128:131], a[244:247], v[192:195], 0
    ds_read_b64_tr_b16 a[224:225], v8 offset:33024
    v_cvt_pk_bf16_f32 v48, v64, v65
    v_mfma_f32_16x16x32_bf16 v[132:135], a[244:247], v[224:227], 0
    ds_read_b64_tr_b16 a[226:227], v8 offset:41216
    s_waitcnt lgkmcnt(10)
    v_mfma_f32_16x16x32_bf16 v[136:139], a[248:251], v[160:163], 0
    ds_read_b64_tr_b16 a[228:229], v9 offset:33024
    v_cvt_pk_bf16_f32 v49, v66, v67
    v_mfma_f32_16x16x32_bf16 v[140:143], a[248:251], v[192:195], 0
    ds_read_b64_tr_b16 a[230:231], v9 offset:41216
    v_cvt_pk_bf16_f32 v50, v76, v77
    v_mfma_f32_16x16x32_bf16 v[144:147], a[248:251], v[224:227], 0
    v_cvt_pk_bf16_f32 v51, v78, v79
    s_add_u32 s32, s40, 6144
    v_mfma_f32_16x16x32_bf16 v[148:151], a[252:255], v[160:163], 0
    buffer_store_dwordx4 v[48:51], v22, s[24:27], s32 offen sc0 sc1
    v_cvt_pk_bf16_f32 v60, v68, v69
    v_mfma_f32_16x16x32_bf16 v[152:155], a[252:255], v[192:195], 0
    v_cvt_pk_bf16_f32 v61, v70, v71
    v_cvt_pk_bf16_f32 v62, v80, v81
    v_mfma_f32_16x16x32_bf16 v[156:159], a[252:255], v[224:227], 0
    v_cvt_pk_bf16_f32 v63, v82, v83
    s_add_u32 s32, s40, 20480
    s_waitcnt lgkmcnt(8)
    v_mfma_f32_16x16x32_bf16 v[112:115], a[208:211], v[164:167], v[112:115]
    ds_read_b64_tr_b16 a[232:233], v10 offset:33024
    buffer_store_dwordx4 v[60:63], v22, s[24:27], s32 offen sc0 sc1
    v_mfma_f32_16x16x32_bf16 v[116:119], a[208:211], v[196:199], v[116:119]
    ds_read_b64_tr_b16 a[234:235], v10 offset:41216
    v_cvt_pk_bf16_f32 v48, v72, v73
    v_mfma_f32_16x16x32_bf16 v[120:123], a[208:211], v[228:231], v[120:123]
    ds_read_b64_tr_b16 a[236:237], v11 offset:33024
    v_cvt_pk_bf16_f32 v49, v74, v75
    v_mfma_f32_16x16x32_bf16 v[124:127], a[212:215], v[164:167], v[124:127]
    ds_read_b64_tr_b16 a[238:239], v11 offset:41216
    v_cvt_pk_bf16_f32 v50, v84, v85
    v_mfma_f32_16x16x32_bf16 v[128:131], a[212:215], v[196:199], v[128:131]
    ds_read_b64_tr_b16 a[240:241], v12 offset:33024
    v_cvt_pk_bf16_f32 v51, v86, v87
    v_mfma_f32_16x16x32_bf16 v[132:135], a[212:215], v[228:231], v[132:135]
    ds_read_b64_tr_b16 a[242:243], v12 offset:41216
    s_waitcnt lgkmcnt(10)
    v_mfma_f32_16x16x32_bf16 v[136:139], a[216:219], v[164:167], v[136:139]
    ds_read_b64_tr_b16 a[244:245], v13 offset:33024
    s_add_u32 s32, s40, 34816
    v_mfma_f32_16x16x32_bf16 v[140:143], a[216:219], v[196:199], v[140:143]
    ds_read_b64_tr_b16 a[246:247], v13 offset:41216
    buffer_store_dwordx4 v[48:51], v22, s[24:27], s32 offen sc0 sc1
    v_mfma_f32_16x16x32_bf16 v[144:147], a[216:219], v[228:231], v[144:147]
    v_cvt_pk_bf16_f32 v60, v88, v89
    v_cvt_pk_bf16_f32 v61, v90, v91
    v_mfma_f32_16x16x32_bf16 v[148:151], a[220:223], v[164:167], v[148:151]
    v_cvt_pk_bf16_f32 v62, v100, v101
    v_cvt_pk_bf16_f32 v63, v102, v103
    v_mfma_f32_16x16x32_bf16 v[152:155], a[220:223], v[196:199], v[152:155]
    s_add_u32 s32, s40, 7168
    buffer_store_dwordx4 v[60:63], v22, s[24:27], s32 offen sc0 sc1
    v_mfma_f32_16x16x32_bf16 v[156:159], a[220:223], v[228:231], v[156:159]
    v_cvt_pk_bf16_f32 v48, v92, v93
    v_cvt_pk_bf16_f32 v49, v94, v95
    s_waitcnt lgkmcnt(8)
    v_mfma_f32_16x16x32_bf16 v[112:115], a[224:227], v[168:171], v[112:115]
    ds_read_b64_tr_b16 a[248:249], v14 offset:33024
    v_cvt_pk_bf16_f32 v50, v104, v105
    v_mfma_f32_16x16x32_bf16 v[116:119], a[224:227], v[200:203], v[116:119]
    ds_read_b64_tr_b16 a[250:251], v14 offset:41216
    v_cvt_pk_bf16_f32 v51, v106, v107
    v_mfma_f32_16x16x32_bf16 v[120:123], a[224:227], v[232:235], v[120:123]
    ds_read_b64_tr_b16 a[252:253], v15 offset:33024
    s_add_u32 s32, s40, 21504
    v_mfma_f32_16x16x32_bf16 v[124:127], a[228:231], v[168:171], v[124:127]
    ds_read_b64_tr_b16 a[254:255], v15 offset:41216
    buffer_store_dwordx4 v[48:51], v22, s[24:27], s32 offen sc0 sc1
    v_mfma_f32_16x16x32_bf16 v[128:131], a[228:231], v[200:203], v[128:131]
    ds_read_b64_tr_b16 a[208:209], v8 offset:49152
    v_cvt_pk_bf16_f32 v60, v96, v97
    v_mfma_f32_16x16x32_bf16 v[132:135], a[228:231], v[232:235], v[132:135]
    ds_read_b64_tr_b16 a[210:211], v8 offset:57344
    s_waitcnt lgkmcnt(10)
    v_mfma_f32_16x16x32_bf16 v[136:139], a[232:235], v[168:171], v[136:139]
    ds_read_b64_tr_b16 a[212:213], v9 offset:49152
    v_cvt_pk_bf16_f32 v61, v98, v99
    v_mfma_f32_16x16x32_bf16 v[140:143], a[232:235], v[200:203], v[140:143]
    ds_read_b64_tr_b16 a[214:215], v9 offset:57344
    v_cvt_pk_bf16_f32 v62, v108, v109
    v_mfma_f32_16x16x32_bf16 v[144:147], a[232:235], v[232:235], v[144:147]
    v_cvt_pk_bf16_f32 v63, v110, v111
    s_add_u32 s32, s40, 35840
    v_mfma_f32_16x16x32_bf16 v[148:151], a[236:239], v[168:171], v[148:151]
    buffer_store_dwordx4 v[60:63], v22, s[24:27], s32 offen sc0 sc1
    v_mfma_f32_16x16x32_bf16 v[152:155], a[236:239], v[200:203], v[152:155]
    v_mfma_f32_16x16x32_bf16 v[156:159], a[236:239], v[232:235], v[156:159]
    s_waitcnt lgkmcnt(8)
    v_mfma_f32_16x16x32_bf16 v[112:115], a[240:243], v[172:175], v[112:115]
    ds_read_b64_tr_b16 a[216:217], v10 offset:49152
    v_mfma_f32_16x16x32_bf16 v[116:119], a[240:243], v[204:207], v[116:119]
    ds_read_b64_tr_b16 a[218:219], v10 offset:57344
    v_mfma_f32_16x16x32_bf16 v[120:123], a[240:243], v[236:239], v[120:123]
    ds_read_b64_tr_b16 a[220:221], v11 offset:49152
    v_mfma_f32_16x16x32_bf16 v[124:127], a[244:247], v[172:175], v[124:127]
    ds_read_b64_tr_b16 a[222:223], v11 offset:57344
    v_mfma_f32_16x16x32_bf16 v[128:131], a[244:247], v[204:207], v[128:131]
    ds_read_b64_tr_b16 a[224:225], v12 offset:49152
    v_mfma_f32_16x16x32_bf16 v[132:135], a[244:247], v[236:239], v[132:135]
    ds_read_b64_tr_b16 a[226:227], v12 offset:57344
    s_waitcnt lgkmcnt(10)
    v_mfma_f32_16x16x32_bf16 v[136:139], a[248:251], v[172:175], v[136:139]
    ds_read_b64_tr_b16 a[228:229], v13 offset:49152
    v_mfma_f32_16x16x32_bf16 v[140:143], a[248:251], v[204:207], v[140:143]
    ds_read_b64_tr_b16 a[230:231], v13 offset:57344
    v_mfma_f32_16x16x32_bf16 v[144:147], a[248:251], v[236:239], v[144:147]
    v_mfma_f32_16x16x32_bf16 v[148:151], a[252:255], v[172:175], v[148:151]
    v_mfma_f32_16x16x32_bf16 v[152:155], a[252:255], v[204:207], v[152:155]
    v_mfma_f32_16x16x32_bf16 v[156:159], a[252:255], v[236:239], v[156:159]
    s_waitcnt lgkmcnt(8)
    v_mfma_f32_16x16x32_bf16 v[112:115], a[208:211], v[176:179], v[112:115]
    ds_read_b64_tr_b16 a[232:233], v14 offset:49152
    v_mfma_f32_16x16x32_bf16 v[116:119], a[208:211], v[208:211], v[116:119]
    ds_read_b64_tr_b16 a[234:235], v14 offset:57344
    v_mfma_f32_16x16x32_bf16 v[120:123], a[208:211], v[240:243], v[120:123]
    ds_read_b64_tr_b16 a[236:237], v15 offset:49152
    v_mfma_f32_16x16x32_bf16 v[124:127], a[212:215], v[176:179], v[124:127]
    ds_read_b64_tr_b16 a[238:239], v15 offset:57344
    v_mfma_f32_16x16x32_bf16 v[128:131], a[212:215], v[208:211], v[128:131]
    ds_read_b64_tr_b16 a[240:241], v8 offset:49408
    v_mfma_f32_16x16x32_bf16 v[132:135], a[212:215], v[240:243], v[132:135]
    ds_read_b64_tr_b16 a[242:243], v8 offset:57600
    s_waitcnt lgkmcnt(10)
    v_mfma_f32_16x16x32_bf16 v[136:139], a[216:219], v[176:179], v[136:139]
    ds_read_b64_tr_b16 a[244:245], v9 offset:49408
    v_mfma_f32_16x16x32_bf16 v[140:143], a[216:219], v[208:211], v[140:143]
    ds_read_b64_tr_b16 a[246:247], v9 offset:57600
    v_mfma_f32_16x16x32_bf16 v[144:147], a[216:219], v[240:243], v[144:147]
    v_mfma_f32_16x16x32_bf16 v[148:151], a[220:223], v[176:179], v[148:151]
    v_mfma_f32_16x16x32_bf16 v[152:155], a[220:223], v[208:211], v[152:155]
    v_mfma_f32_16x16x32_bf16 v[156:159], a[220:223], v[240:243], v[156:159]
    s_waitcnt lgkmcnt(8)
    v_mfma_f32_16x16x32_bf16 v[112:115], a[224:227], v[180:183], v[112:115]
    ds_read_b64_tr_b16 a[248:249], v10 offset:49408
    v_mfma_f32_16x16x32_bf16 v[116:119], a[224:227], v[212:215], v[116:119]
    ds_read_b64_tr_b16 a[250:251], v10 offset:57600
    v_mfma_f32_16x16x32_bf16 v[120:123], a[224:227], v[244:247], v[120:123]
    ds_read_b64_tr_b16 a[252:253], v11 offset:49408
    v_mfma_f32_16x16x32_bf16 v[124:127], a[228:231], v[180:183], v[124:127]
    ds_read_b64_tr_b16 a[254:255], v11 offset:57600
    v_mfma_f32_16x16x32_bf16 v[128:131], a[228:231], v[212:215], v[128:131]
    ds_read_b64_tr_b16 a[208:209], v12 offset:49408
    v_mfma_f32_16x16x32_bf16 v[132:135], a[228:231], v[244:247], v[132:135]
    ds_read_b64_tr_b16 a[210:211], v12 offset:57600
    s_waitcnt lgkmcnt(10)
    v_mfma_f32_16x16x32_bf16 v[136:139], a[232:235], v[180:183], v[136:139]
    ds_read_b64_tr_b16 a[212:213], v13 offset:49408
    v_mfma_f32_16x16x32_bf16 v[140:143], a[232:235], v[212:215], v[140:143]
    ds_read_b64_tr_b16 a[214:215], v13 offset:57600
    v_mfma_f32_16x16x32_bf16 v[144:147], a[232:235], v[244:247], v[144:147]
    v_mfma_f32_16x16x32_bf16 v[148:151], a[236:239], v[180:183], v[148:151]
    v_mfma_f32_16x16x32_bf16 v[152:155], a[236:239], v[212:215], v[152:155]
    v_mfma_f32_16x16x32_bf16 v[156:159], a[236:239], v[244:247], v[156:159]
    s_waitcnt lgkmcnt(8)
    v_mfma_f32_16x16x32_bf16 v[112:115], a[240:243], v[184:187], v[112:115]
    ds_read_b64_tr_b16 a[216:217], v14 offset:49408
    v_mfma_f32_16x16x32_bf16 v[116:119], a[240:243], v[216:219], v[116:119]
    ds_read_b64_tr_b16 a[218:219], v14 offset:57600
    v_mfma_f32_16x16x32_bf16 v[120:123], a[240:243], v[248:251], v[120:123]
    ds_read_b64_tr_b16 a[220:221], v15 offset:49408
    v_mfma_f32_16x16x32_bf16 v[124:127], a[244:247], v[184:187], v[124:127]
    ds_read_b64_tr_b16 a[222:223], v15 offset:57600
    v_mfma_f32_16x16x32_bf16 v[128:131], a[244:247], v[216:219], v[128:131]
    ds_read_b64_tr_b16 a[224:225], v32 offset:0
    v_mfma_f32_16x16x32_bf16 v[132:135], a[244:247], v[248:251], v[132:135]
    ds_read_b64_tr_b16 a[226:227], v32 offset:8192
    s_waitcnt lgkmcnt(10)
    v_mfma_f32_16x16x32_bf16 v[136:139], a[248:251], v[184:187], v[136:139]
    ds_read_b64_tr_b16 a[228:229], v33 offset:0
    v_mfma_f32_16x16x32_bf16 v[140:143], a[248:251], v[216:219], v[140:143]
    ds_read_b64_tr_b16 a[230:231], v33 offset:8192
    v_mfma_f32_16x16x32_bf16 v[144:147], a[248:251], v[248:251], v[144:147]
    v_mfma_f32_16x16x32_bf16 v[148:151], a[252:255], v[184:187], v[148:151]
    v_mfma_f32_16x16x32_bf16 v[152:155], a[252:255], v[216:219], v[152:155]
    v_mfma_f32_16x16x32_bf16 v[156:159], a[252:255], v[248:251], v[156:159]
    s_waitcnt lgkmcnt(8)
    v_mfma_f32_16x16x32_bf16 v[112:115], a[208:211], v[188:191], v[112:115]
    ds_read_b64_tr_b16 a[232:233], v34 offset:0
    v_mfma_f32_16x16x32_bf16 v[116:119], a[208:211], v[220:223], v[116:119]
    ds_read_b64_tr_b16 a[234:235], v34 offset:8192
    v_mfma_f32_16x16x32_bf16 v[120:123], a[208:211], v[252:255], v[120:123]
    ds_read_b64_tr_b16 a[236:237], v35 offset:0
    v_mfma_f32_16x16x32_bf16 v[124:127], a[212:215], v[188:191], v[124:127]
    ds_read_b64_tr_b16 a[238:239], v35 offset:8192
    v_mfma_f32_16x16x32_bf16 v[128:131], a[212:215], v[220:223], v[128:131]
    ds_read_b64_tr_b16 a[240:241], v36 offset:0
    v_mfma_f32_16x16x32_bf16 v[132:135], a[212:215], v[252:255], v[132:135]
    ds_read_b64_tr_b16 a[242:243], v36 offset:8192
    s_waitcnt lgkmcnt(10)
    v_mfma_f32_16x16x32_bf16 v[136:139], a[216:219], v[188:191], v[136:139]
    ds_read_b64_tr_b16 a[244:245], v37 offset:0
    v_mfma_f32_16x16x32_bf16 v[140:143], a[216:219], v[220:223], v[140:143]
    ds_read_b64_tr_b16 a[246:247], v37 offset:8192
    v_mfma_f32_16x16x32_bf16 v[144:147], a[216:219], v[252:255], v[144:147]
    v_mfma_f32_16x16x32_bf16 v[148:151], a[220:223], v[188:191], v[148:151]
    v_mfma_f32_16x16x32_bf16 v[152:155], a[220:223], v[220:223], v[152:155]
    v_mfma_f32_16x16x32_bf16 v[156:159], a[220:223], v[252:255], v[156:159]
    s_waitcnt lgkmcnt(8)
    v_mfma_f32_16x16x32_bf16 v[64:67], a[224:227], v[160:163], 0
    ds_read_b64_tr_b16 a[248:249], v38 offset:0
    v_mfma_f32_16x16x32_bf16 v[68:71], a[224:227], v[192:195], 0
    ds_read_b64_tr_b16 a[250:251], v38 offset:8192
    v_mfma_f32_16x16x32_bf16 v[72:75], a[224:227], v[224:227], 0
    ds_read_b64_tr_b16 a[252:253], v39 offset:0
    v_mfma_f32_16x16x32_bf16 v[76:79], a[228:231], v[160:163], 0
    ds_read_b64_tr_b16 a[254:255], v39 offset:8192
    v_mfma_f32_16x16x32_bf16 v[80:83], a[228:231], v[192:195], 0
    ds_read_b64_tr_b16 a[208:209], v32 offset:256
    v_cvt_pk_bf16_f32 v48, v112, v113
    v_mfma_f32_16x16x32_bf16 v[84:87], a[228:231], v[224:227], 0
    ds_read_b64_tr_b16 a[210:211], v32 offset:8448
    s_waitcnt lgkmcnt(10)
    v_mfma_f32_16x16x32_bf16 v[88:91], a[232:235], v[160:163], 0
    ds_read_b64_tr_b16 a[212:213], v33 offset:256
    v_cvt_pk_bf16_f32 v49, v114, v115
    v_mfma_f32_16x16x32_bf16 v[92:95], a[232:235], v[192:195], 0
    ds_read_b64_tr_b16 a[214:215], v33 offset:8448
    v_cvt_pk_bf16_f32 v50, v124, v125
    v_mfma_f32_16x16x32_bf16 v[96:99], a[232:235], v[224:227], 0
    v_cvt_pk_bf16_f32 v51, v126, v127
    s_add_u32 s32, s40, 8192
    v_mfma_f32_16x16x32_bf16 v[100:103], a[236:239], v[160:163], 0
    buffer_store_dwordx4 v[48:51], v22, s[24:27], s32 offen sc0 sc1
    v_cvt_pk_bf16_f32 v60, v116, v117
    v_mfma_f32_16x16x32_bf16 v[104:107], a[236:239], v[192:195], 0
    v_cvt_pk_bf16_f32 v61, v118, v119
    v_cvt_pk_bf16_f32 v62, v128, v129
    v_mfma_f32_16x16x32_bf16 v[108:111], a[236:239], v[224:227], 0
    v_cvt_pk_bf16_f32 v63, v130, v131
    s_add_u32 s32, s40, 22528
    s_waitcnt lgkmcnt(8)
    v_mfma_f32_16x16x32_bf16 v[64:67], a[240:243], v[164:167], v[64:67]
    ds_read_b64_tr_b16 a[216:217], v34 offset:256
    buffer_store_dwordx4 v[60:63], v22, s[24:27], s32 offen sc0 sc1
    v_mfma_f32_16x16x32_bf16 v[68:71], a[240:243], v[196:199], v[68:71]
    ds_read_b64_tr_b16 a[218:219], v34 offset:8448
    v_cvt_pk_bf16_f32 v48, v120, v121
    v_mfma_f32_16x16x32_bf16 v[72:75], a[240:243], v[228:231], v[72:75]
    ds_read_b64_tr_b16 a[220:221], v35 offset:256
    v_cvt_pk_bf16_f32 v49, v122, v123
    v_mfma_f32_16x16x32_bf16 v[76:79], a[244:247], v[164:167], v[76:79]
    ds_read_b64_tr_b16 a[222:223], v35 offset:8448
    v_cvt_pk_bf16_f32 v50, v132, v133
    v_mfma_f32_16x16x32_bf16 v[80:83], a[244:247], v[196:199], v[80:83]
    ds_read_b64_tr_b16 a[224:225], v36 offset:256
    v_cvt_pk_bf16_f32 v51, v134, v135
    v_mfma_f32_16x16x32_bf16 v[84:87], a[244:247], v[228:231], v[84:87]
    ds_read_b64_tr_b16 a[226:227], v36 offset:8448
    s_waitcnt lgkmcnt(10)
    v_mfma_f32_16x16x32_bf16 v[88:91], a[248:251], v[164:167], v[88:91]
    ds_read_b64_tr_b16 a[228:229], v37 offset:256
    s_add_u32 s32, s40, 36864
    v_mfma_f32_16x16x32_bf16 v[92:95], a[248:251], v[196:199], v[92:95]
    ds_read_b64_tr_b16 a[230:231], v37 offset:8448
    buffer_store_dwordx4 v[48:51], v22, s[24:27], s32 offen sc0 sc1
    v_mfma_f32_16x16x32_bf16 v[96:99], a[248:251], v[228:231], v[96:99]
    v_cvt_pk_bf16_f32 v60, v136, v137
    v_cvt_pk_bf16_f32 v61, v138, v139
    v_mfma_f32_16x16x32_bf16 v[100:103], a[252:255], v[164:167], v[100:103]
    v_cvt_pk_bf16_f32 v62, v148, v149
    v_cvt_pk_bf16_f32 v63, v150, v151
    v_mfma_f32_16x16x32_bf16 v[104:107], a[252:255], v[196:199], v[104:107]
    s_add_u32 s32, s40, 9216
    buffer_store_dwordx4 v[60:63], v22, s[24:27], s32 offen sc0 sc1
    v_mfma_f32_16x16x32_bf16 v[108:111], a[252:255], v[228:231], v[108:111]
    v_cvt_pk_bf16_f32 v48, v140, v141
    v_cvt_pk_bf16_f32 v49, v142, v143
    s_waitcnt lgkmcnt(8)
    v_mfma_f32_16x16x32_bf16 v[64:67], a[208:211], v[168:171], v[64:67]
    ds_read_b64_tr_b16 a[232:233], v38 offset:256
    v_cvt_pk_bf16_f32 v50, v152, v153
    v_mfma_f32_16x16x32_bf16 v[68:71], a[208:211], v[200:203], v[68:71]
    ds_read_b64_tr_b16 a[234:235], v38 offset:8448
    v_cvt_pk_bf16_f32 v51, v154, v155
    v_mfma_f32_16x16x32_bf16 v[72:75], a[208:211], v[232:235], v[72:75]
    ds_read_b64_tr_b16 a[236:237], v39 offset:256
    s_add_u32 s32, s40, 23552
    v_mfma_f32_16x16x32_bf16 v[76:79], a[212:215], v[168:171], v[76:79]
    ds_read_b64_tr_b16 a[238:239], v39 offset:8448
    buffer_store_dwordx4 v[48:51], v22, s[24:27], s32 offen sc0 sc1
    v_mfma_f32_16x16x32_bf16 v[80:83], a[212:215], v[200:203], v[80:83]
    ds_read_b64_tr_b16 a[240:241], v32 offset:16384
    v_cvt_pk_bf16_f32 v60, v144, v145
    v_mfma_f32_16x16x32_bf16 v[84:87], a[212:215], v[232:235], v[84:87]
    ds_read_b64_tr_b16 a[242:243], v32 offset:24576
    s_waitcnt lgkmcnt(10)
    v_mfma_f32_16x16x32_bf16 v[88:91], a[216:219], v[168:171], v[88:91]
    ds_read_b64_tr_b16 a[244:245], v33 offset:16384
    v_cvt_pk_bf16_f32 v61, v146, v147
    v_mfma_f32_16x16x32_bf16 v[92:95], a[216:219], v[200:203], v[92:95]
    ds_read_b64_tr_b16 a[246:247], v33 offset:24576
    v_cvt_pk_bf16_f32 v62, v156, v157
    v_mfma_f32_16x16x32_bf16 v[96:99], a[216:219], v[232:235], v[96:99]
    v_cvt_pk_bf16_f32 v63, v158, v159
    s_add_u32 s32, s40, 37888
    v_mfma_f32_16x16x32_bf16 v[100:103], a[220:223], v[168:171], v[100:103]
    buffer_store_dwordx4 v[60:63], v22, s[24:27], s32 offen sc0 sc1
    v_mfma_f32_16x16x32_bf16 v[104:107], a[220:223], v[200:203], v[104:107]
    v_mfma_f32_16x16x32_bf16 v[108:111], a[220:223], v[232:235], v[108:111]
    s_waitcnt lgkmcnt(8)
    v_mfma_f32_16x16x32_bf16 v[64:67], a[224:227], v[172:175], v[64:67]
    ds_read_b64_tr_b16 a[248:249], v34 offset:16384
    v_mfma_f32_16x16x32_bf16 v[68:71], a[224:227], v[204:207], v[68:71]
    ds_read_b64_tr_b16 a[250:251], v34 offset:24576
    v_mfma_f32_16x16x32_bf16 v[72:75], a[224:227], v[236:239], v[72:75]
    ds_read_b64_tr_b16 a[252:253], v35 offset:16384
    v_mfma_f32_16x16x32_bf16 v[76:79], a[228:231], v[172:175], v[76:79]
    ds_read_b64_tr_b16 a[254:255], v35 offset:24576
    v_mfma_f32_16x16x32_bf16 v[80:83], a[228:231], v[204:207], v[80:83]
    ds_read_b64_tr_b16 a[208:209], v36 offset:16384
    v_mfma_f32_16x16x32_bf16 v[84:87], a[228:231], v[236:239], v[84:87]
    ds_read_b64_tr_b16 a[210:211], v36 offset:24576
    s_waitcnt lgkmcnt(10)
    v_mfma_f32_16x16x32_bf16 v[88:91], a[232:235], v[172:175], v[88:91]
    ds_read_b64_tr_b16 a[212:213], v37 offset:16384
    v_mfma_f32_16x16x32_bf16 v[92:95], a[232:235], v[204:207], v[92:95]
    ds_read_b64_tr_b16 a[214:215], v37 offset:24576
    v_mfma_f32_16x16x32_bf16 v[96:99], a[232:235], v[236:239], v[96:99]
    v_mfma_f32_16x16x32_bf16 v[100:103], a[236:239], v[172:175], v[100:103]
    v_mfma_f32_16x16x32_bf16 v[104:107], a[236:239], v[204:207], v[104:107]
    v_mfma_f32_16x16x32_bf16 v[108:111], a[236:239], v[236:239], v[108:111]
    s_waitcnt vmcnt(6)
    s_mov_b64 exec, 1
    ds_add_rtn_u32 v6, v4, v5 offset:4
    s_mov_b64 exec, -1
    s_waitcnt lgkmcnt(9)
    v_mfma_f32_16x16x32_bf16 v[64:67], a[240:243], v[176:179], v[64:67]
    ds_read_b64_tr_b16 a[216:217], v38 offset:16384
    v_mfma_f32_16x16x32_bf16 v[68:71], a[240:243], v[208:211], v[68:71]
    ds_read_b64_tr_b16 a[218:219], v38 offset:24576
    v_mfma_f32_16x16x32_bf16 v[72:75], a[240:243], v[240:243], v[72:75]
    ds_read_b64_tr_b16 a[220:221], v39 offset:16384
    v_mfma_f32_16x16x32_bf16 v[76:79], a[244:247], v[176:179], v[76:79]
    ds_read_b64_tr_b16 a[222:223], v39 offset:24576
    v_mfma_f32_16x16x32_bf16 v[80:83], a[244:247], v[208:211], v[80:83]
    ds_read_b64_tr_b16 a[224:225], v32 offset:16640
    v_mfma_f32_16x16x32_bf16 v[84:87], a[244:247], v[240:243], v[84:87]
    ds_read_b64_tr_b16 a[226:227], v32 offset:24832
    s_waitcnt lgkmcnt(11)
    v_mfma_f32_16x16x32_bf16 v[88:91], a[248:251], v[176:179], v[88:91]
    ds_read_b64_tr_b16 a[228:229], v33 offset:16640
    v_mfma_f32_16x16x32_bf16 v[92:95], a[248:251], v[208:211], v[92:95]
    ds_read_b64_tr_b16 a[230:231], v33 offset:24832
    v_mfma_f32_16x16x32_bf16 v[96:99], a[248:251], v[240:243], v[96:99]
    v_mfma_f32_16x16x32_bf16 v[100:103], a[252:255], v[176:179], v[100:103]
    v_mfma_f32_16x16x32_bf16 v[104:107], a[252:255], v[208:211], v[104:107]
    v_mfma_f32_16x16x32_bf16 v[108:111], a[252:255], v[240:243], v[108:111]
    s_waitcnt lgkmcnt(8)
    v_readfirstlane_b32 s90, v6
    s_nop 3
    s_cmp_eq_u32 s90, 2
    s_cbranch_scc0 L_nosig1
    s_mov_b64 exec, 1
    s_mov_b32 s88, 4096
    buffer_atomic_add v5, off, s[84:87], s88
    s_mov_b64 exec, -1
L_nosig1:
    v_mfma_f32_16x16x32_bf16 v[64:67], a[208:211], v[180:183], v[64:67]
    ds_read_b64_tr_b16 a[232:233], v34 offset:16640
    v_mfma_f32_16x16x32_bf16 v[68:71], a[208:211], v[212:215], v[68:71]
    ds_read_b64_tr_b16 a[234:235], v34 offset:24832
    v_mfma_f32_16x16x32_bf16 v[72:75], a[208:211], v[244:247], v[72:75]
    ds_read_b64_tr_b16 a[236:237], v35 offset:16640
    v_mfma_f32_16x16x32_bf16 v[76:79], a[212:215], v[180:183], v[76:79]
    ds_read_b64_tr_b16 a[238:239], v35 offset:24832
    v_mfma_f32_16x16x32_bf16 v[80:83], a[212:215], v[212:215], v[80:83]
    ds_read_b64_tr_b16 a[240:241], v36 offset:16640
    v_mfma_f32_16x16x32_bf16 v[84:87], a[212:215], v[244:247], v[84:87]
    ds_read_b64_tr_b16 a[242:243], v36 offset:24832
    s_waitcnt lgkmcnt(10)
    v_mfma_f32_16x16x32_bf16 v[88:91], a[216:219], v[180:183], v[88:91]
    ds_read_b64_tr_b16 a[244:245], v37 offset:16640
    v_mfma_f32_16x16x32_bf16 v[92:95], a[216:219], v[212:215], v[92:95]
    ds_read_b64_tr_b16 a[246:247], v37 offset:24832
    v_mfma_f32_16x16x32_bf16 v[96:99], a[216:219], v[244:247], v[96:99]
    v_mfma_f32_16x16x32_bf16 v[100:103], a[220:223], v[180:183], v[100:103]
    v_mfma_f32_16x16x32_bf16 v[104:107], a[220:223], v[212:215], v[104:107]
    v_mfma_f32_16x16x32_bf16 v[108:111], a[220:223], v[244:247], v[108:111]
    s_waitcnt lgkmcnt(8)
    v_mfma_f32_16x16x32_bf16 v[64:67], a[224:227], v[184:187], v[64:67]
    ds_read_b64_tr_b16 a[248:249], v38 offset:16640
    v_mfma_f32_16x16x32_bf16 v[68:71], a[224:227], v[216:219], v[68:71]
    ds_read_b64_tr_b16 a[250:251], v38 offset:24832
    v_mfma_f32_16x16x32_bf16 v[72:75], a[224:227], v[248:251], v[72:75]
    ds_read_b64_tr_b16 a[252:253], v39 offset:16640
    v_mfma_f32_16x16x32_bf16 v[76:79], a[228:231], v[184:187], v[76:79]
    ds_read_b64_tr_b16 a[254:255], v39 offset:24832
    v_mfma_f32_16x16x32_bf16 v[80:83], a[228:231], v[216:219], v[80:83]
    ds_read_b64_tr_b16 a[208:209], v24 offset:0
    v_mfma_f32_16x16x32_bf16 v[84:87], a[228:231], v[248:251], v[84:87]
    ds_read_b64_tr_b16 a[210:211], v24 offset:8192
    s_waitcnt lgkmcnt(10)
    v_mfma_f32_16x16x32_bf16 v[88:91], a[232:235], v[184:187], v[88:91]
    ds_read_b64_tr_b16 a[212:213], v25 offset:0
    v_mfma_f32_16x16x32_bf16 v[92:95], a[232:235], v[216:219], v[92:95]
    ds_read_b64_tr_b16 a[214:215], v25 offset:8192
    v_mfma_f32_16x16x32_bf16 v[96:99], a[232:235], v[248:251], v[96:99]
    v_mfma_f32_16x16x32_bf16 v[100:103], a[236:239], v[184:187], v[100:103]
    v_mfma_f32_16x16x32_bf16 v[104:107], a[236:239], v[216:219], v[104:107]
    v_mfma_f32_16x16x32_bf16 v[108:111], a[236:239], v[248:251], v[108:111]
    s_waitcnt lgkmcnt(8)
    v_mfma_f32_16x16x32_bf16 v[64:67], a[240:243], v[188:191], v[64:67]
    ds_read_b64_tr_b16 a[216:217], v26 offset:0
    v_mfma_f32_16x16x32_bf16 v[68:71], a[240:243], v[220:223], v[68:71]
    ds_read_b64_tr_b16 a[218:219], v26 offset:8192
    v_mfma_f32_16x16x32_bf16 v[72:75], a[240:243], v[252:255], v[72:75]
    ds_read_b64_tr_b16 a[220:221], v27 offset:0
    v_mfma_f32_16x16x32_bf16 v[76:79], a[244:247], v[188:191], v[76:79]
    ds_read_b64_tr_b16 a[222:223], v27 offset:8192
    v_mfma_f32_16x16x32_bf16 v[80:83], a[244:247], v[220:223], v[80:83]
    ds_read_b64_tr_b16 a[224:225], v28 offset:0
    v_mfma_f32_16x16x32_bf16 v[84:87], a[244:247], v[252:255], v[84:87]
    ds_read_b64_tr_b16 a[226:227], v28 offset:8192
    s_waitcnt lgkmcnt(10)
    v_mfma_f32_16x16x32_bf16 v[88:91], a[248:251], v[188:191], v[88:91]
    ds_read_b64_tr_b16 a[228:229], v29 offset:0
    v_mfma_f32_16x16x32_bf16 v[92:95], a[248:251], v[220:223], v[92:95]
    ds_read_b64_tr_b16 a[230:231], v29 offset:8192
    v_mfma_f32_16x16x32_bf16 v[96:99], a[248:251], v[252:255], v[96:99]
    v_mfma_f32_16x16x32_bf16 v[100:103], a[252:255], v[188:191], v[100:103]
    v_mfma_f32_16x16x32_bf16 v[104:107], a[252:255], v[220:223], v[104:107]
    v_mfma_f32_16x16x32_bf16 v[108:111], a[252:255], v[252:255], v[108:111]
    s_waitcnt lgkmcnt(8)
    v_mfma_f32_16x16x32_bf16 v[112:115], a[208:211], v[160:163], 0
    ds_read_b64_tr_b16 a[232:233], v30 offset:0
    v_mfma_f32_16x16x32_bf16 v[116:119], a[208:211], v[192:195], 0
    ds_read_b64_tr_b16 a[234:235], v30 offset:8192
    v_mfma_f32_16x16x32_bf16 v[120:123], a[208:211], v[224:227], 0
    ds_read_b64_tr_b16 a[236:237], v31 offset:0
    v_mfma_f32_16x16x32_bf16 v[124:127], a[212:215], v[160:163], 0
    ds_read_b64_tr_b16 a[238:239], v31 offset:8192
    v_mfma_f32_16x16x32_bf16 v[128:131], a[212:215], v[192:195], 0
    ds_read_b64_tr_b16 a[240:241], v24 offset:256
    v_cvt_pk_bf16_f32 v48, v64, v65
    v_mfma_f32_16x16x32_bf16 v[132:135], a[212:215], v[224:227], 0
    ds_read_b64_tr_b16 a[242:243], v24 offset:8448
    s_waitcnt lgkmcnt(10)
    v_mfma_f32_16x16x32_bf16 v[136:139], a[216:219], v[160:163], 0
    ds_read_b64_tr_b16 a[244:245], v25 offset:256
    v_cvt_pk_bf16_f32 v49, v66, v67
    v_mfma_f32_16x16x32_bf16 v[140:143], a[216:219], v[192:195], 0
    ds_read_b64_tr_b16 a[246:247], v25 offset:8448
    v_cvt_pk_bf16_f32 v50, v76, v77
    v_mfma_f32_16x16x32_bf16 v[144:147], a[216:219], v[224:227], 0
    v_cvt_pk_bf16_f32 v51, v78, v79
    s_add_u32 s32, s40, 10240
    v_mfma_f32_16x16x32_bf16 v[148:151], a[220:223], v[160:163], 0
    buffer_store_dwordx4 v[48:51], v22, s[24:27], s32 offen sc0 sc1
    v_cvt_pk_bf16_f32 v60, v68, v69
    v_mfma_f32_16x16x32_bf16 v[152:155], a[220:223], v[192:195], 0
    v_cvt_pk_bf16_f32 v61, v70, v71
    v_cvt_pk_bf16_f32 v62, v80, v81
    v_mfma_f32_16x16x32_bf16 v[156:159], a[220:223], v[224:227], 0
    v_cvt_pk_bf16_f32 v63, v82, v83
    s_add_u32 s32, s40, 24576
    s_waitcnt lgkmcnt(8)
    v_mfma_f32_16x16x32_bf16 v[112:115], a[224:227], v[164:167], v[112:115]
    ds_read_b64_tr_b16 a[248:249], v26 offset:256
    buffer_store_dwordx4 v[60:63], v22, s[24:27], s32 offen sc0 sc1
    v_mfma_f32_16x16x32_bf16 v[116:119], a[224:227], v[196:199], v[116:119]
    ds_read_b64_tr_b16 a[250:251], v26 offset:8448
    v_cvt_pk_bf16_f32 v48, v72, v73
    v_mfma_f32_16x16x32_bf16 v[120:123], a[224:227], v[228:231], v[120:123]
    ds_read_b64_tr_b16 a[252:253], v27 offset:256
    v_cvt_pk_bf16_f32 v49, v74, v75
    v_mfma_f32_16x16x32_bf16 v[124:127], a[228:231], v[164:167], v[124:127]
    ds_read_b64_tr_b16 a[254:255], v27 offset:8448
    v_cvt_pk_bf16_f32 v50, v84, v85
    v_mfma_f32_16x16x32_bf16 v[128:131], a[228:231], v[196:199], v[128:131]
    ds_read_b64_tr_b16 a[208:209], v28 offset:256
    v_cvt_pk_bf16_f32 v51, v86, v87
    v_mfma_f32_16x16x32_bf16 v[132:135], a[228:231], v[228:231], v[132:135]
    ds_read_b64_tr_b16 a[210:211], v28 offset:8448
    s_waitcnt lgkmcnt(10)
    v_mfma_f32_16x16x32_bf16 v[136:139], a[232:235], v[164:167], v[136:139]
    ds_read_b64_tr_b16 a[212:213], v29 offset:256
    s_add_u32 s32, s40, 38912
    v_mfma_f32_16x16x32_bf16 v[140:143], a[232:235], v[196:199], v[140:143]
    ds_read_b64_tr_b16 a[214:215], v29 offset:8448
    buffer_store_dwordx4 v[48:51], v22, s[24:27], s32 offen sc0 sc1
    v_mfma_f32_16x16x32_bf16 v[144:147], a[232:235], v[228:231], v[144:147]
    v_cvt_pk_bf16_f32 v60, v88, v89
    v_cvt_pk_bf16_f32 v61, v90, v91
    v_mfma_f32_16x16x32_bf16 v[148:151], a[236:239], v[164:167], v[148:151]
    v_cvt_pk_bf16_f32 v62, v100, v101
    v_cvt_pk_bf16_f32 v63, v102, v103
    v_mfma_f32_16x16x32_bf16 v[152:155], a[236:239], v[196:199], v[152:155]
    s_add_u32 s32, s40, 11264
    buffer_store_dwordx4 v[60:63], v22, s[24:27], s32 offen sc0 sc1
    v_mfma_f32_16x16x32_bf16 v[156:159], a[236:239], v[228:231], v[156:159]
    v_cvt_pk_bf16_f32 v48, v92, v93
    v_cvt_pk_bf16_f32 v49, v94, v95
    s_waitcnt lgkmcnt(8)
    v_mfma_f32_16x16x32_bf16 v[112:115], a[240:243], v[168:171], v[112:115]
    ds_read_b64_tr_b16 a[216:217], v30 offset:256
    v_cvt_pk_bf16_f32 v50, v104, v105
    v_mfma_f32_16x16x32_bf16 v[116:119], a[240:243], v[200:203], v[116:119]
    ds_read_b64_tr_b16 a[218:219], v30 offset:8448
    v_cvt_pk_bf16_f32 v51, v106, v107
    v_mfma_f32_16x16x32_bf16 v[120:123], a[240:243], v[232:235], v[120:123]
    ds_read_b64_tr_b16 a[220:221], v31 offset:256
    s_add_u32 s32, s40, 25600
    v_mfma_f32_16x16x32_bf16 v[124:127], a[244:247], v[168:171], v[124:127]
    ds_read_b64_tr_b16 a[222:223], v31 offset:8448
    buffer_store_dwordx4 v[48:51], v22, s[24:27], s32 offen sc0 sc1
    v_mfma_f32_16x16x32_bf16 v[128:131], a[244:247], v[200:203], v[128:131]
    ds_read_b64_tr_b16 a[224:225], v24 offset:16384
    v_cvt_pk_bf16_f32 v60, v96, v97
    v_mfma_f32_16x16x32_bf16 v[132:135], a[244:247], v[232:235], v[132:135]
    ds_read_b64_tr_b16 a[226:227], v24 offset:24576
    s_waitcnt lgkmcnt(10)
    v_mfma_f32_16x16x32_bf16 v[136:139], a[248:251], v[168:171], v[136:139]
    ds_read_b64_tr_b16 a[228:229], v25 offset:16384
    v_cvt_pk_bf16_f32 v61, v98, v99
    v_mfma_f32_16x16x32_bf16 v[140:143], a[248:251], v[200:203], v[140:143]
    ds_read_b64_tr_b16 a[230:231], v25 offset:24576
    v_cvt_pk_bf16_f32 v62, v108, v109
    v_mfma_f32_16x16x32_bf16 v[144:147], a[248:251], v[232:235], v[144:147]
    v_cvt_pk_bf16_f32 v63, v110, v111
    s_add_u32 s32, s40, 39936
    v_mfma_f32_16x16x32_bf16 v[148:151], a[252:255], v[168:171], v[148:151]
    buffer_store_dwordx4 v[60:63], v22, s[24:27], s32 offen sc0 sc1
    v_mfma_f32_16x16x32_bf16 v[152:155], a[252:255], v[200:203], v[152:155]
    v_mfma_f32_16x16x32_bf16 v[156:159], a[252:255], v[232:235], v[156:159]
    s_waitcnt lgkmcnt(8)
    v_mfma_f32_16x16x32_bf16 v[112:115], a[208:211], v[172:175], v[112:115]
    ds_read_b64_tr_b16 a[232:233], v26 offset:16384
    v_mfma_f32_16x16x32_bf16 v[116:119], a[208:211], v[204:207], v[116:119]
    ds_read_b64_tr_b16 a[234:235], v26 offset:24576
    v_mfma_f32_16x16x32_bf16 v[120:123], a[208:211], v[236:239], v[120:123]
    ds_read_b64_tr_b16 a[236:237], v27 offset:16384
    v_mfma_f32_16x16x32_bf16 v[124:127], a[212:215], v[172:175], v[124:127]
    ds_read_b64_tr_b16 a[238:239], v27 offset:24576
    v_mfma_f32_16x16x32_bf16 v[128:131], a[212:215], v[204:207], v[128:131]
    ds_read_b64_tr_b16 a[240:241], v28 offset:16384
    v_mfma_f32_16x16x32_bf16 v[132:135], a[212:215], v[236:239], v[132:135]
    ds_read_b64_tr_b16 a[242:243], v28 offset:24576
    s_waitcnt lgkmcnt(10)
    v_mfma_f32_16x16x32_bf16 v[136:139], a[216:219], v[172:175], v[136:139]
    ds_read_b64_tr_b16 a[244:245], v29 offset:16384
    v_mfma_f32_16x16x32_bf16 v[140:143], a[216:219], v[204:207], v[140:143]
    ds_read_b64_tr_b16 a[246:247], v29 offset:24576
    v_mfma_f32_16x16x32_bf16 v[144:147], a[216:219], v[236:239], v[144:147]
    v_mfma_f32_16x16x32_bf16 v[148:151], a[220:223], v[172:175], v[148:151]
    v_mfma_f32_16x16x32_bf16 v[152:155], a[220:223], v[204:207], v[152:155]
    v_mfma_f32_16x16x32_bf16 v[156:159], a[220:223], v[236:239], v[156:159]
    s_waitcnt lgkmcnt(8)
    v_mfma_f32_16x16x32_bf16 v[112:115], a[224:227], v[176:179], v[112:115]
    ds_read_b64_tr_b16 a[248:249], v30 offset:16384
    v_mfma_f32_16x16x32_bf16 v[116:119], a[224:227], v[208:211], v[116:119]
    ds_read_b64_tr_b16 a[250:251], v30 offset:24576
    v_mfma_f32_16x16x32_bf16 v[120:123], a[224:227], v[240:243], v[120:123]
    ds_read_b64_tr_b16 a[252:253], v31 offset:16384
    v_mfma_f32_16x16x32_bf16 v[124:127], a[228:231], v[176:179], v[124:127]
    ds_read_b64_tr_b16 a[254:255], v31 offset:24576
    v_mfma_f32_16x16x32_bf16 v[128:131], a[228:231], v[208:211], v[128:131]
    ds_read_b64_tr_b16 a[208:209], v24 offset:16640
    v_mfma_f32_16x16x32_bf16 v[132:135], a[228:231], v[240:243], v[132:135]
    ds_read_b64_tr_b16 a[210:211], v24 offset:24832
    s_waitcnt lgkmcnt(10)
    v_mfma_f32_16x16x32_bf16 v[136:139], a[232:235], v[176:179], v[136:139]
    ds_read_b64_tr_b16 a[212:213], v25 offset:16640
    v_mfma_f32_16x16x32_bf16 v[140:143], a[232:235], v[208:211], v[140:143]
    ds_read_b64_tr_b16 a[214:215], v25 offset:24832
    v_mfma_f32_16x16x32_bf16 v[144:147], a[232:235], v[240:243], v[144:147]
    v_mfma_f32_16x16x32_bf16 v[148:151], a[236:239], v[176:179], v[148:151]
    v_mfma_f32_16x16x32_bf16 v[152:155], a[236:239], v[208:211], v[152:155]
    v_mfma_f32_16x16x32_bf16 v[156:159], a[236:239], v[240:243], v[156:159]
    s_waitcnt lgkmcnt(8)
    v_mfma_f32_16x16x32_bf16 v[112:115], a[240:243], v[180:183], v[112:115]
    ds_read_b64_tr_b16 a[216:217], v26 offset:16640
    v_mfma_f32_16x16x32_bf16 v[116:119], a[240:243], v[212:215], v[116:119]
    ds_read_b64_tr_b16 a[218:219], v26 offset:24832
    v_mfma_f32_16x16x32_bf16 v[120:123], a[240:243], v[244:247], v[120:123]
    ds_read_b64_tr_b16 a[220:221], v27 offset:16640
    v_mfma_f32_16x16x32_bf16 v[124:127], a[244:247], v[180:183], v[124:127]
    ds_read_b64_tr_b16 a[222:223], v27 offset:24832
    v_mfma_f32_16x16x32_bf16 v[128:131], a[244:247], v[212:215], v[128:131]
    ds_read_b64_tr_b16 a[224:225], v28 offset:16640
    v_mfma_f32_16x16x32_bf16 v[132:135], a[244:247], v[244:247], v[132:135]
    ds_read_b64_tr_b16 a[226:227], v28 offset:24832
    s_waitcnt lgkmcnt(10)
    v_mfma_f32_16x16x32_bf16 v[136:139], a[248:251], v[180:183], v[136:139]
    ds_read_b64_tr_b16 a[228:229], v29 offset:16640
    v_mfma_f32_16x16x32_bf16 v[140:143], a[248:251], v[212:215], v[140:143]
    ds_read_b64_tr_b16 a[230:231], v29 offset:24832
    v_mfma_f32_16x16x32_bf16 v[144:147], a[248:251], v[244:247], v[144:147]
    v_mfma_f32_16x16x32_bf16 v[148:151], a[252:255], v[180:183], v[148:151]
    v_mfma_f32_16x16x32_bf16 v[152:155], a[252:255], v[212:215], v[152:155]
    v_mfma_f32_16x16x32_bf16 v[156:159], a[252:255], v[244:247], v[156:159]
    s_waitcnt lgkmcnt(8)
    v_mfma_f32_16x16x32_bf16 v[112:115], a[208:211], v[184:187], v[112:115]
    ds_read_b64_tr_b16 a[232:233], v30 offset:16640
    v_mfma_f32_16x16x32_bf16 v[116:119], a[208:211], v[216:219], v[116:119]
    ds_read_b64_tr_b16 a[234:235], v30 offset:24832
    v_mfma_f32_16x16x32_bf16 v[120:123], a[208:211], v[248:251], v[120:123]
    ds_read_b64_tr_b16 a[236:237], v31 offset:16640
    v_mfma_f32_16x16x32_bf16 v[124:127], a[212:215], v[184:187], v[124:127]
    ds_read_b64_tr_b16 a[238:239], v31 offset:24832
    v_mfma_f32_16x16x32_bf16 v[128:131], a[212:215], v[216:219], v[128:131]
    v_mfma_f32_16x16x32_bf16 v[132:135], a[212:215], v[248:251], v[132:135]
    s_waitcnt lgkmcnt(8)
    v_mfma_f32_16x16x32_bf16 v[136:139], a[216:219], v[184:187], v[136:139]
    v_mfma_f32_16x16x32_bf16 v[140:143], a[216:219], v[216:219], v[140:143]
    v_mfma_f32_16x16x32_bf16 v[144:147], a[216:219], v[248:251], v[144:147]
    v_mfma_f32_16x16x32_bf16 v[148:151], a[220:223], v[184:187], v[148:151]
    v_mfma_f32_16x16x32_bf16 v[152:155], a[220:223], v[216:219], v[152:155]
    v_mfma_f32_16x16x32_bf16 v[156:159], a[220:223], v[248:251], v[156:159]
    s_waitcnt lgkmcnt(4)
    v_mfma_f32_16x16x32_bf16 v[112:115], a[224:227], v[188:191], v[112:115]
    v_mfma_f32_16x16x32_bf16 v[116:119], a[224:227], v[220:223], v[116:119]
    v_mfma_f32_16x16x32_bf16 v[120:123], a[224:227], v[252:255], v[120:123]
    v_mfma_f32_16x16x32_bf16 v[124:127], a[228:231], v[188:191], v[124:127]
    v_mfma_f32_16x16x32_bf16 v[128:131], a[228:231], v[220:223], v[128:131]
    v_mfma_f32_16x16x32_bf16 v[132:135], a[228:231], v[252:255], v[132:135]
    s_waitcnt lgkmcnt(0)
    v_mfma_f32_16x16x32_bf16 v[136:139], a[232:235], v[188:191], v[136:139]
    v_mfma_f32_16x16x32_bf16 v[140:143], a[232:235], v[220:223], v[140:143]
    v_mfma_f32_16x16x32_bf16 v[144:147], a[232:235], v[252:255], v[144:147]
    v_mfma_f32_16x16x32_bf16 v[148:151], a[236:239], v[188:191], v[148:151]
    v_mfma_f32_16x16x32_bf16 v[152:155], a[236:239], v[220:223], v[152:155]
    v_mfma_f32_16x16x32_bf16 v[156:159], a[236:239], v[252:255], v[156:159]
    s_nop 7
    v_cvt_pk_bf16_f32 v48, v112, v113
    v_cvt_pk_bf16_f32 v49, v114, v115
    v_cvt_pk_bf16_f32 v50, v124, v125
    v_cvt_pk_bf16_f32 v51, v126, v127
    s_add_u32 s32, s40, 12288
    buffer_store_dwordx4 v[48:51], v22, s[24:27], s32 offen sc0 sc1
    v_cvt_pk_bf16_f32 v60, v116, v117
    v_cvt_pk_bf16_f32 v61, v118, v119
    v_cvt_pk_bf16_f32 v62, v128, v129
    v_cvt_pk_bf16_f32 v63, v130, v131
    s_add_u32 s32, s40, 26624
    buffer_store_dwordx4 v[60:63], v22, s[24:27], s32 offen sc0 sc1
    v_cvt_pk_bf16_f32 v48, v120, v121
    v_cvt_pk_bf16_f32 v49, v122, v123
    v_cvt_pk_bf16_f32 v50, v132, v133
    v_cvt_pk_bf16_f32 v51, v134, v135
    s_add_u32 s32, s40, 40960
    buffer_store_dwordx4 v[48:51], v22, s[24:27], s32 offen sc0 sc1
    v_cvt_pk_bf16_f32 v60, v136, v137
    v_cvt_pk_bf16_f32 v61, v138, v139
    v_cvt_pk_bf16_f32 v62, v148, v149
    v_cvt_pk_bf16_f32 v63, v150, v151
    s_add_u32 s32, s40, 13312
    buffer_store_dwordx4 v[60:63], v22, s[24:27], s32 offen sc0 sc1
    v_cvt_pk_bf16_f32 v48, v140, v141
    v_cvt_pk_bf16_f32 v49, v142, v143
    v_cvt_pk_bf16_f32 v50, v152, v153
    v_cvt_pk_bf16_f32 v51, v154, v155
    s_add_u32 s32, s40, 27648
    buffer_store_dwordx4 v[48:51], v22, s[24:27], s32 offen sc0 sc1
    v_cvt_pk_bf16_f32 v60, v144, v145
    v_cvt_pk_bf16_f32 v61, v146, v147
    v_cvt_pk_bf16_f32 v62, v156, v157
    v_cvt_pk_bf16_f32 v63, v158, v159
    s_add_u32 s32, s40, 41984
    buffer_store_dwordx4 v[60:63], v22, s[24:27], s32 offen sc0 sc1
L_tail_end:
    s_lshl_b32 s90, s3, 4
    s_add_u32 s78, s90, s29
    s_lshr_b32 s96, s78, 2
    s_and_b32 s97, s78, 3
    s_add_u32 s97, s97, 8
    s_sub_u32 s91, s78, 36
    s_lshr_b32 s98, s91, 1
    s_and_b32 s99, s91, 1
    s_add_u32 s99, s99, 12
    s_cmp_ge_u32 s78, 36
    s_cselect_b32 s96, s98, s96
    s_cselect_b32 s97, s99, s97
    s_sub_u32 s91, s78, 54
    s_cmp_ge_u32 s78, 54
    s_cselect_b32 s96, 8, s96
    s_cselect_b32 s97, s91, s97
    v_lshlrev_b32 v2, 4, v1
    v_and_b32 v3, 15, v1
    v_mul_u32_u24 v3, 1792, v3
    v_lshrrev_b32 v9, 4, v1
    v_lshl_add_u32 v3, v9, 3, v3
    s_lshl_b32 s76, s96, 10
    s_mul_i32 s90, s96, 14
    s_add_u32 s90, s90, s97
    s_lshl_b32 s91, s90, 10
    s_mul_i32 s100, s28, 144
    s_lshl_b32 s90, s96, 4
    s_add_u32 s100, s100, s90
    s_mul_i32 s100, s100, 1792
    s_lshl_b32 s90, s97, 6
    s_add_u32 s100, s100, s90
    s_mul_i32 s90, s30, 896
    s_add_u32 s96, s100, s90
    s_mov_b32 s97, s91
    s_waitcnt vmcnt(0)
    s_mov_b64 exec, 1
    ds_add_rtn_u32 v6, v4, v5 offset:8
    s_mov_b64 exec, -1
    s_waitcnt lgkmcnt(0)
    v_readfirstlane_b32 s90, v6
    s_nop 3
    s_cmp_eq_u32 s90, 2
    s_cbranch_scc0 L_nosig2
    s_mov_b64 exec, 1
    s_mov_b32 s88, 8192
    buffer_atomic_add v5, off, s[84:87], s88
    s_mov_b64 exec, -1
L_nosig2:
    s_mov_b64 exec, 1
    s_mov_b32 s89, 0
L_poll5:
    s_mov_b32 s88, 8192
    buffer_load_dword v9, off, s[84:87], s88 sc1
    s_waitcnt vmcnt(0)
    v_readfirstlane_b32 s90, v9
    s_add_u32 s89, s89, 1
    s_cmp_ge_u32 s90, 16
    s_cbranch_scc1 L_poll_done5
    s_cmp_ge_u32 s89, 0x40000
    s_cbranch_scc1 L_poll_done5
    s_sleep 2
    s_branch L_poll5
L_poll_done5:
    s_mov_b64 exec, -1
    s_cmp_ge_u32 s78, 62
    s_cbranch_scc1 L_fin_done6
    v_and_b32 v5, 15, v1
    v_lshlrev_b32 v5, 6, v5
    s_mov_b32 s91, s97
    buffer_load_dwordx4 v[64:67], v2, s[44:47], s91 offen sc0 sc1
    s_add_u32 s91, s91, 129024
    buffer_load_dwordx4 v[192:195], v5, s[64:67], s76 offen offset:0 sc0 sc1
    buffer_load_dwordx4 v[196:199], v5, s[64:67], s76 offen offset:16 sc0 sc1
    buffer_load_dwordx4 v[200:203], v5, s[64:67], s76 offen offset:32 sc0 sc1
    buffer_load_dwordx4 v[204:207], v5, s[64:67], s76 offen offset:48 sc0 sc1
    buffer_load_dwordx4 v[68:71], v2, s[44:47], s91 offen sc0 sc1
    s_add_u32 s91, s91, 129024
    buffer_load_dwordx4 v[72:75], v2, s[44:47], s91 offen sc0 sc1
    s_add_u32 s91, s91, 129024
    buffer_load_dwordx4 v[76:79], v2, s[44:47], s91 offen sc0 sc1
    s_add_u32 s91, s91, 129024
    buffer_load_dwordx4 v[80:83], v2, s[44:47], s91 offen sc0 sc1
    s_add_u32 s91, s91, 129024
    buffer_load_dwordx4 v[84:87], v2, s[44:47], s91 offen sc0 sc1
    s_add_u32 s91, s91, 129024
    buffer_load_dwordx4 v[88:91], v2, s[44:47], s91 offen sc0 sc1
    s_add_u32 s91, s91, 129024
    buffer_load_dwordx4 v[92:95], v2, s[44:47], s91 offen sc0 sc1
    s_add_u32 s91, s91, 129024
    buffer_load_dwordx4 v[96:99], v2, s[44:47], s91 offen sc0 sc1
    s_add_u32 s91, s91, 129024
    buffer_load_dwordx4 v[100:103], v2, s[44:47], s91 offen sc0 sc1
    s_add_u32 s91, s91, 129024
    buffer_load_dwordx4 v[104:107], v2, s[44:47], s91 offen sc0 sc1
    s_add_u32 s91, s91, 129024
    buffer_load_dwordx4 v[108:111], v2, s[44:47], s91 offen sc0 sc1
    s_add_u32 s91, s91, 129024
    buffer_load_dwordx4 v[112:115], v2, s[44:47], s91 offen sc0 sc1
    s_add_u32 s91, s91, 129024
    buffer_load_dwordx4 v[116:119], v2, s[44:47], s91 offen sc0 sc1
    s_add_u32 s91, s91, 129024
    buffer_load_dwordx4 v[120:123], v2, s[44:47], s91 offen sc0 sc1
    s_add_u32 s91, s91, 129024
    buffer_load_dwordx4 v[124:127], v2, s[44:47], s91 offen sc0 sc1
    s_waitcnt vmcnt(15)
    v_lshlrev_b32 v8, 16, v64
    v_and_b32 v9, 0xffff0000, v64
    v_lshlrev_b32 v10, 16, v65
    v_and_b32 v11, 0xffff0000, v65
    v_lshlrev_b32 v12, 16, v66
    v_and_b32 v13, 0xffff0000, v66
    v_lshlrev_b32 v14, 16, v67
    v_and_b32 v15, 0xffff0000, v67
    v_pk_mul_f32 v[32:33], v[8:9], v[192:193] op_sel:[0,0] op_sel_hi:[1,0]
    v_pk_mul_f32 v[34:35], v[10:11], v[192:193] op_sel:[0,0] op_sel_hi:[1,0]
    v_pk_mul_f32 v[36:37], v[12:13], v[192:193] op_sel:[0,0] op_sel_hi:[1,0]
    v_pk_mul_f32 v[38:39], v[14:15], v[192:193] op_sel:[0,0] op_sel_hi:[1,0]
    s_waitcnt vmcnt(14)
    v_lshlrev_b32 v8, 16, v68
    v_and_b32 v9, 0xffff0000, v68
    v_lshlrev_b32 v10, 16, v69
    v_and_b32 v11, 0xffff0000, v69
    v_lshlrev_b32 v12, 16, v70
    v_and_b32 v13, 0xffff0000, v70
    v_lshlrev_b32 v14, 16, v71
    v_and_b32 v15, 0xffff0000, v71
    v_pk_fma_f32 v[32:33], v[8:9], v[192:193], v[32:33] op_sel:[0,1,0] op_sel_hi:[1,1,1]
    v_pk_fma_f32 v[34:35], v[10:11], v[192:193], v[34:35] op_sel:[0,1,0] op_sel_hi:[1,1,1]
    v_pk_fma_f32 v[36:37], v[12:13], v[192:193], v[36:37] op_sel:[0,1,0] op_sel_hi:[1,1,1]
    v_pk_fma_f32 v[38:39], v[14:15], v[192:193], v[38:39] op_sel:[0,1,0] op_sel_hi:[1,1,1]
    s_waitcnt vmcnt(13)
    v_lshlrev_b32 v8, 16, v72
    v_and_b32 v9, 0xffff0000, v72
    v_lshlrev_b32 v10, 16, v73
    v_and_b32 v11, 0xffff0000, v73
    v_lshlrev_b32 v12, 16, v74
    v_and_b32 v13, 0xffff0000, v74
    v_lshlrev_b32 v14, 16, v75
    v_and_b32 v15, 0xffff0000, v75
    v_pk_fma_f32 v[32:33], v[8:9], v[194:195], v[32:33] op_sel:[0,0,0] op_sel_hi:[1,0,1]
    v_pk_fma_f32 v[34:35], v[10:11], v[194:195], v[34:35] op_sel:[0,0,0] op_sel_hi:[1,0,1]
    v_pk_fma_f32 v[36:37], v[12:13], v[194:195], v[36:37] op_sel:[0,0,0] op_sel_hi:[1,0,1]
    v_pk_fma_f32 v[38:39], v[14:15], v[194:195], v[38:39] op_sel:[0,0,0] op_sel_hi:[1,0,1]
    s_waitcnt vmcnt(12)
    v_lshlrev_b32 v8, 16, v76
    v_and_b32 v9, 0xffff0000, v76
    v_lshlrev_b32 v10, 16, v77
    v_and_b32 v11, 0xffff0000, v77
    v_lshlrev_b32 v12, 16, v78
    v_and_b32 v13, 0xffff0000, v78
    v_lshlrev_b32 v14, 16, v79
    v_and_b32 v15, 0xffff0000, v79
    v_pk_fma_f32 v[32:33], v[8:9], v[194:195], v[32:33] op_sel:[0,1,0] op_sel_hi:[1,1,1]
    v_pk_fma_f32 v[34:35], v[10:11], v[194:195], v[34:35] op_sel:[0,1,0] op_sel_hi:[1,1,1]
    v_pk_fma_f32 v[36:37], v[12:13], v[194:195], v[36:37] op_sel:[0,1,0] op_sel_hi:[1,1,1]
    v_pk_fma_f32 v[38:39], v[14:15], v[194:195], v[38:39] op_sel:[0,1,0] op_sel_hi:[1,1,1]
    s_waitcnt vmcnt(11)
    v_lshlrev_b32 v8, 16, v80
    v_and_b32 v9, 0xffff0000, v80
    v_lshlrev_b32 v10, 16, v81
    v_and_b32 v11, 0xffff0000, v81
    v_lshlrev_b32 v12, 16, v82
    v_and_b32 v13, 0xffff0000, v82
    v_lshlrev_b32 v14, 16, v83
    v_and_b32 v15, 0xffff0000, v83
    v_pk_fma_f32 v[32:33], v[8:9], v[196:197], v[32:33] op_sel:[0,0,0] op_sel_hi:[1,0,1]
    v_pk_fma_f32 v[34:35], v[10:11], v[196:197], v[34:35] op_sel:[0,0,0] op_sel_hi:[1,0,1]
    v_pk_fma_f32 v[36:37], v[12:13], v[196:197], v[36:37] op_sel:[0,0,0] op_sel_hi:[1,0,1]
    v_pk_fma_f32 v[38:39], v[14:15], v[196:197], v[38:39] op_sel:[0,0,0] op_sel_hi:[1,0,1]
    s_waitcnt vmcnt(10)
    v_lshlrev_b32 v8, 16, v84
    v_and_b32 v9, 0xffff0000, v84
    v_lshlrev_b32 v10, 16, v85
    v_and_b32 v11, 0xffff0000, v85
    v_lshlrev_b32 v12, 16, v86
    v_and_b32 v13, 0xffff0000, v86
    v_lshlrev_b32 v14, 16, v87
    v_and_b32 v15, 0xffff0000, v87
    v_pk_fma_f32 v[32:33], v[8:9], v[196:197], v[32:33] op_sel:[0,1,0] op_sel_hi:[1,1,1]
    v_pk_fma_f32 v[34:35], v[10:11], v[196:197], v[34:35] op_sel:[0,1,0] op_sel_hi:[1,1,1]
    v_pk_fma_f32 v[36:37], v[12:13], v[196:197], v[36:37] op_sel:[0,1,0] op_sel_hi:[1,1,1]
    v_pk_fma_f32 v[38:39], v[14:15], v[196:197], v[38:39] op_sel:[0,1,0] op_sel_hi:[1,1,1]
    s_waitcnt vmcnt(9)
    v_lshlrev_b32 v8, 16, v88
    v_and_b32 v9, 0xffff0000, v88
    v_lshlrev_b32 v10, 16, v89
    v_and_b32 v11, 0xffff0000, v89
    v_lshlrev_b32 v12, 16, v90
    v_and_b32 v13, 0xffff0000, v90
    v_lshlrev_b32 v14, 16, v91
    v_and_b32 v15, 0xffff0000, v91
    v_pk_fma_f32 v[32:33], v[8:9], v[198:199], v[32:33] op_sel:[0,0,0] op_sel_hi:[1,0,1]
    v_pk_fma_f32 v[34:35], v[10:11], v[198:199], v[34:35] op_sel:[0,0,0] op_sel_hi:[1,0,1]
    v_pk_fma_f32 v[36:37], v[12:13], v[198:199], v[36:37] op_sel:[0,0,0] op_sel_hi:[1,0,1]
    v_pk_fma_f32 v[38:39], v[14:15], v[198:199], v[38:39] op_sel:[0,0,0] op_sel_hi:[1,0,1]
    s_waitcnt vmcnt(8)
    v_lshlrev_b32 v8, 16, v92
    v_and_b32 v9, 0xffff0000, v92
    v_lshlrev_b32 v10, 16, v93
    v_and_b32 v11, 0xffff0000, v93
    v_lshlrev_b32 v12, 16, v94
    v_and_b32 v13, 0xffff0000, v94
    v_lshlrev_b32 v14, 16, v95
    v_and_b32 v15, 0xffff0000, v95
    v_pk_fma_f32 v[32:33], v[8:9], v[198:199], v[32:33] op_sel:[0,1,0] op_sel_hi:[1,1,1]
    v_pk_fma_f32 v[34:35], v[10:11], v[198:199], v[34:35] op_sel:[0,1,0] op_sel_hi:[1,1,1]
    v_pk_fma_f32 v[36:37], v[12:13], v[198:199], v[36:37] op_sel:[0,1,0] op_sel_hi:[1,1,1]
    v_pk_fma_f32 v[38:39], v[14:15], v[198:199], v[38:39] op_sel:[0,1,0] op_sel_hi:[1,1,1]
    s_waitcnt vmcnt(7)
    v_lshlrev_b32 v8, 16, v96
    v_and_b32 v9, 0xffff0000, v96
    v_lshlrev_b32 v10, 16, v97
    v_and_b32 v11, 0xffff0000, v97
    v_lshlrev_b32 v12, 16, v98
    v_and_b32 v13, 0xffff0000, v98
    v_lshlrev_b32 v14, 16, v99
    v_and_b32 v15, 0xffff0000, v99
    v_pk_fma_f32 v[32:33], v[8:9], v[200:201], v[32:33] op_sel:[0,0,0] op_sel_hi:[1,0,1]
    v_pk_fma_f32 v[34:35], v[10:11], v[200:201], v[34:35] op_sel:[0,0,0] op_sel_hi:[1,0,1]
    v_pk_fma_f32 v[36:37], v[12:13], v[200:201], v[36:37] op_sel:[0,0,0] op_sel_hi:[1,0,1]
    v_pk_fma_f32 v[38:39], v[14:15], v[200:201], v[38:39] op_sel:[0,0,0] op_sel_hi:[1,0,1]
    s_waitcnt vmcnt(6)
    v_lshlrev_b32 v8, 16, v100
    v_and_b32 v9, 0xffff0000, v100
    v_lshlrev_b32 v10, 16, v101
    v_and_b32 v11, 0xffff0000, v101
    v_lshlrev_b32 v12, 16, v102
    v_and_b32 v13, 0xffff0000, v102
    v_lshlrev_b32 v14, 16, v103
    v_and_b32 v15, 0xffff0000, v103
    v_pk_fma_f32 v[32:33], v[8:9], v[200:201], v[32:33] op_sel:[0,1,0] op_sel_hi:[1,1,1]
    v_pk_fma_f32 v[34:35], v[10:11], v[200:201], v[34:35] op_sel:[0,1,0] op_sel_hi:[1,1,1]
    v_pk_fma_f32 v[36:37], v[12:13], v[200:201], v[36:37] op_sel:[0,1,0] op_sel_hi:[1,1,1]
    v_pk_fma_f32 v[38:39], v[14:15], v[200:201], v[38:39] op_sel:[0,1,0] op_sel_hi:[1,1,1]
    s_waitcnt vmcnt(5)
    v_lshlrev_b32 v8, 16, v104
    v_and_b32 v9, 0xffff0000, v104
    v_lshlrev_b32 v10, 16, v105
    v_and_b32 v11, 0xffff0000, v105
    v_lshlrev_b32 v12, 16, v106
    v_and_b32 v13, 0xffff0000, v106
    v_lshlrev_b32 v14, 16, v107
    v_and_b32 v15, 0xffff0000, v107
    v_pk_fma_f32 v[32:33], v[8:9], v[202:203], v[32:33] op_sel:[0,0,0] op_sel_hi:[1,0,1]
    v_pk_fma_f32 v[34:35], v[10:11], v[202:203], v[34:35] op_sel:[0,0,0] op_sel_hi:[1,0,1]
    v_pk_fma_f32 v[36:37], v[12:13], v[202:203], v[36:37] op_sel:[0,0,0] op_sel_hi:[1,0,1]
    v_pk_fma_f32 v[38:39], v[14:15], v[202:203], v[38:39] op_sel:[0,0,0] op_sel_hi:[1,0,1]
    s_waitcnt vmcnt(4)
    v_lshlrev_b32 v8, 16, v108
    v_and_b32 v9, 0xffff0000, v108
    v_lshlrev_b32 v10, 16, v109
    v_and_b32 v11, 0xffff0000, v109
    v_lshlrev_b32 v12, 16, v110
    v_and_b32 v13, 0xffff0000, v110
    v_lshlrev_b32 v14, 16, v111
    v_and_b32 v15, 0xffff0000, v111
    v_pk_fma_f32 v[32:33], v[8:9], v[202:203], v[32:33] op_sel:[0,1,0] op_sel_hi:[1,1,1]
    v_pk_fma_f32 v[34:35], v[10:11], v[202:203], v[34:35] op_sel:[0,1,0] op_sel_hi:[1,1,1]
    v_pk_fma_f32 v[36:37], v[12:13], v[202:203], v[36:37] op_sel:[0,1,0] op_sel_hi:[1,1,1]
    v_pk_fma_f32 v[38:39], v[14:15], v[202:203], v[38:39] op_sel:[0,1,0] op_sel_hi:[1,1,1]
    s_waitcnt vmcnt(3)
    v_lshlrev_b32 v8, 16, v112
    v_and_b32 v9, 0xffff0000, v112
    v_lshlrev_b32 v10, 16, v113
    v_and_b32 v11, 0xffff0000, v113
    v_lshlrev_b32 v12, 16, v114
    v_and_b32 v13, 0xffff0000, v114
    v_lshlrev_b32 v14, 16, v115
    v_and_b32 v15, 0xffff0000, v115
    v_pk_fma_f32 v[32:33], v[8:9], v[204:205], v[32:33] op_sel:[0,0,0] op_sel_hi:[1,0,1]
    v_pk_fma_f32 v[34:35], v[10:11], v[204:205], v[34:35] op_sel:[0,0,0] op_sel_hi:[1,0,1]
    v_pk_fma_f32 v[36:37], v[12:13], v[204:205], v[36:37] op_sel:[0,0,0] op_sel_hi:[1,0,1]
    v_pk_fma_f32 v[38:39], v[14:15], v[204:205], v[38:39] op_sel:[0,0,0] op_sel_hi:[1,0,1]
    s_waitcnt vmcnt(2)
    v_lshlrev_b32 v8, 16, v116
    v_and_b32 v9, 0xffff0000, v116
    v_lshlrev_b32 v10, 16, v117
    v_and_b32 v11, 0xffff0000, v117
    v_lshlrev_b32 v12, 16, v118
    v_and_b32 v13, 0xffff0000, v118
    v_lshlrev_b32 v14, 16, v119
    v_and_b32 v15, 0xffff0000, v119
    v_pk_fma_f32 v[32:33], v[8:9], v[204:205], v[32:33] op_sel:[0,1,0] op_sel_hi:[1,1,1]
    v_pk_fma_f32 v[34:35], v[10:11], v[204:205], v[34:35] op_sel:[0,1,0] op_sel_hi:[1,1,1]
    v_pk_fma_f32 v[36:37], v[12:13], v[204:205], v[36:37] op_sel:[0,1,0] op_sel_hi:[1,1,1]
    v_pk_fma_f32 v[38:39], v[14:15], v[204:205], v[38:39] op_sel:[0,1,0] op_sel_hi:[1,1,1]
    s_waitcnt vmcnt(1)
    v_lshlrev_b32 v8, 16, v120
    v_and_b32 v9, 0xffff0000, v120
    v_lshlrev_b32 v10, 16, v121
    v_and_b32 v11, 0xffff0000, v121
    v_lshlrev_b32 v12, 16, v122
    v_and_b32 v13, 0xffff0000, v122
    v_lshlrev_b32 v14, 16, v123
    v_and_b32 v15, 0xffff0000, v123
    v_pk_fma_f32 v[32:33], v[8:9], v[206:207], v[32:33] op_sel:[0,0,0] op_sel_hi:[1,0,1]
    v_pk_fma_f32 v[34:35], v[10:11], v[206:207], v[34:35] op_sel:[0,0,0] op_sel_hi:[1,0,1]
    v_pk_fma_f32 v[36:37], v[12:13], v[206:207], v[36:37] op_sel:[0,0,0] op_sel_hi:[1,0,1]
    v_pk_fma_f32 v[38:39], v[14:15], v[206:207], v[38:39] op_sel:[0,0,0] op_sel_hi:[1,0,1]
    s_waitcnt vmcnt(0)
    v_lshlrev_b32 v8, 16, v124
    v_and_b32 v9, 0xffff0000, v124
    v_lshlrev_b32 v10, 16, v125
    v_and_b32 v11, 0xffff0000, v125
    v_lshlrev_b32 v12, 16, v126
    v_and_b32 v13, 0xffff0000, v126
    v_lshlrev_b32 v14, 16, v127
    v_and_b32 v15, 0xffff0000, v127
    v_pk_fma_f32 v[32:33], v[8:9], v[206:207], v[32:33] op_sel:[0,1,0] op_sel_hi:[1,1,1]
    v_pk_fma_f32 v[34:35], v[10:11], v[206:207], v[34:35] op_sel:[0,1,0] op_sel_hi:[1,1,1]
    v_pk_fma_f32 v[36:37], v[12:13], v[206:207], v[36:37] op_sel:[0,1,0] op_sel_hi:[1,1,1]
    v_pk_fma_f32 v[38:39], v[14:15], v[206:207], v[38:39] op_sel:[0,1,0] op_sel_hi:[1,1,1]
    v_cvt_pk_bf16_f32 v48, v32, v33
    v_cvt_pk_bf16_f32 v49, v34, v35
    v_cvt_pk_bf16_f32 v50, v36, v37
    v_cvt_pk_bf16_f32 v51, v38, v39
    buffer_store_dwordx2 v[48:49], v3, s[92:95], s96 offen
    buffer_store_dwordx2 v[50:51], v3, s[92:95], s96 offen offset:32
L_fin_done6:
    s_branch L_end
L_loader2:
    s_waitcnt vmcnt(32)
    s_waitcnt vmcnt(16)
    s_barrier
    s_cmp_lg_u32 s29, 0
    s_cbranch_scc1 L_noinit2
    v_mov_b32 v34, 1
    s_mov_b64 exec, 1
    buffer_atomic_add v34, off, s[48:51], s52
    s_mov_b64 exec, -1
L_noinit2:
    s_mov_b32 m0, 114688
    s_mov_b32 s32, 786432
    buffer_load_dwordx4 v20, s[16:19], s32 offen lds
    s_add_u32 m0, m0, s98
    s_add_u32 s32, s32, s99
    buffer_load_dwordx4 v21, s[16:19], s32 offen lds
    s_add_u32 m0, m0, s98
    s_add_u32 s32, s32, s100
    buffer_load_dwordx4 v22, s[16:19], s32 offen lds
    s_add_u32 m0, m0, s98
    s_add_u32 s32, s32, s99
    buffer_load_dwordx4 v23, s[16:19], s32 offen lds
    s_add_u32 m0, m0, s98
    s_add_u32 s32, s32, s100
    buffer_load_dwordx4 v20, s[16:19], s32 offen lds
    s_add_u32 m0, m0, s98
    s_add_u32 s32, s32, s99
    buffer_load_dwordx4 v21, s[16:19], s32 offen lds
    s_add_u32 m0, m0, s98
    s_add_u32 s32, s32, s100
    buffer_load_dwordx4 v22, s[16:19], s32 offen lds
    s_add_u32 m0, m0, s98
    s_add_u32 s32, s32, s99
    buffer_load_dwordx4 v23, s[16:19], s32 offen lds
    s_add_u32 m0, m0, s98
    s_sub_u32 s32, s32, 180224
    buffer_load_dwordx4 v20, s[16:19], s32 offen lds
    s_add_u32 m0, m0, s98
    s_add_u32 s32, s32, s99
    buffer_load_dwordx4 v21, s[16:19], s32 offen lds
    s_add_u32 m0, m0, s98
    s_add_u32 s32, s32, s100
    buffer_load_dwordx4 v22, s[16:19], s32 offen lds
    s_add_u32 m0, m0, s98
    s_add_u32 s32, s32, s99
    buffer_load_dwordx4 v23, s[16:19], s32 offen lds
    s_add_u32 m0, m0, s98
    s_add_u32 s32, s32, s100
    buffer_load_dwordx4 v20, s[16:19], s32 offen lds
    s_add_u32 m0, m0, s98
    s_add_u32 s32, s32, s99
    buffer_load_dwordx4 v21, s[16:19], s32 offen lds
    s_add_u32 m0, m0, s98
    s_add_u32 s32, s32, s100
    buffer_load_dwordx4 v22, s[16:19], s32 offen lds
    s_add_u32 m0, m0, s98
    s_add_u32 s32, s32, s99
    buffer_load_dwordx4 v23, s[16:19], s32 offen lds
    s_waitcnt vmcnt(16)
    s_barrier
    s_mov_b32 m0, 131072
    s_mov_b32 s32, 1048576
    buffer_load_dwordx4 v20, s[16:19], s32 offen lds
    s_add_u32 m0, m0, s98
    s_add_u32 s32, s32, s99
    buffer_load_dwordx4 v21, s[16:19], s32 offen lds
    s_add_u32 m0, m0, s98
    s_add_u32 s32, s32, s100
    buffer_load_dwordx4 v22, s[16:19], s32 offen lds
    s_add_u32 m0, m0, s98
    s_add_u32 s32, s32, s99
    buffer_load_dwordx4 v23, s[16:19], s32 offen lds
    s_add_u32 m0, m0, s98
    s_add_u32 s32, s32, s100
    buffer_load_dwordx4 v20, s[16:19], s32 offen lds
    s_add_u32 m0, m0, s98
    s_add_u32 s32, s32, s99
    buffer_load_dwordx4 v21, s[16:19], s32 offen lds
    s_add_u32 m0, m0, s98
    s_add_u32 s32, s32, s100
    buffer_load_dwordx4 v22, s[16:19], s32 offen lds
    s_add_u32 m0, m0, s98
    s_add_u32 s32, s32, s99
    buffer_load_dwordx4 v23, s[16:19], s32 offen lds
    s_add_u32 m0, m0, s98
    s_sub_u32 s32, s32, 180224
    buffer_load_dwordx4 v20, s[16:19], s32 offen lds
    s_add_u32 m0, m0, s98
    s_add_u32 s32, s32, s99
    buffer_load_dwordx4 v21, s[16:19], s32 offen lds
    s_add_u32 m0, m0, s98
    s_add_u32 s32, s32, s100
    buffer_load_dwordx4 v22, s[16:19], s32 offen lds
    s_add_u32 m0, m0, s98
    s_add_u32 s32, s32, s99
    buffer_load_dwordx4 v23, s[16:19], s32 offen lds
    s_add_u32 m0, m0, s98
    s_add_u32 s32, s32, s100
    buffer_load_dwordx4 v20, s[16:19], s32 offen lds
    s_add_u32 m0, m0, s98
    s_add_u32 s32, s32, s99
    buffer_load_dwordx4 v21, s[16:19], s32 offen lds
    s_add_u32 m0, m0, s98
    s_add_u32 s32, s32, s100
    buffer_load_dwordx4 v22, s[16:19], s32 offen lds
    s_add_u32 m0, m0, s98
    s_add_u32 s32, s32, s99
    buffer_load_dwordx4 v23, s[16:19], s32 offen lds
    s_mov_b32 m0, 32768
    s_mov_b32 s32, 512
    buffer_load_dwordx4 v40, s[4:7], s32 offen lds
    s_mov_b32 m0, 35840
    s_mov_b32 s32, 512
    buffer_load_dwordx4 v41, s[4:7], s32 offen lds
    s_mov_b32 m0, 38912
    s_mov_b32 s32, 14848
    buffer_load_dwordx4 v40, s[4:7], s32 offen lds
    s_mov_b32 m0, 41984
    s_mov_b32 s32, 14848
    buffer_load_dwordx4 v41, s[4:7], s32 offen lds
    s_mov_b32 m0, 45056
    s_mov_b32 s32, 29184
    buffer_load_dwordx4 v40, s[4:7], s32 offen lds
    s_mov_b32 m0, 48128
    s_mov_b32 s32, 29184
    buffer_load_dwordx4 v41, s[4:7], s32 offen lds
    s_mov_b32 m0, 51200
    s_mov_b32 s32, 43520
    buffer_load_dwordx4 v40, s[4:7], s32 offen lds
    s_mov_b32 m0, 54272
    s_mov_b32 s32, 43520
    buffer_load_dwordx4 v41, s[4:7], s32 offen lds
    s_mov_b32 m0, 57344
    s_mov_b32 s32, 57856
    buffer_load_dwordx4 v40, s[4:7], s32 offen lds
    s_mov_b32 m0, 60416
    s_mov_b32 s32, 57856
    buffer_load_dwordx4 v41, s[4:7], s32 offen lds
    s_mov_b32 m0, 63488
    s_mov_b32 s32, 72192
    buffer_load_dwordx4 v40, s[4:7], s32 offen lds
    s_mov_b32 m0, 66560
    s_mov_b32 s32, 72192
    buffer_load_dwordx4 v41, s[4:7], s32 offen lds
    s_mov_b32 m0, 69632
    s_mov_b32 s32, 86528
    buffer_load_dwordx4 v40, s[4:7], s32 offen lds
    s_mov_b32 m0, 72704
    s_mov_b32 s32, 86528
    buffer_load_dwordx4 v41, s[4:7], s32 offen lds
    s_mov_b32 m0, 75776
    s_mov_b32 s32, 100864
    buffer_load_dwordx4 v40, s[4:7], s32 offen lds
    s_mov_b32 m0, 78848
    s_mov_b32 s32, 100864
    buffer_load_dwordx4 v41, s[4:7], s32 offen lds
    s_mov_b32 m0, 81920
    s_mov_b32 s32, 115200
    buffer_load_dwordx4 v40, s[4:7], s32 offen lds
    s_mov_b32 m0, 84992
    s_mov_b32 s32, 115200
    buffer_load_dwordx4 v41, s[4:7], s32 offen lds
    s_waitcnt vmcnt(45)
    s_mov_b32 m0, 33792
    s_mov_b32 s32, 640
    buffer_load_dwordx4 v40, s[4:7], s32 offen lds
    s_mov_b32 m0, 36864
    s_mov_b32 s32, 640
    buffer_load_dwordx4 v41, s[4:7], s32 offen lds
    s_mov_b32 m0, 39936
    s_mov_b32 s32, 14976
    buffer_load_dwordx4 v40, s[4:7], s32 offen lds
    s_mov_b32 m0, 43008
    s_mov_b32 s32, 14976
    buffer_load_dwordx4 v41, s[4:7], s32 offen lds
    s_mov_b32 m0, 46080
    s_mov_b32 s32, 29312
    buffer_load_dwordx4 v40, s[4:7], s32 offen lds
    s_mov_b32 m0, 49152
    s_mov_b32 s32, 29312
    buffer_load_dwordx4 v41, s[4:7], s32 offen lds
    s_mov_b32 m0, 52224
    s_mov_b32 s32, 43648
    buffer_load_dwordx4 v40, s[4:7], s32 offen lds
    s_mov_b32 m0, 55296
    s_mov_b32 s32, 43648
    buffer_load_dwordx4 v41, s[4:7], s32 offen lds
    s_mov_b32 m0, 58368
    s_mov_b32 s32, 57984
    buffer_load_dwordx4 v40, s[4:7], s32 offen lds
    s_mov_b32 m0, 61440
    s_mov_b32 s32, 57984
    buffer_load_dwordx4 v41, s[4:7], s32 offen lds
    s_mov_b32 m0, 64512
    s_mov_b32 s32, 72320
    buffer_load_dwordx4 v40, s[4:7], s32 offen lds
    s_mov_b32 m0, 67584
    s_mov_b32 s32, 72320
    buffer_load_dwordx4 v41, s[4:7], s32 offen lds
    s_mov_b32 m0, 70656
    s_mov_b32 s32, 86656
    buffer_load_dwordx4 v40, s[4:7], s32 offen lds
    s_mov_b32 m0, 73728
    s_mov_b32 s32, 86656
    buffer_load_dwordx4 v41, s[4:7], s32 offen lds
    s_mov_b32 m0, 76800
    s_mov_b32 s32, 100992
    buffer_load_dwordx4 v40, s[4:7], s32 offen lds
    s_mov_b32 m0, 79872
    s_mov_b32 s32, 100992
    buffer_load_dwordx4 v41, s[4:7], s32 offen lds
    s_mov_b32 m0, 82944
    s_mov_b32 s32, 115328
    buffer_load_dwordx4 v40, s[4:7], s32 offen lds
    s_mov_b32 m0, 86016
    s_mov_b32 s32, 115328
    buffer_load_dwordx4 v41, s[4:7], s32 offen lds
    s_waitcnt vmcnt(52)
    s_barrier
    s_waitcnt vmcnt(47)
    s_mov_b32 m0, 147456
    s_mov_b32 s32, 1310720
    buffer_load_dwordx4 v20, s[16:19], s32 offen lds
    s_add_u32 m0, m0, s98
    s_add_u32 s32, s32, s99
    buffer_load_dwordx4 v21, s[16:19], s32 offen lds
    s_add_u32 m0, m0, s98
    s_add_u32 s32, s32, s100
    buffer_load_dwordx4 v22, s[16:19], s32 offen lds
    s_add_u32 m0, m0, s98
    s_add_u32 s32, s32, s99
    buffer_load_dwordx4 v23, s[16:19], s32 offen lds
    s_add_u32 m0, m0, s98
    s_add_u32 s32, s32, s100
    buffer_load_dwordx4 v20, s[16:19], s32 offen lds
    s_add_u32 m0, m0, s98
    s_add_u32 s32, s32, s99
    buffer_load_dwordx4 v21, s[16:19], s32 offen lds
    s_add_u32 m0, m0, s98
    s_add_u32 s32, s32, s100
    buffer_load_dwordx4 v22, s[16:19], s32 offen lds
    s_add_u32 m0, m0, s98
    s_add_u32 s32, s32, s99
    buffer_load_dwordx4 v23, s[16:19], s32 offen lds
    s_add_u32 m0, m0, s98
    s_sub_u32 s32, s32, 180224
    buffer_load_dwordx4 v20, s[16:19], s32 offen lds
    s_add_u32 m0, m0, s98
    s_add_u32 s32, s32, s99
    buffer_load_dwordx4 v21, s[16:19], s32 offen lds
    s_add_u32 m0, m0, s98
    s_add_u32 s32, s32, s100
    buffer_load_dwordx4 v22, s[16:19], s32 offen lds
    s_add_u32 m0, m0, s98
    s_add_u32 s32, s32, s99
    buffer_load_dwordx4 v23, s[16:19], s32 offen lds
    s_add_u32 m0, m0, s98
    s_add_u32 s32, s32, s100
    buffer_load_dwordx4 v20, s[16:19], s32 offen lds
    s_add_u32 m0, m0, s98
    s_add_u32 s32, s32, s99
    buffer_load_dwordx4 v21, s[16:19], s32 offen lds
    s_add_u32 m0, m0, s98
    s_add_u32 s32, s32, s100
    buffer_load_dwordx4 v22, s[16:19], s32 offen lds
    s_add_u32 m0, m0, s98
    s_add_u32 s32, s32, s99
    buffer_load_dwordx4 v23, s[16:19], s32 offen lds
    s_waitcnt vmcnt(45)
    s_mov_b32 m0, 34816
    s_mov_b32 s32, 768
    buffer_load_dwordx4 v40, s[4:7], s32 offen lds
    s_mov_b32 m0, 37888
    s_mov_b32 s32, 768
    buffer_load_dwordx4 v41, s[4:7], s32 offen lds
    s_mov_b32 m0, 40960
    s_mov_b32 s32, 15104
    buffer_load_dwordx4 v40, s[4:7], s32 offen lds
    s_mov_b32 m0, 44032
    s_mov_b32 s32, 15104
    buffer_load_dwordx4 v41, s[4:7], s32 offen lds
    s_mov_b32 m0, 47104
    s_mov_b32 s32, 29440
    buffer_load_dwordx4 v40, s[4:7], s32 offen lds
    s_mov_b32 m0, 50176
    s_mov_b32 s32, 29440
    buffer_load_dwordx4 v41, s[4:7], s32 offen lds
    s_mov_b32 m0, 53248
    s_mov_b32 s32, 43776
    buffer_load_dwordx4 v40, s[4:7], s32 offen lds
    s_mov_b32 m0, 56320
    s_mov_b32 s32, 43776
    buffer_load_dwordx4 v41, s[4:7], s32 offen lds
    s_mov_b32 m0, 59392
    s_mov_b32 s32, 58112
    buffer_load_dwordx4 v40, s[4:7], s32 offen lds
    s_mov_b32 m0, 62464
    s_mov_b32 s32, 58112
    buffer_load_dwordx4 v41, s[4:7], s32 offen lds
    s_mov_b32 m0, 65536
    s_mov_b32 s32, 72448
    buffer_load_dwordx4 v40, s[4:7], s32 offen lds
    s_mov_b32 m0, 68608
    s_mov_b32 s32, 72448
    buffer_load_dwordx4 v41, s[4:7], s32 offen lds
    s_mov_b32 m0, 71680
    s_mov_b32 s32, 86784
    buffer_load_dwordx4 v40, s[4:7], s32 offen lds
    s_mov_b32 m0, 74752
    s_mov_b32 s32, 86784
    buffer_load_dwordx4 v41, s[4:7], s32 offen lds
    s_mov_b32 m0, 77824
    s_mov_b32 s32, 101120
    buffer_load_dwordx4 v40, s[4:7], s32 offen lds
    s_mov_b32 m0, 80896
    s_mov_b32 s32, 101120
    buffer_load_dwordx4 v41, s[4:7], s32 offen lds
    s_mov_b32 m0, 83968
    s_mov_b32 s32, 115456
    buffer_load_dwordx4 v40, s[4:7], s32 offen lds
    s_mov_b32 m0, 87040
    s_mov_b32 s32, 115456
    buffer_load_dwordx4 v41, s[4:7], s32 offen lds
    s_waitcnt vmcnt(47)
    s_mov_b32 m0, 0
    s_mov_b32 s32, 0
    buffer_load_dwordx4 v8, s[8:11], s32 offen offset:0 nt lds
    buffer_load_dwordx4 v9, s[8:11], s32 offen offset:1024 nt lds
    buffer_load_dwordx4 v10, s[8:11], s32 offen offset:2048 nt lds
    buffer_load_dwordx4 v11, s[8:11], s32 offen offset:3072 nt lds
    s_mov_b32 m0, 4096
    s_mov_b32 s32, 4096
    buffer_load_dwordx4 v12, s[8:11], s32 offen offset:0 nt lds
    buffer_load_dwordx4 v13, s[8:11], s32 offen offset:1024 nt lds
    buffer_load_dwordx4 v14, s[8:11], s32 offen offset:2048 nt lds
    buffer_load_dwordx4 v15, s[8:11], s32 offen offset:3072 nt lds
    s_mov_b32 m0, 8192
    s_mov_b32 s32, 8192
    buffer_load_dwordx4 v8, s[8:11], s32 offen offset:0 nt lds
    buffer_load_dwordx4 v9, s[8:11], s32 offen offset:1024 nt lds
    buffer_load_dwordx4 v10, s[8:11], s32 offen offset:2048 nt lds
    buffer_load_dwordx4 v11, s[8:11], s32 offen offset:3072 nt lds
    s_mov_b32 m0, 12288
    s_mov_b32 s32, 12288
    buffer_load_dwordx4 v12, s[8:11], s32 offen offset:0 nt lds
    buffer_load_dwordx4 v13, s[8:11], s32 offen offset:1024 nt lds
    buffer_load_dwordx4 v14, s[8:11], s32 offen offset:2048 nt lds
    buffer_load_dwordx4 v15, s[8:11], s32 offen offset:3072 nt lds
    s_barrier
    s_waitcnt vmcnt(47)
    s_mov_b32 m0, 98304
    s_mov_b32 s32, 1572864
    buffer_load_dwordx4 v20, s[16:19], s32 offen lds
    s_add_u32 m0, m0, s98
    s_add_u32 s32, s32, s99
    buffer_load_dwordx4 v21, s[16:19], s32 offen lds
    s_add_u32 m0, m0, s98
    s_add_u32 s32, s32, s100
    buffer_load_dwordx4 v22, s[16:19], s32 offen lds
    s_add_u32 m0, m0, s98
    s_add_u32 s32, s32, s99
    buffer_load_dwordx4 v23, s[16:19], s32 offen lds
    s_add_u32 m0, m0, s98
    s_add_u32 s32, s32, s100
    buffer_load_dwordx4 v20, s[16:19], s32 offen lds
    s_add_u32 m0, m0, s98
    s_add_u32 s32, s32, s99
    buffer_load_dwordx4 v21, s[16:19], s32 offen lds
    s_add_u32 m0, m0, s98
    s_add_u32 s32, s32, s100
    buffer_load_dwordx4 v22, s[16:19], s32 offen lds
    s_add_u32 m0, m0, s98
    s_add_u32 s32, s32, s99
    buffer_load_dwordx4 v23, s[16:19], s32 offen lds
    s_add_u32 m0, m0, s98
    s_sub_u32 s32, s32, 180224
    buffer_load_dwordx4 v20, s[16:19], s32 offen lds
    s_add_u32 m0, m0, s98
    s_add_u32 s32, s32, s99
    buffer_load_dwordx4 v21, s[16:19], s32 offen lds
    s_add_u32 m0, m0, s98
    s_add_u32 s32, s32, s100
    buffer_load_dwordx4 v22, s[16:19], s32 offen lds
    s_add_u32 m0, m0, s98
    s_add_u32 s32, s32, s99
    buffer_load_dwordx4 v23, s[16:19], s32 offen lds
    s_add_u32 m0, m0, s98
    s_add_u32 s32, s32, s100
    buffer_load_dwordx4 v20, s[16:19], s32 offen lds
    s_add_u32 m0, m0, s98
    s_add_u32 s32, s32, s99
    buffer_load_dwordx4 v21, s[16:19], s32 offen lds
    s_add_u32 m0, m0, s98
    s_add_u32 s32, s32, s100
    buffer_load_dwordx4 v22, s[16:19], s32 offen lds
    s_add_u32 m0, m0, s98
    s_add_u32 s32, s32, s99
    buffer_load_dwordx4 v23, s[16:19], s32 offen lds
    s_waitcnt vmcnt(47)
    s_mov_b32 m0, 16384
    s_mov_b32 s32, 16384
    buffer_load_dwordx4 v8, s[8:11], s32 offen offset:0 nt lds
    buffer_load_dwordx4 v9, s[8:11], s32 offen offset:1024 nt lds
    buffer_load_dwordx4 v10, s[8:11], s32 offen offset:2048 nt lds
    buffer_load_dwordx4 v11, s[8:11], s32 offen offset:3072 nt lds
    s_mov_b32 m0, 20480
    s_mov_b32 s32, 20480
    buffer_load_dwordx4 v12, s[8:11], s32 offen offset:0 nt lds
    buffer_load_dwordx4 v13, s[8:11], s32 offen offset:1024 nt lds
    buffer_load_dwordx4 v14, s[8:11], s32 offen offset:2048 nt lds
    buffer_load_dwordx4 v15, s[8:11], s32 offen offset:3072 nt lds
    s_mov_b32 m0, 24576
    s_mov_b32 s32, 24576
    buffer_load_dwordx4 v8, s[8:11], s32 offen offset:0 nt lds
    buffer_load_dwordx4 v9, s[8:11], s32 offen offset:1024 nt lds
    buffer_load_dwordx4 v10, s[8:11], s32 offen offset:2048 nt lds
    buffer_load_dwordx4 v11, s[8:11], s32 offen offset:3072 nt lds
    s_mov_b32 m0, 28672
    s_mov_b32 s32, 28672
    buffer_load_dwordx4 v12, s[8:11], s32 offen offset:0 nt lds
    buffer_load_dwordx4 v13, s[8:11], s32 offen offset:1024 nt lds
    buffer_load_dwordx4 v14, s[8:11], s32 offen offset:2048 nt lds
    buffer_load_dwordx4 v15, s[8:11], s32 offen offset:3072 nt lds
    s_waitcnt vmcnt(48)
    s_barrier
    s_waitcnt vmcnt(47)
    s_mov_b32 m0, 114688
    s_mov_b32 s32, 1835008
    buffer_load_dwordx4 v20, s[16:19], s32 offen lds
    s_add_u32 m0, m0, s98
    s_add_u32 s32, s32, s99
    buffer_load_dwordx4 v21, s[16:19], s32 offen lds
    s_add_u32 m0, m0, s98
    s_add_u32 s32, s32, s100
    buffer_load_dwordx4 v22, s[16:19], s32 offen lds
    s_add_u32 m0, m0, s98
    s_add_u32 s32, s32, s99
    buffer_load_dwordx4 v23, s[16:19], s32 offen lds
    s_add_u32 m0, m0, s98
    s_add_u32 s32, s32, s100
    buffer_load_dwordx4 v20, s[16:19], s32 offen lds
    s_add_u32 m0, m0, s98
    s_add_u32 s32, s32, s99
    buffer_load_dwordx4 v21, s[16:19], s32 offen lds
    s_add_u32 m0, m0, s98
    s_add_u32 s32, s32, s100
    buffer_load_dwordx4 v22, s[16:19], s32 offen lds
    s_add_u32 m0, m0, s98
    s_add_u32 s32, s32, s99
    buffer_load_dwordx4 v23, s[16:19], s32 offen lds
    s_add_u32 m0, m0, s98
    s_sub_u32 s32, s32, 180224
    buffer_load_dwordx4 v20, s[16:19], s32 offen lds
    s_add_u32 m0, m0, s98
    s_add_u32 s32, s32, s99
    buffer_load_dwordx4 v21, s[16:19], s32 offen lds
    s_add_u32 m0, m0, s98
    s_add_u32 s32, s32, s100
    buffer_load_dwordx4 v22, s[16:19], s32 offen lds
    s_add_u32 m0, m0, s98
    s_add_u32 s32, s32, s99
    buffer_load_dwordx4 v23, s[16:19], s32 offen lds
    s_add_u32 m0, m0, s98
    s_add_u32 s32, s32, s100
    buffer_load_dwordx4 v20, s[16:19], s32 offen lds
    s_add_u32 m0, m0, s98
    s_add_u32 s32, s32, s99
    buffer_load_dwordx4 v21, s[16:19], s32 offen lds
    s_add_u32 m0, m0, s98
    s_add_u32 s32, s32, s100
    buffer_load_dwordx4 v22, s[16:19], s32 offen lds
    s_add_u32 m0, m0, s98
    s_add_u32 s32, s32, s99
    buffer_load_dwordx4 v23, s[16:19], s32 offen lds
    s_waitcnt vmcnt(32)
    s_barrier
    s_mov_b32 m0, 131072
    s_mov_b32 s32, 2097152
    buffer_load_dwordx4 v20, s[16:19], s32 offen lds
    s_add_u32 m0, m0, s98
    s_add_u32 s32, s32, s99
    buffer_load_dwordx4 v21, s[16:19], s32 offen lds
    s_add_u32 m0, m0, s98
    s_add_u32 s32, s32, s100
    buffer_load_dwordx4 v22, s[16:19], s32 offen lds
    s_add_u32 m0, m0, s98
    s_add_u32 s32, s32, s99
    buffer_load_dwordx4 v23, s[16:19], s32 offen lds
    s_add_u32 m0, m0, s98
    s_add_u32 s32, s32, s100
    buffer_load_dwordx4 v20, s[16:19], s32 offen lds
    s_add_u32 m0, m0, s98
    s_add_u32 s32, s32, s99
    buffer_load_dwordx4 v21, s[16:19], s32 offen lds
    s_add_u32 m0, m0, s98
    s_add_u32 s32, s32, s100
    buffer_load_dwordx4 v22, s[16:19], s32 offen lds
    s_add_u32 m0, m0, s98
    s_add_u32 s32, s32, s99
    buffer_load_dwordx4 v23, s[16:19], s32 offen lds
    s_add_u32 m0, m0, s98
    s_sub_u32 s32, s32, 180224
    buffer_load_dwordx4 v20, s[16:19], s32 offen lds
    s_add_u32 m0, m0, s98
    s_add_u32 s32, s32, s99
    buffer_load_dwordx4 v21, s[16:19], s32 offen lds
    s_add_u32 m0, m0, s98
    s_add_u32 s32, s32, s100
    buffer_load_dwordx4 v22, s[16:19], s32 offen lds
    s_add_u32 m0, m0, s98
    s_add_u32 s32, s32, s99
    buffer_load_dwordx4 v23, s[16:19], s32 offen lds
    s_add_u32 m0, m0, s98
    s_add_u32 s32, s32, s100
    buffer_load_dwordx4 v20, s[16:19], s32 offen lds
    s_add_u32 m0, m0, s98
    s_add_u32 s32, s32, s99
    buffer_load_dwordx4 v21, s[16:19], s32 offen lds
    s_add_u32 m0, m0, s98
    s_add_u32 s32, s32, s100
    buffer_load_dwordx4 v22, s[16:19], s32 offen lds
    s_add_u32 m0, m0, s98
    s_add_u32 s32, s32, s99
    buffer_load_dwordx4 v23, s[16:19], s32 offen lds
    s_waitcnt vmcnt(47)
    s_mov_b32 m0, 32768
    s_mov_b32 s32, 32768
    buffer_load_dwordx4 v8, s[8:11], s32 offen offset:0 nt lds
    buffer_load_dwordx4 v9, s[8:11], s32 offen offset:1024 nt lds
    buffer_load_dwordx4 v10, s[8:11], s32 offen offset:2048 nt lds
    buffer_load_dwordx4 v11, s[8:11], s32 offen offset:3072 nt lds
    s_mov_b32 m0, 36864
    s_mov_b32 s32, 36864
    buffer_load_dwordx4 v12, s[8:11], s32 offen offset:0 nt lds
    buffer_load_dwordx4 v13, s[8:11], s32 offen offset:1024 nt lds
    buffer_load_dwordx4 v14, s[8:11], s32 offen offset:2048 nt lds
    buffer_load_dwordx4 v15, s[8:11], s32 offen offset:3072 nt lds
    s_mov_b32 m0, 40960
    s_mov_b32 s32, 40960
    buffer_load_dwordx4 v8, s[8:11], s32 offen offset:0 nt lds
    buffer_load_dwordx4 v9, s[8:11], s32 offen offset:1024 nt lds
    buffer_load_dwordx4 v10, s[8:11], s32 offen offset:2048 nt lds
    buffer_load_dwordx4 v11, s[8:11], s32 offen offset:3072 nt lds
    s_mov_b32 m0, 45056
    s_mov_b32 s32, 45056
    buffer_load_dwordx4 v12, s[8:11], s32 offen offset:0 nt lds
    buffer_load_dwordx4 v13, s[8:11], s32 offen offset:1024 nt lds
    buffer_load_dwordx4 v14, s[8:11], s32 offen offset:2048 nt lds
    buffer_load_dwordx4 v15, s[8:11], s32 offen offset:3072 nt lds
    s_waitcnt vmcnt(32)
    s_barrier
    s_mov_b32 m0, 147456
    s_mov_b32 s32, 2359296
    buffer_load_dwordx4 v20, s[16:19], s32 offen lds
    s_add_u32 m0, m0, s98
    s_add_u32 s32, s32, s99
    buffer_load_dwordx4 v21, s[16:19], s32 offen lds
    s_add_u32 m0, m0, s98
    s_add_u32 s32, s32, s100
    buffer_load_dwordx4 v22, s[16:19], s32 offen lds
    s_add_u32 m0, m0, s98
    s_add_u32 s32, s32, s99
    buffer_load_dwordx4 v23, s[16:19], s32 offen lds
    s_add_u32 m0, m0, s98
    s_add_u32 s32, s32, s100
    buffer_load_dwordx4 v20, s[16:19], s32 offen lds
    s_add_u32 m0, m0, s98
    s_add_u32 s32, s32, s99
    buffer_load_dwordx4 v21, s[16:19], s32 offen lds
    s_add_u32 m0, m0, s98
    s_add_u32 s32, s32, s100
    buffer_load_dwordx4 v22, s[16:19], s32 offen lds
    s_add_u32 m0, m0, s98
    s_add_u32 s32, s32, s99
    buffer_load_dwordx4 v23, s[16:19], s32 offen lds
    s_add_u32 m0, m0, s98
    s_sub_u32 s32, s32, 180224
    buffer_load_dwordx4 v20, s[16:19], s32 offen lds
    s_add_u32 m0, m0, s98
    s_add_u32 s32, s32, s99
    buffer_load_dwordx4 v21, s[16:19], s32 offen lds
    s_add_u32 m0, m0, s98
    s_add_u32 s32, s32, s100
    buffer_load_dwordx4 v22, s[16:19], s32 offen lds
    s_add_u32 m0, m0, s98
    s_add_u32 s32, s32, s99
    buffer_load_dwordx4 v23, s[16:19], s32 offen lds
    s_add_u32 m0, m0, s98
    s_add_u32 s32, s32, s100
    buffer_load_dwordx4 v20, s[16:19], s32 offen lds
    s_add_u32 m0, m0, s98
    s_add_u32 s32, s32, s99
    buffer_load_dwordx4 v21, s[16:19], s32 offen lds
    s_add_u32 m0, m0, s98
    s_add_u32 s32, s32, s100
    buffer_load_dwordx4 v22, s[16:19], s32 offen lds
    s_add_u32 m0, m0, s98
    s_add_u32 s32, s32, s99
    buffer_load_dwordx4 v23, s[16:19], s32 offen lds
    s_waitcnt vmcnt(47)
    s_mov_b32 m0, 65536
    s_mov_b32 s32, 0
    buffer_load_dwordx4 v16, s[12:15], s32 offen offset:0 nt lds
    buffer_load_dwordx4 v17, s[12:15], s32 offen offset:1024 nt lds
    buffer_load_dwordx4 v18, s[12:15], s32 offen offset:2048 nt lds
    buffer_load_dwordx4 v19, s[12:15], s32 offen offset:3072 nt lds
    s_mov_b32 m0, 69632
    s_mov_b32 s32, 4096
    buffer_load_dwordx4 v16, s[12:15], s32 offen offset:0 nt lds
    buffer_load_dwordx4 v17, s[12:15], s32 offen offset:1024 nt lds
    buffer_load_dwordx4 v18, s[12:15], s32 offen offset:2048 nt lds
    buffer_load_dwordx4 v19, s[12:15], s32 offen offset:3072 nt lds
    s_mov_b32 m0, 73728
    s_mov_b32 s32, 8192
    buffer_load_dwordx4 v16, s[12:15], s32 offen offset:0 nt lds
    buffer_load_dwordx4 v17, s[12:15], s32 offen offset:1024 nt lds
    buffer_load_dwordx4 v18, s[12:15], s32 offen offset:2048 nt lds
    buffer_load_dwordx4 v19, s[12:15], s32 offen offset:3072 nt lds
    s_mov_b32 m0, 77824
    s_mov_b32 s32, 12288
    buffer_load_dwordx4 v16, s[12:15], s32 offen offset:0 nt lds
    buffer_load_dwordx4 v17, s[12:15], s32 offen offset:1024 nt lds
    buffer_load_dwordx4 v18, s[12:15], s32 offen offset:2048 nt lds
    buffer_load_dwordx4 v19, s[12:15], s32 offen offset:3072 nt lds
    s_waitcnt vmcnt(48)
    s_barrier
    s_waitcnt vmcnt(47)
    s_mov_b32 m0, 98304
    s_mov_b32 s32, 2621440
    buffer_load_dwordx4 v20, s[16:19], s32 offen lds
    s_add_u32 m0, m0, s98
    s_add_u32 s32, s32, s99
    buffer_load_dwordx4 v21, s[16:19], s32 offen lds
    s_add_u32 m0, m0, s98
    s_add_u32 s32, s32, s100
    buffer_load_dwordx4 v22, s[16:19], s32 offen lds
    s_add_u32 m0, m0, s98
    s_add_u32 s32, s32, s99
    buffer_load_dwordx4 v23, s[16:19], s32 offen lds
    s_add_u32 m0, m0, s98
    s_add_u32 s32, s32, s100
    buffer_load_dwordx4 v20, s[16:19], s32 offen lds
    s_add_u32 m0, m0, s98
    s_add_u32 s32, s32, s99
    buffer_load_dwordx4 v21, s[16:19], s32 offen lds
    s_add_u32 m0, m0, s98
    s_add_u32 s32, s32, s100
    buffer_load_dwordx4 v22, s[16:19], s32 offen lds
    s_add_u32 m0, m0, s98
    s_add_u32 s32, s32, s99
    buffer_load_dwordx4 v23, s[16:19], s32 offen lds
    s_add_u32 m0, m0, s98
    s_sub_u32 s32, s32, 180224
    buffer_load_dwordx4 v20, s[16:19], s32 offen lds
    s_add_u32 m0, m0, s98
    s_add_u32 s32, s32, s99
    buffer_load_dwordx4 v21, s[16:19], s32 offen lds
    s_add_u32 m0, m0, s98
    s_add_u32 s32, s32, s100
    buffer_load_dwordx4 v22, s[16:19], s32 offen lds
    s_add_u32 m0, m0, s98
    s_add_u32 s32, s32, s99
    buffer_load_dwordx4 v23, s[16:19], s32 offen lds
    s_add_u32 m0, m0, s98
    s_add_u32 s32, s32, s100
    buffer_load_dwordx4 v20, s[16:19], s32 offen lds
    s_add_u32 m0, m0, s98
    s_add_u32 s32, s32, s99
    buffer_load_dwordx4 v21, s[16:19], s32 offen lds
    s_add_u32 m0, m0, s98
    s_add_u32 s32, s32, s100
    buffer_load_dwordx4 v22, s[16:19], s32 offen lds
    s_add_u32 m0, m0, s98
    s_add_u32 s32, s32, s99
    buffer_load_dwordx4 v23, s[16:19], s32 offen lds
    s_waitcnt vmcnt(32)
    s_barrier
    s_mov_b32 m0, 114688
    s_mov_b32 s32, 2883584
    buffer_load_dwordx4 v20, s[16:19], s32 offen lds
    s_add_u32 m0, m0, s98
    s_add_u32 s32, s32, s99
    buffer_load_dwordx4 v21, s[16:19], s32 offen lds
    s_add_u32 m0, m0, s98
    s_add_u32 s32, s32, s100
    buffer_load_dwordx4 v22, s[16:19], s32 offen lds
    s_add_u32 m0, m0, s98
    s_add_u32 s32, s32, s99
    buffer_load_dwordx4 v23, s[16:19], s32 offen lds
    s_add_u32 m0, m0, s98
    s_add_u32 s32, s32, s100
    buffer_load_dwordx4 v20, s[16:19], s32 offen lds
    s_add_u32 m0, m0, s98
    s_add_u32 s32, s32, s99
    buffer_load_dwordx4 v21, s[16:19], s32 offen lds
    s_add_u32 m0, m0, s98
    s_add_u32 s32, s32, s100
    buffer_load_dwordx4 v22, s[16:19], s32 offen lds
    s_add_u32 m0, m0, s98
    s_add_u32 s32, s32, s99
    buffer_load_dwordx4 v23, s[16:19], s32 offen lds
    s_add_u32 m0, m0, s98
    s_sub_u32 s32, s32, 180224
    buffer_load_dwordx4 v20, s[16:19], s32 offen lds
    s_add_u32 m0, m0, s98
    s_add_u32 s32, s32, s99
    buffer_load_dwordx4 v21, s[16:19], s32 offen lds
    s_add_u32 m0, m0, s98
    s_add_u32 s32, s32, s100
    buffer_load_dwordx4 v22, s[16:19], s32 offen lds
    s_add_u32 m0, m0, s98
    s_add_u32 s32, s32, s99
    buffer_load_dwordx4 v23, s[16:19], s32 offen lds
    s_add_u32 m0, m0, s98
    s_add_u32 s32, s32, s100
    buffer_load_dwordx4 v20, s[16:19], s32 offen lds
    s_add_u32 m0, m0, s98
    s_add_u32 s32, s32, s99
    buffer_load_dwordx4 v21, s[16:19], s32 offen lds
    s_add_u32 m0, m0, s98
    s_add_u32 s32, s32, s100
    buffer_load_dwordx4 v22, s[16:19], s32 offen lds
    s_add_u32 m0, m0, s98
    s_add_u32 s32, s32, s99
    buffer_load_dwordx4 v23, s[16:19], s32 offen lds
    s_waitcnt vmcnt(47)
    s_mov_b32 m0, 49152
    s_mov_b32 s32, 49152
    buffer_load_dwordx4 v8, s[8:11], s32 offen offset:0 nt lds
    buffer_load_dwordx4 v9, s[8:11], s32 offen offset:1024 nt lds
    buffer_load_dwordx4 v10, s[8:11], s32 offen offset:2048 nt lds
    buffer_load_dwordx4 v11, s[8:11], s32 offen offset:3072 nt lds
    s_mov_b32 m0, 53248
    s_mov_b32 s32, 53248
    buffer_load_dwordx4 v12, s[8:11], s32 offen offset:0 nt lds
    buffer_load_dwordx4 v13, s[8:11], s32 offen offset:1024 nt lds
    buffer_load_dwordx4 v14, s[8:11], s32 offen offset:2048 nt lds
    buffer_load_dwordx4 v15, s[8:11], s32 offen offset:3072 nt lds
    s_mov_b32 m0, 57344
    s_mov_b32 s32, 57344
    buffer_load_dwordx4 v8, s[8:11], s32 offen offset:0 nt lds
    buffer_load_dwordx4 v9, s[8:11], s32 offen offset:1024 nt lds
    buffer_load_dwordx4 v10, s[8:11], s32 offen offset:2048 nt lds
    buffer_load_dwordx4 v11, s[8:11], s32 offen offset:3072 nt lds
    s_mov_b32 m0, 61440
    s_mov_b32 s32, 61440
    buffer_load_dwordx4 v12, s[8:11], s32 offen offset:0 nt lds
    buffer_load_dwordx4 v13, s[8:11], s32 offen offset:1024 nt lds
    buffer_load_dwordx4 v14, s[8:11], s32 offen offset:2048 nt lds
    buffer_load_dwordx4 v15, s[8:11], s32 offen offset:3072 nt lds
    s_waitcnt vmcnt(32)
    s_barrier
    s_mov_b32 m0, 131072
    s_mov_b32 s32, 3145728
    buffer_load_dwordx4 v20, s[16:19], s32 offen lds
    s_add_u32 m0, m0, s98
    s_add_u32 s32, s32, s99
    buffer_load_dwordx4 v21, s[16:19], s32 offen lds
    s_add_u32 m0, m0, s98
    s_add_u32 s32, s32, s100
    buffer_load_dwordx4 v22, s[16:19], s32 offen lds
    s_add_u32 m0, m0, s98
    s_add_u32 s32, s32, s99
    buffer_load_dwordx4 v23, s[16:19], s32 offen lds
    s_add_u32 m0, m0, s98
    s_add_u32 s32, s32, s100
    buffer_load_dwordx4 v20, s[16:19], s32 offen lds
    s_add_u32 m0, m0, s98
    s_add_u32 s32, s32, s99
    buffer_load_dwordx4 v21, s[16:19], s32 offen lds
    s_add_u32 m0, m0, s98
    s_add_u32 s32, s32, s100
    buffer_load_dwordx4 v22, s[16:19], s32 offen lds
    s_add_u32 m0, m0, s98
    s_add_u32 s32, s32, s99
    buffer_load_dwordx4 v23, s[16:19], s32 offen lds
    s_add_u32 m0, m0, s98
    s_sub_u32 s32, s32, 180224
    buffer_load_dwordx4 v20, s[16:19], s32 offen lds
    s_add_u32 m0, m0, s98
    s_add_u32 s32, s32, s99
    buffer_load_dwordx4 v21, s[16:19], s32 offen lds
    s_add_u32 m0, m0, s98
    s_add_u32 s32, s32, s100
    buffer_load_dwordx4 v22, s[16:19], s32 offen lds
    s_add_u32 m0, m0, s98
    s_add_u32 s32, s32, s99
    buffer_load_dwordx4 v23, s[16:19], s32 offen lds
    s_add_u32 m0, m0, s98
    s_add_u32 s32, s32, s100
    buffer_load_dwordx4 v20, s[16:19], s32 offen lds
    s_add_u32 m0, m0, s98
    s_add_u32 s32, s32, s99
    buffer_load_dwordx4 v21, s[16:19], s32 offen lds
    s_add_u32 m0, m0, s98
    s_add_u32 s32, s32, s100
    buffer_load_dwordx4 v22, s[16:19], s32 offen lds
    s_add_u32 m0, m0, s98
    s_add_u32 s32, s32, s99
    buffer_load_dwordx4 v23, s[16:19], s32 offen lds
    s_waitcnt vmcnt(47)
    s_mov_b32 m0, 81920
    s_mov_b32 s32, 16384
    buffer_load_dwordx4 v16, s[12:15], s32 offen offset:0 nt lds
    buffer_load_dwordx4 v17, s[12:15], s32 offen offset:1024 nt lds
    buffer_load_dwordx4 v18, s[12:15], s32 offen offset:2048 nt lds
    buffer_load_dwordx4 v19, s[12:15], s32 offen offset:3072 nt lds
    s_mov_b32 m0, 86016
    s_mov_b32 s32, 20480
    buffer_load_dwordx4 v16, s[12:15], s32 offen offset:0 nt lds
    buffer_load_dwordx4 v17, s[12:15], s32 offen offset:1024 nt lds
    buffer_load_dwordx4 v18, s[12:15], s32 offen offset:2048 nt lds
    buffer_load_dwordx4 v19, s[12:15], s32 offen offset:3072 nt lds
    s_mov_b32 m0, 90112
    s_mov_b32 s32, 24576
    buffer_load_dwordx4 v16, s[12:15], s32 offen offset:0 nt lds
    buffer_load_dwordx4 v17, s[12:15], s32 offen offset:1024 nt lds
    buffer_load_dwordx4 v18, s[12:15], s32 offen offset:2048 nt lds
    buffer_load_dwordx4 v19, s[12:15], s32 offen offset:3072 nt lds
    s_mov_b32 m0, 94208
    s_mov_b32 s32, 28672
    buffer_load_dwordx4 v16, s[12:15], s32 offen offset:0 nt lds
    buffer_load_dwordx4 v17, s[12:15], s32 offen offset:1024 nt lds
    buffer_load_dwordx4 v18, s[12:15], s32 offen offset:2048 nt lds
    buffer_load_dwordx4 v19, s[12:15], s32 offen offset:3072 nt lds
    s_waitcnt vmcnt(48)
    s_barrier
    s_waitcnt vmcnt(47)
    s_mov_b32 m0, 147456
    s_mov_b32 s32, 3407872
    buffer_load_dwordx4 v20, s[16:19], s32 offen lds
    s_add_u32 m0, m0, s98
    s_add_u32 s32, s32, s99
    buffer_load_dwordx4 v21, s[16:19], s32 offen lds
    s_add_u32 m0, m0, s98
    s_add_u32 s32, s32, s100
    buffer_load_dwordx4 v22, s[16:19], s32 offen lds
    s_add_u32 m0, m0, s98
    s_add_u32 s32, s32, s99
    buffer_load_dwordx4 v23, s[16:19], s32 offen lds
    s_add_u32 m0, m0, s98
    s_add_u32 s32, s32, s100
    buffer_load_dwordx4 v20, s[16:19], s32 offen lds
    s_add_u32 m0, m0, s98
    s_add_u32 s32, s32, s99
    buffer_load_dwordx4 v21, s[16:19], s32 offen lds
    s_add_u32 m0, m0, s98
    s_add_u32 s32, s32, s100
    buffer_load_dwordx4 v22, s[16:19], s32 offen lds
    s_add_u32 m0, m0, s98
    s_add_u32 s32, s32, s99
    buffer_load_dwordx4 v23, s[16:19], s32 offen lds
    s_add_u32 m0, m0, s98
    s_sub_u32 s32, s32, 180224
    buffer_load_dwordx4 v20, s[16:19], s32 offen lds
    s_add_u32 m0, m0, s98
    s_add_u32 s32, s32, s99
    buffer_load_dwordx4 v21, s[16:19], s32 offen lds
    s_add_u32 m0, m0, s98
    s_add_u32 s32, s32, s100
    buffer_load_dwordx4 v22, s[16:19], s32 offen lds
    s_add_u32 m0, m0, s98
    s_add_u32 s32, s32, s99
    buffer_load_dwordx4 v23, s[16:19], s32 offen lds
    s_add_u32 m0, m0, s98
    s_add_u32 s32, s32, s100
    buffer_load_dwordx4 v20, s[16:19], s32 offen lds
    s_add_u32 m0, m0, s98
    s_add_u32 s32, s32, s99
    buffer_load_dwordx4 v21, s[16:19], s32 offen lds
    s_add_u32 m0, m0, s98
    s_add_u32 s32, s32, s100
    buffer_load_dwordx4 v22, s[16:19], s32 offen lds
    s_add_u32 m0, m0, s98
    s_add_u32 s32, s32, s99
    buffer_load_dwordx4 v23, s[16:19], s32 offen lds
    s_waitcnt vmcnt(32)
    s_barrier
    s_mov_b32 m0, 98304
    s_mov_b32 s32, 32768
    buffer_load_dwordx4 v16, s[12:15], s32 offen offset:0 nt lds
    buffer_load_dwordx4 v17, s[12:15], s32 offen offset:1024 nt lds
    buffer_load_dwordx4 v18, s[12:15], s32 offen offset:2048 nt lds
    buffer_load_dwordx4 v19, s[12:15], s32 offen offset:3072 nt lds
    s_mov_b32 m0, 102400
    s_mov_b32 s32, 36864
    buffer_load_dwordx4 v16, s[12:15], s32 offen offset:0 nt lds
    buffer_load_dwordx4 v17, s[12:15], s32 offen offset:1024 nt lds
    buffer_load_dwordx4 v18, s[12:15], s32 offen offset:2048 nt lds
    buffer_load_dwordx4 v19, s[12:15], s32 offen offset:3072 nt lds
    s_mov_b32 m0, 106496
    s_mov_b32 s32, 40960
    buffer_load_dwordx4 v16, s[12:15], s32 offen offset:0 nt lds
    buffer_load_dwordx4 v17, s[12:15], s32 offen offset:1024 nt lds
    buffer_load_dwordx4 v18, s[12:15], s32 offen offset:2048 nt lds
    buffer_load_dwordx4 v19, s[12:15], s32 offen offset:3072 nt lds
    s_mov_b32 m0, 110592
    s_mov_b32 s32, 45056
    buffer_load_dwordx4 v16, s[12:15], s32 offen offset:0 nt lds
    buffer_load_dwordx4 v17, s[12:15], s32 offen offset:1024 nt lds
    buffer_load_dwordx4 v18, s[12:15], s32 offen offset:2048 nt lds
    buffer_load_dwordx4 v19, s[12:15], s32 offen offset:3072 nt lds
    s_waitcnt vmcnt(16)
    s_barrier
    s_mov_b32 m0, 114688
    s_mov_b32 s32, 49152
    buffer_load_dwordx4 v16, s[12:15], s32 offen offset:0 nt lds
    buffer_load_dwordx4 v17, s[12:15], s32 offen offset:1024 nt lds
    buffer_load_dwordx4 v18, s[12:15], s32 offen offset:2048 nt lds
    buffer_load_dwordx4 v19, s[12:15], s32 offen offset:3072 nt lds
    s_mov_b32 m0, 118784
    s_mov_b32 s32, 53248
    buffer_load_dwordx4 v16, s[12:15], s32 offen offset:0 nt lds
    buffer_load_dwordx4 v17, s[12:15], s32 offen offset:1024 nt lds
    buffer_load_dwordx4 v18, s[12:15], s32 offen offset:2048 nt lds
    buffer_load_dwordx4 v19, s[12:15], s32 offen offset:3072 nt lds
    s_mov_b32 m0, 122880
    s_mov_b32 s32, 57344
    buffer_load_dwordx4 v16, s[12:15], s32 offen offset:0 nt lds
    buffer_load_dwordx4 v17, s[12:15], s32 offen offset:1024 nt lds
    buffer_load_dwordx4 v18, s[12:15], s32 offen offset:2048 nt lds
    buffer_load_dwordx4 v19, s[12:15], s32 offen offset:3072 nt lds
    s_mov_b32 m0, 126976
    s_mov_b32 s32, 61440
    buffer_load_dwordx4 v16, s[12:15], s32 offen offset:0 nt lds
    buffer_load_dwordx4 v17, s[12:15], s32 offen offset:1024 nt lds
    buffer_load_dwordx4 v18, s[12:15], s32 offen offset:2048 nt lds
    buffer_load_dwordx4 v19, s[12:15], s32 offen offset:3072 nt lds
    s_mov_b32 s32, 65536
    buffer_load_dwordx4 a[0:3], v8, s[8:11], s32 offen offset:0 nt
    buffer_load_dwordx4 a[4:7], v9, s[8:11], s32 offen offset:1024 nt
    buffer_load_dwordx4 a[8:11], v10, s[8:11], s32 offen offset:2048 nt
    buffer_load_dwordx4 a[12:15], v11, s[8:11], s32 offen offset:3072 nt
    s_mov_b32 s32, 69632
    buffer_load_dwordx4 a[16:19], v12, s[8:11], s32 offen offset:0 nt
    buffer_load_dwordx4 a[20:23], v13, s[8:11], s32 offen offset:1024 nt
    buffer_load_dwordx4 a[24:27], v14, s[8:11], s32 offen offset:2048 nt
    buffer_load_dwordx4 a[28:31], v15, s[8:11], s32 offen offset:3072 nt
    s_mov_b32 s32, 73728
    buffer_load_dwordx4 a[32:35], v8, s[8:11], s32 offen offset:0 nt
    buffer_load_dwordx4 a[36:39], v9, s[8:11], s32 offen offset:1024 nt
    buffer_load_dwordx4 a[40:43], v10, s[8:11], s32 offen offset:2048 nt
    buffer_load_dwordx4 a[44:47], v11, s[8:11], s32 offen offset:3072 nt
    s_mov_b32 s32, 77824
    buffer_load_dwordx4 a[48:51], v12, s[8:11], s32 offen offset:0 nt
    buffer_load_dwordx4 a[52:55], v13, s[8:11], s32 offen offset:1024 nt
    buffer_load_dwordx4 a[56:59], v14, s[8:11], s32 offen offset:2048 nt
    buffer_load_dwordx4 a[60:63], v15, s[8:11], s32 offen offset:3072 nt
    s_barrier
    s_waitcnt vmcnt(47)
    s_mov_b32 s32, 81920
    buffer_load_dwordx4 a[64:67], v8, s[8:11], s32 offen offset:0 nt
    buffer_load_dwordx4 a[68:71], v9, s[8:11], s32 offen offset:1024 nt
    buffer_load_dwordx4 a[72:75], v10, s[8:11], s32 offen offset:2048 nt
    buffer_load_dwordx4 a[76:79], v11, s[8:11], s32 offen offset:3072 nt
    s_mov_b32 s32, 86016
    buffer_load_dwordx4 a[80:83], v12, s[8:11], s32 offen offset:0 nt
    buffer_load_dwordx4 a[84:87], v13, s[8:11], s32 offen offset:1024 nt
    buffer_load_dwordx4 a[88:91], v14, s[8:11], s32 offen offset:2048 nt
    buffer_load_dwordx4 a[92:95], v15, s[8:11], s32 offen offset:3072 nt
    s_mov_b32 s32, 90112
    buffer_load_dwordx4 a[96:99], v8, s[8:11], s32 offen offset:0 nt
    buffer_load_dwordx4 a[100:103], v9, s[8:11], s32 offen offset:1024 nt
    buffer_load_dwordx4 a[104:107], v10, s[8:11], s32 offen offset:2048 nt
    buffer_load_dwordx4 a[108:111], v11, s[8:11], s32 offen offset:3072 nt
    s_mov_b32 s32, 94208
    buffer_load_dwordx4 a[112:115], v12, s[8:11], s32 offen offset:0 nt
    buffer_load_dwordx4 a[116:119], v13, s[8:11], s32 offen offset:1024 nt
    buffer_load_dwordx4 a[120:123], v14, s[8:11], s32 offen offset:2048 nt
    buffer_load_dwordx4 a[124:127], v15, s[8:11], s32 offen offset:3072 nt
    s_barrier
    s_waitcnt vmcnt(47)
    s_mov_b32 s32, 65536
    buffer_load_dwordx4 a[128:131], v16, s[12:15], s32 offen offset:0 nt
    buffer_load_dwordx4 a[132:135], v17, s[12:15], s32 offen offset:1024 nt
    buffer_load_dwordx4 a[136:139], v18, s[12:15], s32 offen offset:2048 nt
    buffer_load_dwordx4 a[140:143], v19, s[12:15], s32 offen offset:3072 nt
    s_mov_b32 s32, 69632
    buffer_load_dwordx4 a[144:147], v16, s[12:15], s32 offen offset:0 nt
    buffer_load_dwordx4 a[148:151], v17, s[12:15], s32 offen offset:1024 nt
    buffer_load_dwordx4 a[152:155], v18, s[12:15], s32 offen offset:2048 nt
    buffer_load_dwordx4 a[156:159], v19, s[12:15], s32 offen offset:3072 nt
    s_mov_b32 s32, 73728
    buffer_load_dwordx4 a[160:163], v16, s[12:15], s32 offen offset:0 nt
    buffer_load_dwordx4 a[164:167], v17, s[12:15], s32 offen offset:1024 nt
    buffer_load_dwordx4 a[168:171], v18, s[12:15], s32 offen offset:2048 nt
    buffer_load_dwordx4 a[172:175], v19, s[12:15], s32 offen offset:3072 nt
    s_mov_b32 s32, 77824
    buffer_load_dwordx4 a[176:179], v16, s[12:15], s32 offen offset:0 nt
    buffer_load_dwordx4 a[180:183], v17, s[12:15], s32 offen offset:1024 nt
    buffer_load_dwordx4 a[184:187], v18, s[12:15], s32 offen offset:2048 nt
    buffer_load_dwordx4 a[188:191], v19, s[12:15], s32 offen offset:3072 nt
    s_barrier
    s_waitcnt vmcnt(32)
    v_add_u32 v33, 0, v32
    ds_write_b128 v33, a[0:3] offset:0
    ds_write_b128 v33, a[4:7] offset:1024
    ds_write_b128 v33, a[8:11] offset:2048
    ds_write_b128 v33, a[12:15] offset:3072
    ds_write_b128 v33, a[16:19] offset:4096
    ds_write_b128 v33, a[20:23] offset:5120
    ds_write_b128 v33, a[24:27] offset:6144
    ds_write_b128 v33, a[28:31] offset:7168
    ds_write_b128 v33, a[32:35] offset:8192
    ds_write_b128 v33, a[36:39] offset:9216
    ds_write_b128 v33, a[40:43] offset:10240
    ds_write_b128 v33, a[44:47] offset:11264
    ds_write_b128 v33, a[48:51] offset:12288
    ds_write_b128 v33, a[52:55] offset:13312
    ds_write_b128 v33, a[56:59] offset:14336
    ds_write_b128 v33, a[60:63] offset:15360
    s_mov_b32 s32, 98304
    buffer_load_dwordx4 a[0:3], v8, s[8:11], s32 offen offset:0 nt
    buffer_load_dwordx4 a[4:7], v9, s[8:11], s32 offen offset:1024 nt
    buffer_load_dwordx4 a[8:11], v10, s[8:11], s32 offen offset:2048 nt
    buffer_load_dwordx4 a[12:15], v11, s[8:11], s32 offen offset:3072 nt
    s_mov_b32 s32, 102400
    buffer_load_dwordx4 a[16:19], v12, s[8:11], s32 offen offset:0 nt
    buffer_load_dwordx4 a[20:23], v13, s[8:11], s32 offen offset:1024 nt
    buffer_load_dwordx4 a[24:27], v14, s[8:11], s32 offen offset:2048 nt
    buffer_load_dwordx4 a[28:31], v15, s[8:11], s32 offen offset:3072 nt
    s_mov_b32 s32, 106496
    buffer_load_dwordx4 a[32:35], v8, s[8:11], s32 offen offset:0 nt
    buffer_load_dwordx4 a[36:39], v9, s[8:11], s32 offen offset:1024 nt
    buffer_load_dwordx4 a[40:43], v10, s[8:11], s32 offen offset:2048 nt
    buffer_load_dwordx4 a[44:47], v11, s[8:11], s32 offen offset:3072 nt
    s_mov_b32 s32, 110592
    buffer_load_dwordx4 a[48:51], v12, s[8:11], s32 offen offset:0 nt
    buffer_load_dwordx4 a[52:55], v13, s[8:11], s32 offen offset:1024 nt
    buffer_load_dwordx4 a[56:59], v14, s[8:11], s32 offen offset:2048 nt
    buffer_load_dwordx4 a[60:63], v15, s[8:11], s32 offen offset:3072 nt
    s_barrier
    s_waitcnt vmcnt(32)
    v_add_u32 v33, 16384, v32
    ds_write_b128 v33, a[64:67] offset:0
    ds_write_b128 v33, a[68:71] offset:1024
    ds_write_b128 v33, a[72:75] offset:2048
    ds_write_b128 v33, a[76:79] offset:3072
    ds_write_b128 v33, a[80:83] offset:4096
    ds_write_b128 v33, a[84:87] offset:5120
    ds_write_b128 v33, a[88:91] offset:6144
    ds_write_b128 v33, a[92:95] offset:7168
    ds_write_b128 v33, a[96:99] offset:8192
    ds_write_b128 v33, a[100:103] offset:9216
    ds_write_b128 v33, a[104:107] offset:10240
    ds_write_b128 v33, a[108:111] offset:11264
    ds_write_b128 v33, a[112:115] offset:12288
    ds_write_b128 v33, a[116:119] offset:13312
    ds_write_b128 v33, a[120:123] offset:14336
    ds_write_b128 v33, a[124:127] offset:15360
    s_waitcnt vmcnt(16)
    v_add_u32 v33, 65536, v32
    ds_write_b128 v33, a[128:131] offset:0
    ds_write_b128 v33, a[132:135] offset:1024
    ds_write_b128 v33, a[136:139] offset:2048
    ds_write_b128 v33, a[140:143] offset:3072
    ds_write_b128 v33, a[144:147] offset:4096
    ds_write_b128 v33, a[148:151] offset:5120
    ds_write_b128 v33, a[152:155] offset:6144
    ds_write_b128 v33, a[156:159] offset:7168
    ds_write_b128 v33, a[160:163] offset:8192
    ds_write_b128 v33, a[164:167] offset:9216
    ds_write_b128 v33, a[168:171] offset:10240
    ds_write_b128 v33, a[172:175] offset:11264
    ds_write_b128 v33, a[176:179] offset:12288
    ds_write_b128 v33, a[180:183] offset:13312
    ds_write_b128 v33, a[184:187] offset:14336
    ds_write_b128 v33, a[188:191] offset:15360
    s_mov_b32 s32, 81920
    buffer_load_dwordx4 a[64:67], v16, s[12:15], s32 offen offset:0 nt
    buffer_load_dwordx4 a[68:71], v17, s[12:15], s32 offen offset:1024 nt
    buffer_load_dwordx4 a[72:75], v18, s[12:15], s32 offen offset:2048 nt
    buffer_load_dwordx4 a[76:79], v19, s[12:15], s32 offen offset:3072 nt
    s_mov_b32 s32, 86016
    buffer_load_dwordx4 a[80:83], v16, s[12:15], s32 offen offset:0 nt
    buffer_load_dwordx4 a[84:87], v17, s[12:15], s32 offen offset:1024 nt
    buffer_load_dwordx4 a[88:91], v18, s[12:15], s32 offen offset:2048 nt
    buffer_load_dwordx4 a[92:95], v19, s[12:15], s32 offen offset:3072 nt
    s_mov_b32 s32, 90112
    buffer_load_dwordx4 a[96:99], v16, s[12:15], s32 offen offset:0 nt
    buffer_load_dwordx4 a[100:103], v17, s[12:15], s32 offen offset:1024 nt
    buffer_load_dwordx4 a[104:107], v18, s[12:15], s32 offen offset:2048 nt
    buffer_load_dwordx4 a[108:111], v19, s[12:15], s32 offen offset:3072 nt
    s_mov_b32 s32, 94208
    buffer_load_dwordx4 a[112:115], v16, s[12:15], s32 offen offset:0 nt
    buffer_load_dwordx4 a[116:119], v17, s[12:15], s32 offen offset:1024 nt
    buffer_load_dwordx4 a[120:123], v18, s[12:15], s32 offen offset:2048 nt
    buffer_load_dwordx4 a[124:127], v19, s[12:15], s32 offen offset:3072 nt
    s_mov_b32 s32, 114688
    buffer_load_dwordx4 a[128:131], v8, s[8:11], s32 offen offset:0 nt
    buffer_load_dwordx4 a[132:135], v9, s[8:11], s32 offen offset:1024 nt
    buffer_load_dwordx4 a[136:139], v10, s[8:11], s32 offen offset:2048 nt
    buffer_load_dwordx4 a[140:143], v11, s[8:11], s32 offen offset:3072 nt
    s_mov_b32 s32, 118784
    buffer_load_dwordx4 a[144:147], v12, s[8:11], s32 offen offset:0 nt
    buffer_load_dwordx4 a[148:151], v13, s[8:11], s32 offen offset:1024 nt
    buffer_load_dwordx4 a[152:155], v14, s[8:11], s32 offen offset:2048 nt
    buffer_load_dwordx4 a[156:159], v15, s[8:11], s32 offen offset:3072 nt
    s_mov_b32 s32, 122880
    buffer_load_dwordx4 a[160:163], v8, s[8:11], s32 offen offset:0 nt
    buffer_load_dwordx4 a[164:167], v9, s[8:11], s32 offen offset:1024 nt
    buffer_load_dwordx4 a[168:171], v10, s[8:11], s32 offen offset:2048 nt
    buffer_load_dwordx4 a[172:175], v11, s[8:11], s32 offen offset:3072 nt
    s_mov_b32 s32, 126976
    buffer_load_dwordx4 a[176:179], v12, s[8:11], s32 offen offset:0 nt
    buffer_load_dwordx4 a[180:183], v13, s[8:11], s32 offen offset:1024 nt
    buffer_load_dwordx4 a[184:187], v14, s[8:11], s32 offen offset:2048 nt
    buffer_load_dwordx4 a[188:191], v15, s[8:11], s32 offen offset:3072 nt
    s_waitcnt lgkmcnt(0)
    s_barrier
    s_waitcnt vmcnt(32)
    v_add_u32 v33, 32768, v32
    ds_write_b128 v33, a[0:3] offset:0
    ds_write_b128 v33, a[4:7] offset:1024
    ds_write_b128 v33, a[8:11] offset:2048
    ds_write_b128 v33, a[12:15] offset:3072
    ds_write_b128 v33, a[16:19] offset:4096
    ds_write_b128 v33, a[20:23] offset:5120
    ds_write_b128 v33, a[24:27] offset:6144
    ds_write_b128 v33, a[28:31] offset:7168
    ds_write_b128 v33, a[32:35] offset:8192
    ds_write_b128 v33, a[36:39] offset:9216
    ds_write_b128 v33, a[40:43] offset:10240
    ds_write_b128 v33, a[44:47] offset:11264
    ds_write_b128 v33, a[48:51] offset:12288
    ds_write_b128 v33, a[52:55] offset:13312
    ds_write_b128 v33, a[56:59] offset:14336
    ds_write_b128 v33, a[60:63] offset:15360
    s_mov_b32 s32, 98304
    buffer_load_dwordx4 a[0:3], v16, s[12:15], s32 offen offset:0 nt
    buffer_load_dwordx4 a[4:7], v17, s[12:15], s32 offen offset:1024 nt
    buffer_load_dwordx4 a[8:11], v18, s[12:15], s32 offen offset:2048 nt
    buffer_load_dwordx4 a[12:15], v19, s[12:15], s32 offen offset:3072 nt
    s_mov_b32 s32, 102400
    buffer_load_dwordx4 a[16:19], v16, s[12:15], s32 offen offset:0 nt
    buffer_load_dwordx4 a[20:23], v17, s[12:15], s32 offen offset:1024 nt
    buffer_load_dwordx4 a[24:27], v18, s[12:15], s32 offen offset:2048 nt
    buffer_load_dwordx4 a[28:31], v19, s[12:15], s32 offen offset:3072 nt
    s_mov_b32 s32, 106496
    buffer_load_dwordx4 a[32:35], v16, s[12:15], s32 offen offset:0 nt
    buffer_load_dwordx4 a[36:39], v17, s[12:15], s32 offen offset:1024 nt
    buffer_load_dwordx4 a[40:43], v18, s[12:15], s32 offen offset:2048 nt
    buffer_load_dwordx4 a[44:47], v19, s[12:15], s32 offen offset:3072 nt
    s_mov_b32 s32, 110592
    buffer_load_dwordx4 a[48:51], v16, s[12:15], s32 offen offset:0 nt
    buffer_load_dwordx4 a[52:55], v17, s[12:15], s32 offen offset:1024 nt
    buffer_load_dwordx4 a[56:59], v18, s[12:15], s32 offen offset:2048 nt
    buffer_load_dwordx4 a[60:63], v19, s[12:15], s32 offen offset:3072 nt
    s_waitcnt lgkmcnt(0)
    s_barrier
    s_waitcnt vmcnt(32)
    v_add_u32 v33, 81920, v32
    ds_write_b128 v33, a[64:67] offset:0
    ds_write_b128 v33, a[68:71] offset:1024
    ds_write_b128 v33, a[72:75] offset:2048
    ds_write_b128 v33, a[76:79] offset:3072
    ds_write_b128 v33, a[80:83] offset:4096
    ds_write_b128 v33, a[84:87] offset:5120
    ds_write_b128 v33, a[88:91] offset:6144
    ds_write_b128 v33, a[92:95] offset:7168
    ds_write_b128 v33, a[96:99] offset:8192
    ds_write_b128 v33, a[100:103] offset:9216
    ds_write_b128 v33, a[104:107] offset:10240
    ds_write_b128 v33, a[108:111] offset:11264
    ds_write_b128 v33, a[112:115] offset:12288
    ds_write_b128 v33, a[116:119] offset:13312
    ds_write_b128 v33, a[120:123] offset:14336
    ds_write_b128 v33, a[124:127] offset:15360
    s_waitcnt vmcnt(16)
    v_add_u32 v33, 49152, v32
    ds_write_b128 v33, a[128:131] offset:0
    ds_write_b128 v33, a[132:135] offset:1024
    ds_write_b128 v33, a[136:139] offset:2048
    ds_write_b128 v33, a[140:143] offset:3072
    ds_write_b128 v33, a[144:147] offset:4096
    ds_write_b128 v33, a[148:151] offset:5120
    ds_write_b128 v33, a[152:155] offset:6144
    ds_write_b128 v33, a[156:159] offset:7168
    ds_write_b128 v33, a[160:163] offset:8192
    ds_write_b128 v33, a[164:167] offset:9216
    ds_write_b128 v33, a[168:171] offset:10240
    ds_write_b128 v33, a[172:175] offset:11264
    ds_write_b128 v33, a[176:179] offset:12288
    ds_write_b128 v33, a[180:183] offset:13312
    ds_write_b128 v33, a[184:187] offset:14336
    ds_write_b128 v33, a[188:191] offset:15360
    s_mov_b32 s32, 131072
    buffer_load_dwordx4 a[64:67], v8, s[8:11], s32 offen offset:0 nt
    buffer_load_dwordx4 a[68:71], v9, s[8:11], s32 offen offset:1024 nt
    buffer_load_dwordx4 a[72:75], v10, s[8:11], s32 offen offset:2048 nt
    buffer_load_dwordx4 a[76:79], v11, s[8:11], s32 offen offset:3072 nt
    s_mov_b32 s32, 135168
    buffer_load_dwordx4 a[80:83], v12, s[8:11], s32 offen offset:0 nt
    buffer_load_dwordx4 a[84:87], v13, s[8:11], s32 offen offset:1024 nt
    buffer_load_dwordx4 a[88:91], v14, s[8:11], s32 offen offset:2048 nt
    buffer_load_dwordx4 a[92:95], v15, s[8:11], s32 offen offset:3072 nt
    s_mov_b32 s32, 139264
    buffer_load_dwordx4 a[96:99], v8, s[8:11], s32 offen offset:0 nt
    buffer_load_dwordx4 a[100:103], v9, s[8:11], s32 offen offset:1024 nt
    buffer_load_dwordx4 a[104:107], v10, s[8:11], s32 offen offset:2048 nt
    buffer_load_dwordx4 a[108:111], v11, s[8:11], s32 offen offset:3072 nt
    s_mov_b32 s32, 143360
    buffer_load_dwordx4 a[112:115], v12, s[8:11], s32 offen offset:0 nt
    buffer_load_dwordx4 a[116:119], v13, s[8:11], s32 offen offset:1024 nt
    buffer_load_dwordx4 a[120:123], v14, s[8:11], s32 offen offset:2048 nt
    buffer_load_dwordx4 a[124:127], v15, s[8:11], s32 offen offset:3072 nt
    s_mov_b32 s32, 114688
    buffer_load_dwordx4 a[128:131], v16, s[12:15], s32 offen offset:0 nt
    buffer_load_dwordx4 a[132:135], v17, s[12:15], s32 offen offset:1024 nt
    buffer_load_dwordx4 a[136:139], v18, s[12:15], s32 offen offset:2048 nt
    buffer_load_dwordx4 a[140:143], v19, s[12:15], s32 offen offset:3072 nt
    s_mov_b32 s32, 118784
    buffer_load_dwordx4 a[144:147], v16, s[12:15], s32 offen offset:0 nt
    buffer_load_dwordx4 a[148:151], v17, s[12:15], s32 offen offset:1024 nt
    buffer_load_dwordx4 a[152:155], v18, s[12:15], s32 offen offset:2048 nt
    buffer_load_dwordx4 a[156:159], v19, s[12:15], s32 offen offset:3072 nt
    s_mov_b32 s32, 122880
    buffer_load_dwordx4 a[160:163], v16, s[12:15], s32 offen offset:0 nt
    buffer_load_dwordx4 a[164:167], v17, s[12:15], s32 offen offset:1024 nt
    buffer_load_dwordx4 a[168:171], v18, s[12:15], s32 offen offset:2048 nt
    buffer_load_dwordx4 a[172:175], v19, s[12:15], s32 offen offset:3072 nt
    s_mov_b32 s32, 126976
    buffer_load_dwordx4 a[176:179], v16, s[12:15], s32 offen offset:0 nt
    buffer_load_dwordx4 a[180:183], v17, s[12:15], s32 offen offset:1024 nt
    buffer_load_dwordx4 a[184:187], v18, s[12:15], s32 offen offset:2048 nt
    buffer_load_dwordx4 a[188:191], v19, s[12:15], s32 offen offset:3072 nt
    s_waitcnt lgkmcnt(0)
    s_barrier
    s_waitcnt vmcnt(32)
    v_add_u32 v33, 98304, v32
    ds_write_b128 v33, a[0:3] offset:0
    ds_write_b128 v33, a[4:7] offset:1024
    ds_write_b128 v33, a[8:11] offset:2048
    ds_write_b128 v33, a[12:15] offset:3072
    ds_write_b128 v33, a[16:19] offset:4096
    ds_write_b128 v33, a[20:23] offset:5120
    ds_write_b128 v33, a[24:27] offset:6144
    ds_write_b128 v33, a[28:31] offset:7168
    ds_write_b128 v33, a[32:35] offset:8192
    ds_write_b128 v33, a[36:39] offset:9216
    ds_write_b128 v33, a[40:43] offset:10240
    ds_write_b128 v33, a[44:47] offset:11264
    ds_write_b128 v33, a[48:51] offset:12288
    ds_write_b128 v33, a[52:55] offset:13312
    ds_write_b128 v33, a[56:59] offset:14336
    ds_write_b128 v33, a[60:63] offset:15360
    s_mov_b32 s32, 147456
    buffer_load_dwordx4 a[0:3], v8, s[8:11], s32 offen offset:0 nt
    buffer_load_dwordx4 a[4:7], v9, s[8:11], s32 offen offset:1024 nt
    buffer_load_dwordx4 a[8:11], v10, s[8:11], s32 offen offset:2048 nt
    buffer_load_dwordx4 a[12:15], v11, s[8:11], s32 offen offset:3072 nt
    s_mov_b32 s32, 151552
    buffer_load_dwordx4 a[16:19], v12, s[8:11], s32 offen offset:0 nt
    buffer_load_dwordx4 a[20:23], v13, s[8:11], s32 offen offset:1024 nt
    buffer_load_dwordx4 a[24:27], v14, s[8:11], s32 offen offset:2048 nt
    buffer_load_dwordx4 a[28:31], v15, s[8:11], s32 offen offset:3072 nt
    s_mov_b32 s32, 155648
    buffer_load_dwordx4 a[32:35], v8, s[8:11], s32 offen offset:0 nt
    buffer_load_dwordx4 a[36:39], v9, s[8:11], s32 offen offset:1024 nt
    buffer_load_dwordx4 a[40:43], v10, s[8:11], s32 offen offset:2048 nt
    buffer_load_dwordx4 a[44:47], v11, s[8:11], s32 offen offset:3072 nt
    s_mov_b32 s32, 159744
    buffer_load_dwordx4 a[48:51], v12, s[8:11], s32 offen offset:0 nt
    buffer_load_dwordx4 a[52:55], v13, s[8:11], s32 offen offset:1024 nt
    buffer_load_dwordx4 a[56:59], v14, s[8:11], s32 offen offset:2048 nt
    buffer_load_dwordx4 a[60:63], v15, s[8:11], s32 offen offset:3072 nt
    s_waitcnt lgkmcnt(0)
    s_barrier
    s_waitcnt vmcnt(32)
    v_add_u32 v33, 0, v32
    ds_write_b128 v33, a[64:67] offset:0
    ds_write_b128 v33, a[68:71] offset:1024
    ds_write_b128 v33, a[72:75] offset:2048
    ds_write_b128 v33, a[76:79] offset:3072
    ds_write_b128 v33, a[80:83] offset:4096
    ds_write_b128 v33, a[84:87] offset:5120
    ds_write_b128 v33, a[88:91] offset:6144
    ds_write_b128 v33, a[92:95] offset:7168
    ds_write_b128 v33, a[96:99] offset:8192
    ds_write_b128 v33, a[100:103] offset:9216
    ds_write_b128 v33, a[104:107] offset:10240
    ds_write_b128 v33, a[108:111] offset:11264
    ds_write_b128 v33, a[112:115] offset:12288
    ds_write_b128 v33, a[116:119] offset:13312
    ds_write_b128 v33, a[120:123] offset:14336
    ds_write_b128 v33, a[124:127] offset:15360
    s_waitcnt vmcnt(16)
    v_add_u32 v33, 114688, v32
    ds_write_b128 v33, a[128:131] offset:0
    ds_write_b128 v33, a[132:135] offset:1024
    ds_write_b128 v33, a[136:139] offset:2048
    ds_write_b128 v33, a[140:143] offset:3072
    ds_write_b128 v33, a[144:147] offset:4096
    ds_write_b128 v33, a[148:151] offset:5120
    ds_write_b128 v33, a[152:155] offset:6144
    ds_write_b128 v33, a[156:159] offset:7168
    ds_write_b128 v33, a[160:163] offset:8192
    ds_write_b128 v33, a[164:167] offset:9216
    ds_write_b128 v33, a[168:171] offset:10240
    ds_write_b128 v33, a[172:175] offset:11264
    ds_write_b128 v33, a[176:179] offset:12288
    ds_write_b128 v33, a[180:183] offset:13312
    ds_write_b128 v33, a[184:187] offset:14336
    ds_write_b128 v33, a[188:191] offset:15360
    s_cmp_lt_u32 s53, 1
    s_cbranch_scc1 L_cls1
    s_waitcnt vmcnt(23)
L_cls1:
    s_mov_b32 m0, 65536
    s_mov_b32 s32, 131072
    buffer_load_dwordx4 v16, s[12:15], s32 offen offset:0 nt lds
    buffer_load_dwordx4 v17, s[12:15], s32 offen offset:1024 nt lds
    buffer_load_dwordx4 v18, s[12:15], s32 offen offset:2048 nt lds
    buffer_load_dwordx4 v19, s[12:15], s32 offen offset:3072 nt lds
    s_mov_b32 m0, 69632
    s_mov_b32 s32, 135168
    buffer_load_dwordx4 v16, s[12:15], s32 offen offset:0 nt lds
    buffer_load_dwordx4 v17, s[12:15], s32 offen offset:1024 nt lds
    buffer_load_dwordx4 v18, s[12:15], s32 offen offset:2048 nt lds
    buffer_load_dwordx4 v19, s[12:15], s32 offen offset:3072 nt lds
    s_mov_b32 m0, 73728
    s_mov_b32 s32, 139264
    buffer_load_dwordx4 v16, s[12:15], s32 offen offset:0 nt lds
    buffer_load_dwordx4 v17, s[12:15], s32 offen offset:1024 nt lds
    buffer_load_dwordx4 v18, s[12:15], s32 offen offset:2048 nt lds
    buffer_load_dwordx4 v19, s[12:15], s32 offen offset:3072 nt lds
    s_mov_b32 m0, 77824
    s_mov_b32 s32, 143360
    buffer_load_dwordx4 v16, s[12:15], s32 offen offset:0 nt lds
    buffer_load_dwordx4 v17, s[12:15], s32 offen offset:1024 nt lds
    buffer_load_dwordx4 v18, s[12:15], s32 offen offset:2048 nt lds
    buffer_load_dwordx4 v19, s[12:15], s32 offen offset:3072 nt lds
    s_mov_b32 s32, 163840
    buffer_load_dwordx4 a[64:67], v8, s[8:11], s32 offen offset:0 nt
    buffer_load_dwordx4 a[68:71], v9, s[8:11], s32 offen offset:1024 nt
    buffer_load_dwordx4 a[72:75], v10, s[8:11], s32 offen offset:2048 nt
    buffer_load_dwordx4 a[76:79], v11, s[8:11], s32 offen offset:3072 nt
    s_mov_b32 s32, 167936
    buffer_load_dwordx4 a[80:83], v12, s[8:11], s32 offen offset:0 nt
    buffer_load_dwordx4 a[84:87], v13, s[8:11], s32 offen offset:1024 nt
    buffer_load_dwordx4 a[88:91], v14, s[8:11], s32 offen offset:2048 nt
    buffer_load_dwordx4 a[92:95], v15, s[8:11], s32 offen offset:3072 nt
    s_mov_b32 s32, 172032
    buffer_load_dwordx4 a[96:99], v8, s[8:11], s32 offen offset:0 nt
    buffer_load_dwordx4 a[100:103], v9, s[8:11], s32 offen offset:1024 nt
    buffer_load_dwordx4 a[104:107], v10, s[8:11], s32 offen offset:2048 nt
    buffer_load_dwordx4 a[108:111], v11, s[8:11], s32 offen offset:3072 nt
    s_mov_b32 s32, 176128
    buffer_load_dwordx4 a[112:115], v12, s[8:11], s32 offen offset:0 nt
    buffer_load_dwordx4 a[116:119], v13, s[8:11], s32 offen offset:1024 nt
    buffer_load_dwordx4 a[120:123], v14, s[8:11], s32 offen offset:2048 nt
    buffer_load_dwordx4 a[124:127], v15, s[8:11], s32 offen offset:3072 nt
    s_waitcnt lgkmcnt(0)
    s_barrier
    s_waitcnt vmcnt(32)
    v_add_u32 v33, 16384, v32
    ds_write_b128 v33, a[0:3] offset:0
    ds_write_b128 v33, a[4:7] offset:1024
    ds_write_b128 v33, a[8:11] offset:2048
    ds_write_b128 v33, a[12:15] offset:3072
    ds_write_b128 v33, a[16:19] offset:4096
    ds_write_b128 v33, a[20:23] offset:5120
    ds_write_b128 v33, a[24:27] offset:6144
    ds_write_b128 v33, a[28:31] offset:7168
    ds_write_b128 v33, a[32:35] offset:8192
    ds_write_b128 v33, a[36:39] offset:9216
    ds_write_b128 v33, a[40:43] offset:10240
    ds_write_b128 v33, a[44:47] offset:11264
    ds_write_b128 v33, a[48:51] offset:12288
    ds_write_b128 v33, a[52:55] offset:13312
    ds_write_b128 v33, a[56:59] offset:14336
    ds_write_b128 v33, a[60:63] offset:15360
    s_cmp_lt_u32 s53, 1
    s_cbranch_scc1 L_cls2
    s_waitcnt vmcnt(23)
L_cls2:
    s_mov_b32 m0, 81920
    s_mov_b32 s32, 147456
    buffer_load_dwordx4 v16, s[12:15], s32 offen offset:0 nt lds
    buffer_load_dwordx4 v17, s[12:15], s32 offen offset:1024 nt lds
    buffer_load_dwordx4 v18, s[12:15], s32 offen offset:2048 nt lds
    buffer_load_dwordx4 v19, s[12:15], s32 offen offset:3072 nt lds
    s_mov_b32 m0, 86016
    s_mov_b32 s32, 151552
    buffer_load_dwordx4 v16, s[12:15], s32 offen offset:0 nt lds
    buffer_load_dwordx4 v17, s[12:15], s32 offen offset:1024 nt lds
    buffer_load_dwordx4 v18, s[12:15], s32 offen offset:2048 nt lds
    buffer_load_dwordx4 v19, s[12:15], s32 offen offset:3072 nt lds
    s_mov_b32 m0, 90112
    s_mov_b32 s32, 155648
    buffer_load_dwordx4 v16, s[12:15], s32 offen offset:0 nt lds
    buffer_load_dwordx4 v17, s[12:15], s32 offen offset:1024 nt lds
    buffer_load_dwordx4 v18, s[12:15], s32 offen offset:2048 nt lds
    buffer_load_dwordx4 v19, s[12:15], s32 offen offset:3072 nt lds
    s_mov_b32 m0, 94208
    s_mov_b32 s32, 159744
    buffer_load_dwordx4 v16, s[12:15], s32 offen offset:0 nt lds
    buffer_load_dwordx4 v17, s[12:15], s32 offen offset:1024 nt lds
    buffer_load_dwordx4 v18, s[12:15], s32 offen offset:2048 nt lds
    buffer_load_dwordx4 v19, s[12:15], s32 offen offset:3072 nt lds
    s_waitcnt lgkmcnt(0)
    s_barrier
    s_waitcnt vmcnt(16)
    v_add_u32 v33, 32768, v32
    ds_write_b128 v33, a[64:67] offset:0
    ds_write_b128 v33, a[68:71] offset:1024
    ds_write_b128 v33, a[72:75] offset:2048
    ds_write_b128 v33, a[76:79] offset:3072
    ds_write_b128 v33, a[80:83] offset:4096
    ds_write_b128 v33, a[84:87] offset:5120
    ds_write_b128 v33, a[88:91] offset:6144
    ds_write_b128 v33, a[92:95] offset:7168
    ds_write_b128 v33, a[96:99] offset:8192
    ds_write_b128 v33, a[100:103] offset:9216
    ds_write_b128 v33, a[104:107] offset:10240
    ds_write_b128 v33, a[108:111] offset:11264
    ds_write_b128 v33, a[112:115] offset:12288
    ds_write_b128 v33, a[116:119] offset:13312
    ds_write_b128 v33, a[120:123] offset:14336
    ds_write_b128 v33, a[124:127] offset:15360
    s_cmp_lt_u32 s53, 1
    s_cbranch_scc1 L_cls3
    s_waitcnt vmcnt(23)
L_cls3:
    s_mov_b32 m0, 49152
    s_mov_b32 s32, 180224
    buffer_load_dwordx4 v8, s[8:11], s32 offen offset:0 nt lds
    buffer_load_dwordx4 v9, s[8:11], s32 offen offset:1024 nt lds
    buffer_load_dwordx4 v10, s[8:11], s32 offen offset:2048 nt lds
    buffer_load_dwordx4 v11, s[8:11], s32 offen offset:3072 nt lds
    s_mov_b32 m0, 53248
    s_mov_b32 s32, 184320
    buffer_load_dwordx4 v12, s[8:11], s32 offen offset:0 nt lds
    buffer_load_dwordx4 v13, s[8:11], s32 offen offset:1024 nt lds
    buffer_load_dwordx4 v14, s[8:11], s32 offen offset:2048 nt lds
    buffer_load_dwordx4 v15, s[8:11], s32 offen offset:3072 nt lds
    s_mov_b32 m0, 57344
    s_mov_b32 s32, 188416
    buffer_load_dwordx4 v8, s[8:11], s32 offen offset:0 nt lds
    buffer_load_dwordx4 v9, s[8:11], s32 offen offset:1024 nt lds
    buffer_load_dwordx4 v10, s[8:11], s32 offen offset:2048 nt lds
    buffer_load_dwordx4 v11, s[8:11], s32 offen offset:3072 nt lds
    s_mov_b32 m0, 61440
    s_mov_b32 s32, 192512
    buffer_load_dwordx4 v12, s[8:11], s32 offen offset:0 nt lds
    buffer_load_dwordx4 v13, s[8:11], s32 offen offset:1024 nt lds
    buffer_load_dwordx4 v14, s[8:11], s32 offen offset:2048 nt lds
    buffer_load_dwordx4 v15, s[8:11], s32 offen offset:3072 nt lds
    s_cmp_lt_u32 s53, 1
    s_cbranch_scc1 L_cls4
    s_waitcnt vmcnt(23)
L_cls4:
    s_mov_b32 m0, 98304
    s_mov_b32 s32, 163840
    buffer_load_dwordx4 v16, s[12:15], s32 offen offset:0 nt lds
    buffer_load_dwordx4 v17, s[12:15], s32 offen offset:1024 nt lds
    buffer_load_dwordx4 v18, s[12:15], s32 offen offset:2048 nt lds
    buffer_load_dwordx4 v19, s[12:15], s32 offen offset:3072 nt lds
    s_mov_b32 m0, 102400
    s_mov_b32 s32, 167936
    buffer_load_dwordx4 v16, s[12:15], s32 offen offset:0 nt lds
    buffer_load_dwordx4 v17, s[12:15], s32 offen offset:1024 nt lds
    buffer_load_dwordx4 v18, s[12:15], s32 offen offset:2048 nt lds
    buffer_load_dwordx4 v19, s[12:15], s32 offen offset:3072 nt lds
    s_mov_b32 m0, 106496
    s_mov_b32 s32, 172032
    buffer_load_dwordx4 v16, s[12:15], s32 offen offset:0 nt lds
    buffer_load_dwordx4 v17, s[12:15], s32 offen offset:1024 nt lds
    buffer_load_dwordx4 v18, s[12:15], s32 offen offset:2048 nt lds
    buffer_load_dwordx4 v19, s[12:15], s32 offen offset:3072 nt lds
    s_mov_b32 m0, 110592
    s_mov_b32 s32, 176128
    buffer_load_dwordx4 v16, s[12:15], s32 offen offset:0 nt lds
    buffer_load_dwordx4 v17, s[12:15], s32 offen offset:1024 nt lds
    buffer_load_dwordx4 v18, s[12:15], s32 offen offset:2048 nt lds
    buffer_load_dwordx4 v19, s[12:15], s32 offen offset:3072 nt lds
    s_waitcnt lgkmcnt(0)
    s_barrier
    s_waitcnt vmcnt(47)
    s_cmp_lt_u32 s53, 1
    s_cbranch_scc1 L_cls5
    s_waitcnt vmcnt(23)
L_cls5:
    s_mov_b32 m0, 0
    s_mov_b32 s32, 196608
    buffer_load_dwordx4 v8, s[8:11], s32 offen offset:0 nt lds
    buffer_load_dwordx4 v9, s[8:11], s32 offen offset:1024 nt lds
    buffer_load_dwordx4 v10, s[8:11], s32 offen offset:2048 nt lds
    buffer_load_dwordx4 v11, s[8:11], s32 offen offset:3072 nt lds
    s_mov_b32 m0, 4096
    s_mov_b32 s32, 200704
    buffer_load_dwordx4 v12, s[8:11], s32 offen offset:0 nt lds
    buffer_load_dwordx4 v13, s[8:11], s32 offen offset:1024 nt lds
    buffer_load_dwordx4 v14, s[8:11], s32 offen offset:2048 nt lds
    buffer_load_dwordx4 v15, s[8:11], s32 offen offset:3072 nt lds
    s_mov_b32 m0, 8192
    s_mov_b32 s32, 204800
    buffer_load_dwordx4 v8, s[8:11], s32 offen offset:0 nt lds
    buffer_load_dwordx4 v9, s[8:11], s32 offen offset:1024 nt lds
    buffer_load_dwordx4 v10, s[8:11], s32 offen offset:2048 nt lds
    buffer_load_dwordx4 v11, s[8:11], s32 offen offset:3072 nt lds
    s_mov_b32 m0, 12288
    s_mov_b32 s32, 208896
    buffer_load_dwordx4 v12, s[8:11], s32 offen offset:0 nt lds
    buffer_load_dwordx4 v13, s[8:11], s32 offen offset:1024 nt lds
    buffer_load_dwordx4 v14, s[8:11], s32 offen offset:2048 nt lds
    buffer_load_dwordx4 v15, s[8:11], s32 offen offset:3072 nt lds
    s_waitcnt vmcnt(47)
    s_cmp_lt_u32 s53, 1
    s_cbranch_scc1 L_cls6
    s_waitcnt vmcnt(23)
L_cls6:
    s_mov_b32 m0, 114688
    s_mov_b32 s32, 180224
    buffer_load_dwordx4 v16, s[12:15], s32 offen offset:0 nt lds
    buffer_load_dwordx4 v17, s[12:15], s32 offen offset:1024 nt lds
    buffer_load_dwordx4 v18, s[12:15], s32 offen offset:2048 nt lds
    buffer_load_dwordx4 v19, s[12:15], s32 offen offset:3072 nt lds
    s_mov_b32 m0, 118784
    s_mov_b32 s32, 184320
    buffer_load_dwordx4 v16, s[12:15], s32 offen offset:0 nt lds
    buffer_load_dwordx4 v17, s[12:15], s32 offen offset:1024 nt lds
    buffer_load_dwordx4 v18, s[12:15], s32 offen offset:2048 nt lds
    buffer_load_dwordx4 v19, s[12:15], s32 offen offset:3072 nt lds
    s_mov_b32 m0, 122880
    s_mov_b32 s32, 188416
    buffer_load_dwordx4 v16, s[12:15], s32 offen offset:0 nt lds
    buffer_load_dwordx4 v17, s[12:15], s32 offen offset:1024 nt lds
    buffer_load_dwordx4 v18, s[12:15], s32 offen offset:2048 nt lds
    buffer_load_dwordx4 v19, s[12:15], s32 offen offset:3072 nt lds
    s_mov_b32 m0, 126976
    s_mov_b32 s32, 192512
    buffer_load_dwordx4 v16, s[12:15], s32 offen offset:0 nt lds
    buffer_load_dwordx4 v17, s[12:15], s32 offen offset:1024 nt lds
    buffer_load_dwordx4 v18, s[12:15], s32 offen offset:2048 nt lds
    buffer_load_dwordx4 v19, s[12:15], s32 offen offset:3072 nt lds
    s_waitcnt vmcnt(48)
    s_barrier
    s_waitcnt vmcnt(47)
    s_cmp_lt_u32 s53, 1
    s_cbranch_scc1 L_cls7
    s_waitcnt vmcnt(23)
L_cls7:
    s_mov_b32 m0, 16384
    s_mov_b32 s32, 212992
    buffer_load_dwordx4 v8, s[8:11], s32 offen offset:0 nt lds
    buffer_load_dwordx4 v9, s[8:11], s32 offen offset:1024 nt lds
    buffer_load_dwordx4 v10, s[8:11], s32 offen offset:2048 nt lds
    buffer_load_dwordx4 v11, s[8:11], s32 offen offset:3072 nt lds
    s_mov_b32 m0, 20480
    s_mov_b32 s32, 217088
    buffer_load_dwordx4 v12, s[8:11], s32 offen offset:0 nt lds
    buffer_load_dwordx4 v13, s[8:11], s32 offen offset:1024 nt lds
    buffer_load_dwordx4 v14, s[8:11], s32 offen offset:2048 nt lds
    buffer_load_dwordx4 v15, s[8:11], s32 offen offset:3072 nt lds
    s_mov_b32 m0, 24576
    s_mov_b32 s32, 221184
    buffer_load_dwordx4 v8, s[8:11], s32 offen offset:0 nt lds
    buffer_load_dwordx4 v9, s[8:11], s32 offen offset:1024 nt lds
    buffer_load_dwordx4 v10, s[8:11], s32 offen offset:2048 nt lds
    buffer_load_dwordx4 v11, s[8:11], s32 offen offset:3072 nt lds
    s_mov_b32 m0, 28672
    s_mov_b32 s32, 225280
    buffer_load_dwordx4 v12, s[8:11], s32 offen offset:0 nt lds
    buffer_load_dwordx4 v13, s[8:11], s32 offen offset:1024 nt lds
    buffer_load_dwordx4 v14, s[8:11], s32 offen offset:2048 nt lds
    buffer_load_dwordx4 v15, s[8:11], s32 offen offset:3072 nt lds
    s_waitcnt vmcnt(47)
    s_cmp_lt_u32 s53, 1
    s_cbranch_scc1 L_cls8
    s_waitcnt vmcnt(23)
L_cls8:
    s_mov_b32 m0, 65536
    s_mov_b32 s32, 196608
    buffer_load_dwordx4 v16, s[12:15], s32 offen offset:0 nt lds
    buffer_load_dwordx4 v17, s[12:15], s32 offen offset:1024 nt lds
    buffer_load_dwordx4 v18, s[12:15], s32 offen offset:2048 nt lds
    buffer_load_dwordx4 v19, s[12:15], s32 offen offset:3072 nt lds
    s_mov_b32 m0, 69632
    s_mov_b32 s32, 200704
    buffer_load_dwordx4 v16, s[12:15], s32 offen offset:0 nt lds
    buffer_load_dwordx4 v17, s[12:15], s32 offen offset:1024 nt lds
    buffer_load_dwordx4 v18, s[12:15], s32 offen offset:2048 nt lds
    buffer_load_dwordx4 v19, s[12:15], s32 offen offset:3072 nt lds
    s_mov_b32 m0, 73728
    s_mov_b32 s32, 204800
    buffer_load_dwordx4 v16, s[12:15], s32 offen offset:0 nt lds
    buffer_load_dwordx4 v17, s[12:15], s32 offen offset:1024 nt lds
    buffer_load_dwordx4 v18, s[12:15], s32 offen offset:2048 nt lds
    buffer_load_dwordx4 v19, s[12:15], s32 offen offset:3072 nt lds
    s_mov_b32 m0, 77824
    s_mov_b32 s32, 208896
    buffer_load_dwordx4 v16, s[12:15], s32 offen offset:0 nt lds
    buffer_load_dwordx4 v17, s[12:15], s32 offen offset:1024 nt lds
    buffer_load_dwordx4 v18, s[12:15], s32 offen offset:2048 nt lds
    buffer_load_dwordx4 v19, s[12:15], s32 offen offset:3072 nt lds
    s_waitcnt vmcnt(48)
    s_barrier
    s_waitcnt vmcnt(47)
    s_cmp_lt_u32 s53, 1
    s_cbranch_scc1 L_cls9
    s_waitcnt vmcnt(23)
L_cls9:
    s_mov_b32 m0, 32768
    s_mov_b32 s32, 229376
    buffer_load_dwordx4 v8, s[8:11], s32 offen offset:0 nt lds
    buffer_load_dwordx4 v9, s[8:11], s32 offen offset:1024 nt lds
    buffer_load_dwordx4 v10, s[8:11], s32 offen offset:2048 nt lds
    buffer_load_dwordx4 v11, s[8:11], s32 offen offset:3072 nt lds
    s_mov_b32 m0, 36864
    s_mov_b32 s32, 233472
    buffer_load_dwordx4 v12, s[8:11], s32 offen offset:0 nt lds
    buffer_load_dwordx4 v13, s[8:11], s32 offen offset:1024 nt lds
    buffer_load_dwordx4 v14, s[8:11], s32 offen offset:2048 nt lds
    buffer_load_dwordx4 v15, s[8:11], s32 offen offset:3072 nt lds
    s_mov_b32 m0, 40960
    s_mov_b32 s32, 237568
    buffer_load_dwordx4 v8, s[8:11], s32 offen offset:0 nt lds
    buffer_load_dwordx4 v9, s[8:11], s32 offen offset:1024 nt lds
    buffer_load_dwordx4 v10, s[8:11], s32 offen offset:2048 nt lds
    buffer_load_dwordx4 v11, s[8:11], s32 offen offset:3072 nt lds
    s_mov_b32 m0, 45056
    s_mov_b32 s32, 241664
    buffer_load_dwordx4 v12, s[8:11], s32 offen offset:0 nt lds
    buffer_load_dwordx4 v13, s[8:11], s32 offen offset:1024 nt lds
    buffer_load_dwordx4 v14, s[8:11], s32 offen offset:2048 nt lds
    buffer_load_dwordx4 v15, s[8:11], s32 offen offset:3072 nt lds
    s_waitcnt vmcnt(47)
    s_cmp_lt_u32 s53, 1
    s_cbranch_scc1 L_cls10
    s_waitcnt vmcnt(23)
L_cls10:
    s_mov_b32 m0, 81920
    s_mov_b32 s32, 212992
    buffer_load_dwordx4 v16, s[12:15], s32 offen offset:0 nt lds
    buffer_load_dwordx4 v17, s[12:15], s32 offen offset:1024 nt lds
    buffer_load_dwordx4 v18, s[12:15], s32 offen offset:2048 nt lds
    buffer_load_dwordx4 v19, s[12:15], s32 offen offset:3072 nt lds
    s_mov_b32 m0, 86016
    s_mov_b32 s32, 217088
    buffer_load_dwordx4 v16, s[12:15], s32 offen offset:0 nt lds
    buffer_load_dwordx4 v17, s[12:15], s32 offen offset:1024 nt lds
    buffer_load_dwordx4 v18, s[12:15], s32 offen offset:2048 nt lds
    buffer_load_dwordx4 v19, s[12:15], s32 offen offset:3072 nt lds
    s_mov_b32 m0, 90112
    s_mov_b32 s32, 221184
    buffer_load_dwordx4 v16, s[12:15], s32 offen offset:0 nt lds
    buffer_load_dwordx4 v17, s[12:15], s32 offen offset:1024 nt lds
    buffer_load_dwordx4 v18, s[12:15], s32 offen offset:2048 nt lds
    buffer_load_dwordx4 v19, s[12:15], s32 offen offset:3072 nt lds
    s_mov_b32 m0, 94208
    s_mov_b32 s32, 225280
    buffer_load_dwordx4 v16, s[12:15], s32 offen offset:0 nt lds
    buffer_load_dwordx4 v17, s[12:15], s32 offen offset:1024 nt lds
    buffer_load_dwordx4 v18, s[12:15], s32 offen offset:2048 nt lds
    buffer_load_dwordx4 v19, s[12:15], s32 offen offset:3072 nt lds
    s_waitcnt vmcnt(62)
    s_mov_b64 exec, 1
    buffer_load_dword v35, off, s[48:51], s52 sc1
    s_mov_b64 exec, -1
    s_waitcnt vmcnt(49)
    s_barrier
    s_waitcnt vmcnt(47)
    s_cmp_lt_u32 s53, 1
    s_cbranch_scc1 L_cls11
    s_waitcnt vmcnt(23)
L_cls11:
    s_mov_b32 m0, 49152
    s_mov_b32 s32, 245760
    buffer_load_dwordx4 v8, s[8:11], s32 offen offset:0 nt lds
    buffer_load_dwordx4 v9, s[8:11], s32 offen offset:1024 nt lds
    buffer_load_dwordx4 v10, s[8:11], s32 offen offset:2048 nt lds
    buffer_load_dwordx4 v11, s[8:11], s32 offen offset:3072 nt lds
    s_mov_b32 m0, 53248
    s_mov_b32 s32, 249856
    buffer_load_dwordx4 v12, s[8:11], s32 offen offset:0 nt lds
    buffer_load_dwordx4 v13, s[8:11], s32 offen offset:1024 nt lds
    buffer_load_dwordx4 v14, s[8:11], s32 offen offset:2048 nt lds
    buffer_load_dwordx4 v15, s[8:11], s32 offen offset:3072 nt lds
    s_mov_b32 m0, 57344
    s_mov_b32 s32, 253952
    buffer_load_dwordx4 v8, s[8:11], s32 offen offset:0 nt lds
    buffer_load_dwordx4 v9, s[8:11], s32 offen offset:1024 nt lds
    buffer_load_dwordx4 v10, s[8:11], s32 offen offset:2048 nt lds
    buffer_load_dwordx4 v11, s[8:11], s32 offen offset:3072 nt lds
    s_mov_b32 m0, 61440
    s_mov_b32 s32, 258048
    buffer_load_dwordx4 v12, s[8:11], s32 offen offset:0 nt lds
    buffer_load_dwordx4 v13, s[8:11], s32 offen offset:1024 nt lds
    buffer_load_dwordx4 v14, s[8:11], s32 offen offset:2048 nt lds
    buffer_load_dwordx4 v15, s[8:11], s32 offen offset:3072 nt lds
    s_waitcnt vmcnt(47)
    s_cmp_lt_u32 s53, 1
    s_cbranch_scc1 L_cls12
    s_waitcnt vmcnt(23)
L_cls12:
    s_mov_b32 m0, 98304
    s_mov_b32 s32, 229376
    buffer_load_dwordx4 v16, s[12:15], s32 offen offset:0 nt lds
    buffer_load_dwordx4 v17, s[12:15], s32 offen offset:1024 nt lds
    buffer_load_dwordx4 v18, s[12:15], s32 offen offset:2048 nt lds
    buffer_load_dwordx4 v19, s[12:15], s32 offen offset:3072 nt lds
    s_mov_b32 m0, 102400
    s_mov_b32 s32, 233472
    buffer_load_dwordx4 v16, s[12:15], s32 offen offset:0 nt lds
    buffer_load_dwordx4 v17, s[12:15], s32 offen offset:1024 nt lds
    buffer_load_dwordx4 v18, s[12:15], s32 offen offset:2048 nt lds
    buffer_load_dwordx4 v19, s[12:15], s32 offen offset:3072 nt lds
    s_mov_b32 m0, 106496
    s_mov_b32 s32, 237568
    buffer_load_dwordx4 v16, s[12:15], s32 offen offset:0 nt lds
    buffer_load_dwordx4 v17, s[12:15], s32 offen offset:1024 nt lds
    buffer_load_dwordx4 v18, s[12:15], s32 offen offset:2048 nt lds
    buffer_load_dwordx4 v19, s[12:15], s32 offen offset:3072 nt lds
    s_mov_b32 m0, 110592
    s_mov_b32 s32, 241664
    buffer_load_dwordx4 v16, s[12:15], s32 offen offset:0 nt lds
    buffer_load_dwordx4 v17, s[12:15], s32 offen offset:1024 nt lds
    buffer_load_dwordx4 v18, s[12:15], s32 offen offset:2048 nt lds
    buffer_load_dwordx4 v19, s[12:15], s32 offen offset:3072 nt lds
    s_waitcnt vmcnt(49)
    s_barrier
    s_waitcnt vmcnt(47)
    s_cmp_lt_u32 s53, 1
    s_cbranch_scc1 L_cls13
    s_waitcnt vmcnt(23)
L_cls13:
    s_mov_b32 m0, 0
    s_mov_b32 s32, 262144
    buffer_load_dwordx4 v8, s[8:11], s32 offen offset:0 nt lds
    buffer_load_dwordx4 v9, s[8:11], s32 offen offset:1024 nt lds
    buffer_load_dwordx4 v10, s[8:11], s32 offen offset:2048 nt lds
    buffer_load_dwordx4 v11, s[8:11], s32 offen offset:3072 nt lds
    s_mov_b32 m0, 4096
    s_mov_b32 s32, 266240
    buffer_load_dwordx4 v12, s[8:11], s32 offen offset:0 nt lds
    buffer_load_dwordx4 v13, s[8:11], s32 offen offset:1024 nt lds
    buffer_load_dwordx4 v14, s[8:11], s32 offen offset:2048 nt lds
    buffer_load_dwordx4 v15, s[8:11], s32 offen offset:3072 nt lds
    s_mov_b32 m0, 8192
    s_mov_b32 s32, 270336
    buffer_load_dwordx4 v8, s[8:11], s32 offen offset:0 nt lds
    buffer_load_dwordx4 v9, s[8:11], s32 offen offset:1024 nt lds
    buffer_load_dwordx4 v10, s[8:11], s32 offen offset:2048 nt lds
    buffer_load_dwordx4 v11, s[8:11], s32 offen offset:3072 nt lds
    s_mov_b32 m0, 12288
    s_mov_b32 s32, 274432
    buffer_load_dwordx4 v12, s[8:11], s32 offen offset:0 nt lds
    buffer_load_dwordx4 v13, s[8:11], s32 offen offset:1024 nt lds
    buffer_load_dwordx4 v14, s[8:11], s32 offen offset:2048 nt lds
    buffer_load_dwordx4 v15, s[8:11], s32 offen offset:3072 nt lds
    s_waitcnt vmcnt(47)
    s_cmp_lt_u32 s53, 1
    s_cbranch_scc1 L_cls14
    s_waitcnt vmcnt(23)
L_cls14:
    s_mov_b32 m0, 114688
    s_mov_b32 s32, 245760
    buffer_load_dwordx4 v16, s[12:15], s32 offen offset:0 nt lds
    buffer_load_dwordx4 v17, s[12:15], s32 offen offset:1024 nt lds
    buffer_load_dwordx4 v18, s[12:15], s32 offen offset:2048 nt lds
    buffer_load_dwordx4 v19, s[12:15], s32 offen offset:3072 nt lds
    s_mov_b32 m0, 118784
    s_mov_b32 s32, 249856
    buffer_load_dwordx4 v16, s[12:15], s32 offen offset:0 nt lds
    buffer_load_dwordx4 v17, s[12:15], s32 offen offset:1024 nt lds
    buffer_load_dwordx4 v18, s[12:15], s32 offen offset:2048 nt lds
    buffer_load_dwordx4 v19, s[12:15], s32 offen offset:3072 nt lds
    s_mov_b32 m0, 122880
    s_mov_b32 s32, 253952
    buffer_load_dwordx4 v16, s[12:15], s32 offen offset:0 nt lds
    buffer_load_dwordx4 v17, s[12:15], s32 offen offset:1024 nt lds
    buffer_load_dwordx4 v18, s[12:15], s32 offen offset:2048 nt lds
    buffer_load_dwordx4 v19, s[12:15], s32 offen offset:3072 nt lds
    s_mov_b32 m0, 126976
    s_mov_b32 s32, 258048
    buffer_load_dwordx4 v16, s[12:15], s32 offen offset:0 nt lds
    buffer_load_dwordx4 v17, s[12:15], s32 offen offset:1024 nt lds
    buffer_load_dwordx4 v18, s[12:15], s32 offen offset:2048 nt lds
    buffer_load_dwordx4 v19, s[12:15], s32 offen offset:3072 nt lds
    s_barrier
    s_waitcnt vmcnt(48)
    s_barrier
    s_waitcnt vmcnt(47)
    s_cmp_lt_u32 s53, 1
    s_cbranch_scc1 L_cls15
    s_waitcnt vmcnt(23)
L_cls15:
    s_mov_b32 m0, 16384
    s_mov_b32 s32, 278528
    buffer_load_dwordx4 v8, s[8:11], s32 offen offset:0 nt lds
    buffer_load_dwordx4 v9, s[8:11], s32 offen offset:1024 nt lds
    buffer_load_dwordx4 v10, s[8:11], s32 offen offset:2048 nt lds
    buffer_load_dwordx4 v11, s[8:11], s32 offen offset:3072 nt lds
    s_mov_b32 m0, 20480
    s_mov_b32 s32, 282624
    buffer_load_dwordx4 v12, s[8:11], s32 offen offset:0 nt lds
    buffer_load_dwordx4 v13, s[8:11], s32 offen offset:1024 nt lds
    buffer_load_dwordx4 v14, s[8:11], s32 offen offset:2048 nt lds
    buffer_load_dwordx4 v15, s[8:11], s32 offen offset:3072 nt lds
    s_mov_b32 m0, 24576
    s_mov_b32 s32, 286720
    buffer_load_dwordx4 v8, s[8:11], s32 offen offset:0 nt lds
    buffer_load_dwordx4 v9, s[8:11], s32 offen offset:1024 nt lds
    buffer_load_dwordx4 v10, s[8:11], s32 offen offset:2048 nt lds
    buffer_load_dwordx4 v11, s[8:11], s32 offen offset:3072 nt lds
    s_mov_b32 m0, 28672
    s_mov_b32 s32, 290816
    buffer_load_dwordx4 v12, s[8:11], s32 offen offset:0 nt lds
    buffer_load_dwordx4 v13, s[8:11], s32 offen offset:1024 nt lds
    buffer_load_dwordx4 v14, s[8:11], s32 offen offset:2048 nt lds
    buffer_load_dwordx4 v15, s[8:11], s32 offen offset:3072 nt lds
    s_waitcnt vmcnt(48)
    s_barrier
    s_waitcnt vmcnt(47)
    s_cmp_lt_u32 s53, 1
    s_cbranch_scc1 L_cls16
    s_waitcnt vmcnt(23)
L_cls16:
    s_mov_b32 m0, 65536
    s_mov_b32 s32, 262144
    buffer_load_dwordx4 v16, s[12:15], s32 offen offset:0 nt lds
    buffer_load_dwordx4 v17, s[12:15], s32 offen offset:1024 nt lds
    buffer_load_dwordx4 v18, s[12:15], s32 offen offset:2048 nt lds
    buffer_load_dwordx4 v19, s[12:15], s32 offen offset:3072 nt lds
    s_mov_b32 m0, 69632
    s_mov_b32 s32, 266240
    buffer_load_dwordx4 v16, s[12:15], s32 offen offset:0 nt lds
    buffer_load_dwordx4 v17, s[12:15], s32 offen offset:1024 nt lds
    buffer_load_dwordx4 v18, s[12:15], s32 offen offset:2048 nt lds
    buffer_load_dwordx4 v19, s[12:15], s32 offen offset:3072 nt lds
    s_mov_b32 m0, 73728
    s_mov_b32 s32, 270336
    buffer_load_dwordx4 v16, s[12:15], s32 offen offset:0 nt lds
    buffer_load_dwordx4 v17, s[12:15], s32 offen offset:1024 nt lds
    buffer_load_dwordx4 v18, s[12:15], s32 offen offset:2048 nt lds
    buffer_load_dwordx4 v19, s[12:15], s32 offen offset:3072 nt lds
    s_mov_b32 m0, 77824
    s_mov_b32 s32, 274432
    buffer_load_dwordx4 v16, s[12:15], s32 offen offset:0 nt lds
    buffer_load_dwordx4 v17, s[12:15], s32 offen offset:1024 nt lds
    buffer_load_dwordx4 v18, s[12:15], s32 offen offset:2048 nt lds
    buffer_load_dwordx4 v19, s[12:15], s32 offen offset:3072 nt lds
    v_readfirstlane_b32 s90, v35
    s_nop 3
    s_cmp_ge_u32 s90, 1
    s_cbranch_scc1 L_init_ok
    s_mov_b64 exec, 1
    s_mov_b32 s89, 0
L_init_poll:
    buffer_load_dword v35, off, s[48:51], s52 sc1
    s_waitcnt vmcnt(0)
    v_readfirstlane_b32 s90, v35
    s_add_u32 s89, s89, 1
    s_cmp_ge_u32 s90, 1
    s_cbranch_scc1 L_init_done
    s_cmp_ge_u32 s89, 0x40000
    s_cbranch_scc1 L_init_done
    s_sleep 8
    s_branch L_init_poll
L_init_done:
    s_mov_b64 exec, -1
L_init_ok:
    s_waitcnt vmcnt(55)
    s_mov_b32 s32, 115200
    buffer_load_dwordx4 a[0:3], v28, s[20:23], s32 offen
    s_mov_b32 s32, 116992
    buffer_load_dwordx4 a[4:7], v29, s[20:23], s32 offen
    s_mov_b32 s32, 118784
    buffer_load_dwordx4 a[8:11], v30, s[20:23], s32 offen
    s_mov_b32 s32, 120576
    buffer_load_dwordx4 a[12:15], v31, s[20:23], s32 offen
    s_mov_b32 s32, 122368
    buffer_load_dwordx4 a[16:19], v28, s[20:23], s32 offen
    s_mov_b32 s32, 124160
    buffer_load_dwordx4 a[20:23], v29, s[20:23], s32 offen
    s_mov_b32 s32, 125952
    buffer_load_dwordx4 a[24:27], v30, s[20:23], s32 offen
    s_mov_b32 s32, 127744
    buffer_load_dwordx4 a[28:31], v31, s[20:23], s32 offen
    s_waitcnt vmcnt(56)
    s_barrier
    s_waitcnt vmcnt(47)
    s_cmp_lt_u32 s53, 1
    s_cbranch_scc1 L_cls17
    s_waitcnt vmcnt(23)
L_cls17:
    s_mov_b32 m0, 32768
    s_mov_b32 s32, 294912
    buffer_load_dwordx4 v8, s[8:11], s32 offen offset:0 nt lds
    buffer_load_dwordx4 v9, s[8:11], s32 offen offset:1024 nt lds
    buffer_load_dwordx4 v10, s[8:11], s32 offen offset:2048 nt lds
    buffer_load_dwordx4 v11, s[8:11], s32 offen offset:3072 nt lds
    s_mov_b32 m0, 36864
    s_mov_b32 s32, 299008
    buffer_load_dwordx4 v12, s[8:11], s32 offen offset:0 nt lds
    buffer_load_dwordx4 v13, s[8:11], s32 offen offset:1024 nt lds
    buffer_load_dwordx4 v14, s[8:11], s32 offen offset:2048 nt lds
    buffer_load_dwordx4 v15, s[8:11], s32 offen offset:3072 nt lds
    s_mov_b32 m0, 40960
    s_mov_b32 s32, 303104
    buffer_load_dwordx4 v8, s[8:11], s32 offen offset:0 nt lds
    buffer_load_dwordx4 v9, s[8:11], s32 offen offset:1024 nt lds
    buffer_load_dwordx4 v10, s[8:11], s32 offen offset:2048 nt lds
    buffer_load_dwordx4 v11, s[8:11], s32 offen offset:3072 nt lds
    s_mov_b32 m0, 45056
    s_mov_b32 s32, 307200
    buffer_load_dwordx4 v12, s[8:11], s32 offen offset:0 nt lds
    buffer_load_dwordx4 v13, s[8:11], s32 offen offset:1024 nt lds
    buffer_load_dwordx4 v14, s[8:11], s32 offen offset:2048 nt lds
    buffer_load_dwordx4 v15, s[8:11], s32 offen offset:3072 nt lds
    s_waitcnt vmcnt(56)
    s_barrier
    s_waitcnt vmcnt(47)
    s_cmp_lt_u32 s53, 1
    s_cbranch_scc1 L_cls18
    s_waitcnt vmcnt(23)
L_cls18:
    s_mov_b32 m0, 81920
    s_mov_b32 s32, 278528
    buffer_load_dwordx4 v16, s[12:15], s32 offen offset:0 nt lds
    buffer_load_dwordx4 v17, s[12:15], s32 offen offset:1024 nt lds
    buffer_load_dwordx4 v18, s[12:15], s32 offen offset:2048 nt lds
    buffer_load_dwordx4 v19, s[12:15], s32 offen offset:3072 nt lds
    s_mov_b32 m0, 86016
    s_mov_b32 s32, 282624
    buffer_load_dwordx4 v16, s[12:15], s32 offen offset:0 nt lds
    buffer_load_dwordx4 v17, s[12:15], s32 offen offset:1024 nt lds
    buffer_load_dwordx4 v18, s[12:15], s32 offen offset:2048 nt lds
    buffer_load_dwordx4 v19, s[12:15], s32 offen offset:3072 nt lds
    s_mov_b32 m0, 90112
    s_mov_b32 s32, 286720
    buffer_load_dwordx4 v16, s[12:15], s32 offen offset:0 nt lds
    buffer_load_dwordx4 v17, s[12:15], s32 offen offset:1024 nt lds
    buffer_load_dwordx4 v18, s[12:15], s32 offen offset:2048 nt lds
    buffer_load_dwordx4 v19, s[12:15], s32 offen offset:3072 nt lds
    s_mov_b32 m0, 94208
    s_mov_b32 s32, 290816
    buffer_load_dwordx4 v16, s[12:15], s32 offen offset:0 nt lds
    buffer_load_dwordx4 v17, s[12:15], s32 offen offset:1024 nt lds
    buffer_load_dwordx4 v18, s[12:15], s32 offen offset:2048 nt lds
    buffer_load_dwordx4 v19, s[12:15], s32 offen offset:3072 nt lds
    s_waitcnt vmcnt(55)
    s_mov_b32 s32, 129536
    buffer_load_dwordx4 a[32:35], v28, s[20:23], s32 offen
    s_mov_b32 s32, 131328
    buffer_load_dwordx4 a[36:39], v29, s[20:23], s32 offen
    s_mov_b32 s32, 133120
    buffer_load_dwordx4 a[40:43], v30, s[20:23], s32 offen
    s_mov_b32 s32, 134912
    buffer_load_dwordx4 a[44:47], v31, s[20:23], s32 offen
    s_mov_b32 s32, 136704
    buffer_load_dwordx4 a[48:51], v28, s[20:23], s32 offen
    s_mov_b32 s32, 138496
    buffer_load_dwordx4 a[52:55], v29, s[20:23], s32 offen
    s_mov_b32 s32, 140288
    buffer_load_dwordx4 a[56:59], v30, s[20:23], s32 offen
    s_mov_b32 s32, 142080
    buffer_load_dwordx4 a[60:63], v31, s[20:23], s32 offen
    s_barrier
    s_waitcnt vmcnt(47)
    s_cmp_lt_u32 s53, 1
    s_cbranch_scc1 L_cls19
    s_waitcnt vmcnt(23)
L_cls19:
    s_mov_b32 m0, 49152
    s_mov_b32 s32, 311296
    buffer_load_dwordx4 v8, s[8:11], s32 offen offset:0 nt lds
    buffer_load_dwordx4 v9, s[8:11], s32 offen offset:1024 nt lds
    buffer_load_dwordx4 v10, s[8:11], s32 offen offset:2048 nt lds
    buffer_load_dwordx4 v11, s[8:11], s32 offen offset:3072 nt lds
    s_mov_b32 m0, 53248
    s_mov_b32 s32, 315392
    buffer_load_dwordx4 v12, s[8:11], s32 offen offset:0 nt lds
    buffer_load_dwordx4 v13, s[8:11], s32 offen offset:1024 nt lds
    buffer_load_dwordx4 v14, s[8:11], s32 offen offset:2048 nt lds
    buffer_load_dwordx4 v15, s[8:11], s32 offen offset:3072 nt lds
    s_mov_b32 m0, 57344
    s_mov_b32 s32, 319488
    buffer_load_dwordx4 v8, s[8:11], s32 offen offset:0 nt lds
    buffer_load_dwordx4 v9, s[8:11], s32 offen offset:1024 nt lds
    buffer_load_dwordx4 v10, s[8:11], s32 offen offset:2048 nt lds
    buffer_load_dwordx4 v11, s[8:11], s32 offen offset:3072 nt lds
    s_mov_b32 m0, 61440
    s_mov_b32 s32, 323584
    buffer_load_dwordx4 v12, s[8:11], s32 offen offset:0 nt lds
    buffer_load_dwordx4 v13, s[8:11], s32 offen offset:1024 nt lds
    buffer_load_dwordx4 v14, s[8:11], s32 offen offset:2048 nt lds
    buffer_load_dwordx4 v15, s[8:11], s32 offen offset:3072 nt lds
    s_barrier
    s_waitcnt vmcnt(47)
    s_cmp_lt_u32 s53, 1
    s_cbranch_scc1 L_cls20
    s_waitcnt vmcnt(23)
L_cls20:
    s_mov_b32 m0, 98304
    s_mov_b32 s32, 294912
    buffer_load_dwordx4 v16, s[12:15], s32 offen offset:0 nt lds
    buffer_load_dwordx4 v17, s[12:15], s32 offen offset:1024 nt lds
    buffer_load_dwordx4 v18, s[12:15], s32 offen offset:2048 nt lds
    buffer_load_dwordx4 v19, s[12:15], s32 offen offset:3072 nt lds
    s_mov_b32 m0, 102400
    s_mov_b32 s32, 299008
    buffer_load_dwordx4 v16, s[12:15], s32 offen offset:0 nt lds
    buffer_load_dwordx4 v17, s[12:15], s32 offen offset:1024 nt lds
    buffer_load_dwordx4 v18, s[12:15], s32 offen offset:2048 nt lds
    buffer_load_dwordx4 v19, s[12:15], s32 offen offset:3072 nt lds
    s_mov_b32 m0, 106496
    s_mov_b32 s32, 303104
    buffer_load_dwordx4 v16, s[12:15], s32 offen offset:0 nt lds
    buffer_load_dwordx4 v17, s[12:15], s32 offen offset:1024 nt lds
    buffer_load_dwordx4 v18, s[12:15], s32 offen offset:2048 nt lds
    buffer_load_dwordx4 v19, s[12:15], s32 offen offset:3072 nt lds
    s_mov_b32 m0, 110592
    s_mov_b32 s32, 307200
    buffer_load_dwordx4 v16, s[12:15], s32 offen offset:0 nt lds
    buffer_load_dwordx4 v17, s[12:15], s32 offen offset:1024 nt lds
    buffer_load_dwordx4 v18, s[12:15], s32 offen offset:2048 nt lds
    buffer_load_dwordx4 v19, s[12:15], s32 offen offset:3072 nt lds
    s_waitcnt vmcnt(55)
    s_mov_b32 s32, 640
    buffer_load_dwordx4 a[64:67], v28, s[20:23], s32 offen
    s_mov_b32 s32, 2432
    buffer_load_dwordx4 a[68:71], v29, s[20:23], s32 offen
    s_mov_b32 s32, 4224
    buffer_load_dwordx4 a[72:75], v30, s[20:23], s32 offen
    s_mov_b32 s32, 6016
    buffer_load_dwordx4 a[76:79], v31, s[20:23], s32 offen
    s_mov_b32 s32, 7808
    buffer_load_dwordx4 a[80:83], v28, s[20:23], s32 offen
    s_mov_b32 s32, 9600
    buffer_load_dwordx4 a[84:87], v29, s[20:23], s32 offen
    s_mov_b32 s32, 11392
    buffer_load_dwordx4 a[88:91], v30, s[20:23], s32 offen
    s_mov_b32 s32, 13184
    buffer_load_dwordx4 a[92:95], v31, s[20:23], s32 offen
    s_barrier
    s_waitcnt vmcnt(47)
    s_cmp_lt_u32 s53, 1
    s_cbranch_scc1 L_cls21
    s_waitcnt vmcnt(23)
L_cls21:
    s_mov_b32 m0, 0
    s_mov_b32 s32, 327680
    buffer_load_dwordx4 v8, s[8:11], s32 offen offset:0 nt lds
    buffer_load_dwordx4 v9, s[8:11], s32 offen offset:1024 nt lds
    buffer_load_dwordx4 v10, s[8:11], s32 offen offset:2048 nt lds
    buffer_load_dwordx4 v11, s[8:11], s32 offen offset:3072 nt lds
    s_mov_b32 m0, 4096
    s_mov_b32 s32, 331776
    buffer_load_dwordx4 v12, s[8:11], s32 offen offset:0 nt lds
    buffer_load_dwordx4 v13, s[8:11], s32 offen offset:1024 nt lds
    buffer_load_dwordx4 v14, s[8:11], s32 offen offset:2048 nt lds
    buffer_load_dwordx4 v15, s[8:11], s32 offen offset:3072 nt lds
    s_mov_b32 m0, 8192
    s_mov_b32 s32, 335872
    buffer_load_dwordx4 v8, s[8:11], s32 offen offset:0 nt lds
    buffer_load_dwordx4 v9, s[8:11], s32 offen offset:1024 nt lds
    buffer_load_dwordx4 v10, s[8:11], s32 offen offset:2048 nt lds
    buffer_load_dwordx4 v11, s[8:11], s32 offen offset:3072 nt lds
    s_mov_b32 m0, 12288
    s_mov_b32 s32, 339968
    buffer_load_dwordx4 v12, s[8:11], s32 offen offset:0 nt lds
    buffer_load_dwordx4 v13, s[8:11], s32 offen offset:1024 nt lds
    buffer_load_dwordx4 v14, s[8:11], s32 offen offset:2048 nt lds
    buffer_load_dwordx4 v15, s[8:11], s32 offen offset:3072 nt lds
    s_barrier
    s_waitcnt vmcnt(47)
    s_cmp_lt_u32 s53, 1
    s_cbranch_scc1 L_cls22
    s_waitcnt vmcnt(23)
L_cls22:
    s_mov_b32 m0, 114688
    s_mov_b32 s32, 311296
    buffer_load_dwordx4 v16, s[12:15], s32 offen offset:0 nt lds
    buffer_load_dwordx4 v17, s[12:15], s32 offen offset:1024 nt lds
    buffer_load_dwordx4 v18, s[12:15], s32 offen offset:2048 nt lds
    buffer_load_dwordx4 v19, s[12:15], s32 offen offset:3072 nt lds
    s_mov_b32 m0, 118784
    s_mov_b32 s32, 315392
    buffer_load_dwordx4 v16, s[12:15], s32 offen offset:0 nt lds
    buffer_load_dwordx4 v17, s[12:15], s32 offen offset:1024 nt lds
    buffer_load_dwordx4 v18, s[12:15], s32 offen offset:2048 nt lds
    buffer_load_dwordx4 v19, s[12:15], s32 offen offset:3072 nt lds
    s_mov_b32 m0, 122880
    s_mov_b32 s32, 319488
    buffer_load_dwordx4 v16, s[12:15], s32 offen offset:0 nt lds
    buffer_load_dwordx4 v17, s[12:15], s32 offen offset:1024 nt lds
    buffer_load_dwordx4 v18, s[12:15], s32 offen offset:2048 nt lds
    buffer_load_dwordx4 v19, s[12:15], s32 offen offset:3072 nt lds
    s_mov_b32 m0, 126976
    s_mov_b32 s32, 323584
    buffer_load_dwordx4 v16, s[12:15], s32 offen offset:0 nt lds
    buffer_load_dwordx4 v17, s[12:15], s32 offen offset:1024 nt lds
    buffer_load_dwordx4 v18, s[12:15], s32 offen offset:2048 nt lds
    buffer_load_dwordx4 v19, s[12:15], s32 offen offset:3072 nt lds
    s_waitcnt vmcnt(55)
    s_mov_b32 s32, 14976
    buffer_load_dwordx4 a[96:99], v28, s[20:23], s32 offen
    s_mov_b32 s32, 16768
    buffer_load_dwordx4 a[100:103], v29, s[20:23], s32 offen
    s_mov_b32 s32, 18560
    buffer_load_dwordx4 a[104:107], v30, s[20:23], s32 offen
    s_mov_b32 s32, 20352
    buffer_load_dwordx4 a[108:111], v31, s[20:23], s32 offen
    s_mov_b32 s32, 22144
    buffer_load_dwordx4 a[112:115], v28, s[20:23], s32 offen
    s_mov_b32 s32, 23936
    buffer_load_dwordx4 a[116:119], v29, s[20:23], s32 offen
    s_mov_b32 s32, 25728
    buffer_load_dwordx4 a[120:123], v30, s[20:23], s32 offen
    s_mov_b32 s32, 27520
    buffer_load_dwordx4 a[124:127], v31, s[20:23], s32 offen
    s_barrier
    s_waitcnt vmcnt(47)
    s_cmp_lt_u32 s53, 1
    s_cbranch_scc1 L_cls23
    s_waitcnt vmcnt(23)
L_cls23:
    s_mov_b32 m0, 16384
    s_mov_b32 s32, 344064
    buffer_load_dwordx4 v8, s[8:11], s32 offen offset:0 nt lds
    buffer_load_dwordx4 v9, s[8:11], s32 offen offset:1024 nt lds
    buffer_load_dwordx4 v10, s[8:11], s32 offen offset:2048 nt lds
    buffer_load_dwordx4 v11, s[8:11], s32 offen offset:3072 nt lds
    s_mov_b32 m0, 20480
    s_mov_b32 s32, 348160
    buffer_load_dwordx4 v12, s[8:11], s32 offen offset:0 nt lds
    buffer_load_dwordx4 v13, s[8:11], s32 offen offset:1024 nt lds
    buffer_load_dwordx4 v14, s[8:11], s32 offen offset:2048 nt lds
    buffer_load_dwordx4 v15, s[8:11], s32 offen offset:3072 nt lds
    s_mov_b32 m0, 24576
    s_mov_b32 s32, 352256
    buffer_load_dwordx4 v8, s[8:11], s32 offen offset:0 nt lds
    buffer_load_dwordx4 v9, s[8:11], s32 offen offset:1024 nt lds
    buffer_load_dwordx4 v10, s[8:11], s32 offen offset:2048 nt lds
    buffer_load_dwordx4 v11, s[8:11], s32 offen offset:3072 nt lds
    s_mov_b32 m0, 28672
    s_mov_b32 s32, 356352
    buffer_load_dwordx4 v12, s[8:11], s32 offen offset:0 nt lds
    buffer_load_dwordx4 v13, s[8:11], s32 offen offset:1024 nt lds
    buffer_load_dwordx4 v14, s[8:11], s32 offen offset:2048 nt lds
    buffer_load_dwordx4 v15, s[8:11], s32 offen offset:3072 nt lds
    s_barrier
    s_waitcnt vmcnt(47)
    s_cmp_lt_u32 s53, 1
    s_cbranch_scc1 L_cls24
    s_waitcnt vmcnt(23)
L_cls24:
    s_mov_b32 m0, 65536
    s_mov_b32 s32, 327680
    buffer_load_dwordx4 v16, s[12:15], s32 offen offset:0 nt lds
    buffer_load_dwordx4 v17, s[12:15], s32 offen offset:1024 nt lds
    buffer_load_dwordx4 v18, s[12:15], s32 offen offset:2048 nt lds
    buffer_load_dwordx4 v19, s[12:15], s32 offen offset:3072 nt lds
    s_mov_b32 m0, 69632
    s_mov_b32 s32, 331776
    buffer_load_dwordx4 v16, s[12:15], s32 offen offset:0 nt lds
    buffer_load_dwordx4 v17, s[12:15], s32 offen offset:1024 nt lds
    buffer_load_dwordx4 v18, s[12:15], s32 offen offset:2048 nt lds
    buffer_load_dwordx4 v19, s[12:15], s32 offen offset:3072 nt lds
    s_mov_b32 m0, 73728
    s_mov_b32 s32, 335872
    buffer_load_dwordx4 v16, s[12:15], s32 offen offset:0 nt lds
    buffer_load_dwordx4 v17, s[12:15], s32 offen offset:1024 nt lds
    buffer_load_dwordx4 v18, s[12:15], s32 offen offset:2048 nt lds
    buffer_load_dwordx4 v19, s[12:15], s32 offen offset:3072 nt lds
    s_mov_b32 m0, 77824
    s_mov_b32 s32, 339968
    buffer_load_dwordx4 v16, s[12:15], s32 offen offset:0 nt lds
    buffer_load_dwordx4 v17, s[12:15], s32 offen offset:1024 nt lds
    buffer_load_dwordx4 v18, s[12:15], s32 offen offset:2048 nt lds
    buffer_load_dwordx4 v19, s[12:15], s32 offen offset:3072 nt lds
    s_waitcnt vmcnt(55)
    s_mov_b32 s32, 115328
    buffer_load_dwordx4 a[128:131], v28, s[20:23], s32 offen
    s_mov_b32 s32, 117120
    buffer_load_dwordx4 a[132:135], v29, s[20:23], s32 offen
    s_mov_b32 s32, 118912
    buffer_load_dwordx4 a[136:139], v30, s[20:23], s32 offen
    s_mov_b32 s32, 120704
    buffer_load_dwordx4 a[140:143], v31, s[20:23], s32 offen
    s_mov_b32 s32, 122496
    buffer_load_dwordx4 a[144:147], v28, s[20:23], s32 offen
    s_mov_b32 s32, 124288
    buffer_load_dwordx4 a[148:151], v29, s[20:23], s32 offen
    s_mov_b32 s32, 126080
    buffer_load_dwordx4 a[152:155], v30, s[20:23], s32 offen
    s_mov_b32 s32, 127872
    buffer_load_dwordx4 a[156:159], v31, s[20:23], s32 offen
    s_barrier
    s_waitcnt vmcnt(47)
    s_cmp_lt_u32 s53, 1
    s_cbranch_scc1 L_cls25
    s_waitcnt vmcnt(23)
L_cls25:
    s_mov_b32 m0, 32768
    s_mov_b32 s32, 360448
    buffer_load_dwordx4 v8, s[8:11], s32 offen offset:0 nt lds
    buffer_load_dwordx4 v9, s[8:11], s32 offen offset:1024 nt lds
    buffer_load_dwordx4 v10, s[8:11], s32 offen offset:2048 nt lds
    buffer_load_dwordx4 v11, s[8:11], s32 offen offset:3072 nt lds
    s_mov_b32 m0, 36864
    s_mov_b32 s32, 364544
    buffer_load_dwordx4 v12, s[8:11], s32 offen offset:0 nt lds
    buffer_load_dwordx4 v13, s[8:11], s32 offen offset:1024 nt lds
    buffer_load_dwordx4 v14, s[8:11], s32 offen offset:2048 nt lds
    buffer_load_dwordx4 v15, s[8:11], s32 offen offset:3072 nt lds
    s_mov_b32 m0, 40960
    s_mov_b32 s32, 368640
    buffer_load_dwordx4 v8, s[8:11], s32 offen offset:0 nt lds
    buffer_load_dwordx4 v9, s[8:11], s32 offen offset:1024 nt lds
    buffer_load_dwordx4 v10, s[8:11], s32 offen offset:2048 nt lds
    buffer_load_dwordx4 v11, s[8:11], s32 offen offset:3072 nt lds
    s_mov_b32 m0, 45056
    s_mov_b32 s32, 372736
    buffer_load_dwordx4 v12, s[8:11], s32 offen offset:0 nt lds
    buffer_load_dwordx4 v13, s[8:11], s32 offen offset:1024 nt lds
    buffer_load_dwordx4 v14, s[8:11], s32 offen offset:2048 nt lds
    buffer_load_dwordx4 v15, s[8:11], s32 offen offset:3072 nt lds
    s_barrier
    s_waitcnt vmcnt(47)
    s_cmp_lt_u32 s53, 1
    s_cbranch_scc1 L_cls26
    s_waitcnt vmcnt(23)
L_cls26:
    s_mov_b32 m0, 81920
    s_mov_b32 s32, 344064
    buffer_load_dwordx4 v16, s[12:15], s32 offen offset:0 nt lds
    buffer_load_dwordx4 v17, s[12:15], s32 offen offset:1024 nt lds
    buffer_load_dwordx4 v18, s[12:15], s32 offen offset:2048 nt lds
    buffer_load_dwordx4 v19, s[12:15], s32 offen offset:3072 nt lds
    s_mov_b32 m0, 86016
    s_mov_b32 s32, 348160
    buffer_load_dwordx4 v16, s[12:15], s32 offen offset:0 nt lds
    buffer_load_dwordx4 v17, s[12:15], s32 offen offset:1024 nt lds
    buffer_load_dwordx4 v18, s[12:15], s32 offen offset:2048 nt lds
    buffer_load_dwordx4 v19, s[12:15], s32 offen offset:3072 nt lds
    s_mov_b32 m0, 90112
    s_mov_b32 s32, 352256
    buffer_load_dwordx4 v16, s[12:15], s32 offen offset:0 nt lds
    buffer_load_dwordx4 v17, s[12:15], s32 offen offset:1024 nt lds
    buffer_load_dwordx4 v18, s[12:15], s32 offen offset:2048 nt lds
    buffer_load_dwordx4 v19, s[12:15], s32 offen offset:3072 nt lds
    s_mov_b32 m0, 94208
    s_mov_b32 s32, 356352
    buffer_load_dwordx4 v16, s[12:15], s32 offen offset:0 nt lds
    buffer_load_dwordx4 v17, s[12:15], s32 offen offset:1024 nt lds
    buffer_load_dwordx4 v18, s[12:15], s32 offen offset:2048 nt lds
    buffer_load_dwordx4 v19, s[12:15], s32 offen offset:3072 nt lds
    s_waitcnt vmcnt(55)
    s_mov_b32 s32, 129664
    buffer_load_dwordx4 a[160:163], v28, s[20:23], s32 offen
    s_mov_b32 s32, 131456
    buffer_load_dwordx4 a[164:167], v29, s[20:23], s32 offen
    s_mov_b32 s32, 133248
    buffer_load_dwordx4 a[168:171], v30, s[20:23], s32 offen
    s_mov_b32 s32, 135040
    buffer_load_dwordx4 a[172:175], v31, s[20:23], s32 offen
    s_mov_b32 s32, 136832
    buffer_load_dwordx4 a[176:179], v28, s[20:23], s32 offen
    s_mov_b32 s32, 138624
    buffer_load_dwordx4 a[180:183], v29, s[20:23], s32 offen
    s_mov_b32 s32, 140416
    buffer_load_dwordx4 a[184:187], v30, s[20:23], s32 offen
    s_mov_b32 s32, 142208
    buffer_load_dwordx4 a[188:191], v31, s[20:23], s32 offen
    s_barrier
    s_waitcnt vmcnt(47)
    s_cmp_lt_u32 s53, 1
    s_cbranch_scc1 L_cls27
    s_waitcnt vmcnt(23)
L_cls27:
    s_mov_b32 m0, 49152
    s_mov_b32 s32, 376832
    buffer_load_dwordx4 v8, s[8:11], s32 offen offset:0 nt lds
    buffer_load_dwordx4 v9, s[8:11], s32 offen offset:1024 nt lds
    buffer_load_dwordx4 v10, s[8:11], s32 offen offset:2048 nt lds
    buffer_load_dwordx4 v11, s[8:11], s32 offen offset:3072 nt lds
    s_mov_b32 m0, 53248
    s_mov_b32 s32, 380928
    buffer_load_dwordx4 v12, s[8:11], s32 offen offset:0 nt lds
    buffer_load_dwordx4 v13, s[8:11], s32 offen offset:1024 nt lds
    buffer_load_dwordx4 v14, s[8:11], s32 offen offset:2048 nt lds
    buffer_load_dwordx4 v15, s[8:11], s32 offen offset:3072 nt lds
    s_mov_b32 m0, 57344
    s_mov_b32 s32, 385024
    buffer_load_dwordx4 v8, s[8:11], s32 offen offset:0 nt lds
    buffer_load_dwordx4 v9, s[8:11], s32 offen offset:1024 nt lds
    buffer_load_dwordx4 v10, s[8:11], s32 offen offset:2048 nt lds
    buffer_load_dwordx4 v11, s[8:11], s32 offen offset:3072 nt lds
    s_mov_b32 m0, 61440
    s_mov_b32 s32, 389120
    buffer_load_dwordx4 v12, s[8:11], s32 offen offset:0 nt lds
    buffer_load_dwordx4 v13, s[8:11], s32 offen offset:1024 nt lds
    buffer_load_dwordx4 v14, s[8:11], s32 offen offset:2048 nt lds
    buffer_load_dwordx4 v15, s[8:11], s32 offen offset:3072 nt lds
    s_barrier
    s_waitcnt vmcnt(47)
    s_cmp_lt_u32 s53, 1
    s_cbranch_scc1 L_cls28
    s_waitcnt vmcnt(23)
L_cls28:
    s_mov_b32 m0, 98304
    s_mov_b32 s32, 360448
    buffer_load_dwordx4 v16, s[12:15], s32 offen offset:0 nt lds
    buffer_load_dwordx4 v17, s[12:15], s32 offen offset:1024 nt lds
    buffer_load_dwordx4 v18, s[12:15], s32 offen offset:2048 nt lds
    buffer_load_dwordx4 v19, s[12:15], s32 offen offset:3072 nt lds
    s_mov_b32 m0, 102400
    s_mov_b32 s32, 364544
    buffer_load_dwordx4 v16, s[12:15], s32 offen offset:0 nt lds
    buffer_load_dwordx4 v17, s[12:15], s32 offen offset:1024 nt lds
    buffer_load_dwordx4 v18, s[12:15], s32 offen offset:2048 nt lds
    buffer_load_dwordx4 v19, s[12:15], s32 offen offset:3072 nt lds
    s_mov_b32 m0, 106496
    s_mov_b32 s32, 368640
    buffer_load_dwordx4 v16, s[12:15], s32 offen offset:0 nt lds
    buffer_load_dwordx4 v17, s[12:15], s32 offen offset:1024 nt lds
    buffer_load_dwordx4 v18, s[12:15], s32 offen offset:2048 nt lds
    buffer_load_dwordx4 v19, s[12:15], s32 offen offset:3072 nt lds
    s_mov_b32 m0, 110592
    s_mov_b32 s32, 372736
    buffer_load_dwordx4 v16, s[12:15], s32 offen offset:0 nt lds
    buffer_load_dwordx4 v17, s[12:15], s32 offen offset:1024 nt lds
    buffer_load_dwordx4 v18, s[12:15], s32 offen offset:2048 nt lds
    buffer_load_dwordx4 v19, s[12:15], s32 offen offset:3072 nt lds
    s_waitcnt vmcnt(55)
    s_mov_b32 s32, 768
    buffer_load_dwordx4 a[192:195], v28, s[20:23], s32 offen
    s_mov_b32 s32, 2560
    buffer_load_dwordx4 a[196:199], v29, s[20:23], s32 offen
    s_mov_b32 s32, 4352
    buffer_load_dwordx4 a[200:203], v30, s[20:23], s32 offen
    s_mov_b32 s32, 6144
    buffer_load_dwordx4 a[204:207], v31, s[20:23], s32 offen
    s_mov_b32 s32, 7936
    buffer_load_dwordx4 a[208:211], v28, s[20:23], s32 offen
    s_mov_b32 s32, 9728
    buffer_load_dwordx4 a[212:215], v29, s[20:23], s32 offen
    s_mov_b32 s32, 11520
    buffer_load_dwordx4 a[216:219], v30, s[20:23], s32 offen
    s_mov_b32 s32, 13312
    buffer_load_dwordx4 a[220:223], v31, s[20:23], s32 offen
    s_barrier
    s_waitcnt vmcnt(47)
    s_cmp_lt_u32 s53, 1
    s_cbranch_scc1 L_cls29
    s_waitcnt vmcnt(23)
L_cls29:
    s_mov_b32 m0, 0
    s_mov_b32 s32, 393216
    buffer_load_dwordx4 v8, s[8:11], s32 offen offset:0 nt lds
    buffer_load_dwordx4 v9, s[8:11], s32 offen offset:1024 nt lds
    buffer_load_dwordx4 v10, s[8:11], s32 offen offset:2048 nt lds
    buffer_load_dwordx4 v11, s[8:11], s32 offen offset:3072 nt lds
    s_mov_b32 m0, 4096
    s_mov_b32 s32, 397312
    buffer_load_dwordx4 v12, s[8:11], s32 offen offset:0 nt lds
    buffer_load_dwordx4 v13, s[8:11], s32 offen offset:1024 nt lds
    buffer_load_dwordx4 v14, s[8:11], s32 offen offset:2048 nt lds
    buffer_load_dwordx4 v15, s[8:11], s32 offen offset:3072 nt lds
    s_mov_b32 m0, 8192
    s_mov_b32 s32, 401408
    buffer_load_dwordx4 v8, s[8:11], s32 offen offset:0 nt lds
    buffer_load_dwordx4 v9, s[8:11], s32 offen offset:1024 nt lds
    buffer_load_dwordx4 v10, s[8:11], s32 offen offset:2048 nt lds
    buffer_load_dwordx4 v11, s[8:11], s32 offen offset:3072 nt lds
    s_mov_b32 m0, 12288
    s_mov_b32 s32, 405504
    buffer_load_dwordx4 v12, s[8:11], s32 offen offset:0 nt lds
    buffer_load_dwordx4 v13, s[8:11], s32 offen offset:1024 nt lds
    buffer_load_dwordx4 v14, s[8:11], s32 offen offset:2048 nt lds
    buffer_load_dwordx4 v15, s[8:11], s32 offen offset:3072 nt lds
    s_barrier
    s_waitcnt vmcnt(47)
    s_cmp_lt_u32 s53, 1
    s_cbranch_scc1 L_cls30
    s_waitcnt vmcnt(23)
L_cls30:
    s_mov_b32 m0, 114688
    s_mov_b32 s32, 376832
    buffer_load_dwordx4 v16, s[12:15], s32 offen offset:0 nt lds
    buffer_load_dwordx4 v17, s[12:15], s32 offen offset:1024 nt lds
    buffer_load_dwordx4 v18, s[12:15], s32 offen offset:2048 nt lds
    buffer_load_dwordx4 v19, s[12:15], s32 offen offset:3072 nt lds
    s_mov_b32 m0, 118784
    s_mov_b32 s32, 380928
    buffer_load_dwordx4 v16, s[12:15], s32 offen offset:0 nt lds
    buffer_load_dwordx4 v17, s[12:15], s32 offen offset:1024 nt lds
    buffer_load_dwordx4 v18, s[12:15], s32 offen offset:2048 nt lds
    buffer_load_dwordx4 v19, s[12:15], s32 offen offset:3072 nt lds
    s_mov_b32 m0, 122880
    s_mov_b32 s32, 385024
    buffer_load_dwordx4 v16, s[12:15], s32 offen offset:0 nt lds
    buffer_load_dwordx4 v17, s[12:15], s32 offen offset:1024 nt lds
    buffer_load_dwordx4 v18, s[12:15], s32 offen offset:2048 nt lds
    buffer_load_dwordx4 v19, s[12:15], s32 offen offset:3072 nt lds
    s_mov_b32 m0, 126976
    s_mov_b32 s32, 389120
    buffer_load_dwordx4 v16, s[12:15], s32 offen offset:0 nt lds
    buffer_load_dwordx4 v17, s[12:15], s32 offen offset:1024 nt lds
    buffer_load_dwordx4 v18, s[12:15], s32 offen offset:2048 nt lds
    buffer_load_dwordx4 v19, s[12:15], s32 offen offset:3072 nt lds
    s_waitcnt vmcnt(55)
    s_mov_b32 s32, 15104
    buffer_load_dwordx4 a[224:227], v28, s[20:23], s32 offen
    s_mov_b32 s32, 16896
    buffer_load_dwordx4 a[228:231], v29, s[20:23], s32 offen
    s_mov_b32 s32, 18688
    buffer_load_dwordx4 a[232:235], v30, s[20:23], s32 offen
    s_mov_b32 s32, 20480
    buffer_load_dwordx4 a[236:239], v31, s[20:23], s32 offen
    s_mov_b32 s32, 22272
    buffer_load_dwordx4 a[240:243], v28, s[20:23], s32 offen
    s_mov_b32 s32, 24064
    buffer_load_dwordx4 a[244:247], v29, s[20:23], s32 offen
    s_mov_b32 s32, 25856
    buffer_load_dwordx4 a[248:251], v30, s[20:23], s32 offen
    s_mov_b32 s32, 27648
    buffer_load_dwordx4 a[252:255], v31, s[20:23], s32 offen
    s_barrier
    s_waitcnt vmcnt(47)
    s_cmp_lt_u32 s53, 1
    s_cbranch_scc1 L_cls31
    s_waitcnt vmcnt(23)
L_cls31:
    s_mov_b32 m0, 16384
    s_mov_b32 s32, 409600
    buffer_load_dwordx4 v8, s[8:11], s32 offen offset:0 nt lds
    buffer_load_dwordx4 v9, s[8:11], s32 offen offset:1024 nt lds
    buffer_load_dwordx4 v10, s[8:11], s32 offen offset:2048 nt lds
    buffer_load_dwordx4 v11, s[8:11], s32 offen offset:3072 nt lds
    s_mov_b32 m0, 20480
    s_mov_b32 s32, 413696
    buffer_load_dwordx4 v12, s[8:11], s32 offen offset:0 nt lds
    buffer_load_dwordx4 v13, s[8:11], s32 offen offset:1024 nt lds
    buffer_load_dwordx4 v14, s[8:11], s32 offen offset:2048 nt lds
    buffer_load_dwordx4 v15, s[8:11], s32 offen offset:3072 nt lds
    s_mov_b32 m0, 24576
    s_mov_b32 s32, 417792
    buffer_load_dwordx4 v8, s[8:11], s32 offen offset:0 nt lds
    buffer_load_dwordx4 v9, s[8:11], s32 offen offset:1024 nt lds
    buffer_load_dwordx4 v10, s[8:11], s32 offen offset:2048 nt lds
    buffer_load_dwordx4 v11, s[8:11], s32 offen offset:3072 nt lds
    s_mov_b32 m0, 28672
    s_mov_b32 s32, 421888
    buffer_load_dwordx4 v12, s[8:11], s32 offen offset:0 nt lds
    buffer_load_dwordx4 v13, s[8:11], s32 offen offset:1024 nt lds
    buffer_load_dwordx4 v14, s[8:11], s32 offen offset:2048 nt lds
    buffer_load_dwordx4 v15, s[8:11], s32 offen offset:3072 nt lds
    s_barrier
    s_waitcnt vmcnt(47)
    s_cmp_lt_u32 s53, 1
    s_cbranch_scc1 L_cls32
    s_waitcnt vmcnt(23)
L_cls32:
    s_mov_b32 m0, 65536
    s_mov_b32 s32, 393216
    buffer_load_dwordx4 v16, s[12:15], s32 offen offset:0 nt lds
    buffer_load_dwordx4 v17, s[12:15], s32 offen offset:1024 nt lds
    buffer_load_dwordx4 v18, s[12:15], s32 offen offset:2048 nt lds
    buffer_load_dwordx4 v19, s[12:15], s32 offen offset:3072 nt lds
    s_mov_b32 m0, 69632
    s_mov_b32 s32, 397312
    buffer_load_dwordx4 v16, s[12:15], s32 offen offset:0 nt lds
    buffer_load_dwordx4 v17, s[12:15], s32 offen offset:1024 nt lds
    buffer_load_dwordx4 v18, s[12:15], s32 offen offset:2048 nt lds
    buffer_load_dwordx4 v19, s[12:15], s32 offen offset:3072 nt lds
    s_mov_b32 m0, 73728
    s_mov_b32 s32, 401408
    buffer_load_dwordx4 v16, s[12:15], s32 offen offset:0 nt lds
    buffer_load_dwordx4 v17, s[12:15], s32 offen offset:1024 nt lds
    buffer_load_dwordx4 v18, s[12:15], s32 offen offset:2048 nt lds
    buffer_load_dwordx4 v19, s[12:15], s32 offen offset:3072 nt lds
    s_mov_b32 m0, 77824
    s_mov_b32 s32, 405504
    buffer_load_dwordx4 v16, s[12:15], s32 offen offset:0 nt lds
    buffer_load_dwordx4 v17, s[12:15], s32 offen offset:1024 nt lds
    buffer_load_dwordx4 v18, s[12:15], s32 offen offset:2048 nt lds
    buffer_load_dwordx4 v19, s[12:15], s32 offen offset:3072 nt lds
    s_waitcnt vmcnt(55)
    s_mov_b32 s32, 115456
    buffer_load_dwordx4 v[64:67], v28, s[20:23], s32 offen
    s_mov_b32 s32, 117248
    buffer_load_dwordx4 v[68:71], v29, s[20:23], s32 offen
    s_mov_b32 s32, 119040
    buffer_load_dwordx4 v[72:75], v30, s[20:23], s32 offen
    s_mov_b32 s32, 120832
    buffer_load_dwordx4 v[76:79], v31, s[20:23], s32 offen
    s_mov_b32 s32, 122624
    buffer_load_dwordx4 v[80:83], v28, s[20:23], s32 offen
    s_mov_b32 s32, 124416
    buffer_load_dwordx4 v[84:87], v29, s[20:23], s32 offen
    s_mov_b32 s32, 126208
    buffer_load_dwordx4 v[88:91], v30, s[20:23], s32 offen
    s_mov_b32 s32, 128000
    buffer_load_dwordx4 v[92:95], v31, s[20:23], s32 offen
    s_barrier
    s_waitcnt vmcnt(47)
    s_cmp_lt_u32 s53, 1
    s_cbranch_scc1 L_cls33
    s_waitcnt vmcnt(23)
L_cls33:
    s_mov_b32 m0, 32768
    s_mov_b32 s32, 425984
    buffer_load_dwordx4 v8, s[8:11], s32 offen offset:0 nt lds
    buffer_load_dwordx4 v9, s[8:11], s32 offen offset:1024 nt lds
    buffer_load_dwordx4 v10, s[8:11], s32 offen offset:2048 nt lds
    buffer_load_dwordx4 v11, s[8:11], s32 offen offset:3072 nt lds
    s_mov_b32 m0, 36864
    s_mov_b32 s32, 430080
    buffer_load_dwordx4 v12, s[8:11], s32 offen offset:0 nt lds
    buffer_load_dwordx4 v13, s[8:11], s32 offen offset:1024 nt lds
    buffer_load_dwordx4 v14, s[8:11], s32 offen offset:2048 nt lds
    buffer_load_dwordx4 v15, s[8:11], s32 offen offset:3072 nt lds
    s_mov_b32 m0, 40960
    s_mov_b32 s32, 434176
    buffer_load_dwordx4 v8, s[8:11], s32 offen offset:0 nt lds
    buffer_load_dwordx4 v9, s[8:11], s32 offen offset:1024 nt lds
    buffer_load_dwordx4 v10, s[8:11], s32 offen offset:2048 nt lds
    buffer_load_dwordx4 v11, s[8:11], s32 offen offset:3072 nt lds
    s_mov_b32 m0, 45056
    s_mov_b32 s32, 438272
    buffer_load_dwordx4 v12, s[8:11], s32 offen offset:0 nt lds
    buffer_load_dwordx4 v13, s[8:11], s32 offen offset:1024 nt lds
    buffer_load_dwordx4 v14, s[8:11], s32 offen offset:2048 nt lds
    buffer_load_dwordx4 v15, s[8:11], s32 offen offset:3072 nt lds
    s_barrier
    s_waitcnt vmcnt(47)
    s_cmp_lt_u32 s53, 1
    s_cbranch_scc1 L_cls34
    s_waitcnt vmcnt(23)
L_cls34:
    s_mov_b32 m0, 81920
    s_mov_b32 s32, 409600
    buffer_load_dwordx4 v16, s[12:15], s32 offen offset:0 nt lds
    buffer_load_dwordx4 v17, s[12:15], s32 offen offset:1024 nt lds
    buffer_load_dwordx4 v18, s[12:15], s32 offen offset:2048 nt lds
    buffer_load_dwordx4 v19, s[12:15], s32 offen offset:3072 nt lds
    s_mov_b32 m0, 86016
    s_mov_b32 s32, 413696
    buffer_load_dwordx4 v16, s[12:15], s32 offen offset:0 nt lds
    buffer_load_dwordx4 v17, s[12:15], s32 offen offset:1024 nt lds
    buffer_load_dwordx4 v18, s[12:15], s32 offen offset:2048 nt lds
    buffer_load_dwordx4 v19, s[12:15], s32 offen offset:3072 nt lds
    s_mov_b32 m0, 90112
    s_mov_b32 s32, 417792
    buffer_load_dwordx4 v16, s[12:15], s32 offen offset:0 nt lds
    buffer_load_dwordx4 v17, s[12:15], s32 offen offset:1024 nt lds
    buffer_load_dwordx4 v18, s[12:15], s32 offen offset:2048 nt lds
    buffer_load_dwordx4 v19, s[12:15], s32 offen offset:3072 nt lds
    s_mov_b32 m0, 94208
    s_mov_b32 s32, 421888
    buffer_load_dwordx4 v16, s[12:15], s32 offen offset:0 nt lds
    buffer_load_dwordx4 v17, s[12:15], s32 offen offset:1024 nt lds
    buffer_load_dwordx4 v18, s[12:15], s32 offen offset:2048 nt lds
    buffer_load_dwordx4 v19, s[12:15], s32 offen offset:3072 nt lds
    s_waitcnt vmcnt(55)
    s_mov_b32 s32, 129792
    buffer_load_dwordx4 v[96:99], v28, s[20:23], s32 offen
    s_mov_b32 s32, 131584
    buffer_load_dwordx4 v[100:103], v29, s[20:23], s32 offen
    s_mov_b32 s32, 133376
    buffer_load_dwordx4 v[104:107], v30, s[20:23], s32 offen
    s_mov_b32 s32, 135168
    buffer_load_dwordx4 v[108:111], v31, s[20:23], s32 offen
    s_mov_b32 s32, 136960
    buffer_load_dwordx4 v[112:115], v28, s[20:23], s32 offen
    s_mov_b32 s32, 138752
    buffer_load_dwordx4 v[116:119], v29, s[20:23], s32 offen
    s_mov_b32 s32, 140544
    buffer_load_dwordx4 v[120:123], v30, s[20:23], s32 offen
    s_mov_b32 s32, 142336
    buffer_load_dwordx4 v[124:127], v31, s[20:23], s32 offen
    s_barrier
    s_waitcnt vmcnt(47)
    s_cmp_lt_u32 s53, 1
    s_cbranch_scc1 L_cls35
    s_waitcnt vmcnt(23)
L_cls35:
    s_mov_b32 m0, 49152
    s_mov_b32 s32, 442368
    buffer_load_dwordx4 v8, s[8:11], s32 offen offset:0 nt lds
    buffer_load_dwordx4 v9, s[8:11], s32 offen offset:1024 nt lds
    buffer_load_dwordx4 v10, s[8:11], s32 offen offset:2048 nt lds
    buffer_load_dwordx4 v11, s[8:11], s32 offen offset:3072 nt lds
    s_mov_b32 m0, 53248
    s_mov_b32 s32, 446464
    buffer_load_dwordx4 v12, s[8:11], s32 offen offset:0 nt lds
    buffer_load_dwordx4 v13, s[8:11], s32 offen offset:1024 nt lds
    buffer_load_dwordx4 v14, s[8:11], s32 offen offset:2048 nt lds
    buffer_load_dwordx4 v15, s[8:11], s32 offen offset:3072 nt lds
    s_mov_b32 m0, 57344
    s_mov_b32 s32, 450560
    buffer_load_dwordx4 v8, s[8:11], s32 offen offset:0 nt lds
    buffer_load_dwordx4 v9, s[8:11], s32 offen offset:1024 nt lds
    buffer_load_dwordx4 v10, s[8:11], s32 offen offset:2048 nt lds
    buffer_load_dwordx4 v11, s[8:11], s32 offen offset:3072 nt lds
    s_mov_b32 m0, 61440
    s_mov_b32 s32, 454656
    buffer_load_dwordx4 v12, s[8:11], s32 offen offset:0 nt lds
    buffer_load_dwordx4 v13, s[8:11], s32 offen offset:1024 nt lds
    buffer_load_dwordx4 v14, s[8:11], s32 offen offset:2048 nt lds
    buffer_load_dwordx4 v15, s[8:11], s32 offen offset:3072 nt lds
    s_barrier
    s_waitcnt vmcnt(47)
    s_cmp_lt_u32 s53, 1
    s_cbranch_scc1 L_cls36
    s_waitcnt vmcnt(23)
L_cls36:
    s_mov_b32 m0, 98304
    s_mov_b32 s32, 425984
    buffer_load_dwordx4 v16, s[12:15], s32 offen offset:0 nt lds
    buffer_load_dwordx4 v17, s[12:15], s32 offen offset:1024 nt lds
    buffer_load_dwordx4 v18, s[12:15], s32 offen offset:2048 nt lds
    buffer_load_dwordx4 v19, s[12:15], s32 offen offset:3072 nt lds
    s_mov_b32 m0, 102400
    s_mov_b32 s32, 430080
    buffer_load_dwordx4 v16, s[12:15], s32 offen offset:0 nt lds
    buffer_load_dwordx4 v17, s[12:15], s32 offen offset:1024 nt lds
    buffer_load_dwordx4 v18, s[12:15], s32 offen offset:2048 nt lds
    buffer_load_dwordx4 v19, s[12:15], s32 offen offset:3072 nt lds
    s_mov_b32 m0, 106496
    s_mov_b32 s32, 434176
    buffer_load_dwordx4 v16, s[12:15], s32 offen offset:0 nt lds
    buffer_load_dwordx4 v17, s[12:15], s32 offen offset:1024 nt lds
    buffer_load_dwordx4 v18, s[12:15], s32 offen offset:2048 nt lds
    buffer_load_dwordx4 v19, s[12:15], s32 offen offset:3072 nt lds
    s_mov_b32 m0, 110592
    s_mov_b32 s32, 438272
    buffer_load_dwordx4 v16, s[12:15], s32 offen offset:0 nt lds
    buffer_load_dwordx4 v17, s[12:15], s32 offen offset:1024 nt lds
    buffer_load_dwordx4 v18, s[12:15], s32 offen offset:2048 nt lds
    buffer_load_dwordx4 v19, s[12:15], s32 offen offset:3072 nt lds
    s_waitcnt vmcnt(56)
    s_barrier
    s_waitcnt vmcnt(47)
    s_cmp_lt_u32 s53, 1
    s_cbranch_scc1 L_cls37
    s_waitcnt vmcnt(23)
L_cls37:
    s_mov_b32 m0, 0
    s_mov_b32 s32, 458752
    buffer_load_dwordx4 v8, s[8:11], s32 offen offset:0 nt lds
    buffer_load_dwordx4 v9, s[8:11], s32 offen offset:1024 nt lds
    buffer_load_dwordx4 v10, s[8:11], s32 offen offset:2048 nt lds
    buffer_load_dwordx4 v11, s[8:11], s32 offen offset:3072 nt lds
    s_mov_b32 m0, 4096
    s_mov_b32 s32, 462848
    buffer_load_dwordx4 v12, s[8:11], s32 offen offset:0 nt lds
    buffer_load_dwordx4 v13, s[8:11], s32 offen offset:1024 nt lds
    buffer_load_dwordx4 v14, s[8:11], s32 offen offset:2048 nt lds
    buffer_load_dwordx4 v15, s[8:11], s32 offen offset:3072 nt lds
    s_mov_b32 m0, 8192
    s_mov_b32 s32, 466944
    buffer_load_dwordx4 v8, s[8:11], s32 offen offset:0 nt lds
    buffer_load_dwordx4 v9, s[8:11], s32 offen offset:1024 nt lds
    buffer_load_dwordx4 v10, s[8:11], s32 offen offset:2048 nt lds
    buffer_load_dwordx4 v11, s[8:11], s32 offen offset:3072 nt lds
    s_mov_b32 m0, 12288
    s_mov_b32 s32, 471040
    buffer_load_dwordx4 v12, s[8:11], s32 offen offset:0 nt lds
    buffer_load_dwordx4 v13, s[8:11], s32 offen offset:1024 nt lds
    buffer_load_dwordx4 v14, s[8:11], s32 offen offset:2048 nt lds
    buffer_load_dwordx4 v15, s[8:11], s32 offen offset:3072 nt lds
    s_waitcnt vmcnt(56)
    s_barrier
    s_waitcnt vmcnt(47)
    s_cmp_lt_u32 s53, 1
    s_cbranch_scc1 L_cls38
    s_waitcnt vmcnt(23)
L_cls38:
    s_mov_b32 m0, 114688
    s_mov_b32 s32, 442368
    buffer_load_dwordx4 v16, s[12:15], s32 offen offset:0 nt lds
    buffer_load_dwordx4 v17, s[12:15], s32 offen offset:1024 nt lds
    buffer_load_dwordx4 v18, s[12:15], s32 offen offset:2048 nt lds
    buffer_load_dwordx4 v19, s[12:15], s32 offen offset:3072 nt lds
    s_mov_b32 m0, 118784
    s_mov_b32 s32, 446464
    buffer_load_dwordx4 v16, s[12:15], s32 offen offset:0 nt lds
    buffer_load_dwordx4 v17, s[12:15], s32 offen offset:1024 nt lds
    buffer_load_dwordx4 v18, s[12:15], s32 offen offset:2048 nt lds
    buffer_load_dwordx4 v19, s[12:15], s32 offen offset:3072 nt lds
    s_mov_b32 m0, 122880
    s_mov_b32 s32, 450560
    buffer_load_dwordx4 v16, s[12:15], s32 offen offset:0 nt lds
    buffer_load_dwordx4 v17, s[12:15], s32 offen offset:1024 nt lds
    buffer_load_dwordx4 v18, s[12:15], s32 offen offset:2048 nt lds
    buffer_load_dwordx4 v19, s[12:15], s32 offen offset:3072 nt lds
    s_mov_b32 m0, 126976
    s_mov_b32 s32, 454656
    buffer_load_dwordx4 v16, s[12:15], s32 offen offset:0 nt lds
    buffer_load_dwordx4 v17, s[12:15], s32 offen offset:1024 nt lds
    buffer_load_dwordx4 v18, s[12:15], s32 offen offset:2048 nt lds
    buffer_load_dwordx4 v19, s[12:15], s32 offen offset:3072 nt lds
    s_getpc_b64 s[56:57]
L_pc_tail:
    s_add_u32 s56, s56, L_tail_code-L_pc_tail
    s_addc_u32 s57, s57, (L_tail_code-L_pc_tail)>>32
    s_mov_b32 s58, L_tail_end-L_tail_code
    s_mov_b32 s59, 0x20000
    s_lshr_b32 s33, s2, 3
    s_mul_i32 s33, s33, 3072
    s_waitcnt vmcnt(60)
    buffer_load_dwordx4 v[36:39], v32, s[56:59], s33 offen offset:0
    buffer_load_dwordx4 v[36:39], v32, s[56:59], s33 offen offset:1024
    buffer_load_dwordx4 v[36:39], v32, s[56:59], s33 offen offset:2048
    s_waitcnt vmcnt(51)
    s_barrier
    s_waitcnt vmcnt(47)
    s_cmp_lt_u32 s53, 1
    s_cbranch_scc1 L_cls39
    s_waitcnt vmcnt(23)
L_cls39:
    s_mov_b32 m0, 16384
    s_mov_b32 s32, 475136
    buffer_load_dwordx4 v8, s[8:11], s32 offen offset:0 nt lds
    buffer_load_dwordx4 v9, s[8:11], s32 offen offset:1024 nt lds
    buffer_load_dwordx4 v10, s[8:11], s32 offen offset:2048 nt lds
    buffer_load_dwordx4 v11, s[8:11], s32 offen offset:3072 nt lds
    s_mov_b32 m0, 20480
    s_mov_b32 s32, 479232
    buffer_load_dwordx4 v12, s[8:11], s32 offen offset:0 nt lds
    buffer_load_dwordx4 v13, s[8:11], s32 offen offset:1024 nt lds
    buffer_load_dwordx4 v14, s[8:11], s32 offen offset:2048 nt lds
    buffer_load_dwordx4 v15, s[8:11], s32 offen offset:3072 nt lds
    s_mov_b32 m0, 24576
    s_mov_b32 s32, 483328
    buffer_load_dwordx4 v8, s[8:11], s32 offen offset:0 nt lds
    buffer_load_dwordx4 v9, s[8:11], s32 offen offset:1024 nt lds
    buffer_load_dwordx4 v10, s[8:11], s32 offen offset:2048 nt lds
    buffer_load_dwordx4 v11, s[8:11], s32 offen offset:3072 nt lds
    s_mov_b32 m0, 28672
    s_mov_b32 s32, 487424
    buffer_load_dwordx4 v12, s[8:11], s32 offen offset:0 nt lds
    buffer_load_dwordx4 v13, s[8:11], s32 offen offset:1024 nt lds
    buffer_load_dwordx4 v14, s[8:11], s32 offen offset:2048 nt lds
    buffer_load_dwordx4 v15, s[8:11], s32 offen offset:3072 nt lds
    s_waitcnt vmcnt(47)
    s_mov_b32 m0, 131072
    s_mov_b32 s32, 0
    buffer_load_dwordx4 v24, s[20:23], s32 offen lds
    s_mov_b32 m0, 132096
    s_mov_b32 s32, 1792
    buffer_load_dwordx4 v25, s[20:23], s32 offen lds
    s_mov_b32 m0, 133120
    s_mov_b32 s32, 3584
    buffer_load_dwordx4 v26, s[20:23], s32 offen lds
    s_mov_b32 m0, 134144
    s_mov_b32 s32, 5376
    buffer_load_dwordx4 v27, s[20:23], s32 offen lds
    s_mov_b32 m0, 135168
    s_mov_b32 s32, 7168
    buffer_load_dwordx4 v24, s[20:23], s32 offen lds
    s_mov_b32 m0, 136192
    s_mov_b32 s32, 8960
    buffer_load_dwordx4 v25, s[20:23], s32 offen lds
    s_mov_b32 m0, 137216
    s_mov_b32 s32, 10752
    buffer_load_dwordx4 v26, s[20:23], s32 offen lds
    s_mov_b32 m0, 138240
    s_mov_b32 s32, 12544
    buffer_load_dwordx4 v27, s[20:23], s32 offen lds
    s_mov_b32 m0, 139264
    s_mov_b32 s32, 14336
    buffer_load_dwordx4 v24, s[20:23], s32 offen lds
    s_mov_b32 m0, 140288
    s_mov_b32 s32, 16128
    buffer_load_dwordx4 v25, s[20:23], s32 offen lds
    s_mov_b32 m0, 141312
    s_mov_b32 s32, 17920
    buffer_load_dwordx4 v26, s[20:23], s32 offen lds
    s_mov_b32 m0, 142336
    s_mov_b32 s32, 19712
    buffer_load_dwordx4 v27, s[20:23], s32 offen lds
    s_mov_b32 m0, 143360
    s_mov_b32 s32, 21504
    buffer_load_dwordx4 v24, s[20:23], s32 offen lds
    s_mov_b32 m0, 144384
    s_mov_b32 s32, 23296
    buffer_load_dwordx4 v25, s[20:23], s32 offen lds
    s_mov_b32 m0, 145408
    s_mov_b32 s32, 25088
    buffer_load_dwordx4 v26, s[20:23], s32 offen lds
    s_mov_b32 m0, 146432
    s_mov_b32 s32, 26880
    buffer_load_dwordx4 v27, s[20:23], s32 offen lds
    s_barrier
    s_waitcnt vmcnt(47)
    s_cmp_lt_u32 s53, 1
    s_cbranch_scc1 L_cls40
    s_waitcnt vmcnt(23)
L_cls40:
    s_mov_b32 m0, 65536
    s_mov_b32 s32, 458752
    buffer_load_dwordx4 v16, s[12:15], s32 offen offset:0 nt lds
    buffer_load_dwordx4 v17, s[12:15], s32 offen offset:1024 nt lds
    buffer_load_dwordx4 v18, s[12:15], s32 offen offset:2048 nt lds
    buffer_load_dwordx4 v19, s[12:15], s32 offen offset:3072 nt lds
    s_mov_b32 m0, 69632
    s_mov_b32 s32, 462848
    buffer_load_dwordx4 v16, s[12:15], s32 offen offset:0 nt lds
    buffer_load_dwordx4 v17, s[12:15], s32 offen offset:1024 nt lds
    buffer_load_dwordx4 v18, s[12:15], s32 offen offset:2048 nt lds
    buffer_load_dwordx4 v19, s[12:15], s32 offen offset:3072 nt lds
    s_mov_b32 m0, 73728
    s_mov_b32 s32, 466944
    buffer_load_dwordx4 v16, s[12:15], s32 offen offset:0 nt lds
    buffer_load_dwordx4 v17, s[12:15], s32 offen offset:1024 nt lds
    buffer_load_dwordx4 v18, s[12:15], s32 offen offset:2048 nt lds
    buffer_load_dwordx4 v19, s[12:15], s32 offen offset:3072 nt lds
    s_mov_b32 m0, 77824
    s_mov_b32 s32, 471040
    buffer_load_dwordx4 v16, s[12:15], s32 offen offset:0 nt lds
    buffer_load_dwordx4 v17, s[12:15], s32 offen offset:1024 nt lds
    buffer_load_dwordx4 v18, s[12:15], s32 offen offset:2048 nt lds
    buffer_load_dwordx4 v19, s[12:15], s32 offen offset:3072 nt lds
    s_barrier
    s_waitcnt vmcnt(47)
    s_cmp_lt_u32 s53, 1
    s_cbranch_scc1 L_cls41
    s_waitcnt vmcnt(23)
L_cls41:
    s_mov_b32 m0, 32768
    s_mov_b32 s32, 491520
    buffer_load_dwordx4 v8, s[8:11], s32 offen offset:0 nt lds
    buffer_load_dwordx4 v9, s[8:11], s32 offen offset:1024 nt lds
    buffer_load_dwordx4 v10, s[8:11], s32 offen offset:2048 nt lds
    buffer_load_dwordx4 v11, s[8:11], s32 offen offset:3072 nt lds
    s_mov_b32 m0, 36864
    s_mov_b32 s32, 495616
    buffer_load_dwordx4 v12, s[8:11], s32 offen offset:0 nt lds
    buffer_load_dwordx4 v13, s[8:11], s32 offen offset:1024 nt lds
    buffer_load_dwordx4 v14, s[8:11], s32 offen offset:2048 nt lds
    buffer_load_dwordx4 v15, s[8:11], s32 offen offset:3072 nt lds
    s_mov_b32 m0, 40960
    s_mov_b32 s32, 499712
    buffer_load_dwordx4 v8, s[8:11], s32 offen offset:0 nt lds
    buffer_load_dwordx4 v9, s[8:11], s32 offen offset:1024 nt lds
    buffer_load_dwordx4 v10, s[8:11], s32 offen offset:2048 nt lds
    buffer_load_dwordx4 v11, s[8:11], s32 offen offset:3072 nt lds
    s_mov_b32 m0, 45056
    s_mov_b32 s32, 503808
    buffer_load_dwordx4 v12, s[8:11], s32 offen offset:0 nt lds
    buffer_load_dwordx4 v13, s[8:11], s32 offen offset:1024 nt lds
    buffer_load_dwordx4 v14, s[8:11], s32 offen offset:2048 nt lds
    buffer_load_dwordx4 v15, s[8:11], s32 offen offset:3072 nt lds
    s_waitcnt vmcnt(47)
    s_mov_b32 m0, 147456
    s_mov_b32 s32, 57344
    buffer_load_dwordx4 v24, s[20:23], s32 offen lds
    s_mov_b32 m0, 148480
    s_mov_b32 s32, 59136
    buffer_load_dwordx4 v25, s[20:23], s32 offen lds
    s_mov_b32 m0, 149504
    s_mov_b32 s32, 60928
    buffer_load_dwordx4 v26, s[20:23], s32 offen lds
    s_mov_b32 m0, 150528
    s_mov_b32 s32, 62720
    buffer_load_dwordx4 v27, s[20:23], s32 offen lds
    s_mov_b32 m0, 151552
    s_mov_b32 s32, 64512
    buffer_load_dwordx4 v24, s[20:23], s32 offen lds
    s_mov_b32 m0, 152576
    s_mov_b32 s32, 66304
    buffer_load_dwordx4 v25, s[20:23], s32 offen lds
    s_mov_b32 m0, 153600
    s_mov_b32 s32, 68096
    buffer_load_dwordx4 v26, s[20:23], s32 offen lds
    s_mov_b32 m0, 154624
    s_mov_b32 s32, 69888
    buffer_load_dwordx4 v27, s[20:23], s32 offen lds
    s_mov_b32 m0, 155648
    s_mov_b32 s32, 71680
    buffer_load_dwordx4 v24, s[20:23], s32 offen lds
    s_mov_b32 m0, 156672
    s_mov_b32 s32, 73472
    buffer_load_dwordx4 v25, s[20:23], s32 offen lds
    s_mov_b32 m0, 157696
    s_mov_b32 s32, 75264
    buffer_load_dwordx4 v26, s[20:23], s32 offen lds
    s_mov_b32 m0, 158720
    s_mov_b32 s32, 77056
    buffer_load_dwordx4 v27, s[20:23], s32 offen lds
    s_mov_b32 m0, 159744
    s_mov_b32 s32, 78848
    buffer_load_dwordx4 v24, s[20:23], s32 offen lds
    s_mov_b32 m0, 160768
    s_mov_b32 s32, 80640
    buffer_load_dwordx4 v25, s[20:23], s32 offen lds
    s_mov_b32 m0, 161792
    s_mov_b32 s32, 82432
    buffer_load_dwordx4 v26, s[20:23], s32 offen lds
    s_mov_b32 m0, 162816
    s_mov_b32 s32, 84224
    buffer_load_dwordx4 v27, s[20:23], s32 offen lds
    s_barrier
    s_waitcnt vmcnt(47)
    s_cmp_lt_u32 s53, 1
    s_cbranch_scc1 L_cls42
    s_waitcnt vmcnt(23)
L_cls42:
    s_mov_b32 m0, 81920
    s_mov_b32 s32, 475136
    buffer_load_dwordx4 v16, s[12:15], s32 offen offset:0 nt lds
    buffer_load_dwordx4 v17, s[12:15], s32 offen offset:1024 nt lds
    buffer_load_dwordx4 v18, s[12:15], s32 offen offset:2048 nt lds
    buffer_load_dwordx4 v19, s[12:15], s32 offen offset:3072 nt lds
    s_mov_b32 m0, 86016
    s_mov_b32 s32, 479232
    buffer_load_dwordx4 v16, s[12:15], s32 offen offset:0 nt lds
    buffer_load_dwordx4 v17, s[12:15], s32 offen offset:1024 nt lds
    buffer_load_dwordx4 v18, s[12:15], s32 offen offset:2048 nt lds
    buffer_load_dwordx4 v19, s[12:15], s32 offen offset:3072 nt lds
    s_mov_b32 m0, 90112
    s_mov_b32 s32, 483328
    buffer_load_dwordx4 v16, s[12:15], s32 offen offset:0 nt lds
    buffer_load_dwordx4 v17, s[12:15], s32 offen offset:1024 nt lds
    buffer_load_dwordx4 v18, s[12:15], s32 offen offset:2048 nt lds
    buffer_load_dwordx4 v19, s[12:15], s32 offen offset:3072 nt lds
    s_mov_b32 m0, 94208
    s_mov_b32 s32, 487424
    buffer_load_dwordx4 v16, s[12:15], s32 offen offset:0 nt lds
    buffer_load_dwordx4 v17, s[12:15], s32 offen offset:1024 nt lds
    buffer_load_dwordx4 v18, s[12:15], s32 offen offset:2048 nt lds
    buffer_load_dwordx4 v19, s[12:15], s32 offen offset:3072 nt lds
    s_barrier
    s_waitcnt vmcnt(47)
    s_cmp_lt_u32 s53, 1
    s_cbranch_scc1 L_cls43
    s_waitcnt vmcnt(23)
L_cls43:
    s_mov_b32 m0, 49152
    s_mov_b32 s32, 507904
    buffer_load_dwordx4 v8, s[8:11], s32 offen offset:0 nt lds
    buffer_load_dwordx4 v9, s[8:11], s32 offen offset:1024 nt lds
    buffer_load_dwordx4 v10, s[8:11], s32 offen offset:2048 nt lds
    buffer_load_dwordx4 v11, s[8:11], s32 offen offset:3072 nt lds
    s_mov_b32 m0, 53248
    s_mov_b32 s32, 512000
    buffer_load_dwordx4 v12, s[8:11], s32 offen offset:0 nt lds
    buffer_load_dwordx4 v13, s[8:11], s32 offen offset:1024 nt lds
    buffer_load_dwordx4 v14, s[8:11], s32 offen offset:2048 nt lds
    buffer_load_dwordx4 v15, s[8:11], s32 offen offset:3072 nt lds
    s_mov_b32 m0, 57344
    s_mov_b32 s32, 516096
    buffer_load_dwordx4 v8, s[8:11], s32 offen offset:0 nt lds
    buffer_load_dwordx4 v9, s[8:11], s32 offen offset:1024 nt lds
    buffer_load_dwordx4 v10, s[8:11], s32 offen offset:2048 nt lds
    buffer_load_dwordx4 v11, s[8:11], s32 offen offset:3072 nt lds
    s_mov_b32 m0, 61440
    s_mov_b32 s32, 520192
    buffer_load_dwordx4 v12, s[8:11], s32 offen offset:0 nt lds
    buffer_load_dwordx4 v13, s[8:11], s32 offen offset:1024 nt lds
    buffer_load_dwordx4 v14, s[8:11], s32 offen offset:2048 nt lds
    buffer_load_dwordx4 v15, s[8:11], s32 offen offset:3072 nt lds
    s_waitcnt vmcnt(47)
    s_mov_b32 m0, 0
    s_mov_b32 s32, 114688
    buffer_load_dwordx4 v24, s[20:23], s32 offen lds
    s_mov_b32 m0, 1024
    s_mov_b32 s32, 116480
    buffer_load_dwordx4 v25, s[20:23], s32 offen lds
    s_mov_b32 m0, 2048
    s_mov_b32 s32, 118272
    buffer_load_dwordx4 v26, s[20:23], s32 offen lds
    s_mov_b32 m0, 3072
    s_mov_b32 s32, 120064
    buffer_load_dwordx4 v27, s[20:23], s32 offen lds
    s_mov_b32 m0, 4096
    s_mov_b32 s32, 121856
    buffer_load_dwordx4 v24, s[20:23], s32 offen lds
    s_mov_b32 m0, 5120
    s_mov_b32 s32, 123648
    buffer_load_dwordx4 v25, s[20:23], s32 offen lds
    s_mov_b32 m0, 6144
    s_mov_b32 s32, 125440
    buffer_load_dwordx4 v26, s[20:23], s32 offen lds
    s_mov_b32 m0, 7168
    s_mov_b32 s32, 127232
    buffer_load_dwordx4 v27, s[20:23], s32 offen lds
    s_mov_b32 m0, 8192
    s_mov_b32 s32, 129024
    buffer_load_dwordx4 v24, s[20:23], s32 offen lds
    s_mov_b32 m0, 9216
    s_mov_b32 s32, 130816
    buffer_load_dwordx4 v25, s[20:23], s32 offen lds
    s_mov_b32 m0, 10240
    s_mov_b32 s32, 132608
    buffer_load_dwordx4 v26, s[20:23], s32 offen lds
    s_mov_b32 m0, 11264
    s_mov_b32 s32, 134400
    buffer_load_dwordx4 v27, s[20:23], s32 offen lds
    s_mov_b32 m0, 12288
    s_mov_b32 s32, 136192
    buffer_load_dwordx4 v24, s[20:23], s32 offen lds
    s_mov_b32 m0, 13312
    s_mov_b32 s32, 137984
    buffer_load_dwordx4 v25, s[20:23], s32 offen lds
    s_mov_b32 m0, 14336
    s_mov_b32 s32, 139776
    buffer_load_dwordx4 v26, s[20:23], s32 offen lds
    s_mov_b32 m0, 15360
    s_mov_b32 s32, 141568
    buffer_load_dwordx4 v27, s[20:23], s32 offen lds
    s_barrier
    s_waitcnt vmcnt(47)
    s_cmp_lt_u32 s53, 1
    s_cbranch_scc1 L_cls44
    s_waitcnt vmcnt(23)
L_cls44:
    s_mov_b32 m0, 98304
    s_mov_b32 s32, 491520
    buffer_load_dwordx4 v16, s[12:15], s32 offen offset:0 nt lds
    buffer_load_dwordx4 v17, s[12:15], s32 offen offset:1024 nt lds
    buffer_load_dwordx4 v18, s[12:15], s32 offen offset:2048 nt lds
    buffer_load_dwordx4 v19, s[12:15], s32 offen offset:3072 nt lds
    s_mov_b32 m0, 102400
    s_mov_b32 s32, 495616
    buffer_load_dwordx4 v16, s[12:15], s32 offen offset:0 nt lds
    buffer_load_dwordx4 v17, s[12:15], s32 offen offset:1024 nt lds
    buffer_load_dwordx4 v18, s[12:15], s32 offen offset:2048 nt lds
    buffer_load_dwordx4 v19, s[12:15], s32 offen offset:3072 nt lds
    s_mov_b32 m0, 106496
    s_mov_b32 s32, 499712
    buffer_load_dwordx4 v16, s[12:15], s32 offen offset:0 nt lds
    buffer_load_dwordx4 v17, s[12:15], s32 offen offset:1024 nt lds
    buffer_load_dwordx4 v18, s[12:15], s32 offen offset:2048 nt lds
    buffer_load_dwordx4 v19, s[12:15], s32 offen offset:3072 nt lds
    s_mov_b32 m0, 110592
    s_mov_b32 s32, 503808
    buffer_load_dwordx4 v16, s[12:15], s32 offen offset:0 nt lds
    buffer_load_dwordx4 v17, s[12:15], s32 offen offset:1024 nt lds
    buffer_load_dwordx4 v18, s[12:15], s32 offen offset:2048 nt lds
    buffer_load_dwordx4 v19, s[12:15], s32 offen offset:3072 nt lds
    s_barrier
    s_waitcnt vmcnt(47)
    s_mov_b32 m0, 16384
    s_mov_b32 s32, 172032
    buffer_load_dwordx4 v24, s[20:23], s32 offen lds
    s_mov_b32 m0, 17408
    s_mov_b32 s32, 173824
    buffer_load_dwordx4 v25, s[20:23], s32 offen lds
    s_mov_b32 m0, 18432
    s_mov_b32 s32, 175616
    buffer_load_dwordx4 v26, s[20:23], s32 offen lds
    s_mov_b32 m0, 19456
    s_mov_b32 s32, 177408
    buffer_load_dwordx4 v27, s[20:23], s32 offen lds
    s_mov_b32 m0, 20480
    s_mov_b32 s32, 179200
    buffer_load_dwordx4 v24, s[20:23], s32 offen lds
    s_mov_b32 m0, 21504
    s_mov_b32 s32, 180992
    buffer_load_dwordx4 v25, s[20:23], s32 offen lds
    s_mov_b32 m0, 22528
    s_mov_b32 s32, 182784
    buffer_load_dwordx4 v26, s[20:23], s32 offen lds
    s_mov_b32 m0, 23552
    s_mov_b32 s32, 184576
    buffer_load_dwordx4 v27, s[20:23], s32 offen lds
    s_mov_b32 m0, 24576
    s_mov_b32 s32, 186368
    buffer_load_dwordx4 v24, s[20:23], s32 offen lds
    s_mov_b32 m0, 25600
    s_mov_b32 s32, 188160
    buffer_load_dwordx4 v25, s[20:23], s32 offen lds
    s_mov_b32 m0, 26624
    s_mov_b32 s32, 189952
    buffer_load_dwordx4 v26, s[20:23], s32 offen lds
    s_mov_b32 m0, 27648
    s_mov_b32 s32, 191744
    buffer_load_dwordx4 v27, s[20:23], s32 offen lds
    s_mov_b32 m0, 28672
    s_mov_b32 s32, 193536
    buffer_load_dwordx4 v24, s[20:23], s32 offen lds
    s_mov_b32 m0, 29696
    s_mov_b32 s32, 195328
    buffer_load_dwordx4 v25, s[20:23], s32 offen lds
    s_mov_b32 m0, 30720
    s_mov_b32 s32, 197120
    buffer_load_dwordx4 v26, s[20:23], s32 offen lds
    s_mov_b32 m0, 31744
    s_mov_b32 s32, 198912
    buffer_load_dwordx4 v27, s[20:23], s32 offen lds
    s_barrier
    s_waitcnt vmcnt(47)
    s_cmp_lt_u32 s53, 1
    s_cbranch_scc1 L_cls45
    s_waitcnt vmcnt(23)
L_cls45:
    s_mov_b32 m0, 114688
    s_mov_b32 s32, 507904
    buffer_load_dwordx4 v16, s[12:15], s32 offen offset:0 nt lds
    buffer_load_dwordx4 v17, s[12:15], s32 offen offset:1024 nt lds
    buffer_load_dwordx4 v18, s[12:15], s32 offen offset:2048 nt lds
    buffer_load_dwordx4 v19, s[12:15], s32 offen offset:3072 nt lds
    s_mov_b32 m0, 118784
    s_mov_b32 s32, 512000
    buffer_load_dwordx4 v16, s[12:15], s32 offen offset:0 nt lds
    buffer_load_dwordx4 v17, s[12:15], s32 offen offset:1024 nt lds
    buffer_load_dwordx4 v18, s[12:15], s32 offen offset:2048 nt lds
    buffer_load_dwordx4 v19, s[12:15], s32 offen offset:3072 nt lds
    s_mov_b32 m0, 122880
    s_mov_b32 s32, 516096
    buffer_load_dwordx4 v16, s[12:15], s32 offen offset:0 nt lds
    buffer_load_dwordx4 v17, s[12:15], s32 offen offset:1024 nt lds
    buffer_load_dwordx4 v18, s[12:15], s32 offen offset:2048 nt lds
    buffer_load_dwordx4 v19, s[12:15], s32 offen offset:3072 nt lds
    s_mov_b32 m0, 126976
    s_mov_b32 s32, 520192
    buffer_load_dwordx4 v16, s[12:15], s32 offen offset:0 nt lds
    buffer_load_dwordx4 v17, s[12:15], s32 offen offset:1024 nt lds
    buffer_load_dwordx4 v18, s[12:15], s32 offen offset:2048 nt lds
    buffer_load_dwordx4 v19, s[12:15], s32 offen offset:3072 nt lds
    s_waitcnt vmcnt(47)
    s_mov_b32 m0, 65536
    s_mov_b32 s32, 256
    buffer_load_dwordx4 v28, s[20:23], s32 offen lds
    s_mov_b32 m0, 66560
    s_mov_b32 s32, 2048
    buffer_load_dwordx4 v29, s[20:23], s32 offen lds
    s_mov_b32 m0, 67584
    s_mov_b32 s32, 3840
    buffer_load_dwordx4 v30, s[20:23], s32 offen lds
    s_mov_b32 m0, 68608
    s_mov_b32 s32, 5632
    buffer_load_dwordx4 v31, s[20:23], s32 offen lds
    s_mov_b32 m0, 69632
    s_mov_b32 s32, 7424
    buffer_load_dwordx4 v28, s[20:23], s32 offen lds
    s_mov_b32 m0, 70656
    s_mov_b32 s32, 9216
    buffer_load_dwordx4 v29, s[20:23], s32 offen lds
    s_mov_b32 m0, 71680
    s_mov_b32 s32, 11008
    buffer_load_dwordx4 v30, s[20:23], s32 offen lds
    s_mov_b32 m0, 72704
    s_mov_b32 s32, 12800
    buffer_load_dwordx4 v31, s[20:23], s32 offen lds
    s_mov_b32 m0, 73728
    s_mov_b32 s32, 14592
    buffer_load_dwordx4 v28, s[20:23], s32 offen lds
    s_mov_b32 m0, 74752
    s_mov_b32 s32, 16384
    buffer_load_dwordx4 v29, s[20:23], s32 offen lds
    s_mov_b32 m0, 75776
    s_mov_b32 s32, 18176
    buffer_load_dwordx4 v30, s[20:23], s32 offen lds
    s_mov_b32 m0, 76800
    s_mov_b32 s32, 19968
    buffer_load_dwordx4 v31, s[20:23], s32 offen lds
    s_mov_b32 m0, 77824
    s_mov_b32 s32, 21760
    buffer_load_dwordx4 v28, s[20:23], s32 offen lds
    s_mov_b32 m0, 78848
    s_mov_b32 s32, 23552
    buffer_load_dwordx4 v29, s[20:23], s32 offen lds
    s_mov_b32 m0, 79872
    s_mov_b32 s32, 25344
    buffer_load_dwordx4 v30, s[20:23], s32 offen lds
    s_mov_b32 m0, 80896
    s_mov_b32 s32, 27136
    buffer_load_dwordx4 v31, s[20:23], s32 offen lds
    s_barrier
    s_waitcnt vmcnt(47)
    s_mov_b32 m0, 32768
    s_mov_b32 s32, 114944
    buffer_load_dwordx4 v28, s[20:23], s32 offen lds
    s_mov_b32 m0, 33792
    s_mov_b32 s32, 116736
    buffer_load_dwordx4 v29, s[20:23], s32 offen lds
    s_mov_b32 m0, 34816
    s_mov_b32 s32, 118528
    buffer_load_dwordx4 v30, s[20:23], s32 offen lds
    s_mov_b32 m0, 35840
    s_mov_b32 s32, 120320
    buffer_load_dwordx4 v31, s[20:23], s32 offen lds
    s_mov_b32 m0, 36864
    s_mov_b32 s32, 122112
    buffer_load_dwordx4 v28, s[20:23], s32 offen lds
    s_mov_b32 m0, 37888
    s_mov_b32 s32, 123904
    buffer_load_dwordx4 v29, s[20:23], s32 offen lds
    s_mov_b32 m0, 38912
    s_mov_b32 s32, 125696
    buffer_load_dwordx4 v30, s[20:23], s32 offen lds
    s_mov_b32 m0, 39936
    s_mov_b32 s32, 127488
    buffer_load_dwordx4 v31, s[20:23], s32 offen lds
    s_mov_b32 m0, 40960
    s_mov_b32 s32, 129280
    buffer_load_dwordx4 v28, s[20:23], s32 offen lds
    s_mov_b32 m0, 41984
    s_mov_b32 s32, 131072
    buffer_load_dwordx4 v29, s[20:23], s32 offen lds
    s_mov_b32 m0, 43008
    s_mov_b32 s32, 132864
    buffer_load_dwordx4 v30, s[20:23], s32 offen lds
    s_mov_b32 m0, 44032
    s_mov_b32 s32, 134656
    buffer_load_dwordx4 v31, s[20:23], s32 offen lds
    s_mov_b32 m0, 45056
    s_mov_b32 s32, 136448
    buffer_load_dwordx4 v28, s[20:23], s32 offen lds
    s_mov_b32 m0, 46080
    s_mov_b32 s32, 138240
    buffer_load_dwordx4 v29, s[20:23], s32 offen lds
    s_mov_b32 m0, 47104
    s_mov_b32 s32, 140032
    buffer_load_dwordx4 v30, s[20:23], s32 offen lds
    s_mov_b32 m0, 48128
    s_mov_b32 s32, 141824
    buffer_load_dwordx4 v31, s[20:23], s32 offen lds
    s_barrier
    s_waitcnt vmcnt(47)
    s_mov_b32 m0, 81920
    s_mov_b32 s32, 384
    buffer_load_dwordx4 v28, s[20:23], s32 offen lds
    s_mov_b32 m0, 82944
    s_mov_b32 s32, 2176
    buffer_load_dwordx4 v29, s[20:23], s32 offen lds
    s_mov_b32 m0, 83968
    s_mov_b32 s32, 3968
    buffer_load_dwordx4 v30, s[20:23], s32 offen lds
    s_mov_b32 m0, 84992
    s_mov_b32 s32, 5760
    buffer_load_dwordx4 v31, s[20:23], s32 offen lds
    s_mov_b32 m0, 86016
    s_mov_b32 s32, 7552
    buffer_load_dwordx4 v28, s[20:23], s32 offen lds
    s_mov_b32 m0, 87040
    s_mov_b32 s32, 9344
    buffer_load_dwordx4 v29, s[20:23], s32 offen lds
    s_mov_b32 m0, 88064
    s_mov_b32 s32, 11136
    buffer_load_dwordx4 v30, s[20:23], s32 offen lds
    s_mov_b32 m0, 89088
    s_mov_b32 s32, 12928
    buffer_load_dwordx4 v31, s[20:23], s32 offen lds
    s_mov_b32 m0, 90112
    s_mov_b32 s32, 14720
    buffer_load_dwordx4 v28, s[20:23], s32 offen lds
    s_mov_b32 m0, 91136
    s_mov_b32 s32, 16512
    buffer_load_dwordx4 v29, s[20:23], s32 offen lds
    s_mov_b32 m0, 92160
    s_mov_b32 s32, 18304
    buffer_load_dwordx4 v30, s[20:23], s32 offen lds
    s_mov_b32 m0, 93184
    s_mov_b32 s32, 20096
    buffer_load_dwordx4 v31, s[20:23], s32 offen lds
    s_mov_b32 m0, 94208
    s_mov_b32 s32, 21888
    buffer_load_dwordx4 v28, s[20:23], s32 offen lds
    s_mov_b32 m0, 95232
    s_mov_b32 s32, 23680
    buffer_load_dwordx4 v29, s[20:23], s32 offen lds
    s_mov_b32 m0, 96256
    s_mov_b32 s32, 25472
    buffer_load_dwordx4 v30, s[20:23], s32 offen lds
    s_mov_b32 m0, 97280
    s_mov_b32 s32, 27264
    buffer_load_dwordx4 v31, s[20:23], s32 offen lds
    s_waitcnt vmcnt(48)
    s_barrier
    s_waitcnt vmcnt(47)
    s_mov_b32 m0, 49152
    s_mov_b32 s32, 115072
    buffer_load_dwordx4 v28, s[20:23], s32 offen lds
    s_mov_b32 m0, 50176
    s_mov_b32 s32, 116864
    buffer_load_dwordx4 v29, s[20:23], s32 offen lds
    s_mov_b32 m0, 51200
    s_mov_b32 s32, 118656
    buffer_load_dwordx4 v30, s[20:23], s32 offen lds
    s_mov_b32 m0, 52224
    s_mov_b32 s32, 120448
    buffer_load_dwordx4 v31, s[20:23], s32 offen lds
    s_mov_b32 m0, 53248
    s_mov_b32 s32, 122240
    buffer_load_dwordx4 v28, s[20:23], s32 offen lds
    s_mov_b32 m0, 54272
    s_mov_b32 s32, 124032
    buffer_load_dwordx4 v29, s[20:23], s32 offen lds
    s_mov_b32 m0, 55296
    s_mov_b32 s32, 125824
    buffer_load_dwordx4 v30, s[20:23], s32 offen lds
    s_mov_b32 m0, 56320
    s_mov_b32 s32, 127616
    buffer_load_dwordx4 v31, s[20:23], s32 offen lds
    s_mov_b32 m0, 57344
    s_mov_b32 s32, 129408
    buffer_load_dwordx4 v28, s[20:23], s32 offen lds
    s_mov_b32 m0, 58368
    s_mov_b32 s32, 131200
    buffer_load_dwordx4 v29, s[20:23], s32 offen lds
    s_mov_b32 m0, 59392
    s_mov_b32 s32, 132992
    buffer_load_dwordx4 v30, s[20:23], s32 offen lds
    s_mov_b32 m0, 60416
    s_mov_b32 s32, 134784
    buffer_load_dwordx4 v31, s[20:23], s32 offen lds
    s_mov_b32 m0, 61440
    s_mov_b32 s32, 136576
    buffer_load_dwordx4 v28, s[20:23], s32 offen lds
    s_mov_b32 m0, 62464
    s_mov_b32 s32, 138368
    buffer_load_dwordx4 v29, s[20:23], s32 offen lds
    s_mov_b32 m0, 63488
    s_mov_b32 s32, 140160
    buffer_load_dwordx4 v30, s[20:23], s32 offen lds
    s_mov_b32 m0, 64512
    s_mov_b32 s32, 141952
    buffer_load_dwordx4 v31, s[20:23], s32 offen lds
    s_waitcnt vmcnt(47)
    s_mov_b32 m0, 98304
    s_mov_b32 s32, 512
    buffer_load_dwordx4 v28, s[20:23], s32 offen lds
    s_mov_b32 m0, 99328
    s_mov_b32 s32, 2304
    buffer_load_dwordx4 v29, s[20:23], s32 offen lds
    s_mov_b32 m0, 100352
    s_mov_b32 s32, 4096
    buffer_load_dwordx4 v30, s[20:23], s32 offen lds
    s_mov_b32 m0, 101376
    s_mov_b32 s32, 5888
    buffer_load_dwordx4 v31, s[20:23], s32 offen lds
    s_mov_b32 m0, 102400
    s_mov_b32 s32, 7680
    buffer_load_dwordx4 v28, s[20:23], s32 offen lds
    s_mov_b32 m0, 103424
    s_mov_b32 s32, 9472
    buffer_load_dwordx4 v29, s[20:23], s32 offen lds
    s_mov_b32 m0, 104448
    s_mov_b32 s32, 11264
    buffer_load_dwordx4 v30, s[20:23], s32 offen lds
    s_mov_b32 m0, 105472
    s_mov_b32 s32, 13056
    buffer_load_dwordx4 v31, s[20:23], s32 offen lds
    s_mov_b32 m0, 106496
    s_mov_b32 s32, 14848
    buffer_load_dwordx4 v28, s[20:23], s32 offen lds
    s_mov_b32 m0, 107520
    s_mov_b32 s32, 16640
    buffer_load_dwordx4 v29, s[20:23], s32 offen lds
    s_mov_b32 m0, 108544
    s_mov_b32 s32, 18432
    buffer_load_dwordx4 v30, s[20:23], s32 offen lds
    s_mov_b32 m0, 109568
    s_mov_b32 s32, 20224
    buffer_load_dwordx4 v31, s[20:23], s32 offen lds
    s_mov_b32 m0, 110592
    s_mov_b32 s32, 22016
    buffer_load_dwordx4 v28, s[20:23], s32 offen lds
    s_mov_b32 m0, 111616
    s_mov_b32 s32, 23808
    buffer_load_dwordx4 v29, s[20:23], s32 offen lds
    s_mov_b32 m0, 112640
    s_mov_b32 s32, 25600
    buffer_load_dwordx4 v30, s[20:23], s32 offen lds
    s_mov_b32 m0, 113664
    s_mov_b32 s32, 27392
    buffer_load_dwordx4 v31, s[20:23], s32 offen lds
    s_barrier
    v_add_u32 v33, 114688, v32
    ds_write_b128 v33, a[0:3] offset:0
    ds_write_b128 v33, a[4:7] offset:1024
    ds_write_b128 v33, a[8:11] offset:2048
    ds_write_b128 v33, a[12:15] offset:3072
    ds_write_b128 v33, a[16:19] offset:4096
    ds_write_b128 v33, a[20:23] offset:5120
    ds_write_b128 v33, a[24:27] offset:6144
    ds_write_b128 v33, a[28:31] offset:7168
    ds_write_b128 v33, a[32:35] offset:8192
    ds_write_b128 v33, a[36:39] offset:9216
    s_barrier
    v_add_u32 v33, 114688, v32
    ds_write_b128 v33, a[40:43] offset:10240
    ds_write_b128 v33, a[44:47] offset:11264
    ds_write_b128 v33, a[48:51] offset:12288
    ds_write_b128 v33, a[52:55] offset:13312
    ds_write_b128 v33, a[56:59] offset:14336
    ds_write_b128 v33, a[60:63] offset:15360
    v_add_u32 v33, 131072, v32
    ds_write_b128 v33, a[64:67] offset:0
    ds_write_b128 v33, a[68:71] offset:1024
    ds_write_b128 v33, a[72:75] offset:2048
    ds_write_b128 v33, a[76:79] offset:3072
    s_barrier
    v_add_u32 v33, 131072, v32
    ds_write_b128 v33, a[80:83] offset:4096
    ds_write_b128 v33, a[84:87] offset:5120
    ds_write_b128 v33, a[88:91] offset:6144
    ds_write_b128 v33, a[92:95] offset:7168
    ds_write_b128 v33, a[96:99] offset:8192
    ds_write_b128 v33, a[100:103] offset:9216
    ds_write_b128 v33, a[104:107] offset:10240
    ds_write_b128 v33, a[108:111] offset:11264
    ds_write_b128 v33, a[112:115] offset:12288
    ds_write_b128 v33, a[116:119] offset:13312
    s_barrier
    v_add_u32 v33, 131072, v32
    ds_write_b128 v33, a[120:123] offset:14336
    ds_write_b128 v33, a[124:127] offset:15360
    v_add_u32 v33, 147456, v32
    ds_write_b128 v33, a[128:131] offset:0
    ds_write_b128 v33, a[132:135] offset:1024
    ds_write_b128 v33, a[136:139] offset:2048
    ds_write_b128 v33, a[140:143] offset:3072
    ds_write_b128 v33, a[144:147] offset:4096
    ds_write_b128 v33, a[148:151] offset:5120
    ds_write_b128 v33, a[152:155] offset:6144
    ds_write_b128 v33, a[156:159] offset:7168
    s_waitcnt vmcnt(48)
    s_barrier
    v_add_u32 v33, 147456, v32
    ds_write_b128 v33, a[160:163] offset:8192
    ds_write_b128 v33, a[164:167] offset:9216
    ds_write_b128 v33, a[168:171] offset:10240
    ds_write_b128 v33, a[172:175] offset:11264
    ds_write_b128 v33, a[176:179] offset:12288
    ds_write_b128 v33, a[180:183] offset:13312
    ds_write_b128 v33, a[184:187] offset:14336
    ds_write_b128 v33, a[188:191] offset:15360
    v_add_u32 v33, 0, v32
    ds_write_b128 v33, a[192:195] offset:0
    ds_write_b128 v33, a[196:199] offset:1024
    s_waitcnt vmcnt(32)
    s_barrier
    v_add_u32 v33, 0, v32
    ds_write_b128 v33, a[200:203] offset:2048
    ds_write_b128 v33, a[204:207] offset:3072
    ds_write_b128 v33, a[208:211] offset:4096
    ds_write_b128 v33, a[212:215] offset:5120
    ds_write_b128 v33, a[216:219] offset:6144
    ds_write_b128 v33, a[220:223] offset:7168
    ds_write_b128 v33, a[224:227] offset:8192
    ds_write_b128 v33, a[228:231] offset:9216
    ds_write_b128 v33, a[232:235] offset:10240
    ds_write_b128 v33, a[236:239] offset:11264
    v_lshlrev_b32 v33, 2, v1
    v_add_u32 v33, 65536, v33
    v_mov_b32 v34, 0
    ds_write_b32 v33, v34
    s_waitcnt lgkmcnt(0)
    s_waitcnt vmcnt(16)
    s_barrier
    v_add_u32 v33, 0, v32
    ds_write_b128 v33, a[240:243] offset:12288
    ds_write_b128 v33, a[244:247] offset:13312
    ds_write_b128 v33, a[248:251] offset:14336
    ds_write_b128 v33, a[252:255] offset:15360
    v_add_u32 v33, 16384, v32
    ds_write_b128 v33, v[64:67] offset:0
    ds_write_b128 v33, v[68:71] offset:1024
    ds_write_b128 v33, v[72:75] offset:2048
    ds_write_b128 v33, v[76:79] offset:3072
    ds_write_b128 v33, v[80:83] offset:4096
    ds_write_b128 v33, v[84:87] offset:5120
    s_waitcnt vmcnt(0)
    s_barrier
    v_add_u32 v33, 16384, v32
    ds_write_b128 v33, v[88:91] offset:6144
    ds_write_b128 v33, v[92:95] offset:7168
    ds_write_b128 v33, v[96:99] offset:8192
    ds_write_b128 v33, v[100:103] offset:9216
    ds_write_b128 v33, v[104:107] offset:10240
    ds_write_b128 v33, v[108:111] offset:11264
    ds_write_b128 v33, v[112:115] offset:12288
    ds_write_b128 v33, v[116:119] offset:13312
    ds_write_b128 v33, v[120:123] offset:14336
    ds_write_b128 v33, v[124:127] offset:15360
    s_waitcnt lgkmcnt(0)
    s_barrier
    s_waitcnt vmcnt(0)
    s_lshl_b32 s84, s30, 3
    s_add_u32 s84, s84, s28
    s_lshl_b32 s84, s84, 14
    s_add_u32 s84, s84, 34603008
    s_add_u32 s84, s72, s84
    s_addc_u32 s85, s73, 0
    s_mov_b32 s86, 16384
    s_mov_b32 s87, 0x20000
    s_lshl_b32 s88, s30, 3
    s_add_u32 s88, s88, s28
    s_mul_i32 s45, s88, 2064384
    s_add_u32 s44, s72, s45
    s_addc_u32 s45, s73, 0
    s_mov_b32 s46, 2064384
    s_mov_b32 s47, 0x20000
    s_mov_b32 s92, s80
    s_mov_b32 s93, s81
    s_mov_b32 s94, 2064384
    s_mov_b32 s95, 0x20000
    s_mul_i32 s64, s88, 9216
    s_add_u32 s64, s64, 35651584
    s_add_u32 s64, s72, s64
    s_addc_u32 s65, s73, 0
    s_mov_b32 s66, 9216
    s_mov_b32 s67, 0x20000
    s_add_u32 s90, s29, 0
    s_lshr_b32 s96, s90, 2
    s_and_b32 s90, s90, 3
    s_add_u32 s97, s90, 0
    s_add_u32 s90, s29, 16
    s_lshr_b32 s98, s90, 2
    s_and_b32 s90, s90, 3
    s_add_u32 s99, s90, 0
    v_lshlrev_b32 v2, 4, v1
    v_and_b32 v3, 15, v1
    v_mul_u32_u24 v3, 1792, v3
    v_lshrrev_b32 v9, 4, v1
    v_lshl_add_u32 v3, v9, 3, v3
    s_lshl_b32 s76, s96, 10
    s_mul_i32 s90, s96, 14
    s_add_u32 s90, s90, s97
    s_lshl_b32 s91, s90, 10
    s_mul_i32 s100, s28, 144
    s_lshl_b32 s90, s96, 4
    s_add_u32 s100, s100, s90
    s_mul_i32 s100, s100, 1792
    s_lshl_b32 s90, s97, 6
    s_add_u32 s100, s100, s90
    s_mul_i32 s90, s30, 896
    s_add_u32 s96, s100, s90
    s_mov_b32 s97, s91
    s_lshl_b32 s77, s98, 10
    s_mul_i32 s90, s98, 14
    s_add_u32 s90, s90, s99
    s_lshl_b32 s91, s90, 10
    s_mul_i32 s100, s28, 144
    s_lshl_b32 s90, s98, 4
    s_add_u32 s100, s100, s90
    s_mul_i32 s100, s100, 1792
    s_lshl_b32 s90, s99, 6
    s_add_u32 s100, s100, s90
    s_mul_i32 s90, s30, 896
    s_add_u32 s98, s100, s90
    s_mov_b32 s99, s91
    s_mov_b64 exec, 1
    s_mov_b32 s89, 0
L_poll1:
    s_mov_b32 s88, 0
    buffer_load_dword v9, off, s[84:87], s88 sc1
    s_waitcnt vmcnt(0)
    v_readfirstlane_b32 s90, v9
    s_add_u32 s89, s89, 1
    s_cmp_ge_u32 s90, 16
    s_cbranch_scc1 L_poll_done1
    s_cmp_ge_u32 s89, 0x40000
    s_cbranch_scc1 L_poll_done1
    s_sleep 2
    s_branch L_poll1
L_poll_done1:
    s_mov_b64 exec, -1
    v_and_b32 v5, 15, v1
    v_lshlrev_b32 v5, 6, v5
    s_mov_b32 s91, s97
    buffer_load_dwordx4 v[64:67], v2, s[44:47], s91 offen sc0 sc1
    s_add_u32 s91, s91, 129024
    buffer_load_dwordx4 v[192:195], v5, s[64:67], s76 offen offset:0 sc0 sc1
    buffer_load_dwordx4 v[196:199], v5, s[64:67], s76 offen offset:16 sc0 sc1
    buffer_load_dwordx4 v[200:203], v5, s[64:67], s76 offen offset:32 sc0 sc1
    buffer_load_dwordx4 v[204:207], v5, s[64:67], s76 offen offset:48 sc0 sc1
    buffer_load_dwordx4 v[68:71], v2, s[44:47], s91 offen sc0 sc1
    s_add_u32 s91, s91, 129024
    buffer_load_dwordx4 v[72:75], v2, s[44:47], s91 offen sc0 sc1
    s_add_u32 s91, s91, 129024
    buffer_load_dwordx4 v[76:79], v2, s[44:47], s91 offen sc0 sc1
    s_add_u32 s91, s91, 129024
    buffer_load_dwordx4 v[80:83], v2, s[44:47], s91 offen sc0 sc1
    s_add_u32 s91, s91, 129024
    buffer_load_dwordx4 v[84:87], v2, s[44:47], s91 offen sc0 sc1
    s_add_u32 s91, s91, 129024
    buffer_load_dwordx4 v[88:91], v2, s[44:47], s91 offen sc0 sc1
    s_add_u32 s91, s91, 129024
    buffer_load_dwordx4 v[92:95], v2, s[44:47], s91 offen sc0 sc1
    s_add_u32 s91, s91, 129024
    buffer_load_dwordx4 v[96:99], v2, s[44:47], s91 offen sc0 sc1
    s_add_u32 s91, s91, 129024
    buffer_load_dwordx4 v[100:103], v2, s[44:47], s91 offen sc0 sc1
    s_add_u32 s91, s91, 129024
    buffer_load_dwordx4 v[104:107], v2, s[44:47], s91 offen sc0 sc1
    s_add_u32 s91, s91, 129024
    buffer_load_dwordx4 v[108:111], v2, s[44:47], s91 offen sc0 sc1
    s_add_u32 s91, s91, 129024
    buffer_load_dwordx4 v[112:115], v2, s[44:47], s91 offen sc0 sc1
    s_add_u32 s91, s91, 129024
    buffer_load_dwordx4 v[116:119], v2, s[44:47], s91 offen sc0 sc1
    s_add_u32 s91, s91, 129024
    buffer_load_dwordx4 v[120:123], v2, s[44:47], s91 offen sc0 sc1
    s_add_u32 s91, s91, 129024
    buffer_load_dwordx4 v[124:127], v2, s[44:47], s91 offen sc0 sc1
    s_mov_b32 s91, s99
    buffer_load_dwordx4 v[128:131], v2, s[44:47], s91 offen sc0 sc1
    s_add_u32 s91, s91, 129024
    buffer_load_dwordx4 v[208:211], v5, s[64:67], s77 offen offset:0 sc0 sc1
    buffer_load_dwordx4 v[212:215], v5, s[64:67], s77 offen offset:16 sc0 sc1
    buffer_load_dwordx4 v[216:219], v5, s[64:67], s77 offen offset:32 sc0 sc1
    buffer_load_dwordx4 v[220:223], v5, s[64:67], s77 offen offset:48 sc0 sc1
    buffer_load_dwordx4 v[132:135], v2, s[44:47], s91 offen sc0 sc1
    s_add_u32 s91, s91, 129024
    buffer_load_dwordx4 v[136:139], v2, s[44:47], s91 offen sc0 sc1
    s_add_u32 s91, s91, 129024
    buffer_load_dwordx4 v[140:143], v2, s[44:47], s91 offen sc0 sc1
    s_add_u32 s91, s91, 129024
    buffer_load_dwordx4 v[144:147], v2, s[44:47], s91 offen sc0 sc1
    s_add_u32 s91, s91, 129024
    buffer_load_dwordx4 v[148:151], v2, s[44:47], s91 offen sc0 sc1
    s_add_u32 s91, s91, 129024
    buffer_load_dwordx4 v[152:155], v2, s[44:47], s91 offen sc0 sc1
    s_add_u32 s91, s91, 129024
    buffer_load_dwordx4 v[156:159], v2, s[44:47], s91 offen sc0 sc1
    s_add_u32 s91, s91, 129024
    buffer_load_dwordx4 v[160:163], v2, s[44:47], s91 offen sc0 sc1
    s_add_u32 s91, s91, 129024
    buffer_load_dwordx4 v[164:167], v2, s[44:47], s91 offen sc0 sc1
    s_add_u32 s91, s91, 129024
    buffer_load_dwordx4 v[168:171], v2, s[44:47], s91 offen sc0 sc1
    s_add_u32 s91, s91, 129024
    buffer_load_dwordx4 v[172:175], v2, s[44:47], s91 offen sc0 sc1
    s_add_u32 s91, s91, 129024
    buffer_load_dwordx4 v[176:179], v2, s[44:47], s91 offen sc0 sc1
    s_add_u32 s91, s91, 129024
    buffer_load_dwordx4 v[180:183], v2, s[44:47], s91 offen sc0 sc1
    s_add_u32 s91, s91, 129024
    buffer_load_dwordx4 v[184:187], v2, s[44:47], s91 offen sc0 sc1
    s_add_u32 s91, s91, 129024
    buffer_load_dwordx4 v[188:191], v2, s[44:47], s91 offen sc0 sc1
    s_waitcnt vmcnt(35)
    v_lshlrev_b32 v8, 16, v64
    v_and_b32 v9, 0xffff0000, v64
    v_lshlrev_b32 v10, 16, v65
    v_and_b32 v11, 0xffff0000, v65
    v_lshlrev_b32 v12, 16, v66
    v_and_b32 v13, 0xffff0000, v66
    v_lshlrev_b32 v14, 16, v67
    v_and_b32 v15, 0xffff0000, v67
    v_pk_mul_f32 v[32:33], v[8:9], v[192:193] op_sel:[0,0] op_sel_hi:[1,0]
    v_pk_mul_f32 v[34:35], v[10:11], v[192:193] op_sel:[0,0] op_sel_hi:[1,0]
    v_pk_mul_f32 v[36:37], v[12:13], v[192:193] op_sel:[0,0] op_sel_hi:[1,0]
    v_pk_mul_f32 v[38:39], v[14:15], v[192:193] op_sel:[0,0] op_sel_hi:[1,0]
    s_waitcnt vmcnt(34)
    v_lshlrev_b32 v8, 16, v68
    v_and_b32 v9, 0xffff0000, v68
    v_lshlrev_b32 v10, 16, v69
    v_and_b32 v11, 0xffff0000, v69
    v_lshlrev_b32 v12, 16, v70
    v_and_b32 v13, 0xffff0000, v70
    v_lshlrev_b32 v14, 16, v71
    v_and_b32 v15, 0xffff0000, v71
    v_pk_fma_f32 v[32:33], v[8:9], v[192:193], v[32:33] op_sel:[0,1,0] op_sel_hi:[1,1,1]
    v_pk_fma_f32 v[34:35], v[10:11], v[192:193], v[34:35] op_sel:[0,1,0] op_sel_hi:[1,1,1]
    v_pk_fma_f32 v[36:37], v[12:13], v[192:193], v[36:37] op_sel:[0,1,0] op_sel_hi:[1,1,1]
    v_pk_fma_f32 v[38:39], v[14:15], v[192:193], v[38:39] op_sel:[0,1,0] op_sel_hi:[1,1,1]
    s_waitcnt vmcnt(33)
    v_lshlrev_b32 v8, 16, v72
    v_and_b32 v9, 0xffff0000, v72
    v_lshlrev_b32 v10, 16, v73
    v_and_b32 v11, 0xffff0000, v73
    v_lshlrev_b32 v12, 16, v74
    v_and_b32 v13, 0xffff0000, v74
    v_lshlrev_b32 v14, 16, v75
    v_and_b32 v15, 0xffff0000, v75
    v_pk_fma_f32 v[32:33], v[8:9], v[194:195], v[32:33] op_sel:[0,0,0] op_sel_hi:[1,0,1]
    v_pk_fma_f32 v[34:35], v[10:11], v[194:195], v[34:35] op_sel:[0,0,0] op_sel_hi:[1,0,1]
    v_pk_fma_f32 v[36:37], v[12:13], v[194:195], v[36:37] op_sel:[0,0,0] op_sel_hi:[1,0,1]
    v_pk_fma_f32 v[38:39], v[14:15], v[194:195], v[38:39] op_sel:[0,0,0] op_sel_hi:[1,0,1]
    s_waitcnt vmcnt(32)
    v_lshlrev_b32 v8, 16, v76
    v_and_b32 v9, 0xffff0000, v76
    v_lshlrev_b32 v10, 16, v77
    v_and_b32 v11, 0xffff0000, v77
    v_lshlrev_b32 v12, 16, v78
    v_and_b32 v13, 0xffff0000, v78
    v_lshlrev_b32 v14, 16, v79
    v_and_b32 v15, 0xffff0000, v79
    v_pk_fma_f32 v[32:33], v[8:9], v[194:195], v[32:33] op_sel:[0,1,0] op_sel_hi:[1,1,1]
    v_pk_fma_f32 v[34:35], v[10:11], v[194:195], v[34:35] op_sel:[0,1,0] op_sel_hi:[1,1,1]
    v_pk_fma_f32 v[36:37], v[12:13], v[194:195], v[36:37] op_sel:[0,1,0] op_sel_hi:[1,1,1]
    v_pk_fma_f32 v[38:39], v[14:15], v[194:195], v[38:39] op_sel:[0,1,0] op_sel_hi:[1,1,1]
    s_waitcnt vmcnt(31)
    v_lshlrev_b32 v8, 16, v80
    v_and_b32 v9, 0xffff0000, v80
    v_lshlrev_b32 v10, 16, v81
    v_and_b32 v11, 0xffff0000, v81
    v_lshlrev_b32 v12, 16, v82
    v_and_b32 v13, 0xffff0000, v82
    v_lshlrev_b32 v14, 16, v83
    v_and_b32 v15, 0xffff0000, v83
    v_pk_fma_f32 v[32:33], v[8:9], v[196:197], v[32:33] op_sel:[0,0,0] op_sel_hi:[1,0,1]
    v_pk_fma_f32 v[34:35], v[10:11], v[196:197], v[34:35] op_sel:[0,0,0] op_sel_hi:[1,0,1]
    v_pk_fma_f32 v[36:37], v[12:13], v[196:197], v[36:37] op_sel:[0,0,0] op_sel_hi:[1,0,1]
    v_pk_fma_f32 v[38:39], v[14:15], v[196:197], v[38:39] op_sel:[0,0,0] op_sel_hi:[1,0,1]
    s_waitcnt vmcnt(30)
    v_lshlrev_b32 v8, 16, v84
    v_and_b32 v9, 0xffff0000, v84
    v_lshlrev_b32 v10, 16, v85
    v_and_b32 v11, 0xffff0000, v85
    v_lshlrev_b32 v12, 16, v86
    v_and_b32 v13, 0xffff0000, v86
    v_lshlrev_b32 v14, 16, v87
    v_and_b32 v15, 0xffff0000, v87
    v_pk_fma_f32 v[32:33], v[8:9], v[196:197], v[32:33] op_sel:[0,1,0] op_sel_hi:[1,1,1]
    v_pk_fma_f32 v[34:35], v[10:11], v[196:197], v[34:35] op_sel:[0,1,0] op_sel_hi:[1,1,1]
    v_pk_fma_f32 v[36:37], v[12:13], v[196:197], v[36:37] op_sel:[0,1,0] op_sel_hi:[1,1,1]
    v_pk_fma_f32 v[38:39], v[14:15], v[196:197], v[38:39] op_sel:[0,1,0] op_sel_hi:[1,1,1]
    s_waitcnt vmcnt(29)
    v_lshlrev_b32 v8, 16, v88
    v_and_b32 v9, 0xffff0000, v88
    v_lshlrev_b32 v10, 16, v89
    v_and_b32 v11, 0xffff0000, v89
    v_lshlrev_b32 v12, 16, v90
    v_and_b32 v13, 0xffff0000, v90
    v_lshlrev_b32 v14, 16, v91
    v_and_b32 v15, 0xffff0000, v91
    v_pk_fma_f32 v[32:33], v[8:9], v[198:199], v[32:33] op_sel:[0,0,0] op_sel_hi:[1,0,1]
    v_pk_fma_f32 v[34:35], v[10:11], v[198:199], v[34:35] op_sel:[0,0,0] op_sel_hi:[1,0,1]
    v_pk_fma_f32 v[36:37], v[12:13], v[198:199], v[36:37] op_sel:[0,0,0] op_sel_hi:[1,0,1]
    v_pk_fma_f32 v[38:39], v[14:15], v[198:199], v[38:39] op_sel:[0,0,0] op_sel_hi:[1,0,1]
    s_waitcnt vmcnt(28)
    v_lshlrev_b32 v8, 16, v92
    v_and_b32 v9, 0xffff0000, v92
    v_lshlrev_b32 v10, 16, v93
    v_and_b32 v11, 0xffff0000, v93
    v_lshlrev_b32 v12, 16, v94
    v_and_b32 v13, 0xffff0000, v94
    v_lshlrev_b32 v14, 16, v95
    v_and_b32 v15, 0xffff0000, v95
    v_pk_fma_f32 v[32:33], v[8:9], v[198:199], v[32:33] op_sel:[0,1,0] op_sel_hi:[1,1,1]
    v_pk_fma_f32 v[34:35], v[10:11], v[198:199], v[34:35] op_sel:[0,1,0] op_sel_hi:[1,1,1]
    v_pk_fma_f32 v[36:37], v[12:13], v[198:199], v[36:37] op_sel:[0,1,0] op_sel_hi:[1,1,1]
    v_pk_fma_f32 v[38:39], v[14:15], v[198:199], v[38:39] op_sel:[0,1,0] op_sel_hi:[1,1,1]
    s_waitcnt vmcnt(27)
    v_lshlrev_b32 v8, 16, v96
    v_and_b32 v9, 0xffff0000, v96
    v_lshlrev_b32 v10, 16, v97
    v_and_b32 v11, 0xffff0000, v97
    v_lshlrev_b32 v12, 16, v98
    v_and_b32 v13, 0xffff0000, v98
    v_lshlrev_b32 v14, 16, v99
    v_and_b32 v15, 0xffff0000, v99
    v_pk_fma_f32 v[32:33], v[8:9], v[200:201], v[32:33] op_sel:[0,0,0] op_sel_hi:[1,0,1]
    v_pk_fma_f32 v[34:35], v[10:11], v[200:201], v[34:35] op_sel:[0,0,0] op_sel_hi:[1,0,1]
    v_pk_fma_f32 v[36:37], v[12:13], v[200:201], v[36:37] op_sel:[0,0,0] op_sel_hi:[1,0,1]
    v_pk_fma_f32 v[38:39], v[14:15], v[200:201], v[38:39] op_sel:[0,0,0] op_sel_hi:[1,0,1]
    s_waitcnt vmcnt(26)
    v_lshlrev_b32 v8, 16, v100
    v_and_b32 v9, 0xffff0000, v100
    v_lshlrev_b32 v10, 16, v101
    v_and_b32 v11, 0xffff0000, v101
    v_lshlrev_b32 v12, 16, v102
    v_and_b32 v13, 0xffff0000, v102
    v_lshlrev_b32 v14, 16, v103
    v_and_b32 v15, 0xffff0000, v103
    v_pk_fma_f32 v[32:33], v[8:9], v[200:201], v[32:33] op_sel:[0,1,0] op_sel_hi:[1,1,1]
    v_pk_fma_f32 v[34:35], v[10:11], v[200:201], v[34:35] op_sel:[0,1,0] op_sel_hi:[1,1,1]
    v_pk_fma_f32 v[36:37], v[12:13], v[200:201], v[36:37] op_sel:[0,1,0] op_sel_hi:[1,1,1]
    v_pk_fma_f32 v[38:39], v[14:15], v[200:201], v[38:39] op_sel:[0,1,0] op_sel_hi:[1,1,1]
    s_waitcnt vmcnt(25)
    v_lshlrev_b32 v8, 16, v104
    v_and_b32 v9, 0xffff0000, v104
    v_lshlrev_b32 v10, 16, v105
    v_and_b32 v11, 0xffff0000, v105
    v_lshlrev_b32 v12, 16, v106
    v_and_b32 v13, 0xffff0000, v106
    v_lshlrev_b32 v14, 16, v107
    v_and_b32 v15, 0xffff0000, v107
    v_pk_fma_f32 v[32:33], v[8:9], v[202:203], v[32:33] op_sel:[0,0,0] op_sel_hi:[1,0,1]
    v_pk_fma_f32 v[34:35], v[10:11], v[202:203], v[34:35] op_sel:[0,0,0] op_sel_hi:[1,0,1]
    v_pk_fma_f32 v[36:37], v[12:13], v[202:203], v[36:37] op_sel:[0,0,0] op_sel_hi:[1,0,1]
    v_pk_fma_f32 v[38:39], v[14:15], v[202:203], v[38:39] op_sel:[0,0,0] op_sel_hi:[1,0,1]
    s_waitcnt vmcnt(24)
    v_lshlrev_b32 v8, 16, v108
    v_and_b32 v9, 0xffff0000, v108
    v_lshlrev_b32 v10, 16, v109
    v_and_b32 v11, 0xffff0000, v109
    v_lshlrev_b32 v12, 16, v110
    v_and_b32 v13, 0xffff0000, v110
    v_lshlrev_b32 v14, 16, v111
    v_and_b32 v15, 0xffff0000, v111
    v_pk_fma_f32 v[32:33], v[8:9], v[202:203], v[32:33] op_sel:[0,1,0] op_sel_hi:[1,1,1]
    v_pk_fma_f32 v[34:35], v[10:11], v[202:203], v[34:35] op_sel:[0,1,0] op_sel_hi:[1,1,1]
    v_pk_fma_f32 v[36:37], v[12:13], v[202:203], v[36:37] op_sel:[0,1,0] op_sel_hi:[1,1,1]
    v_pk_fma_f32 v[38:39], v[14:15], v[202:203], v[38:39] op_sel:[0,1,0] op_sel_hi:[1,1,1]
    s_waitcnt vmcnt(23)
    v_lshlrev_b32 v8, 16, v112
    v_and_b32 v9, 0xffff0000, v112
    v_lshlrev_b32 v10, 16, v113
    v_and_b32 v11, 0xffff0000, v113
    v_lshlrev_b32 v12, 16, v114
    v_and_b32 v13, 0xffff0000, v114
    v_lshlrev_b32 v14, 16, v115
    v_and_b32 v15, 0xffff0000, v115
    v_pk_fma_f32 v[32:33], v[8:9], v[204:205], v[32:33] op_sel:[0,0,0] op_sel_hi:[1,0,1]
    v_pk_fma_f32 v[34:35], v[10:11], v[204:205], v[34:35] op_sel:[0,0,0] op_sel_hi:[1,0,1]
    v_pk_fma_f32 v[36:37], v[12:13], v[204:205], v[36:37] op_sel:[0,0,0] op_sel_hi:[1,0,1]
    v_pk_fma_f32 v[38:39], v[14:15], v[204:205], v[38:39] op_sel:[0,0,0] op_sel_hi:[1,0,1]
    s_waitcnt vmcnt(22)
    v_lshlrev_b32 v8, 16, v116
    v_and_b32 v9, 0xffff0000, v116
    v_lshlrev_b32 v10, 16, v117
    v_and_b32 v11, 0xffff0000, v117
    v_lshlrev_b32 v12, 16, v118
    v_and_b32 v13, 0xffff0000, v118
    v_lshlrev_b32 v14, 16, v119
    v_and_b32 v15, 0xffff0000, v119
    v_pk_fma_f32 v[32:33], v[8:9], v[204:205], v[32:33] op_sel:[0,1,0] op_sel_hi:[1,1,1]
    v_pk_fma_f32 v[34:35], v[10:11], v[204:205], v[34:35] op_sel:[0,1,0] op_sel_hi:[1,1,1]
    v_pk_fma_f32 v[36:37], v[12:13], v[204:205], v[36:37] op_sel:[0,1,0] op_sel_hi:[1,1,1]
    v_pk_fma_f32 v[38:39], v[14:15], v[204:205], v[38:39] op_sel:[0,1,0] op_sel_hi:[1,1,1]
    s_waitcnt vmcnt(21)
    v_lshlrev_b32 v8, 16, v120
    v_and_b32 v9, 0xffff0000, v120
    v_lshlrev_b32 v10, 16, v121
    v_and_b32 v11, 0xffff0000, v121
    v_lshlrev_b32 v12, 16, v122
    v_and_b32 v13, 0xffff0000, v122
    v_lshlrev_b32 v14, 16, v123
    v_and_b32 v15, 0xffff0000, v123
    v_pk_fma_f32 v[32:33], v[8:9], v[206:207], v[32:33] op_sel:[0,0,0] op_sel_hi:[1,0,1]
    v_pk_fma_f32 v[34:35], v[10:11], v[206:207], v[34:35] op_sel:[0,0,0] op_sel_hi:[1,0,1]
    v_pk_fma_f32 v[36:37], v[12:13], v[206:207], v[36:37] op_sel:[0,0,0] op_sel_hi:[1,0,1]
    v_pk_fma_f32 v[38:39], v[14:15], v[206:207], v[38:39] op_sel:[0,0,0] op_sel_hi:[1,0,1]
    s_waitcnt vmcnt(20)
    v_lshlrev_b32 v8, 16, v124
    v_and_b32 v9, 0xffff0000, v124
    v_lshlrev_b32 v10, 16, v125
    v_and_b32 v11, 0xffff0000, v125
    v_lshlrev_b32 v12, 16, v126
    v_and_b32 v13, 0xffff0000, v126
    v_lshlrev_b32 v14, 16, v127
    v_and_b32 v15, 0xffff0000, v127
    v_pk_fma_f32 v[32:33], v[8:9], v[206:207], v[32:33] op_sel:[0,1,0] op_sel_hi:[1,1,1]
    v_pk_fma_f32 v[34:35], v[10:11], v[206:207], v[34:35] op_sel:[0,1,0] op_sel_hi:[1,1,1]
    v_pk_fma_f32 v[36:37], v[12:13], v[206:207], v[36:37] op_sel:[0,1,0] op_sel_hi:[1,1,1]
    v_pk_fma_f32 v[38:39], v[14:15], v[206:207], v[38:39] op_sel:[0,1,0] op_sel_hi:[1,1,1]
    v_cvt_pk_bf16_f32 v48, v32, v33
    v_cvt_pk_bf16_f32 v49, v34, v35
    v_cvt_pk_bf16_f32 v50, v36, v37
    v_cvt_pk_bf16_f32 v51, v38, v39
    s_waitcnt vmcnt(15)
    v_lshlrev_b32 v8, 16, v128
    v_and_b32 v9, 0xffff0000, v128
    v_lshlrev_b32 v10, 16, v129
    v_and_b32 v11, 0xffff0000, v129
    v_lshlrev_b32 v12, 16, v130
    v_and_b32 v13, 0xffff0000, v130
    v_lshlrev_b32 v14, 16, v131
    v_and_b32 v15, 0xffff0000, v131
    v_pk_mul_f32 v[40:41], v[8:9], v[208:209] op_sel:[0,0] op_sel_hi:[1,0]
    v_pk_mul_f32 v[42:43], v[10:11], v[208:209] op_sel:[0,0] op_sel_hi:[1,0]
    v_pk_mul_f32 v[44:45], v[12:13], v[208:209] op_sel:[0,0] op_sel_hi:[1,0]
    v_pk_mul_f32 v[46:47], v[14:15], v[208:209] op_sel:[0,0] op_sel_hi:[1,0]
    s_waitcnt vmcnt(14)
    v_lshlrev_b32 v8, 16, v132
    v_and_b32 v9, 0xffff0000, v132
    v_lshlrev_b32 v10, 16, v133
    v_and_b32 v11, 0xffff0000, v133
    v_lshlrev_b32 v12, 16, v134
    v_and_b32 v13, 0xffff0000, v134
    v_lshlrev_b32 v14, 16, v135
    v_and_b32 v15, 0xffff0000, v135
    v_pk_fma_f32 v[40:41], v[8:9], v[208:209], v[40:41] op_sel:[0,1,0] op_sel_hi:[1,1,1]
    v_pk_fma_f32 v[42:43], v[10:11], v[208:209], v[42:43] op_sel:[0,1,0] op_sel_hi:[1,1,1]
    v_pk_fma_f32 v[44:45], v[12:13], v[208:209], v[44:45] op_sel:[0,1,0] op_sel_hi:[1,1,1]
    v_pk_fma_f32 v[46:47], v[14:15], v[208:209], v[46:47] op_sel:[0,1,0] op_sel_hi:[1,1,1]
    s_waitcnt vmcnt(13)
    v_lshlrev_b32 v8, 16, v136
    v_and_b32 v9, 0xffff0000, v136
    v_lshlrev_b32 v10, 16, v137
    v_and_b32 v11, 0xffff0000, v137
    v_lshlrev_b32 v12, 16, v138
    v_and_b32 v13, 0xffff0000, v138
    v_lshlrev_b32 v14, 16, v139
    v_and_b32 v15, 0xffff0000, v139
    v_pk_fma_f32 v[40:41], v[8:9], v[210:211], v[40:41] op_sel:[0,0,0] op_sel_hi:[1,0,1]
    v_pk_fma_f32 v[42:43], v[10:11], v[210:211], v[42:43] op_sel:[0,0,0] op_sel_hi:[1,0,1]
    v_pk_fma_f32 v[44:45], v[12:13], v[210:211], v[44:45] op_sel:[0,0,0] op_sel_hi:[1,0,1]
    v_pk_fma_f32 v[46:47], v[14:15], v[210:211], v[46:47] op_sel:[0,0,0] op_sel_hi:[1,0,1]
    s_waitcnt vmcnt(12)
    v_lshlrev_b32 v8, 16, v140
    v_and_b32 v9, 0xffff0000, v140
    v_lshlrev_b32 v10, 16, v141
    v_and_b32 v11, 0xffff0000, v141
    v_lshlrev_b32 v12, 16, v142
    v_and_b32 v13, 0xffff0000, v142
    v_lshlrev_b32 v14, 16, v143
    v_and_b32 v15, 0xffff0000, v143
    v_pk_fma_f32 v[40:41], v[8:9], v[210:211], v[40:41] op_sel:[0,1,0] op_sel_hi:[1,1,1]
    v_pk_fma_f32 v[42:43], v[10:11], v[210:211], v[42:43] op_sel:[0,1,0] op_sel_hi:[1,1,1]
    v_pk_fma_f32 v[44:45], v[12:13], v[210:211], v[44:45] op_sel:[0,1,0] op_sel_hi:[1,1,1]
    v_pk_fma_f32 v[46:47], v[14:15], v[210:211], v[46:47] op_sel:[0,1,0] op_sel_hi:[1,1,1]
    s_waitcnt vmcnt(11)
    v_lshlrev_b32 v8, 16, v144
    v_and_b32 v9, 0xffff0000, v144
    v_lshlrev_b32 v10, 16, v145
    v_and_b32 v11, 0xffff0000, v145
    v_lshlrev_b32 v12, 16, v146
    v_and_b32 v13, 0xffff0000, v146
    v_lshlrev_b32 v14, 16, v147
    v_and_b32 v15, 0xffff0000, v147
    v_pk_fma_f32 v[40:41], v[8:9], v[212:213], v[40:41] op_sel:[0,0,0] op_sel_hi:[1,0,1]
    v_pk_fma_f32 v[42:43], v[10:11], v[212:213], v[42:43] op_sel:[0,0,0] op_sel_hi:[1,0,1]
    v_pk_fma_f32 v[44:45], v[12:13], v[212:213], v[44:45] op_sel:[0,0,0] op_sel_hi:[1,0,1]
    v_pk_fma_f32 v[46:47], v[14:15], v[212:213], v[46:47] op_sel:[0,0,0] op_sel_hi:[1,0,1]
    s_waitcnt vmcnt(10)
    v_lshlrev_b32 v8, 16, v148
    v_and_b32 v9, 0xffff0000, v148
    v_lshlrev_b32 v10, 16, v149
    v_and_b32 v11, 0xffff0000, v149
    v_lshlrev_b32 v12, 16, v150
    v_and_b32 v13, 0xffff0000, v150
    v_lshlrev_b32 v14, 16, v151
    v_and_b32 v15, 0xffff0000, v151
    v_pk_fma_f32 v[40:41], v[8:9], v[212:213], v[40:41] op_sel:[0,1,0] op_sel_hi:[1,1,1]
    v_pk_fma_f32 v[42:43], v[10:11], v[212:213], v[42:43] op_sel:[0,1,0] op_sel_hi:[1,1,1]
    v_pk_fma_f32 v[44:45], v[12:13], v[212:213], v[44:45] op_sel:[0,1,0] op_sel_hi:[1,1,1]
    v_pk_fma_f32 v[46:47], v[14:15], v[212:213], v[46:47] op_sel:[0,1,0] op_sel_hi:[1,1,1]
    s_waitcnt vmcnt(9)
    v_lshlrev_b32 v8, 16, v152
    v_and_b32 v9, 0xffff0000, v152
    v_lshlrev_b32 v10, 16, v153
    v_and_b32 v11, 0xffff0000, v153
    v_lshlrev_b32 v12, 16, v154
    v_and_b32 v13, 0xffff0000, v154
    v_lshlrev_b32 v14, 16, v155
    v_and_b32 v15, 0xffff0000, v155
    v_pk_fma_f32 v[40:41], v[8:9], v[214:215], v[40:41] op_sel:[0,0,0] op_sel_hi:[1,0,1]
    v_pk_fma_f32 v[42:43], v[10:11], v[214:215], v[42:43] op_sel:[0,0,0] op_sel_hi:[1,0,1]
    v_pk_fma_f32 v[44:45], v[12:13], v[214:215], v[44:45] op_sel:[0,0,0] op_sel_hi:[1,0,1]
    v_pk_fma_f32 v[46:47], v[14:15], v[214:215], v[46:47] op_sel:[0,0,0] op_sel_hi:[1,0,1]
    s_waitcnt vmcnt(8)
    v_lshlrev_b32 v8, 16, v156
    v_and_b32 v9, 0xffff0000, v156
    v_lshlrev_b32 v10, 16, v157
    v_and_b32 v11, 0xffff0000, v157
    v_lshlrev_b32 v12, 16, v158
    v_and_b32 v13, 0xffff0000, v158
    v_lshlrev_b32 v14, 16, v159
    v_and_b32 v15, 0xffff0000, v159
    v_pk_fma_f32 v[40:41], v[8:9], v[214:215], v[40:41] op_sel:[0,1,0] op_sel_hi:[1,1,1]
    v_pk_fma_f32 v[42:43], v[10:11], v[214:215], v[42:43] op_sel:[0,1,0] op_sel_hi:[1,1,1]
    v_pk_fma_f32 v[44:45], v[12:13], v[214:215], v[44:45] op_sel:[0,1,0] op_sel_hi:[1,1,1]
    v_pk_fma_f32 v[46:47], v[14:15], v[214:215], v[46:47] op_sel:[0,1,0] op_sel_hi:[1,1,1]
    s_waitcnt vmcnt(7)
    v_lshlrev_b32 v8, 16, v160
    v_and_b32 v9, 0xffff0000, v160
    v_lshlrev_b32 v10, 16, v161
    v_and_b32 v11, 0xffff0000, v161
    v_lshlrev_b32 v12, 16, v162
    v_and_b32 v13, 0xffff0000, v162
    v_lshlrev_b32 v14, 16, v163
    v_and_b32 v15, 0xffff0000, v163
    v_pk_fma_f32 v[40:41], v[8:9], v[216:217], v[40:41] op_sel:[0,0,0] op_sel_hi:[1,0,1]
    v_pk_fma_f32 v[42:43], v[10:11], v[216:217], v[42:43] op_sel:[0,0,0] op_sel_hi:[1,0,1]
    v_pk_fma_f32 v[44:45], v[12:13], v[216:217], v[44:45] op_sel:[0,0,0] op_sel_hi:[1,0,1]
    v_pk_fma_f32 v[46:47], v[14:15], v[216:217], v[46:47] op_sel:[0,0,0] op_sel_hi:[1,0,1]
    s_waitcnt vmcnt(6)
    v_lshlrev_b32 v8, 16, v164
    v_and_b32 v9, 0xffff0000, v164
    v_lshlrev_b32 v10, 16, v165
    v_and_b32 v11, 0xffff0000, v165
    v_lshlrev_b32 v12, 16, v166
    v_and_b32 v13, 0xffff0000, v166
    v_lshlrev_b32 v14, 16, v167
    v_and_b32 v15, 0xffff0000, v167
    v_pk_fma_f32 v[40:41], v[8:9], v[216:217], v[40:41] op_sel:[0,1,0] op_sel_hi:[1,1,1]
    v_pk_fma_f32 v[42:43], v[10:11], v[216:217], v[42:43] op_sel:[0,1,0] op_sel_hi:[1,1,1]
    v_pk_fma_f32 v[44:45], v[12:13], v[216:217], v[44:45] op_sel:[0,1,0] op_sel_hi:[1,1,1]
    v_pk_fma_f32 v[46:47], v[14:15], v[216:217], v[46:47] op_sel:[0,1,0] op_sel_hi:[1,1,1]
    s_waitcnt vmcnt(5)
    v_lshlrev_b32 v8, 16, v168
    v_and_b32 v9, 0xffff0000, v168
    v_lshlrev_b32 v10, 16, v169
    v_and_b32 v11, 0xffff0000, v169
    v_lshlrev_b32 v12, 16, v170
    v_and_b32 v13, 0xffff0000, v170
    v_lshlrev_b32 v14, 16, v171
    v_and_b32 v15, 0xffff0000, v171
    v_pk_fma_f32 v[40:41], v[8:9], v[218:219], v[40:41] op_sel:[0,0,0] op_sel_hi:[1,0,1]
    v_pk_fma_f32 v[42:43], v[10:11], v[218:219], v[42:43] op_sel:[0,0,0] op_sel_hi:[1,0,1]
    v_pk_fma_f32 v[44:45], v[12:13], v[218:219], v[44:45] op_sel:[0,0,0] op_sel_hi:[1,0,1]
    v_pk_fma_f32 v[46:47], v[14:15], v[218:219], v[46:47] op_sel:[0,0,0] op_sel_hi:[1,0,1]
    s_waitcnt vmcnt(4)
    v_lshlrev_b32 v8, 16, v172
    v_and_b32 v9, 0xffff0000, v172
    v_lshlrev_b32 v10, 16, v173
    v_and_b32 v11, 0xffff0000, v173
    v_lshlrev_b32 v12, 16, v174
    v_and_b32 v13, 0xffff0000, v174
    v_lshlrev_b32 v14, 16, v175
    v_and_b32 v15, 0xffff0000, v175
    v_pk_fma_f32 v[40:41], v[8:9], v[218:219], v[40:41] op_sel:[0,1,0] op_sel_hi:[1,1,1]
    v_pk_fma_f32 v[42:43], v[10:11], v[218:219], v[42:43] op_sel:[0,1,0] op_sel_hi:[1,1,1]
    v_pk_fma_f32 v[44:45], v[12:13], v[218:219], v[44:45] op_sel:[0,1,0] op_sel_hi:[1,1,1]
    v_pk_fma_f32 v[46:47], v[14:15], v[218:219], v[46:47] op_sel:[0,1,0] op_sel_hi:[1,1,1]
    s_waitcnt vmcnt(3)
    v_lshlrev_b32 v8, 16, v176
    v_and_b32 v9, 0xffff0000, v176
    v_lshlrev_b32 v10, 16, v177
    v_and_b32 v11, 0xffff0000, v177
    v_lshlrev_b32 v12, 16, v178
    v_and_b32 v13, 0xffff0000, v178
    v_lshlrev_b32 v14, 16, v179
    v_and_b32 v15, 0xffff0000, v179
    v_pk_fma_f32 v[40:41], v[8:9], v[220:221], v[40:41] op_sel:[0,0,0] op_sel_hi:[1,0,1]
    v_pk_fma_f32 v[42:43], v[10:11], v[220:221], v[42:43] op_sel:[0,0,0] op_sel_hi:[1,0,1]
    v_pk_fma_f32 v[44:45], v[12:13], v[220:221], v[44:45] op_sel:[0,0,0] op_sel_hi:[1,0,1]
    v_pk_fma_f32 v[46:47], v[14:15], v[220:221], v[46:47] op_sel:[0,0,0] op_sel_hi:[1,0,1]
    s_waitcnt vmcnt(2)
    v_lshlrev_b32 v8, 16, v180
    v_and_b32 v9, 0xffff0000, v180
    v_lshlrev_b32 v10, 16, v181
    v_and_b32 v11, 0xffff0000, v181
    v_lshlrev_b32 v12, 16, v182
    v_and_b32 v13, 0xffff0000, v182
    v_lshlrev_b32 v14, 16, v183
    v_and_b32 v15, 0xffff0000, v183
    v_pk_fma_f32 v[40:41], v[8:9], v[220:221], v[40:41] op_sel:[0,1,0] op_sel_hi:[1,1,1]
    v_pk_fma_f32 v[42:43], v[10:11], v[220:221], v[42:43] op_sel:[0,1,0] op_sel_hi:[1,1,1]
    v_pk_fma_f32 v[44:45], v[12:13], v[220:221], v[44:45] op_sel:[0,1,0] op_sel_hi:[1,1,1]
    v_pk_fma_f32 v[46:47], v[14:15], v[220:221], v[46:47] op_sel:[0,1,0] op_sel_hi:[1,1,1]
    s_waitcnt vmcnt(1)
    v_lshlrev_b32 v8, 16, v184
    v_and_b32 v9, 0xffff0000, v184
    v_lshlrev_b32 v10, 16, v185
    v_and_b32 v11, 0xffff0000, v185
    v_lshlrev_b32 v12, 16, v186
    v_and_b32 v13, 0xffff0000, v186
    v_lshlrev_b32 v14, 16, v187
    v_and_b32 v15, 0xffff0000, v187
    v_pk_fma_f32 v[40:41], v[8:9], v[222:223], v[40:41] op_sel:[0,0,0] op_sel_hi:[1,0,1]
    v_pk_fma_f32 v[42:43], v[10:11], v[222:223], v[42:43] op_sel:[0,0,0] op_sel_hi:[1,0,1]
    v_pk_fma_f32 v[44:45], v[12:13], v[222:223], v[44:45] op_sel:[0,0,0] op_sel_hi:[1,0,1]
    v_pk_fma_f32 v[46:47], v[14:15], v[222:223], v[46:47] op_sel:[0,0,0] op_sel_hi:[1,0,1]
    s_waitcnt vmcnt(0)
    v_lshlrev_b32 v8, 16, v188
    v_and_b32 v9, 0xffff0000, v188
    v_lshlrev_b32 v10, 16, v189
    v_and_b32 v11, 0xffff0000, v189
    v_lshlrev_b32 v12, 16, v190
    v_and_b32 v13, 0xffff0000, v190
    v_lshlrev_b32 v14, 16, v191
    v_and_b32 v15, 0xffff0000, v191
    v_pk_fma_f32 v[40:41], v[8:9], v[222:223], v[40:41] op_sel:[0,1,0] op_sel_hi:[1,1,1]
    v_pk_fma_f32 v[42:43], v[10:11], v[222:223], v[42:43] op_sel:[0,1,0] op_sel_hi:[1,1,1]
    v_pk_fma_f32 v[44:45], v[12:13], v[222:223], v[44:45] op_sel:[0,1,0] op_sel_hi:[1,1,1]
    v_pk_fma_f32 v[46:47], v[14:15], v[222:223], v[46:47] op_sel:[0,1,0] op_sel_hi:[1,1,1]
    v_cvt_pk_bf16_f32 v52, v40, v41
    v_cvt_pk_bf16_f32 v53, v42, v43
    v_cvt_pk_bf16_f32 v54, v44, v45
    v_cvt_pk_bf16_f32 v55, v46, v47
    buffer_store_dwordx2 v[48:49], v3, s[92:95], s96 offen
    buffer_store_dwordx2 v[50:51], v3, s[92:95], s96 offen offset:32
    buffer_store_dwordx2 v[52:53], v3, s[92:95], s98 offen
    buffer_store_dwordx2 v[54:55], v3, s[92:95], s98 offen offset:32
    s_add_u32 s90, s29, 0
    s_lshr_b32 s96, s90, 2
    s_and_b32 s90, s90, 3
    s_add_u32 s97, s90, 4
    s_add_u32 s90, s29, 16
    s_lshr_b32 s98, s90, 2
    s_and_b32 s90, s90, 3
    s_add_u32 s99, s90, 4
    v_lshlrev_b32 v2, 4, v1
    v_and_b32 v3, 15, v1
    v_mul_u32_u24 v3, 1792, v3
    v_lshrrev_b32 v9, 4, v1
    v_lshl_add_u32 v3, v9, 3, v3
    s_lshl_b32 s76, s96, 10
    s_mul_i32 s90, s96, 14
    s_add_u32 s90, s90, s97
    s_lshl_b32 s91, s90, 10
    s_mul_i32 s100, s28, 144
    s_lshl_b32 s90, s96, 4
    s_add_u32 s100, s100, s90
    s_mul_i32 s100, s100, 1792
    s_lshl_b32 s90, s97, 6
    s_add_u32 s100, s100, s90
    s_mul_i32 s90, s30, 896
    s_add_u32 s96, s100, s90
    s_mov_b32 s97, s91
    s_lshl_b32 s77, s98, 10
    s_mul_i32 s90, s98, 14
    s_add_u32 s90, s90, s99
    s_lshl_b32 s91, s90, 10
    s_mul_i32 s100, s28, 144
    s_lshl_b32 s90, s98, 4
    s_add_u32 s100, s100, s90
    s_mul_i32 s100, s100, 1792
    s_lshl_b32 s90, s99, 6
    s_add_u32 s100, s100, s90
    s_mul_i32 s90, s30, 896
    s_add_u32 s98, s100, s90
    s_mov_b32 s99, s91
    s_mov_b64 exec, 1
    s_mov_b32 s89, 0
L_poll2:
    s_mov_b32 s88, 4096
    buffer_load_dword v9, off, s[84:87], s88 sc1
    s_waitcnt vmcnt(0)
    v_readfirstlane_b32 s90, v9
    s_add_u32 s89, s89, 1
    s_cmp_ge_u32 s90, 16
    s_cbranch_scc1 L_poll_done2
    s_cmp_ge_u32 s89, 0x40000
    s_cbranch_scc1 L_poll_done2
    s_sleep 2
    s_branch L_poll2
L_poll_done2:
    s_mov_b64 exec, -1
    v_and_b32 v5, 15, v1
    v_lshlrev_b32 v5, 6, v5
    s_mov_b32 s91, s97
    buffer_load_dwordx4 v[64:67], v2, s[44:47], s91 offen sc0 sc1
    s_add_u32 s91, s91, 129024
    buffer_load_dwordx4 v[192:195], v5, s[64:67], s76 offen offset:0 sc0 sc1
    buffer_load_dwordx4 v[196:199], v5, s[64:67], s76 offen offset:16 sc0 sc1
    buffer_load_dwordx4 v[200:203], v5, s[64:67], s76 offen offset:32 sc0 sc1
    buffer_load_dwordx4 v[204:207], v5, s[64:67], s76 offen offset:48 sc0 sc1
    buffer_load_dwordx4 v[68:71], v2, s[44:47], s91 offen sc0 sc1
    s_add_u32 s91, s91, 129024
    buffer_load_dwordx4 v[72:75], v2, s[44:47], s91 offen sc0 sc1
    s_add_u32 s91, s91, 129024
    buffer_load_dwordx4 v[76:79], v2, s[44:47], s91 offen sc0 sc1
    s_add_u32 s91, s91, 129024
    buffer_load_dwordx4 v[80:83], v2, s[44:47], s91 offen sc0 sc1
    s_add_u32 s91, s91, 129024
    buffer_load_dwordx4 v[84:87], v2, s[44:47], s91 offen sc0 sc1
    s_add_u32 s91, s91, 129024
    buffer_load_dwordx4 v[88:91], v2, s[44:47], s91 offen sc0 sc1
    s_add_u32 s91, s91, 129024
    buffer_load_dwordx4 v[92:95], v2, s[44:47], s91 offen sc0 sc1
    s_add_u32 s91, s91, 129024
    buffer_load_dwordx4 v[96:99], v2, s[44:47], s91 offen sc0 sc1
    s_add_u32 s91, s91, 129024
    buffer_load_dwordx4 v[100:103], v2, s[44:47], s91 offen sc0 sc1
    s_add_u32 s91, s91, 129024
    buffer_load_dwordx4 v[104:107], v2, s[44:47], s91 offen sc0 sc1
    s_add_u32 s91, s91, 129024
    buffer_load_dwordx4 v[108:111], v2, s[44:47], s91 offen sc0 sc1
    s_add_u32 s91, s91, 129024
    buffer_load_dwordx4 v[112:115], v2, s[44:47], s91 offen sc0 sc1
    s_add_u32 s91, s91, 129024
    buffer_load_dwordx4 v[116:119], v2, s[44:47], s91 offen sc0 sc1
    s_add_u32 s91, s91, 129024
    buffer_load_dwordx4 v[120:123], v2, s[44:47], s91 offen sc0 sc1
    s_add_u32 s91, s91, 129024
    buffer_load_dwordx4 v[124:127], v2, s[44:47], s91 offen sc0 sc1
    s_mov_b32 s91, s99
    buffer_load_dwordx4 v[128:131], v2, s[44:47], s91 offen sc0 sc1
    s_add_u32 s91, s91, 129024
    buffer_load_dwordx4 v[208:211], v5, s[64:67], s77 offen offset:0 sc0 sc1
    buffer_load_dwordx4 v[212:215], v5, s[64:67], s77 offen offset:16 sc0 sc1
    buffer_load_dwordx4 v[216:219], v5, s[64:67], s77 offen offset:32 sc0 sc1
    buffer_load_dwordx4 v[220:223], v5, s[64:67], s77 offen offset:48 sc0 sc1
    buffer_load_dwordx4 v[132:135], v2, s[44:47], s91 offen sc0 sc1
    s_add_u32 s91, s91, 129024
    buffer_load_dwordx4 v[136:139], v2, s[44:47], s91 offen sc0 sc1
    s_add_u32 s91, s91, 129024
    buffer_load_dwordx4 v[140:143], v2, s[44:47], s91 offen sc0 sc1
    s_add_u32 s91, s91, 129024
    buffer_load_dwordx4 v[144:147], v2, s[44:47], s91 offen sc0 sc1
    s_add_u32 s91, s91, 129024
    buffer_load_dwordx4 v[148:151], v2, s[44:47], s91 offen sc0 sc1
    s_add_u32 s91, s91, 129024
    buffer_load_dwordx4 v[152:155], v2, s[44:47], s91 offen sc0 sc1
    s_add_u32 s91, s91, 129024
    buffer_load_dwordx4 v[156:159], v2, s[44:47], s91 offen sc0 sc1
    s_add_u32 s91, s91, 129024
    buffer_load_dwordx4 v[160:163], v2, s[44:47], s91 offen sc0 sc1
    s_add_u32 s91, s91, 129024
    buffer_load_dwordx4 v[164:167], v2, s[44:47], s91 offen sc0 sc1
    s_add_u32 s91, s91, 129024
    buffer_load_dwordx4 v[168:171], v2, s[44:47], s91 offen sc0 sc1
    s_add_u32 s91, s91, 129024
    buffer_load_dwordx4 v[172:175], v2, s[44:47], s91 offen sc0 sc1
    s_add_u32 s91, s91, 129024
    buffer_load_dwordx4 v[176:179], v2, s[44:47], s91 offen sc0 sc1
    s_add_u32 s91, s91, 129024
    buffer_load_dwordx4 v[180:183], v2, s[44:47], s91 offen sc0 sc1
    s_add_u32 s91, s91, 129024
    buffer_load_dwordx4 v[184:187], v2, s[44:47], s91 offen sc0 sc1
    s_add_u32 s91, s91, 129024
    buffer_load_dwordx4 v[188:191], v2, s[44:47], s91 offen sc0 sc1
    s_waitcnt vmcnt(35)
    v_lshlrev_b32 v8, 16, v64
    v_and_b32 v9, 0xffff0000, v64
    v_lshlrev_b32 v10, 16, v65
    v_and_b32 v11, 0xffff0000, v65
    v_lshlrev_b32 v12, 16, v66
    v_and_b32 v13, 0xffff0000, v66
    v_lshlrev_b32 v14, 16, v67
    v_and_b32 v15, 0xffff0000, v67
    v_pk_mul_f32 v[32:33], v[8:9], v[192:193] op_sel:[0,0] op_sel_hi:[1,0]
    v_pk_mul_f32 v[34:35], v[10:11], v[192:193] op_sel:[0,0] op_sel_hi:[1,0]
    v_pk_mul_f32 v[36:37], v[12:13], v[192:193] op_sel:[0,0] op_sel_hi:[1,0]
    v_pk_mul_f32 v[38:39], v[14:15], v[192:193] op_sel:[0,0] op_sel_hi:[1,0]
    s_waitcnt vmcnt(34)
    v_lshlrev_b32 v8, 16, v68
    v_and_b32 v9, 0xffff0000, v68
    v_lshlrev_b32 v10, 16, v69
    v_and_b32 v11, 0xffff0000, v69
    v_lshlrev_b32 v12, 16, v70
    v_and_b32 v13, 0xffff0000, v70
    v_lshlrev_b32 v14, 16, v71
    v_and_b32 v15, 0xffff0000, v71
    v_pk_fma_f32 v[32:33], v[8:9], v[192:193], v[32:33] op_sel:[0,1,0] op_sel_hi:[1,1,1]
    v_pk_fma_f32 v[34:35], v[10:11], v[192:193], v[34:35] op_sel:[0,1,0] op_sel_hi:[1,1,1]
    v_pk_fma_f32 v[36:37], v[12:13], v[192:193], v[36:37] op_sel:[0,1,0] op_sel_hi:[1,1,1]
    v_pk_fma_f32 v[38:39], v[14:15], v[192:193], v[38:39] op_sel:[0,1,0] op_sel_hi:[1,1,1]
    s_waitcnt vmcnt(33)
    v_lshlrev_b32 v8, 16, v72
    v_and_b32 v9, 0xffff0000, v72
    v_lshlrev_b32 v10, 16, v73
    v_and_b32 v11, 0xffff0000, v73
    v_lshlrev_b32 v12, 16, v74
    v_and_b32 v13, 0xffff0000, v74
    v_lshlrev_b32 v14, 16, v75
    v_and_b32 v15, 0xffff0000, v75
    v_pk_fma_f32 v[32:33], v[8:9], v[194:195], v[32:33] op_sel:[0,0,0] op_sel_hi:[1,0,1]
    v_pk_fma_f32 v[34:35], v[10:11], v[194:195], v[34:35] op_sel:[0,0,0] op_sel_hi:[1,0,1]
    v_pk_fma_f32 v[36:37], v[12:13], v[194:195], v[36:37] op_sel:[0,0,0] op_sel_hi:[1,0,1]
    v_pk_fma_f32 v[38:39], v[14:15], v[194:195], v[38:39] op_sel:[0,0,0] op_sel_hi:[1,0,1]
    s_waitcnt vmcnt(32)
    v_lshlrev_b32 v8, 16, v76
    v_and_b32 v9, 0xffff0000, v76
    v_lshlrev_b32 v10, 16, v77
    v_and_b32 v11, 0xffff0000, v77
    v_lshlrev_b32 v12, 16, v78
    v_and_b32 v13, 0xffff0000, v78
    v_lshlrev_b32 v14, 16, v79
    v_and_b32 v15, 0xffff0000, v79
    v_pk_fma_f32 v[32:33], v[8:9], v[194:195], v[32:33] op_sel:[0,1,0] op_sel_hi:[1,1,1]
    v_pk_fma_f32 v[34:35], v[10:11], v[194:195], v[34:35] op_sel:[0,1,0] op_sel_hi:[1,1,1]
    v_pk_fma_f32 v[36:37], v[12:13], v[194:195], v[36:37] op_sel:[0,1,0] op_sel_hi:[1,1,1]
    v_pk_fma_f32 v[38:39], v[14:15], v[194:195], v[38:39] op_sel:[0,1,0] op_sel_hi:[1,1,1]
    s_waitcnt vmcnt(31)
    v_lshlrev_b32 v8, 16, v80
    v_and_b32 v9, 0xffff0000, v80
    v_lshlrev_b32 v10, 16, v81
    v_and_b32 v11, 0xffff0000, v81
    v_lshlrev_b32 v12, 16, v82
    v_and_b32 v13, 0xffff0000, v82
    v_lshlrev_b32 v14, 16, v83
    v_and_b32 v15, 0xffff0000, v83
    v_pk_fma_f32 v[32:33], v[8:9], v[196:197], v[32:33] op_sel:[0,0,0] op_sel_hi:[1,0,1]
    v_pk_fma_f32 v[34:35], v[10:11], v[196:197], v[34:35] op_sel:[0,0,0] op_sel_hi:[1,0,1]
    v_pk_fma_f32 v[36:37], v[12:13], v[196:197], v[36:37] op_sel:[0,0,0] op_sel_hi:[1,0,1]
    v_pk_fma_f32 v[38:39], v[14:15], v[196:197], v[38:39] op_sel:[0,0,0] op_sel_hi:[1,0,1]
    s_waitcnt vmcnt(30)
    v_lshlrev_b32 v8, 16, v84
    v_and_b32 v9, 0xffff0000, v84
    v_lshlrev_b32 v10, 16, v85
    v_and_b32 v11, 0xffff0000, v85
    v_lshlrev_b32 v12, 16, v86
    v_and_b32 v13, 0xffff0000, v86
    v_lshlrev_b32 v14, 16, v87
    v_and_b32 v15, 0xffff0000, v87
    v_pk_fma_f32 v[32:33], v[8:9], v[196:197], v[32:33] op_sel:[0,1,0] op_sel_hi:[1,1,1]
    v_pk_fma_f32 v[34:35], v[10:11], v[196:197], v[34:35] op_sel:[0,1,0] op_sel_hi:[1,1,1]
    v_pk_fma_f32 v[36:37], v[12:13], v[196:197], v[36:37] op_sel:[0,1,0] op_sel_hi:[1,1,1]
    v_pk_fma_f32 v[38:39], v[14:15], v[196:197], v[38:39] op_sel:[0,1,0] op_sel_hi:[1,1,1]
    s_waitcnt vmcnt(29)
    v_lshlrev_b32 v8, 16, v88
    v_and_b32 v9, 0xffff0000, v88
    v_lshlrev_b32 v10, 16, v89
    v_and_b32 v11, 0xffff0000, v89
    v_lshlrev_b32 v12, 16, v90
    v_and_b32 v13, 0xffff0000, v90
    v_lshlrev_b32 v14, 16, v91
    v_and_b32 v15, 0xffff0000, v91
    v_pk_fma_f32 v[32:33], v[8:9], v[198:199], v[32:33] op_sel:[0,0,0] op_sel_hi:[1,0,1]
    v_pk_fma_f32 v[34:35], v[10:11], v[198:199], v[34:35] op_sel:[0,0,0] op_sel_hi:[1,0,1]
    v_pk_fma_f32 v[36:37], v[12:13], v[198:199], v[36:37] op_sel:[0,0,0] op_sel_hi:[1,0,1]
    v_pk_fma_f32 v[38:39], v[14:15], v[198:199], v[38:39] op_sel:[0,0,0] op_sel_hi:[1,0,1]
    s_waitcnt vmcnt(28)
    v_lshlrev_b32 v8, 16, v92
    v_and_b32 v9, 0xffff0000, v92
    v_lshlrev_b32 v10, 16, v93
    v_and_b32 v11, 0xffff0000, v93
    v_lshlrev_b32 v12, 16, v94
    v_and_b32 v13, 0xffff0000, v94
    v_lshlrev_b32 v14, 16, v95
    v_and_b32 v15, 0xffff0000, v95
    v_pk_fma_f32 v[32:33], v[8:9], v[198:199], v[32:33] op_sel:[0,1,0] op_sel_hi:[1,1,1]
    v_pk_fma_f32 v[34:35], v[10:11], v[198:199], v[34:35] op_sel:[0,1,0] op_sel_hi:[1,1,1]
    v_pk_fma_f32 v[36:37], v[12:13], v[198:199], v[36:37] op_sel:[0,1,0] op_sel_hi:[1,1,1]
    v_pk_fma_f32 v[38:39], v[14:15], v[198:199], v[38:39] op_sel:[0,1,0] op_sel_hi:[1,1,1]
    s_waitcnt vmcnt(27)
    v_lshlrev_b32 v8, 16, v96
    v_and_b32 v9, 0xffff0000, v96
    v_lshlrev_b32 v10, 16, v97
    v_and_b32 v11, 0xffff0000, v97
    v_lshlrev_b32 v12, 16, v98
    v_and_b32 v13, 0xffff0000, v98
    v_lshlrev_b32 v14, 16, v99
    v_and_b32 v15, 0xffff0000, v99
    v_pk_fma_f32 v[32:33], v[8:9], v[200:201], v[32:33] op_sel:[0,0,0] op_sel_hi:[1,0,1]
    v_pk_fma_f32 v[34:35], v[10:11], v[200:201], v[34:35] op_sel:[0,0,0] op_sel_hi:[1,0,1]
    v_pk_fma_f32 v[36:37], v[12:13], v[200:201], v[36:37] op_sel:[0,0,0] op_sel_hi:[1,0,1]
    v_pk_fma_f32 v[38:39], v[14:15], v[200:201], v[38:39] op_sel:[0,0,0] op_sel_hi:[1,0,1]
    s_waitcnt vmcnt(26)
    v_lshlrev_b32 v8, 16, v100
    v_and_b32 v9, 0xffff0000, v100
    v_lshlrev_b32 v10, 16, v101
    v_and_b32 v11, 0xffff0000, v101
    v_lshlrev_b32 v12, 16, v102
    v_and_b32 v13, 0xffff0000, v102
    v_lshlrev_b32 v14, 16, v103
    v_and_b32 v15, 0xffff0000, v103
    v_pk_fma_f32 v[32:33], v[8:9], v[200:201], v[32:33] op_sel:[0,1,0] op_sel_hi:[1,1,1]
    v_pk_fma_f32 v[34:35], v[10:11], v[200:201], v[34:35] op_sel:[0,1,0] op_sel_hi:[1,1,1]
    v_pk_fma_f32 v[36:37], v[12:13], v[200:201], v[36:37] op_sel:[0,1,0] op_sel_hi:[1,1,1]
    v_pk_fma_f32 v[38:39], v[14:15], v[200:201], v[38:39] op_sel:[0,1,0] op_sel_hi:[1,1,1]
    s_waitcnt vmcnt(25)
    v_lshlrev_b32 v8, 16, v104
    v_and_b32 v9, 0xffff0000, v104
    v_lshlrev_b32 v10, 16, v105
    v_and_b32 v11, 0xffff0000, v105
    v_lshlrev_b32 v12, 16, v106
    v_and_b32 v13, 0xffff0000, v106
    v_lshlrev_b32 v14, 16, v107
    v_and_b32 v15, 0xffff0000, v107
    v_pk_fma_f32 v[32:33], v[8:9], v[202:203], v[32:33] op_sel:[0,0,0] op_sel_hi:[1,0,1]
    v_pk_fma_f32 v[34:35], v[10:11], v[202:203], v[34:35] op_sel:[0,0,0] op_sel_hi:[1,0,1]
    v_pk_fma_f32 v[36:37], v[12:13], v[202:203], v[36:37] op_sel:[0,0,0] op_sel_hi:[1,0,1]
    v_pk_fma_f32 v[38:39], v[14:15], v[202:203], v[38:39] op_sel:[0,0,0] op_sel_hi:[1,0,1]
    s_waitcnt vmcnt(24)
    v_lshlrev_b32 v8, 16, v108
    v_and_b32 v9, 0xffff0000, v108
    v_lshlrev_b32 v10, 16, v109
    v_and_b32 v11, 0xffff0000, v109
    v_lshlrev_b32 v12, 16, v110
    v_and_b32 v13, 0xffff0000, v110
    v_lshlrev_b32 v14, 16, v111
    v_and_b32 v15, 0xffff0000, v111
    v_pk_fma_f32 v[32:33], v[8:9], v[202:203], v[32:33] op_sel:[0,1,0] op_sel_hi:[1,1,1]
    v_pk_fma_f32 v[34:35], v[10:11], v[202:203], v[34:35] op_sel:[0,1,0] op_sel_hi:[1,1,1]
    v_pk_fma_f32 v[36:37], v[12:13], v[202:203], v[36:37] op_sel:[0,1,0] op_sel_hi:[1,1,1]
    v_pk_fma_f32 v[38:39], v[14:15], v[202:203], v[38:39] op_sel:[0,1,0] op_sel_hi:[1,1,1]
    s_waitcnt vmcnt(23)
    v_lshlrev_b32 v8, 16, v112
    v_and_b32 v9, 0xffff0000, v112
    v_lshlrev_b32 v10, 16, v113
    v_and_b32 v11, 0xffff0000, v113
    v_lshlrev_b32 v12, 16, v114
    v_and_b32 v13, 0xffff0000, v114
    v_lshlrev_b32 v14, 16, v115
    v_and_b32 v15, 0xffff0000, v115
    v_pk_fma_f32 v[32:33], v[8:9], v[204:205], v[32:33] op_sel:[0,0,0] op_sel_hi:[1,0,1]
    v_pk_fma_f32 v[34:35], v[10:11], v[204:205], v[34:35] op_sel:[0,0,0] op_sel_hi:[1,0,1]
    v_pk_fma_f32 v[36:37], v[12:13], v[204:205], v[36:37] op_sel:[0,0,0] op_sel_hi:[1,0,1]
    v_pk_fma_f32 v[38:39], v[14:15], v[204:205], v[38:39] op_sel:[0,0,0] op_sel_hi:[1,0,1]
    s_waitcnt vmcnt(22)
    v_lshlrev_b32 v8, 16, v116
    v_and_b32 v9, 0xffff0000, v116
    v_lshlrev_b32 v10, 16, v117
    v_and_b32 v11, 0xffff0000, v117
    v_lshlrev_b32 v12, 16, v118
    v_and_b32 v13, 0xffff0000, v118
    v_lshlrev_b32 v14, 16, v119
    v_and_b32 v15, 0xffff0000, v119
    v_pk_fma_f32 v[32:33], v[8:9], v[204:205], v[32:33] op_sel:[0,1,0] op_sel_hi:[1,1,1]
    v_pk_fma_f32 v[34:35], v[10:11], v[204:205], v[34:35] op_sel:[0,1,0] op_sel_hi:[1,1,1]
    v_pk_fma_f32 v[36:37], v[12:13], v[204:205], v[36:37] op_sel:[0,1,0] op_sel_hi:[1,1,1]
    v_pk_fma_f32 v[38:39], v[14:15], v[204:205], v[38:39] op_sel:[0,1,0] op_sel_hi:[1,1,1]
    s_waitcnt vmcnt(21)
    v_lshlrev_b32 v8, 16, v120
    v_and_b32 v9, 0xffff0000, v120
    v_lshlrev_b32 v10, 16, v121
    v_and_b32 v11, 0xffff0000, v121
    v_lshlrev_b32 v12, 16, v122
    v_and_b32 v13, 0xffff0000, v122
    v_lshlrev_b32 v14, 16, v123
    v_and_b32 v15, 0xffff0000, v123
    v_pk_fma_f32 v[32:33], v[8:9], v[206:207], v[32:33] op_sel:[0,0,0] op_sel_hi:[1,0,1]
    v_pk_fma_f32 v[34:35], v[10:11], v[206:207], v[34:35] op_sel:[0,0,0] op_sel_hi:[1,0,1]
    v_pk_fma_f32 v[36:37], v[12:13], v[206:207], v[36:37] op_sel:[0,0,0] op_sel_hi:[1,0,1]
    v_pk_fma_f32 v[38:39], v[14:15], v[206:207], v[38:39] op_sel:[0,0,0] op_sel_hi:[1,0,1]
    s_waitcnt vmcnt(20)
    v_lshlrev_b32 v8, 16, v124
    v_and_b32 v9, 0xffff0000, v124
    v_lshlrev_b32 v10, 16, v125
    v_and_b32 v11, 0xffff0000, v125
    v_lshlrev_b32 v12, 16, v126
    v_and_b32 v13, 0xffff0000, v126
    v_lshlrev_b32 v14, 16, v127
    v_and_b32 v15, 0xffff0000, v127
    v_pk_fma_f32 v[32:33], v[8:9], v[206:207], v[32:33] op_sel:[0,1,0] op_sel_hi:[1,1,1]
    v_pk_fma_f32 v[34:35], v[10:11], v[206:207], v[34:35] op_sel:[0,1,0] op_sel_hi:[1,1,1]
    v_pk_fma_f32 v[36:37], v[12:13], v[206:207], v[36:37] op_sel:[0,1,0] op_sel_hi:[1,1,1]
    v_pk_fma_f32 v[38:39], v[14:15], v[206:207], v[38:39] op_sel:[0,1,0] op_sel_hi:[1,1,1]
    v_cvt_pk_bf16_f32 v48, v32, v33
    v_cvt_pk_bf16_f32 v49, v34, v35
    v_cvt_pk_bf16_f32 v50, v36, v37
    v_cvt_pk_bf16_f32 v51, v38, v39
    s_waitcnt vmcnt(15)
    v_lshlrev_b32 v8, 16, v128
    v_and_b32 v9, 0xffff0000, v128
    v_lshlrev_b32 v10, 16, v129
    v_and_b32 v11, 0xffff0000, v129
    v_lshlrev_b32 v12, 16, v130
    v_and_b32 v13, 0xffff0000, v130
    v_lshlrev_b32 v14, 16, v131
    v_and_b32 v15, 0xffff0000, v131
    v_pk_mul_f32 v[40:41], v[8:9], v[208:209] op_sel:[0,0] op_sel_hi:[1,0]
    v_pk_mul_f32 v[42:43], v[10:11], v[208:209] op_sel:[0,0] op_sel_hi:[1,0]
    v_pk_mul_f32 v[44:45], v[12:13], v[208:209] op_sel:[0,0] op_sel_hi:[1,0]
    v_pk_mul_f32 v[46:47], v[14:15], v[208:209] op_sel:[0,0] op_sel_hi:[1,0]
    s_waitcnt vmcnt(14)
    v_lshlrev_b32 v8, 16, v132
    v_and_b32 v9, 0xffff0000, v132
    v_lshlrev_b32 v10, 16, v133
    v_and_b32 v11, 0xffff0000, v133
    v_lshlrev_b32 v12, 16, v134
    v_and_b32 v13, 0xffff0000, v134
    v_lshlrev_b32 v14, 16, v135
    v_and_b32 v15, 0xffff0000, v135
    v_pk_fma_f32 v[40:41], v[8:9], v[208:209], v[40:41] op_sel:[0,1,0] op_sel_hi:[1,1,1]
    v_pk_fma_f32 v[42:43], v[10:11], v[208:209], v[42:43] op_sel:[0,1,0] op_sel_hi:[1,1,1]
    v_pk_fma_f32 v[44:45], v[12:13], v[208:209], v[44:45] op_sel:[0,1,0] op_sel_hi:[1,1,1]
    v_pk_fma_f32 v[46:47], v[14:15], v[208:209], v[46:47] op_sel:[0,1,0] op_sel_hi:[1,1,1]
    s_waitcnt vmcnt(13)
    v_lshlrev_b32 v8, 16, v136
    v_and_b32 v9, 0xffff0000, v136
    v_lshlrev_b32 v10, 16, v137
    v_and_b32 v11, 0xffff0000, v137
    v_lshlrev_b32 v12, 16, v138
    v_and_b32 v13, 0xffff0000, v138
    v_lshlrev_b32 v14, 16, v139
    v_and_b32 v15, 0xffff0000, v139
    v_pk_fma_f32 v[40:41], v[8:9], v[210:211], v[40:41] op_sel:[0,0,0] op_sel_hi:[1,0,1]
    v_pk_fma_f32 v[42:43], v[10:11], v[210:211], v[42:43] op_sel:[0,0,0] op_sel_hi:[1,0,1]
    v_pk_fma_f32 v[44:45], v[12:13], v[210:211], v[44:45] op_sel:[0,0,0] op_sel_hi:[1,0,1]
    v_pk_fma_f32 v[46:47], v[14:15], v[210:211], v[46:47] op_sel:[0,0,0] op_sel_hi:[1,0,1]
    s_waitcnt vmcnt(12)
    v_lshlrev_b32 v8, 16, v140
    v_and_b32 v9, 0xffff0000, v140
    v_lshlrev_b32 v10, 16, v141
    v_and_b32 v11, 0xffff0000, v141
    v_lshlrev_b32 v12, 16, v142
    v_and_b32 v13, 0xffff0000, v142
    v_lshlrev_b32 v14, 16, v143
    v_and_b32 v15, 0xffff0000, v143
    v_pk_fma_f32 v[40:41], v[8:9], v[210:211], v[40:41] op_sel:[0,1,0] op_sel_hi:[1,1,1]
    v_pk_fma_f32 v[42:43], v[10:11], v[210:211], v[42:43] op_sel:[0,1,0] op_sel_hi:[1,1,1]
    v_pk_fma_f32 v[44:45], v[12:13], v[210:211], v[44:45] op_sel:[0,1,0] op_sel_hi:[1,1,1]
    v_pk_fma_f32 v[46:47], v[14:15], v[210:211], v[46:47] op_sel:[0,1,0] op_sel_hi:[1,1,1]
    s_waitcnt vmcnt(11)
    v_lshlrev_b32 v8, 16, v144
    v_and_b32 v9, 0xffff0000, v144
    v_lshlrev_b32 v10, 16, v145
    v_and_b32 v11, 0xffff0000, v145
    v_lshlrev_b32 v12, 16, v146
    v_and_b32 v13, 0xffff0000, v146
    v_lshlrev_b32 v14, 16, v147
    v_and_b32 v15, 0xffff0000, v147
    v_pk_fma_f32 v[40:41], v[8:9], v[212:213], v[40:41] op_sel:[0,0,0] op_sel_hi:[1,0,1]
    v_pk_fma_f32 v[42:43], v[10:11], v[212:213], v[42:43] op_sel:[0,0,0] op_sel_hi:[1,0,1]
    v_pk_fma_f32 v[44:45], v[12:13], v[212:213], v[44:45] op_sel:[0,0,0] op_sel_hi:[1,0,1]
    v_pk_fma_f32 v[46:47], v[14:15], v[212:213], v[46:47] op_sel:[0,0,0] op_sel_hi:[1,0,1]
    s_waitcnt vmcnt(10)
    v_lshlrev_b32 v8, 16, v148
    v_and_b32 v9, 0xffff0000, v148
    v_lshlrev_b32 v10, 16, v149
    v_and_b32 v11, 0xffff0000, v149
    v_lshlrev_b32 v12, 16, v150
    v_and_b32 v13, 0xffff0000, v150
    v_lshlrev_b32 v14, 16, v151
    v_and_b32 v15, 0xffff0000, v151
    v_pk_fma_f32 v[40:41], v[8:9], v[212:213], v[40:41] op_sel:[0,1,0] op_sel_hi:[1,1,1]
    v_pk_fma_f32 v[42:43], v[10:11], v[212:213], v[42:43] op_sel:[0,1,0] op_sel_hi:[1,1,1]
    v_pk_fma_f32 v[44:45], v[12:13], v[212:213], v[44:45] op_sel:[0,1,0] op_sel_hi:[1,1,1]
    v_pk_fma_f32 v[46:47], v[14:15], v[212:213], v[46:47] op_sel:[0,1,0] op_sel_hi:[1,1,1]
    s_waitcnt vmcnt(9)
    v_lshlrev_b32 v8, 16, v152
    v_and_b32 v9, 0xffff0000, v152
    v_lshlrev_b32 v10, 16, v153
    v_and_b32 v11, 0xffff0000, v153
    v_lshlrev_b32 v12, 16, v154
    v_and_b32 v13, 0xffff0000, v154
    v_lshlrev_b32 v14, 16, v155
    v_and_b32 v15, 0xffff0000, v155
    v_pk_fma_f32 v[40:41], v[8:9], v[214:215], v[40:41] op_sel:[0,0,0] op_sel_hi:[1,0,1]
    v_pk_fma_f32 v[42:43], v[10:11], v[214:215], v[42:43] op_sel:[0,0,0] op_sel_hi:[1,0,1]
    v_pk_fma_f32 v[44:45], v[12:13], v[214:215], v[44:45] op_sel:[0,0,0] op_sel_hi:[1,0,1]
    v_pk_fma_f32 v[46:47], v[14:15], v[214:215], v[46:47] op_sel:[0,0,0] op_sel_hi:[1,0,1]
    s_waitcnt vmcnt(8)
    v_lshlrev_b32 v8, 16, v156
    v_and_b32 v9, 0xffff0000, v156
    v_lshlrev_b32 v10, 16, v157
    v_and_b32 v11, 0xffff0000, v157
    v_lshlrev_b32 v12, 16, v158
    v_and_b32 v13, 0xffff0000, v158
    v_lshlrev_b32 v14, 16, v159
    v_and_b32 v15, 0xffff0000, v159
    v_pk_fma_f32 v[40:41], v[8:9], v[214:215], v[40:41] op_sel:[0,1,0] op_sel_hi:[1,1,1]
    v_pk_fma_f32 v[42:43], v[10:11], v[214:215], v[42:43] op_sel:[0,1,0] op_sel_hi:[1,1,1]
    v_pk_fma_f32 v[44:45], v[12:13], v[214:215], v[44:45] op_sel:[0,1,0] op_sel_hi:[1,1,1]
    v_pk_fma_f32 v[46:47], v[14:15], v[214:215], v[46:47] op_sel:[0,1,0] op_sel_hi:[1,1,1]
    s_waitcnt vmcnt(7)
    v_lshlrev_b32 v8, 16, v160
    v_and_b32 v9, 0xffff0000, v160
    v_lshlrev_b32 v10, 16, v161
    v_and_b32 v11, 0xffff0000, v161
    v_lshlrev_b32 v12, 16, v162
    v_and_b32 v13, 0xffff0000, v162
    v_lshlrev_b32 v14, 16, v163
    v_and_b32 v15, 0xffff0000, v163
    v_pk_fma_f32 v[40:41], v[8:9], v[216:217], v[40:41] op_sel:[0,0,0] op_sel_hi:[1,0,1]
    v_pk_fma_f32 v[42:43], v[10:11], v[216:217], v[42:43] op_sel:[0,0,0] op_sel_hi:[1,0,1]
    v_pk_fma_f32 v[44:45], v[12:13], v[216:217], v[44:45] op_sel:[0,0,0] op_sel_hi:[1,0,1]
    v_pk_fma_f32 v[46:47], v[14:15], v[216:217], v[46:47] op_sel:[0,0,0] op_sel_hi:[1,0,1]
    s_waitcnt vmcnt(6)
    v_lshlrev_b32 v8, 16, v164
    v_and_b32 v9, 0xffff0000, v164
    v_lshlrev_b32 v10, 16, v165
    v_and_b32 v11, 0xffff0000, v165
    v_lshlrev_b32 v12, 16, v166
    v_and_b32 v13, 0xffff0000, v166
    v_lshlrev_b32 v14, 16, v167
    v_and_b32 v15, 0xffff0000, v167
    v_pk_fma_f32 v[40:41], v[8:9], v[216:217], v[40:41] op_sel:[0,1,0] op_sel_hi:[1,1,1]
    v_pk_fma_f32 v[42:43], v[10:11], v[216:217], v[42:43] op_sel:[0,1,0] op_sel_hi:[1,1,1]
    v_pk_fma_f32 v[44:45], v[12:13], v[216:217], v[44:45] op_sel:[0,1,0] op_sel_hi:[1,1,1]
    v_pk_fma_f32 v[46:47], v[14:15], v[216:217], v[46:47] op_sel:[0,1,0] op_sel_hi:[1,1,1]
    s_waitcnt vmcnt(5)
    v_lshlrev_b32 v8, 16, v168
    v_and_b32 v9, 0xffff0000, v168
    v_lshlrev_b32 v10, 16, v169
    v_and_b32 v11, 0xffff0000, v169
    v_lshlrev_b32 v12, 16, v170
    v_and_b32 v13, 0xffff0000, v170
    v_lshlrev_b32 v14, 16, v171
    v_and_b32 v15, 0xffff0000, v171
    v_pk_fma_f32 v[40:41], v[8:9], v[218:219], v[40:41] op_sel:[0,0,0] op_sel_hi:[1,0,1]
    v_pk_fma_f32 v[42:43], v[10:11], v[218:219], v[42:43] op_sel:[0,0,0] op_sel_hi:[1,0,1]
    v_pk_fma_f32 v[44:45], v[12:13], v[218:219], v[44:45] op_sel:[0,0,0] op_sel_hi:[1,0,1]
    v_pk_fma_f32 v[46:47], v[14:15], v[218:219], v[46:47] op_sel:[0,0,0] op_sel_hi:[1,0,1]
    s_waitcnt vmcnt(4)
    v_lshlrev_b32 v8, 16, v172
    v_and_b32 v9, 0xffff0000, v172
    v_lshlrev_b32 v10, 16, v173
    v_and_b32 v11, 0xffff0000, v173
    v_lshlrev_b32 v12, 16, v174
    v_and_b32 v13, 0xffff0000, v174
    v_lshlrev_b32 v14, 16, v175
    v_and_b32 v15, 0xffff0000, v175
    v_pk_fma_f32 v[40:41], v[8:9], v[218:219], v[40:41] op_sel:[0,1,0] op_sel_hi:[1,1,1]
    v_pk_fma_f32 v[42:43], v[10:11], v[218:219], v[42:43] op_sel:[0,1,0] op_sel_hi:[1,1,1]
    v_pk_fma_f32 v[44:45], v[12:13], v[218:219], v[44:45] op_sel:[0,1,0] op_sel_hi:[1,1,1]
    v_pk_fma_f32 v[46:47], v[14:15], v[218:219], v[46:47] op_sel:[0,1,0] op_sel_hi:[1,1,1]
    s_waitcnt vmcnt(3)
    v_lshlrev_b32 v8, 16, v176
    v_and_b32 v9, 0xffff0000, v176
    v_lshlrev_b32 v10, 16, v177
    v_and_b32 v11, 0xffff0000, v177
    v_lshlrev_b32 v12, 16, v178
    v_and_b32 v13, 0xffff0000, v178
    v_lshlrev_b32 v14, 16, v179
    v_and_b32 v15, 0xffff0000, v179
    v_pk_fma_f32 v[40:41], v[8:9], v[220:221], v[40:41] op_sel:[0,0,0] op_sel_hi:[1,0,1]
    v_pk_fma_f32 v[42:43], v[10:11], v[220:221], v[42:43] op_sel:[0,0,0] op_sel_hi:[1,0,1]
    v_pk_fma_f32 v[44:45], v[12:13], v[220:221], v[44:45] op_sel:[0,0,0] op_sel_hi:[1,0,1]
    v_pk_fma_f32 v[46:47], v[14:15], v[220:221], v[46:47] op_sel:[0,0,0] op_sel_hi:[1,0,1]
    s_waitcnt vmcnt(2)
    v_lshlrev_b32 v8, 16, v180
    v_and_b32 v9, 0xffff0000, v180
    v_lshlrev_b32 v10, 16, v181
    v_and_b32 v11, 0xffff0000, v181
    v_lshlrev_b32 v12, 16, v182
    v_and_b32 v13, 0xffff0000, v182
    v_lshlrev_b32 v14, 16, v183
    v_and_b32 v15, 0xffff0000, v183
    v_pk_fma_f32 v[40:41], v[8:9], v[220:221], v[40:41] op_sel:[0,1,0] op_sel_hi:[1,1,1]
    v_pk_fma_f32 v[42:43], v[10:11], v[220:221], v[42:43] op_sel:[0,1,0] op_sel_hi:[1,1,1]
    v_pk_fma_f32 v[44:45], v[12:13], v[220:221], v[44:45] op_sel:[0,1,0] op_sel_hi:[1,1,1]
    v_pk_fma_f32 v[46:47], v[14:15], v[220:221], v[46:47] op_sel:[0,1,0] op_sel_hi:[1,1,1]
    s_waitcnt vmcnt(1)
    v_lshlrev_b32 v8, 16, v184
    v_and_b32 v9, 0xffff0000, v184
    v_lshlrev_b32 v10, 16, v185
    v_and_b32 v11, 0xffff0000, v185
    v_lshlrev_b32 v12, 16, v186
    v_and_b32 v13, 0xffff0000, v186
    v_lshlrev_b32 v14, 16, v187
    v_and_b32 v15, 0xffff0000, v187
    v_pk_fma_f32 v[40:41], v[8:9], v[222:223], v[40:41] op_sel:[0,0,0] op_sel_hi:[1,0,1]
    v_pk_fma_f32 v[42:43], v[10:11], v[222:223], v[42:43] op_sel:[0,0,0] op_sel_hi:[1,0,1]
    v_pk_fma_f32 v[44:45], v[12:13], v[222:223], v[44:45] op_sel:[0,0,0] op_sel_hi:[1,0,1]
    v_pk_fma_f32 v[46:47], v[14:15], v[222:223], v[46:47] op_sel:[0,0,0] op_sel_hi:[1,0,1]
    s_waitcnt vmcnt(0)
    v_lshlrev_b32 v8, 16, v188
    v_and_b32 v9, 0xffff0000, v188
    v_lshlrev_b32 v10, 16, v189
    v_and_b32 v11, 0xffff0000, v189
    v_lshlrev_b32 v12, 16, v190
    v_and_b32 v13, 0xffff0000, v190
    v_lshlrev_b32 v14, 16, v191
    v_and_b32 v15, 0xffff0000, v191
    v_pk_fma_f32 v[40:41], v[8:9], v[222:223], v[40:41] op_sel:[0,1,0] op_sel_hi:[1,1,1]
    v_pk_fma_f32 v[42:43], v[10:11], v[222:223], v[42:43] op_sel:[0,1,0] op_sel_hi:[1,1,1]
    v_pk_fma_f32 v[44:45], v[12:13], v[222:223], v[44:45] op_sel:[0,1,0] op_sel_hi:[1,1,1]
    v_pk_fma_f32 v[46:47], v[14:15], v[222:223], v[46:47] op_sel:[0,1,0] op_sel_hi:[1,1,1]
    v_cvt_pk_bf16_f32 v52, v40, v41
    v_cvt_pk_bf16_f32 v53, v42, v43
    v_cvt_pk_bf16_f32 v54, v44, v45
    v_cvt_pk_bf16_f32 v55, v46, v47
    buffer_store_dwordx2 v[48:49], v3, s[92:95], s96 offen
    buffer_store_dwordx2 v[50:51], v3, s[92:95], s96 offen offset:32
    buffer_store_dwordx2 v[52:53], v3, s[92:95], s98 offen
    buffer_store_dwordx2 v[54:55], v3, s[92:95], s98 offen offset:32
    s_lshl_b32 s90, s3, 4
    s_add_u32 s78, s90, s29
    s_lshr_b32 s96, s78, 2
    s_and_b32 s97, s78, 3
    s_add_u32 s97, s97, 8
    s_sub_u32 s91, s78, 36
    s_lshr_b32 s98, s91, 1
    s_and_b32 s99, s91, 1
    s_add_u32 s99, s99, 12
    s_cmp_ge_u32 s78, 36
    s_cselect_b32 s96, s98, s96
    s_cselect_b32 s97, s99, s97
    s_sub_u32 s91, s78, 54
    s_cmp_ge_u32 s78, 54
    s_cselect_b32 s96, 8, s96
    s_cselect_b32 s97, s91, s97
    v_lshlrev_b32 v2, 4, v1
    v_and_b32 v3, 15, v1
    v_mul_u32_u24 v3, 1792, v3
    v_lshrrev_b32 v9, 4, v1
    v_lshl_add_u32 v3, v9, 3, v3
    s_lshl_b32 s76, s96, 10
    s_mul_i32 s90, s96, 14
    s_add_u32 s90, s90, s97
    s_lshl_b32 s91, s90, 10
    s_mul_i32 s100, s28, 144
    s_lshl_b32 s90, s96, 4
    s_add_u32 s100, s100, s90
    s_mul_i32 s100, s100, 1792
    s_lshl_b32 s90, s97, 6
    s_add_u32 s100, s100, s90
    s_mul_i32 s90, s30, 896
    s_add_u32 s96, s100, s90
    s_mov_b32 s97, s91
    s_mov_b64 exec, 1
    s_mov_b32 s89, 0
L_poll3:
    s_mov_b32 s88, 8192
    buffer_load_dword v9, off, s[84:87], s88 sc1
    s_waitcnt vmcnt(0)
    v_readfirstlane_b32 s90, v9
    s_add_u32 s89, s89, 1
    s_cmp_ge_u32 s90, 16
    s_cbranch_scc1 L_poll_done3
    s_cmp_ge_u32 s89, 0x40000
    s_cbranch_scc1 L_poll_done3
    s_sleep 2
    s_branch L_poll3
L_poll_done3:
    s_mov_b64 exec, -1
    s_cmp_ge_u32 s78, 62
    s_cbranch_scc1 L_fin_done4
    v_and_b32 v5, 15, v1
    v_lshlrev_b32 v5, 6, v5
    s_mov_b32 s91, s97
    buffer_load_dwordx4 v[64:67], v2, s[44:47], s91 offen sc0 sc1
    s_add_u32 s91, s91, 129024
    buffer_load_dwordx4 v[192:195], v5, s[64:67], s76 offen offset:0 sc0 sc1
    buffer_load_dwordx4 v[196:199], v5, s[64:67], s76 offen offset:16 sc0 sc1
    buffer_load_dwordx4 v[200:203], v5, s[64:67], s76 offen offset:32 sc0 sc1
    buffer_load_dwordx4 v[204:207], v5, s[64:67], s76 offen offset:48 sc0 sc1
    buffer_load_dwordx4 v[68:71], v2, s[44:47], s91 offen sc0 sc1
    s_add_u32 s91, s91, 129024
    buffer_load_dwordx4 v[72:75], v2, s[44:47], s91 offen sc0 sc1
    s_add_u32 s91, s91, 129024
    buffer_load_dwordx4 v[76:79], v2, s[44:47], s91 offen sc0 sc1
    s_add_u32 s91, s91, 129024
    buffer_load_dwordx4 v[80:83], v2, s[44:47], s91 offen sc0 sc1
    s_add_u32 s91, s91, 129024
    buffer_load_dwordx4 v[84:87], v2, s[44:47], s91 offen sc0 sc1
    s_add_u32 s91, s91, 129024
    buffer_load_dwordx4 v[88:91], v2, s[44:47], s91 offen sc0 sc1
    s_add_u32 s91, s91, 129024
    buffer_load_dwordx4 v[92:95], v2, s[44:47], s91 offen sc0 sc1
    s_add_u32 s91, s91, 129024
    buffer_load_dwordx4 v[96:99], v2, s[44:47], s91 offen sc0 sc1
    s_add_u32 s91, s91, 129024
    buffer_load_dwordx4 v[100:103], v2, s[44:47], s91 offen sc0 sc1
    s_add_u32 s91, s91, 129024
    buffer_load_dwordx4 v[104:107], v2, s[44:47], s91 offen sc0 sc1
    s_add_u32 s91, s91, 129024
    buffer_load_dwordx4 v[108:111], v2, s[44:47], s91 offen sc0 sc1
    s_add_u32 s91, s91, 129024
    buffer_load_dwordx4 v[112:115], v2, s[44:47], s91 offen sc0 sc1
    s_add_u32 s91, s91, 129024
    buffer_load_dwordx4 v[116:119], v2, s[44:47], s91 offen sc0 sc1
    s_add_u32 s91, s91, 129024
    buffer_load_dwordx4 v[120:123], v2, s[44:47], s91 offen sc0 sc1
    s_add_u32 s91, s91, 129024
    buffer_load_dwordx4 v[124:127], v2, s[44:47], s91 offen sc0 sc1
    s_waitcnt vmcnt(15)
    v_lshlrev_b32 v8, 16, v64
    v_and_b32 v9, 0xffff0000, v64
    v_lshlrev_b32 v10, 16, v65
    v_and_b32 v11, 0xffff0000, v65
    v_lshlrev_b32 v12, 16, v66
    v_and_b32 v13, 0xffff0000, v66
    v_lshlrev_b32 v14, 16, v67
    v_and_b32 v15, 0xffff0000, v67
    v_pk_mul_f32 v[32:33], v[8:9], v[192:193] op_sel:[0,0] op_sel_hi:[1,0]
    v_pk_mul_f32 v[34:35], v[10:11], v[192:193] op_sel:[0,0] op_sel_hi:[1,0]
    v_pk_mul_f32 v[36:37], v[12:13], v[192:193] op_sel:[0,0] op_sel_hi:[1,0]
    v_pk_mul_f32 v[38:39], v[14:15], v[192:193] op_sel:[0,0] op_sel_hi:[1,0]
    s_waitcnt vmcnt(14)
    v_lshlrev_b32 v8, 16, v68
    v_and_b32 v9, 0xffff0000, v68
    v_lshlrev_b32 v10, 16, v69
    v_and_b32 v11, 0xffff0000, v69
    v_lshlrev_b32 v12, 16, v70
    v_and_b32 v13, 0xffff0000, v70
    v_lshlrev_b32 v14, 16, v71
    v_and_b32 v15, 0xffff0000, v71
    v_pk_fma_f32 v[32:33], v[8:9], v[192:193], v[32:33] op_sel:[0,1,0] op_sel_hi:[1,1,1]
    v_pk_fma_f32 v[34:35], v[10:11], v[192:193], v[34:35] op_sel:[0,1,0] op_sel_hi:[1,1,1]
    v_pk_fma_f32 v[36:37], v[12:13], v[192:193], v[36:37] op_sel:[0,1,0] op_sel_hi:[1,1,1]
    v_pk_fma_f32 v[38:39], v[14:15], v[192:193], v[38:39] op_sel:[0,1,0] op_sel_hi:[1,1,1]
    s_waitcnt vmcnt(13)
    v_lshlrev_b32 v8, 16, v72
    v_and_b32 v9, 0xffff0000, v72
    v_lshlrev_b32 v10, 16, v73
    v_and_b32 v11, 0xffff0000, v73
    v_lshlrev_b32 v12, 16, v74
    v_and_b32 v13, 0xffff0000, v74
    v_lshlrev_b32 v14, 16, v75
    v_and_b32 v15, 0xffff0000, v75
    v_pk_fma_f32 v[32:33], v[8:9], v[194:195], v[32:33] op_sel:[0,0,0] op_sel_hi:[1,0,1]
    v_pk_fma_f32 v[34:35], v[10:11], v[194:195], v[34:35] op_sel:[0,0,0] op_sel_hi:[1,0,1]
    v_pk_fma_f32 v[36:37], v[12:13], v[194:195], v[36:37] op_sel:[0,0,0] op_sel_hi:[1,0,1]
    v_pk_fma_f32 v[38:39], v[14:15], v[194:195], v[38:39] op_sel:[0,0,0] op_sel_hi:[1,0,1]
    s_waitcnt vmcnt(12)
    v_lshlrev_b32 v8, 16, v76
    v_and_b32 v9, 0xffff0000, v76
    v_lshlrev_b32 v10, 16, v77
    v_and_b32 v11, 0xffff0000, v77
    v_lshlrev_b32 v12, 16, v78
    v_and_b32 v13, 0xffff0000, v78
    v_lshlrev_b32 v14, 16, v79
    v_and_b32 v15, 0xffff0000, v79
    v_pk_fma_f32 v[32:33], v[8:9], v[194:195], v[32:33] op_sel:[0,1,0] op_sel_hi:[1,1,1]
    v_pk_fma_f32 v[34:35], v[10:11], v[194:195], v[34:35] op_sel:[0,1,0] op_sel_hi:[1,1,1]
    v_pk_fma_f32 v[36:37], v[12:13], v[194:195], v[36:37] op_sel:[0,1,0] op_sel_hi:[1,1,1]
    v_pk_fma_f32 v[38:39], v[14:15], v[194:195], v[38:39] op_sel:[0,1,0] op_sel_hi:[1,1,1]
    s_waitcnt vmcnt(11)
    v_lshlrev_b32 v8, 16, v80
    v_and_b32 v9, 0xffff0000, v80
    v_lshlrev_b32 v10, 16, v81
    v_and_b32 v11, 0xffff0000, v81
    v_lshlrev_b32 v12, 16, v82
    v_and_b32 v13, 0xffff0000, v82
    v_lshlrev_b32 v14, 16, v83
    v_and_b32 v15, 0xffff0000, v83
    v_pk_fma_f32 v[32:33], v[8:9], v[196:197], v[32:33] op_sel:[0,0,0] op_sel_hi:[1,0,1]
    v_pk_fma_f32 v[34:35], v[10:11], v[196:197], v[34:35] op_sel:[0,0,0] op_sel_hi:[1,0,1]
    v_pk_fma_f32 v[36:37], v[12:13], v[196:197], v[36:37] op_sel:[0,0,0] op_sel_hi:[1,0,1]
    v_pk_fma_f32 v[38:39], v[14:15], v[196:197], v[38:39] op_sel:[0,0,0] op_sel_hi:[1,0,1]
    s_waitcnt vmcnt(10)
    v_lshlrev_b32 v8, 16, v84
    v_and_b32 v9, 0xffff0000, v84
    v_lshlrev_b32 v10, 16, v85
    v_and_b32 v11, 0xffff0000, v85
    v_lshlrev_b32 v12, 16, v86
    v_and_b32 v13, 0xffff0000, v86
    v_lshlrev_b32 v14, 16, v87
    v_and_b32 v15, 0xffff0000, v87
    v_pk_fma_f32 v[32:33], v[8:9], v[196:197], v[32:33] op_sel:[0,1,0] op_sel_hi:[1,1,1]
    v_pk_fma_f32 v[34:35], v[10:11], v[196:197], v[34:35] op_sel:[0,1,0] op_sel_hi:[1,1,1]
    v_pk_fma_f32 v[36:37], v[12:13], v[196:197], v[36:37] op_sel:[0,1,0] op_sel_hi:[1,1,1]
    v_pk_fma_f32 v[38:39], v[14:15], v[196:197], v[38:39] op_sel:[0,1,0] op_sel_hi:[1,1,1]
    s_waitcnt vmcnt(9)
    v_lshlrev_b32 v8, 16, v88
    v_and_b32 v9, 0xffff0000, v88
    v_lshlrev_b32 v10, 16, v89
    v_and_b32 v11, 0xffff0000, v89
    v_lshlrev_b32 v12, 16, v90
    v_and_b32 v13, 0xffff0000, v90
    v_lshlrev_b32 v14, 16, v91
    v_and_b32 v15, 0xffff0000, v91
    v_pk_fma_f32 v[32:33], v[8:9], v[198:199], v[32:33] op_sel:[0,0,0] op_sel_hi:[1,0,1]
    v_pk_fma_f32 v[34:35], v[10:11], v[198:199], v[34:35] op_sel:[0,0,0] op_sel_hi:[1,0,1]
    v_pk_fma_f32 v[36:37], v[12:13], v[198:199], v[36:37] op_sel:[0,0,0] op_sel_hi:[1,0,1]
    v_pk_fma_f32 v[38:39], v[14:15], v[198:199], v[38:39] op_sel:[0,0,0] op_sel_hi:[1,0,1]
    s_waitcnt vmcnt(8)
    v_lshlrev_b32 v8, 16, v92
    v_and_b32 v9, 0xffff0000, v92
    v_lshlrev_b32 v10, 16, v93
    v_and_b32 v11, 0xffff0000, v93
    v_lshlrev_b32 v12, 16, v94
    v_and_b32 v13, 0xffff0000, v94
    v_lshlrev_b32 v14, 16, v95
    v_and_b32 v15, 0xffff0000, v95
    v_pk_fma_f32 v[32:33], v[8:9], v[198:199], v[32:33] op_sel:[0,1,0] op_sel_hi:[1,1,1]
    v_pk_fma_f32 v[34:35], v[10:11], v[198:199], v[34:35] op_sel:[0,1,0] op_sel_hi:[1,1,1]
    v_pk_fma_f32 v[36:37], v[12:13], v[198:199], v[36:37] op_sel:[0,1,0] op_sel_hi:[1,1,1]
    v_pk_fma_f32 v[38:39], v[14:15], v[198:199], v[38:39] op_sel:[0,1,0] op_sel_hi:[1,1,1]
    s_waitcnt vmcnt(7)
    v_lshlrev_b32 v8, 16, v96
    v_and_b32 v9, 0xffff0000, v96
    v_lshlrev_b32 v10, 16, v97
    v_and_b32 v11, 0xffff0000, v97
    v_lshlrev_b32 v12, 16, v98
    v_and_b32 v13, 0xffff0000, v98
    v_lshlrev_b32 v14, 16, v99
    v_and_b32 v15, 0xffff0000, v99
    v_pk_fma_f32 v[32:33], v[8:9], v[200:201], v[32:33] op_sel:[0,0,0] op_sel_hi:[1,0,1]
    v_pk_fma_f32 v[34:35], v[10:11], v[200:201], v[34:35] op_sel:[0,0,0] op_sel_hi:[1,0,1]
    v_pk_fma_f32 v[36:37], v[12:13], v[200:201], v[36:37] op_sel:[0,0,0] op_sel_hi:[1,0,1]
    v_pk_fma_f32 v[38:39], v[14:15], v[200:201], v[38:39] op_sel:[0,0,0] op_sel_hi:[1,0,1]
    s_waitcnt vmcnt(6)
    v_lshlrev_b32 v8, 16, v100
    v_and_b32 v9, 0xffff0000, v100
    v_lshlrev_b32 v10, 16, v101
    v_and_b32 v11, 0xffff0000, v101
    v_lshlrev_b32 v12, 16, v102
    v_and_b32 v13, 0xffff0000, v102
    v_lshlrev_b32 v14, 16, v103
    v_and_b32 v15, 0xffff0000, v103
    v_pk_fma_f32 v[32:33], v[8:9], v[200:201], v[32:33] op_sel:[0,1,0] op_sel_hi:[1,1,1]
    v_pk_fma_f32 v[34:35], v[10:11], v[200:201], v[34:35] op_sel:[0,1,0] op_sel_hi:[1,1,1]
    v_pk_fma_f32 v[36:37], v[12:13], v[200:201], v[36:37] op_sel:[0,1,0] op_sel_hi:[1,1,1]
    v_pk_fma_f32 v[38:39], v[14:15], v[200:201], v[38:39] op_sel:[0,1,0] op_sel_hi:[1,1,1]
    s_waitcnt vmcnt(5)
    v_lshlrev_b32 v8, 16, v104
    v_and_b32 v9, 0xffff0000, v104
    v_lshlrev_b32 v10, 16, v105
    v_and_b32 v11, 0xffff0000, v105
    v_lshlrev_b32 v12, 16, v106
    v_and_b32 v13, 0xffff0000, v106
    v_lshlrev_b32 v14, 16, v107
    v_and_b32 v15, 0xffff0000, v107
    v_pk_fma_f32 v[32:33], v[8:9], v[202:203], v[32:33] op_sel:[0,0,0] op_sel_hi:[1,0,1]
    v_pk_fma_f32 v[34:35], v[10:11], v[202:203], v[34:35] op_sel:[0,0,0] op_sel_hi:[1,0,1]
    v_pk_fma_f32 v[36:37], v[12:13], v[202:203], v[36:37] op_sel:[0,0,0] op_sel_hi:[1,0,1]
    v_pk_fma_f32 v[38:39], v[14:15], v[202:203], v[38:39] op_sel:[0,0,0] op_sel_hi:[1,0,1]
    s_waitcnt vmcnt(4)
    v_lshlrev_b32 v8, 16, v108
    v_and_b32 v9, 0xffff0000, v108
    v_lshlrev_b32 v10, 16, v109
    v_and_b32 v11, 0xffff0000, v109
    v_lshlrev_b32 v12, 16, v110
    v_and_b32 v13, 0xffff0000, v110
    v_lshlrev_b32 v14, 16, v111
    v_and_b32 v15, 0xffff0000, v111
    v_pk_fma_f32 v[32:33], v[8:9], v[202:203], v[32:33] op_sel:[0,1,0] op_sel_hi:[1,1,1]
    v_pk_fma_f32 v[34:35], v[10:11], v[202:203], v[34:35] op_sel:[0,1,0] op_sel_hi:[1,1,1]
    v_pk_fma_f32 v[36:37], v[12:13], v[202:203], v[36:37] op_sel:[0,1,0] op_sel_hi:[1,1,1]
    v_pk_fma_f32 v[38:39], v[14:15], v[202:203], v[38:39] op_sel:[0,1,0] op_sel_hi:[1,1,1]
    s_waitcnt vmcnt(3)
    v_lshlrev_b32 v8, 16, v112
    v_and_b32 v9, 0xffff0000, v112
    v_lshlrev_b32 v10, 16, v113
    v_and_b32 v11, 0xffff0000, v113
    v_lshlrev_b32 v12, 16, v114
    v_and_b32 v13, 0xffff0000, v114
    v_lshlrev_b32 v14, 16, v115
    v_and_b32 v15, 0xffff0000, v115
    v_pk_fma_f32 v[32:33], v[8:9], v[204:205], v[32:33] op_sel:[0,0,0] op_sel_hi:[1,0,1]
    v_pk_fma_f32 v[34:35], v[10:11], v[204:205], v[34:35] op_sel:[0,0,0] op_sel_hi:[1,0,1]
    v_pk_fma_f32 v[36:37], v[12:13], v[204:205], v[36:37] op_sel:[0,0,0] op_sel_hi:[1,0,1]
    v_pk_fma_f32 v[38:39], v[14:15], v[204:205], v[38:39] op_sel:[0,0,0] op_sel_hi:[1,0,1]
    s_waitcnt vmcnt(2)
    v_lshlrev_b32 v8, 16, v116
    v_and_b32 v9, 0xffff0000, v116
    v_lshlrev_b32 v10, 16, v117
    v_and_b32 v11, 0xffff0000, v117
    v_lshlrev_b32 v12, 16, v118
    v_and_b32 v13, 0xffff0000, v118
    v_lshlrev_b32 v14, 16, v119
    v_and_b32 v15, 0xffff0000, v119
    v_pk_fma_f32 v[32:33], v[8:9], v[204:205], v[32:33] op_sel:[0,1,0] op_sel_hi:[1,1,1]
    v_pk_fma_f32 v[34:35], v[10:11], v[204:205], v[34:35] op_sel:[0,1,0] op_sel_hi:[1,1,1]
    v_pk_fma_f32 v[36:37], v[12:13], v[204:205], v[36:37] op_sel:[0,1,0] op_sel_hi:[1,1,1]
    v_pk_fma_f32 v[38:39], v[14:15], v[204:205], v[38:39] op_sel:[0,1,0] op_sel_hi:[1,1,1]
    s_waitcnt vmcnt(1)
    v_lshlrev_b32 v8, 16, v120
    v_and_b32 v9, 0xffff0000, v120
    v_lshlrev_b32 v10, 16, v121
    v_and_b32 v11, 0xffff0000, v121
    v_lshlrev_b32 v12, 16, v122
    v_and_b32 v13, 0xffff0000, v122
    v_lshlrev_b32 v14, 16, v123
    v_and_b32 v15, 0xffff0000, v123
    v_pk_fma_f32 v[32:33], v[8:9], v[206:207], v[32:33] op_sel:[0,0,0] op_sel_hi:[1,0,1]
    v_pk_fma_f32 v[34:35], v[10:11], v[206:207], v[34:35] op_sel:[0,0,0] op_sel_hi:[1,0,1]
    v_pk_fma_f32 v[36:37], v[12:13], v[206:207], v[36:37] op_sel:[0,0,0] op_sel_hi:[1,0,1]
    v_pk_fma_f32 v[38:39], v[14:15], v[206:207], v[38:39] op_sel:[0,0,0] op_sel_hi:[1,0,1]
    s_waitcnt vmcnt(0)
    v_lshlrev_b32 v8, 16, v124
    v_and_b32 v9, 0xffff0000, v124
    v_lshlrev_b32 v10, 16, v125
    v_and_b32 v11, 0xffff0000, v125
    v_lshlrev_b32 v12, 16, v126
    v_and_b32 v13, 0xffff0000, v126
    v_lshlrev_b32 v14, 16, v127
    v_and_b32 v15, 0xffff0000, v127
    v_pk_fma_f32 v[32:33], v[8:9], v[206:207], v[32:33] op_sel:[0,1,0] op_sel_hi:[1,1,1]
    v_pk_fma_f32 v[34:35], v[10:11], v[206:207], v[34:35] op_sel:[0,1,0] op_sel_hi:[1,1,1]
    v_pk_fma_f32 v[36:37], v[12:13], v[206:207], v[36:37] op_sel:[0,1,0] op_sel_hi:[1,1,1]
    v_pk_fma_f32 v[38:39], v[14:15], v[206:207], v[38:39] op_sel:[0,1,0] op_sel_hi:[1,1,1]
    v_cvt_pk_bf16_f32 v48, v32, v33
    v_cvt_pk_bf16_f32 v49, v34, v35
    v_cvt_pk_bf16_f32 v50, v36, v37
    v_cvt_pk_bf16_f32 v51, v38, v39
    buffer_store_dwordx2 v[48:49], v3, s[92:95], s96 offen
    buffer_store_dwordx2 v[50:51], v3, s[92:95], s96 offen offset:32
L_fin_done4:
    s_branch L_end
L_code_end:
L_rare_p0:
    s_nop 7
    v_max3_f32 v16, v48, v49, v50
    v_max3_f32 v16, v16, v51, v52
    v_max3_f32 v16, v16, v53, v54
    v_max_f32 v16, v16, v55
    v_mov_b32 v20, v16
    s_nop 1
    v_permlane32_swap_b32 v16, v20
    s_nop 1
    v_max_f32 v16, v16, v20
    v_mov_b32 v20, v16
    s_nop 1
    v_permlane16_swap_b32 v16, v20
    s_nop 1
    v_max_f32 v16, v16, v20
    v_max_f32 v16, 0, v16
    v_sub_f32 v48, v48, v16
    v_sub_f32 v49, v49, v16
    v_sub_f32 v50, v50, v16
    v_sub_f32 v51, v51, v16
    v_sub_f32 v52, v52, v16
    v_sub_f32 v53, v53, v16
    v_sub_f32 v54, v54, v16
    v_sub_f32 v55, v55, v16
    v_sub_f32 v84, v84, v16
    v_sub_f32 v85, v85, v16
    v_sub_f32 v86, v86, v16
    v_sub_f32 v87, v87, v16
    v_sub_f32 v16, 0, v16
    v_exp_f32 v16, v16
    v_max3_f32 v17, v56, v57, v58
    v_max3_f32 v17, v17, v59, v60
    v_max3_f32 v17, v17, v61, v62
    v_max_f32 v17, v17, v63
    v_mov_b32 v20, v17
    s_nop 1
    v_permlane32_swap_b32 v17, v20
    s_nop 1
    v_max_f32 v17, v17, v20
    v_mov_b32 v20, v17
    s_nop 1
    v_permlane16_swap_b32 v17, v20
    s_nop 1
    v_max_f32 v17, v17, v20
    v_max_f32 v17, 0, v17
    v_sub_f32 v56, v56, v17
    v_sub_f32 v57, v57, v17
    v_sub_f32 v58, v58, v17
    v_sub_f32 v59, v59, v17
    v_sub_f32 v60, v60, v17
    v_sub_f32 v61, v61, v17
    v_sub_f32 v62, v62, v17
    v_sub_f32 v63, v63, v17
    v_sub_f32 v88, v88, v17
    v_sub_f32 v89, v89, v17
    v_sub_f32 v90, v90, v17
    v_sub_f32 v91, v91, v17
    v_sub_f32 v17, 0, v17
    v_exp_f32 v17, v17
    v_max3_f32 v18, v64, v65, v66
    v_max3_f32 v18, v18, v67, v68
    v_max3_f32 v18, v18, v69, v70
    v_max_f32 v18, v18, v71
    v_mov_b32 v20, v18
    s_nop 1
    v_permlane32_swap_b32 v18, v20
    s_nop 1
    v_max_f32 v18, v18, v20
    v_mov_b32 v20, v18
    s_nop 1
    v_permlane16_swap_b32 v18, v20
    s_nop 1
    v_max_f32 v18, v18, v20
    v_max_f32 v18, 0, v18
    v_sub_f32 v64, v64, v18
    v_sub_f32 v65, v65, v18
    v_sub_f32 v66, v66, v18
    v_sub_f32 v67, v67, v18
    v_sub_f32 v68, v68, v18
    v_sub_f32 v69, v69, v18
    v_sub_f32 v70, v70, v18
    v_sub_f32 v71, v71, v18
    v_sub_f32 v92, v92, v18
    v_sub_f32 v93, v93, v18
    v_sub_f32 v94, v94, v18
    v_sub_f32 v95, v95, v18
    v_sub_f32 v18, 0, v18
    v_exp_f32 v18, v18
    s_getpc_b64 s[38:39]
L_pc_p0:
    s_add_u32 s38, s38, L_rescale-L_pc_p0
    s_addc_u32 s39, s39, 0
    s_swappc_b64 s[36:37], s[38:39]
    s_branch L_back_p0
L_rare_L_loop_1:
    s_nop 7
    v_max3_f32 v16, v24, v25, v26
    v_max3_f32 v16, v16, v27, v28
    v_max3_f32 v16, v16, v29, v30
    v_max_f32 v16, v16, v31
    v_mov_b32 v20, v16
    s_nop 1
    v_permlane32_swap_b32 v16, v20
    s_nop 1
    v_max_f32 v16, v16, v20
    v_mov_b32 v20, v16
    s_nop 1
    v_permlane16_swap_b32 v16, v20
    s_nop 1
    v_max_f32 v16, v16, v20
    v_max_f32 v16, 0, v16
    v_sub_f32 v24, v24, v16
    v_sub_f32 v25, v25, v16
    v_sub_f32 v26, v26, v16
    v_sub_f32 v27, v27, v16
    v_sub_f32 v28, v28, v16
    v_sub_f32 v29, v29, v16
    v_sub_f32 v30, v30, v16
    v_sub_f32 v31, v31, v16
    v_sub_f32 v84, v84, v16
    v_sub_f32 v85, v85, v16
    v_sub_f32 v86, v86, v16
    v_sub_f32 v87, v87, v16
    v_sub_f32 v16, 0, v16
    v_exp_f32 v16, v16
    v_max3_f32 v17, v32, v33, v34
    v_max3_f32 v17, v17, v35, v36
    v_max3_f32 v17, v17, v37, v38
    v_max_f32 v17, v17, v39
    v_mov_b32 v20, v17
    s_nop 1
    v_permlane32_swap_b32 v17, v20
    s_nop 1
    v_max_f32 v17, v17, v20
    v_mov_b32 v20, v17
    s_nop 1
    v_permlane16_swap_b32 v17, v20
    s_nop 1
    v_max_f32 v17, v17, v20
    v_max_f32 v17, 0, v17
    v_sub_f32 v32, v32, v17
    v_sub_f32 v33, v33, v17
    v_sub_f32 v34, v34, v17
    v_sub_f32 v35, v35, v17
    v_sub_f32 v36, v36, v17
    v_sub_f32 v37, v37, v17
    v_sub_f32 v38, v38, v17
    v_sub_f32 v39, v39, v17
    v_sub_f32 v88, v88, v17
    v_sub_f32 v89, v89, v17
    v_sub_f32 v90, v90, v17
    v_sub_f32 v91, v91, v17
    v_sub_f32 v17, 0, v17
    v_exp_f32 v17, v17
    v_max3_f32 v18, v40, v41, v42
    v_max3_f32 v18, v18, v43, v44
    v_max3_f32 v18, v18, v45, v46
    v_max_f32 v18, v18, v47
    v_mov_b32 v20, v18
    s_nop 1
    v_permlane32_swap_b32 v18, v20
    s_nop 1
    v_max_f32 v18, v18, v20
    v_mov_b32 v20, v18
    s_nop 1
    v_permlane16_swap_b32 v18, v20
    s_nop 1
    v_max_f32 v18, v18, v20
    v_max_f32 v18, 0, v18
    v_sub_f32 v40, v40, v18
    v_sub_f32 v41, v41, v18
    v_sub_f32 v42, v42, v18
    v_sub_f32 v43, v43, v18
    v_sub_f32 v44, v44, v18
    v_sub_f32 v45, v45, v18
    v_sub_f32 v46, v46, v18
    v_sub_f32 v47, v47, v18
    v_sub_f32 v92, v92, v18
    v_sub_f32 v93, v93, v18
    v_sub_f32 v94, v94, v18
    v_sub_f32 v95, v95, v18
    v_sub_f32 v18, 0, v18
    v_exp_f32 v18, v18
    s_getpc_b64 s[38:39]
L_pc_L_loop_1:
    s_add_u32 s38, s38, L_rescale-L_pc_L_loop_1
    s_addc_u32 s39, s39, 0
    s_swappc_b64 s[36:37], s[38:39]
    s_branch L_back_L_loop_1
L_rare_L_loop_2:
    s_nop 7
    v_max3_f32 v16, v48, v49, v50
    v_max3_f32 v16, v16, v51, v52
    v_max3_f32 v16, v16, v53, v54
    v_max_f32 v16, v16, v55
    v_mov_b32 v20, v16
    s_nop 1
    v_permlane32_swap_b32 v16, v20
    s_nop 1
    v_max_f32 v16, v16, v20
    v_mov_b32 v20, v16
    s_nop 1
    v_permlane16_swap_b32 v16, v20
    s_nop 1
    v_max_f32 v16, v16, v20
    v_max_f32 v16, 0, v16
    v_sub_f32 v48, v48, v16
    v_sub_f32 v49, v49, v16
    v_sub_f32 v50, v50, v16
    v_sub_f32 v51, v51, v16
    v_sub_f32 v52, v52, v16
    v_sub_f32 v53, v53, v16
    v_sub_f32 v54, v54, v16
    v_sub_f32 v55, v55, v16
    v_sub_f32 v84, v84, v16
    v_sub_f32 v85, v85, v16
    v_sub_f32 v86, v86, v16
    v_sub_f32 v87, v87, v16
    v_sub_f32 v16, 0, v16
    v_exp_f32 v16, v16
    v_max3_f32 v17, v56, v57, v58
    v_max3_f32 v17, v17, v59, v60
    v_max3_f32 v17, v17, v61, v62
    v_max_f32 v17, v17, v63
    v_mov_b32 v20, v17
    s_nop 1
    v_permlane32_swap_b32 v17, v20
    s_nop 1
    v_max_f32 v17, v17, v20
    v_mov_b32 v20, v17
    s_nop 1
    v_permlane16_swap_b32 v17, v20
    s_nop 1
    v_max_f32 v17, v17, v20
    v_max_f32 v17, 0, v17
    v_sub_f32 v56, v56, v17
    v_sub_f32 v57, v57, v17
    v_sub_f32 v58, v58, v17
    v_sub_f32 v59, v59, v17
    v_sub_f32 v60, v60, v17
    v_sub_f32 v61, v61, v17
    v_sub_f32 v62, v62, v17
    v_sub_f32 v63, v63, v17
    v_sub_f32 v88, v88, v17
    v_sub_f32 v89, v89, v17
    v_sub_f32 v90, v90, v17
    v_sub_f32 v91, v91, v17
    v_sub_f32 v17, 0, v17
    v_exp_f32 v17, v17
    v_max3_f32 v18, v64, v65, v66
    v_max3_f32 v18, v18, v67, v68
    v_max3_f32 v18, v18, v69, v70
    v_max_f32 v18, v18, v71
    v_mov_b32 v20, v18
    s_nop 1
    v_permlane32_swap_b32 v18, v20
    s_nop 1
    v_max_f32 v18, v18, v20
    v_mov_b32 v20, v18
    s_nop 1
    v_permlane16_swap_b32 v18, v20
    s_nop 1
    v_max_f32 v18, v18, v20
    v_max_f32 v18, 0, v18
    v_sub_f32 v64, v64, v18
    v_sub_f32 v65, v65, v18
    v_sub_f32 v66, v66, v18
    v_sub_f32 v67, v67, v18
    v_sub_f32 v68, v68, v18
    v_sub_f32 v69, v69, v18
    v_sub_f32 v70, v70, v18
    v_sub_f32 v71, v71, v18
    v_sub_f32 v92, v92, v18
    v_sub_f32 v93, v93, v18
    v_sub_f32 v94, v94, v18
    v_sub_f32 v95, v95, v18
    v_sub_f32 v18, 0, v18
    v_exp_f32 v18, v18
    s_getpc_b64 s[38:39]
L_pc_L_loop_2:
    s_add_u32 s38, s38, L_rescale-L_pc_L_loop_2
    s_addc_u32 s39, s39, 0
    s_swappc_b64 s[36:37], s[38:39]
    s_branch L_back_L_loop_2
L_rare_L_loop_3:
    s_nop 7
    v_max3_f32 v16, v24, v25, v26
    v_max3_f32 v16, v16, v27, v28
    v_max3_f32 v16, v16, v29, v30
    v_max_f32 v16, v16, v31
    v_mov_b32 v20, v16
    s_nop 1
    v_permlane32_swap_b32 v16, v20
    s_nop 1
    v_max_f32 v16, v16, v20
    v_mov_b32 v20, v16
    s_nop 1
    v_permlane16_swap_b32 v16, v20
    s_nop 1
    v_max_f32 v16, v16, v20
    v_max_f32 v16, 0, v16
    v_sub_f32 v24, v24, v16
    v_sub_f32 v25, v25, v16
    v_sub_f32 v26, v26, v16
    v_sub_f32 v27, v27, v16
    v_sub_f32 v28, v28, v16
    v_sub_f32 v29, v29, v16
    v_sub_f32 v30, v30, v16
    v_sub_f32 v31, v31, v16
    v_sub_f32 v84, v84, v16
    v_sub_f32 v85, v85, v16
    v_sub_f32 v86, v86, v16
    v_sub_f32 v87, v87, v16
    v_sub_f32 v16, 0, v16
    v_exp_f32 v16, v16
    v_max3_f32 v17, v32, v33, v34
    v_max3_f32 v17, v17, v35, v36
    v_max3_f32 v17, v17, v37, v38
    v_max_f32 v17, v17, v39
    v_mov_b32 v20, v17
    s_nop 1
    v_permlane32_swap_b32 v17, v20
    s_nop 1
    v_max_f32 v17, v17, v20
    v_mov_b32 v20, v17
    s_nop 1
    v_permlane16_swap_b32 v17, v20
    s_nop 1
    v_max_f32 v17, v17, v20
    v_max_f32 v17, 0, v17
    v_sub_f32 v32, v32, v17
    v_sub_f32 v33, v33, v17
    v_sub_f32 v34, v34, v17
    v_sub_f32 v35, v35, v17
    v_sub_f32 v36, v36, v17
    v_sub_f32 v37, v37, v17
    v_sub_f32 v38, v38, v17
    v_sub_f32 v39, v39, v17
    v_sub_f32 v88, v88, v17
    v_sub_f32 v89, v89, v17
    v_sub_f32 v90, v90, v17
    v_sub_f32 v91, v91, v17
    v_sub_f32 v17, 0, v17
    v_exp_f32 v17, v17
    v_max3_f32 v18, v40, v41, v42
    v_max3_f32 v18, v18, v43, v44
    v_max3_f32 v18, v18, v45, v46
    v_max_f32 v18, v18, v47
    v_mov_b32 v20, v18
    s_nop 1
    v_permlane32_swap_b32 v18, v20
    s_nop 1
    v_max_f32 v18, v18, v20
    v_mov_b32 v20, v18
    s_nop 1
    v_permlane16_swap_b32 v18, v20
    s_nop 1
    v_max_f32 v18, v18, v20
    v_max_f32 v18, 0, v18
    v_sub_f32 v40, v40, v18
    v_sub_f32 v41, v41, v18
    v_sub_f32 v42, v42, v18
    v_sub_f32 v43, v43, v18
    v_sub_f32 v44, v44, v18
    v_sub_f32 v45, v45, v18
    v_sub_f32 v46, v46, v18
    v_sub_f32 v47, v47, v18
    v_sub_f32 v92, v92, v18
    v_sub_f32 v93, v93, v18
    v_sub_f32 v94, v94, v18
    v_sub_f32 v95, v95, v18
    v_sub_f32 v18, 0, v18
    v_exp_f32 v18, v18
    s_getpc_b64 s[38:39]
L_pc_L_loop_3:
    s_add_u32 s38, s38, L_rescale-L_pc_L_loop_3
    s_addc_u32 s39, s39, 0
    s_swappc_b64 s[36:37], s[38:39]
    s_branch L_back_L_loop_3
L_rare_L_loop_4:
    s_nop 7
    v_max3_f32 v16, v48, v49, v50
    v_max3_f32 v16, v16, v51, v52
    v_max3_f32 v16, v16, v53, v54
    v_max_f32 v16, v16, v55
    v_mov_b32 v20, v16
    s_nop 1
    v_permlane32_swap_b32 v16, v20
    s_nop 1
    v_max_f32 v16, v16, v20
    v_mov_b32 v20, v16
    s_nop 1
    v_permlane16_swap_b32 v16, v20
    s_nop 1
    v_max_f32 v16, v16, v20
    v_max_f32 v16, 0, v16
    v_sub_f32 v48, v48, v16
    v_sub_f32 v49, v49, v16
    v_sub_f32 v50, v50, v16
    v_sub_f32 v51, v51, v16
    v_sub_f32 v52, v52, v16
    v_sub_f32 v53, v53, v16
    v_sub_f32 v54, v54, v16
    v_sub_f32 v55, v55, v16
    v_sub_f32 v84, v84, v16
    v_sub_f32 v85, v85, v16
    v_sub_f32 v86, v86, v16
    v_sub_f32 v87, v87, v16
    v_sub_f32 v16, 0, v16
    v_exp_f32 v16, v16
    v_max3_f32 v17, v56, v57, v58
    v_max3_f32 v17, v17, v59, v60
    v_max3_f32 v17, v17, v61, v62
    v_max_f32 v17, v17, v63
    v_mov_b32 v20, v17
    s_nop 1
    v_permlane32_swap_b32 v17, v20
    s_nop 1
    v_max_f32 v17, v17, v20
    v_mov_b32 v20, v17
    s_nop 1
    v_permlane16_swap_b32 v17, v20
    s_nop 1
    v_max_f32 v17, v17, v20
    v_max_f32 v17, 0, v17
    v_sub_f32 v56, v56, v17
    v_sub_f32 v57, v57, v17
    v_sub_f32 v58, v58, v17
    v_sub_f32 v59, v59, v17
    v_sub_f32 v60, v60, v17
    v_sub_f32 v61, v61, v17
    v_sub_f32 v62, v62, v17
    v_sub_f32 v63, v63, v17
    v_sub_f32 v88, v88, v17
    v_sub_f32 v89, v89, v17
    v_sub_f32 v90, v90, v17
    v_sub_f32 v91, v91, v17
    v_sub_f32 v17, 0, v17
    v_exp_f32 v17, v17
    v_max3_f32 v18, v64, v65, v66
    v_max3_f32 v18, v18, v67, v68
    v_max3_f32 v18, v18, v69, v70
    v_max_f32 v18, v18, v71
    v_mov_b32 v20, v18
    s_nop 1
    v_permlane32_swap_b32 v18, v20
    s_nop 1
    v_max_f32 v18, v18, v20
    v_mov_b32 v20, v18
    s_nop 1
    v_permlane16_swap_b32 v18, v20
    s_nop 1
    v_max_f32 v18, v18, v20
    v_max_f32 v18, 0, v18
    v_sub_f32 v64, v64, v18
    v_sub_f32 v65, v65, v18
    v_sub_f32 v66, v66, v18
    v_sub_f32 v67, v67, v18
    v_sub_f32 v68, v68, v18
    v_sub_f32 v69, v69, v18
    v_sub_f32 v70, v70, v18
    v_sub_f32 v71, v71, v18
    v_sub_f32 v92, v92, v18
    v_sub_f32 v93, v93, v18
    v_sub_f32 v94, v94, v18
    v_sub_f32 v95, v95, v18
    v_sub_f32 v18, 0, v18
    v_exp_f32 v18, v18
    s_getpc_b64 s[38:39]
L_pc_L_loop_4:
    s_add_u32 s38, s38, L_rescale-L_pc_L_loop_4
    s_addc_u32 s39, s39, 0
    s_swappc_b64 s[36:37], s[38:39]
    s_branch L_back_L_loop_4
L_rare_L_loopm_13:
    s_nop 7
    v_max3_f32 v16, v24, v25, v26
    v_max3_f32 v16, v16, v27, v28
    v_max3_f32 v16, v16, v29, v30
    v_max_f32 v16, v16, v31
    v_mov_b32 v20, v16
    s_nop 1
    v_permlane32_swap_b32 v16, v20
    s_nop 1
    v_max_f32 v16, v16, v20
    v_mov_b32 v20, v16
    s_nop 1
    v_permlane16_swap_b32 v16, v20
    s_nop 1
    v_max_f32 v16, v16, v20
    v_max_f32 v16, 0, v16
    v_sub_f32 v24, v24, v16
    v_sub_f32 v25, v25, v16
    v_sub_f32 v26, v26, v16
    v_sub_f32 v27, v27, v16
    v_sub_f32 v28, v28, v16
    v_sub_f32 v29, v29, v16
    v_sub_f32 v30, v30, v16
    v_sub_f32 v31, v31, v16
    v_sub_f32 v84, v84, v16
    v_sub_f32 v85, v85, v16
    v_sub_f32 v86, v86, v16
    v_sub_f32 v87, v87, v16
    v_sub_f32 v16, 0, v16
    v_exp_f32 v16, v16
    v_max3_f32 v17, v32, v33, v34
    v_max3_f32 v17, v17, v35, v36
    v_max3_f32 v17, v17, v37, v38
    v_max_f32 v17, v17, v39
    v_mov_b32 v20, v17
    s_nop 1
    v_permlane32_swap_b32 v17, v20
    s_nop 1
    v_max_f32 v17, v17, v20
    v_mov_b32 v20, v17
    s_nop 1
    v_permlane16_swap_b32 v17, v20
    s_nop 1
    v_max_f32 v17, v17, v20
    v_max_f32 v17, 0, v17
    v_sub_f32 v32, v32, v17
    v_sub_f32 v33, v33, v17
    v_sub_f32 v34, v34, v17
    v_sub_f32 v35, v35, v17
    v_sub_f32 v36, v36, v17
    v_sub_f32 v37, v37, v17
    v_sub_f32 v38, v38, v17
    v_sub_f32 v39, v39, v17
    v_sub_f32 v88, v88, v17
    v_sub_f32 v89, v89, v17
    v_sub_f32 v90, v90, v17
    v_sub_f32 v91, v91, v17
    v_sub_f32 v17, 0, v17
    v_exp_f32 v17, v17
    v_max3_f32 v18, v40, v41, v42
    v_max3_f32 v18, v18, v43, v44
    v_max3_f32 v18, v18, v45, v46
    v_max_f32 v18, v18, v47
    v_mov_b32 v20, v18
    s_nop 1
    v_permlane32_swap_b32 v18, v20
    s_nop 1
    v_max_f32 v18, v18, v20
    v_mov_b32 v20, v18
    s_nop 1
    v_permlane16_swap_b32 v18, v20
    s_nop 1
    v_max_f32 v18, v18, v20
    v_max_f32 v18, 0, v18
    v_sub_f32 v40, v40, v18
    v_sub_f32 v41, v41, v18
    v_sub_f32 v42, v42, v18
    v_sub_f32 v43, v43, v18
    v_sub_f32 v44, v44, v18
    v_sub_f32 v45, v45, v18
    v_sub_f32 v46, v46, v18
    v_sub_f32 v47, v47, v18
    v_sub_f32 v92, v92, v18
    v_sub_f32 v93, v93, v18
    v_sub_f32 v94, v94, v18
    v_sub_f32 v95, v95, v18
    v_sub_f32 v18, 0, v18
    v_exp_f32 v18, v18
    s_getpc_b64 s[38:39]
L_pc_L_loopm_13:
    s_add_u32 s38, s38, L_rescale-L_pc_L_loopm_13
    s_addc_u32 s39, s39, 0
    s_swappc_b64 s[36:37], s[38:39]
    s_branch L_back_L_loopm_13
L_rare_L_loopm_14:
    s_nop 7
    v_max3_f32 v16, v48, v49, v50
    v_max3_f32 v16, v16, v51, v52
    v_max3_f32 v16, v16, v53, v54
    v_max_f32 v16, v16, v55
    v_mov_b32 v20, v16
    s_nop 1
    v_permlane32_swap_b32 v16, v20
    s_nop 1
    v_max_f32 v16, v16, v20
    v_mov_b32 v20, v16
    s_nop 1
    v_permlane16_swap_b32 v16, v20
    s_nop 1
    v_max_f32 v16, v16, v20
    v_max_f32 v16, 0, v16
    v_sub_f32 v48, v48, v16
    v_sub_f32 v49, v49, v16
    v_sub_f32 v50, v50, v16
    v_sub_f32 v51, v51, v16
    v_sub_f32 v52, v52, v16
    v_sub_f32 v53, v53, v16
    v_sub_f32 v54, v54, v16
    v_sub_f32 v55, v55, v16
    v_sub_f32 v84, v84, v16
    v_sub_f32 v85, v85, v16
    v_sub_f32 v86, v86, v16
    v_sub_f32 v87, v87, v16
    v_sub_f32 v16, 0, v16
    v_exp_f32 v16, v16
    v_max3_f32 v17, v56, v57, v58
    v_max3_f32 v17, v17, v59, v60
    v_max3_f32 v17, v17, v61, v62
    v_max_f32 v17, v17, v63
    v_mov_b32 v20, v17
    s_nop 1
    v_permlane32_swap_b32 v17, v20
    s_nop 1
    v_max_f32 v17, v17, v20
    v_mov_b32 v20, v17
    s_nop 1
    v_permlane16_swap_b32 v17, v20
    s_nop 1
    v_max_f32 v17, v17, v20
    v_max_f32 v17, 0, v17
    v_sub_f32 v56, v56, v17
    v_sub_f32 v57, v57, v17
    v_sub_f32 v58, v58, v17
    v_sub_f32 v59, v59, v17
    v_sub_f32 v60, v60, v17
    v_sub_f32 v61, v61, v17
    v_sub_f32 v62, v62, v17
    v_sub_f32 v63, v63, v17
    v_sub_f32 v88, v88, v17
    v_sub_f32 v89, v89, v17
    v_sub_f32 v90, v90, v17
    v_sub_f32 v91, v91, v17
    v_sub_f32 v17, 0, v17
    v_exp_f32 v17, v17
    v_max3_f32 v18, v64, v65, v66
    v_max3_f32 v18, v18, v67, v68
    v_max3_f32 v18, v18, v69, v70
    v_max_f32 v18, v18, v71
    v_mov_b32 v20, v18
    s_nop 1
    v_permlane32_swap_b32 v18, v20
    s_nop 1
    v_max_f32 v18, v18, v20
    v_mov_b32 v20, v18
    s_nop 1
    v_permlane16_swap_b32 v18, v20
    s_nop 1
    v_max_f32 v18, v18, v20
    v_max_f32 v18, 0, v18
    v_sub_f32 v64, v64, v18
    v_sub_f32 v65, v65, v18
    v_sub_f32 v66, v66, v18
    v_sub_f32 v67, v67, v18
    v_sub_f32 v68, v68, v18
    v_sub_f32 v69, v69, v18
    v_sub_f32 v70, v70, v18
    v_sub_f32 v71, v71, v18
    v_sub_f32 v92, v92, v18
    v_sub_f32 v93, v93, v18
    v_sub_f32 v94, v94, v18
    v_sub_f32 v95, v95, v18
    v_sub_f32 v18, 0, v18
    v_exp_f32 v18, v18
    s_getpc_b64 s[38:39]
L_pc_L_loopm_14:
    s_add_u32 s38, s38, L_rescale-L_pc_L_loopm_14
    s_addc_u32 s39, s39, 0
    s_swappc_b64 s[36:37], s[38:39]
    s_branch L_back_L_loopm_14
L_rare_L_loopm_15:
    s_nop 7
    v_max3_f32 v16, v24, v25, v26
    v_max3_f32 v16, v16, v27, v28
    v_max3_f32 v16, v16, v29, v30
    v_max_f32 v16, v16, v31
    v_mov_b32 v20, v16
    s_nop 1
    v_permlane32_swap_b32 v16, v20
    s_nop 1
    v_max_f32 v16, v16, v20
    v_mov_b32 v20, v16
    s_nop 1
    v_permlane16_swap_b32 v16, v20
    s_nop 1
    v_max_f32 v16, v16, v20
    v_max_f32 v16, 0, v16
    v_sub_f32 v24, v24, v16
    v_sub_f32 v25, v25, v16
    v_sub_f32 v26, v26, v16
    v_sub_f32 v27, v27, v16
    v_sub_f32 v28, v28, v16
    v_sub_f32 v29, v29, v16
    v_sub_f32 v30, v30, v16
    v_sub_f32 v31, v31, v16
    v_sub_f32 v84, v84, v16
    v_sub_f32 v85, v85, v16
    v_sub_f32 v86, v86, v16
    v_sub_f32 v87, v87, v16
    v_sub_f32 v16, 0, v16
    v_exp_f32 v16, v16
    v_max3_f32 v17, v32, v33, v34
    v_max3_f32 v17, v17, v35, v36
    v_max3_f32 v17, v17, v37, v38
    v_max_f32 v17, v17, v39
    v_mov_b32 v20, v17
    s_nop 1
    v_permlane32_swap_b32 v17, v20
    s_nop 1
    v_max_f32 v17, v17, v20
    v_mov_b32 v20, v17
    s_nop 1
    v_permlane16_swap_b32 v17, v20
    s_nop 1
    v_max_f32 v17, v17, v20
    v_max_f32 v17, 0, v17
    v_sub_f32 v32, v32, v17
    v_sub_f32 v33, v33, v17
    v_sub_f32 v34, v34, v17
    v_sub_f32 v35, v35, v17
    v_sub_f32 v36, v36, v17
    v_sub_f32 v37, v37, v17
    v_sub_f32 v38, v38, v17
    v_sub_f32 v39, v39, v17
    v_sub_f32 v88, v88, v17
    v_sub_f32 v89, v89, v17
    v_sub_f32 v90, v90, v17
    v_sub_f32 v91, v91, v17
    v_sub_f32 v17, 0, v17
    v_exp_f32 v17, v17
    v_max3_f32 v18, v40, v41, v42
    v_max3_f32 v18, v18, v43, v44
    v_max3_f32 v18, v18, v45, v46
    v_max_f32 v18, v18, v47
    v_mov_b32 v20, v18
    s_nop 1
    v_permlane32_swap_b32 v18, v20
    s_nop 1
    v_max_f32 v18, v18, v20
    v_mov_b32 v20, v18
    s_nop 1
    v_permlane16_swap_b32 v18, v20
    s_nop 1
    v_max_f32 v18, v18, v20
    v_max_f32 v18, 0, v18
    v_sub_f32 v40, v40, v18
    v_sub_f32 v41, v41, v18
    v_sub_f32 v42, v42, v18
    v_sub_f32 v43, v43, v18
    v_sub_f32 v44, v44, v18
    v_sub_f32 v45, v45, v18
    v_sub_f32 v46, v46, v18
    v_sub_f32 v47, v47, v18
    v_sub_f32 v92, v92, v18
    v_sub_f32 v93, v93, v18
    v_sub_f32 v94, v94, v18
    v_sub_f32 v95, v95, v18
    v_sub_f32 v18, 0, v18
    v_exp_f32 v18, v18
    s_getpc_b64 s[38:39]
L_pc_L_loopm_15:
    s_add_u32 s38, s38, L_rescale-L_pc_L_loopm_15
    s_addc_u32 s39, s39, 0
    s_swappc_b64 s[36:37], s[38:39]
    s_branch L_back_L_loopm_15
L_rare_L_loopm_16:
    s_nop 7
    v_max3_f32 v16, v48, v49, v50
    v_max3_f32 v16, v16, v51, v52
    v_max3_f32 v16, v16, v53, v54
    v_max_f32 v16, v16, v55
    v_mov_b32 v20, v16
    s_nop 1
    v_permlane32_swap_b32 v16, v20
    s_nop 1
    v_max_f32 v16, v16, v20
    v_mov_b32 v20, v16
    s_nop 1
    v_permlane16_swap_b32 v16, v20
    s_nop 1
    v_max_f32 v16, v16, v20
    v_max_f32 v16, 0, v16
    v_sub_f32 v48, v48, v16
    v_sub_f32 v49, v49, v16
    v_sub_f32 v50, v50, v16
    v_sub_f32 v51, v51, v16
    v_sub_f32 v52, v52, v16
    v_sub_f32 v53, v53, v16
    v_sub_f32 v54, v54, v16
    v_sub_f32 v55, v55, v16
    v_sub_f32 v84, v84, v16
    v_sub_f32 v85, v85, v16
    v_sub_f32 v86, v86, v16
    v_sub_f32 v87, v87, v16
    v_sub_f32 v16, 0, v16
    v_exp_f32 v16, v16
    v_max3_f32 v17, v56, v57, v58
    v_max3_f32 v17, v17, v59, v60
    v_max3_f32 v17, v17, v61, v62
    v_max_f32 v17, v17, v63
    v_mov_b32 v20, v17
    s_nop 1
    v_permlane32_swap_b32 v17, v20
    s_nop 1
    v_max_f32 v17, v17, v20
    v_mov_b32 v20, v17
    s_nop 1
    v_permlane16_swap_b32 v17, v20
    s_nop 1
    v_max_f32 v17, v17, v20
    v_max_f32 v17, 0, v17
    v_sub_f32 v56, v56, v17
    v_sub_f32 v57, v57, v17
    v_sub_f32 v58, v58, v17
    v_sub_f32 v59, v59, v17
    v_sub_f32 v60, v60, v17
    v_sub_f32 v61, v61, v17
    v_sub_f32 v62, v62, v17
    v_sub_f32 v63, v63, v17
    v_sub_f32 v88, v88, v17
    v_sub_f32 v89, v89, v17
    v_sub_f32 v90, v90, v17
    v_sub_f32 v91, v91, v17
    v_sub_f32 v17, 0, v17
    v_exp_f32 v17, v17
    v_max3_f32 v18, v64, v65, v66
    v_max3_f32 v18, v18, v67, v68
    v_max3_f32 v18, v18, v69, v70
    v_max_f32 v18, v18, v71
    v_mov_b32 v20, v18
    s_nop 1
    v_permlane32_swap_b32 v18, v20
    s_nop 1
    v_max_f32 v18, v18, v20
    v_mov_b32 v20, v18
    s_nop 1
    v_permlane16_swap_b32 v18, v20
    s_nop 1
    v_max_f32 v18, v18, v20
    v_max_f32 v18, 0, v18
    v_sub_f32 v64, v64, v18
    v_sub_f32 v65, v65, v18
    v_sub_f32 v66, v66, v18
    v_sub_f32 v67, v67, v18
    v_sub_f32 v68, v68, v18
    v_sub_f32 v69, v69, v18
    v_sub_f32 v70, v70, v18
    v_sub_f32 v71, v71, v18
    v_sub_f32 v92, v92, v18
    v_sub_f32 v93, v93, v18
    v_sub_f32 v94, v94, v18
    v_sub_f32 v95, v95, v18
    v_sub_f32 v18, 0, v18
    v_exp_f32 v18, v18
    s_getpc_b64 s[38:39]
L_pc_L_loopm_16:
    s_add_u32 s38, s38, L_rescale-L_pc_L_loopm_16
    s_addc_u32 s39, s39, 0
    s_swappc_b64 s[36:37], s[38:39]
    s_branch L_back_L_loopm_16
L_rare_e29:
    s_nop 7
    v_max3_f32 v16, v24, v25, v26
    v_max3_f32 v16, v16, v27, v28
    v_max3_f32 v16, v16, v29, v30
    v_max_f32 v16, v16, v31
    v_mov_b32 v20, v16
    s_nop 1
    v_permlane32_swap_b32 v16, v20
    s_nop 1
    v_max_f32 v16, v16, v20
    v_mov_b32 v20, v16
    s_nop 1
    v_permlane16_swap_b32 v16, v20
    s_nop 1
    v_max_f32 v16, v16, v20
    v_max_f32 v16, 0, v16
    v_sub_f32 v24, v24, v16
    v_sub_f32 v25, v25, v16
    v_sub_f32 v26, v26, v16
    v_sub_f32 v27, v27, v16
    v_sub_f32 v28, v28, v16
    v_sub_f32 v29, v29, v16
    v_sub_f32 v30, v30, v16
    v_sub_f32 v31, v31, v16
    v_sub_f32 v84, v84, v16
    v_sub_f32 v85, v85, v16
    v_sub_f32 v86, v86, v16
    v_sub_f32 v87, v87, v16
    v_sub_f32 v16, 0, v16
    v_exp_f32 v16, v16
    v_max3_f32 v17, v32, v33, v34
    v_max3_f32 v17, v17, v35, v36
    v_max3_f32 v17, v17, v37, v38
    v_max_f32 v17, v17, v39
    v_mov_b32 v20, v17
    s_nop 1
    v_permlane32_swap_b32 v17, v20
    s_nop 1
    v_max_f32 v17, v17, v20
    v_mov_b32 v20, v17
    s_nop 1
    v_permlane16_swap_b32 v17, v20
    s_nop 1
    v_max_f32 v17, v17, v20
    v_max_f32 v17, 0, v17
    v_sub_f32 v32, v32, v17
    v_sub_f32 v33, v33, v17
    v_sub_f32 v34, v34, v17
    v_sub_f32 v35, v35, v17
    v_sub_f32 v36, v36, v17
    v_sub_f32 v37, v37, v17
    v_sub_f32 v38, v38, v17
    v_sub_f32 v39, v39, v17
    v_sub_f32 v88, v88, v17
    v_sub_f32 v89, v89, v17
    v_sub_f32 v90, v90, v17
    v_sub_f32 v91, v91, v17
    v_sub_f32 v17, 0, v17
    v_exp_f32 v17, v17
    v_max3_f32 v18, v40, v41, v42
    v_max3_f32 v18, v18, v43, v44
    v_max3_f32 v18, v18, v45, v46
    v_max_f32 v18, v18, v47
    v_mov_b32 v20, v18
    s_nop 1
    v_permlane32_swap_b32 v18, v20
    s_nop 1
    v_max_f32 v18, v18, v20
    v_mov_b32 v20, v18
    s_nop 1
    v_permlane16_swap_b32 v18, v20
    s_nop 1
    v_max_f32 v18, v18, v20
    v_max_f32 v18, 0, v18
    v_sub_f32 v40, v40, v18
    v_sub_f32 v41, v41, v18
    v_sub_f32 v42, v42, v18
    v_sub_f32 v43, v43, v18
    v_sub_f32 v44, v44, v18
    v_sub_f32 v45, v45, v18
    v_sub_f32 v46, v46, v18
    v_sub_f32 v47, v47, v18
    v_sub_f32 v92, v92, v18
    v_sub_f32 v93, v93, v18
    v_sub_f32 v94, v94, v18
    v_sub_f32 v95, v95, v18
    v_sub_f32 v18, 0, v18
    v_exp_f32 v18, v18
    s_getpc_b64 s[38:39]
L_pc_e29:
    s_add_u32 s38, s38, L_rescale-L_pc_e29
    s_addc_u32 s39, s39, 0
    s_swappc_b64 s[36:37], s[38:39]
    s_branch L_back_e29
L_rare_e30:
    s_nop 7
    v_max3_f32 v16, v48, v49, v50
    v_max3_f32 v16, v16, v51, v52
    v_max3_f32 v16, v16, v53, v54
    v_max_f32 v16, v16, v55
    v_mov_b32 v20, v16
    s_nop 1
    v_permlane32_swap_b32 v16, v20
    s_nop 1
    v_max_f32 v16, v16, v20
    v_mov_b32 v20, v16
    s_nop 1
    v_permlane16_swap_b32 v16, v20
    s_nop 1
    v_max_f32 v16, v16, v20
    v_max_f32 v16, 0, v16
    v_sub_f32 v48, v48, v16
    v_sub_f32 v49, v49, v16
    v_sub_f32 v50, v50, v16
    v_sub_f32 v51, v51, v16
    v_sub_f32 v52, v52, v16
    v_sub_f32 v53, v53, v16
    v_sub_f32 v54, v54, v16
    v_sub_f32 v55, v55, v16
    v_sub_f32 v84, v84, v16
    v_sub_f32 v85, v85, v16
    v_sub_f32 v86, v86, v16
    v_sub_f32 v87, v87, v16
    v_sub_f32 v16, 0, v16
    v_exp_f32 v16, v16
    v_max3_f32 v17, v56, v57, v58
    v_max3_f32 v17, v17, v59, v60
    v_max3_f32 v17, v17, v61, v62
    v_max_f32 v17, v17, v63
    v_mov_b32 v20, v17
    s_nop 1
    v_permlane32_swap_b32 v17, v20
    s_nop 1
    v_max_f32 v17, v17, v20
    v_mov_b32 v20, v17
    s_nop 1
    v_permlane16_swap_b32 v17, v20
    s_nop 1
    v_max_f32 v17, v17, v20
    v_max_f32 v17, 0, v17
    v_sub_f32 v56, v56, v17
    v_sub_f32 v57, v57, v17
    v_sub_f32 v58, v58, v17
    v_sub_f32 v59, v59, v17
    v_sub_f32 v60, v60, v17
    v_sub_f32 v61, v61, v17
    v_sub_f32 v62, v62, v17
    v_sub_f32 v63, v63, v17
    v_sub_f32 v88, v88, v17
    v_sub_f32 v89, v89, v17
    v_sub_f32 v90, v90, v17
    v_sub_f32 v91, v91, v17
    v_sub_f32 v17, 0, v17
    v_exp_f32 v17, v17
    v_max3_f32 v18, v64, v65, v66
    v_max3_f32 v18, v18, v67, v68
    v_max3_f32 v18, v18, v69, v70
    v_max_f32 v18, v18, v71
    v_mov_b32 v20, v18
    s_nop 1
    v_permlane32_swap_b32 v18, v20
    s_nop 1
    v_max_f32 v18, v18, v20
    v_mov_b32 v20, v18
    s_nop 1
    v_permlane16_swap_b32 v18, v20
    s_nop 1
    v_max_f32 v18, v18, v20
    v_max_f32 v18, 0, v18
    v_sub_f32 v64, v64, v18
    v_sub_f32 v65, v65, v18
    v_sub_f32 v66, v66, v18
    v_sub_f32 v67, v67, v18
    v_sub_f32 v68, v68, v18
    v_sub_f32 v69, v69, v18
    v_sub_f32 v70, v70, v18
    v_sub_f32 v71, v71, v18
    v_sub_f32 v92, v92, v18
    v_sub_f32 v93, v93, v18
    v_sub_f32 v94, v94, v18
    v_sub_f32 v95, v95, v18
    v_sub_f32 v18, 0, v18
    v_exp_f32 v18, v18
    s_getpc_b64 s[38:39]
L_pc_e30:
    s_add_u32 s38, s38, L_rescale-L_pc_e30
    s_addc_u32 s39, s39, 0
    s_swappc_b64 s[36:37], s[38:39]
    s_branch L_back_e30
L_rescale:
    s_nop 7
    v_accvgpr_read_b32 v20, a0
    v_accvgpr_read_b32 v21, a1
    v_accvgpr_read_b32 v22, a2
    v_accvgpr_read_b32 v23, a3
    v_mul_f32 v20, v16, v20
    v_mul_f32 v21, v16, v21
    v_mul_f32 v22, v16, v22
    v_mul_f32 v23, v16, v23
    v_accvgpr_write_b32 a0, v20
    v_accvgpr_write_b32 a1, v21
    v_accvgpr_write_b32 a2, v22
    v_accvgpr_write_b32 a3, v23
    v_accvgpr_read_b32 v20, a12
    v_accvgpr_read_b32 v21, a13
    v_accvgpr_read_b32 v22, a14
    v_accvgpr_read_b32 v23, a15
    v_mul_f32 v20, v16, v20
    v_mul_f32 v21, v16, v21
    v_mul_f32 v22, v16, v22
    v_mul_f32 v23, v16, v23
    v_accvgpr_write_b32 a12, v20
    v_accvgpr_write_b32 a13, v21
    v_accvgpr_write_b32 a14, v22
    v_accvgpr_write_b32 a15, v23
    v_accvgpr_read_b32 v20, a24
    v_accvgpr_read_b32 v21, a25
    v_accvgpr_read_b32 v22, a26
    v_accvgpr_read_b32 v23, a27
    v_mul_f32 v20, v16, v20
    v_mul_f32 v21, v16, v21
    v_mul_f32 v22, v16, v22
    v_mul_f32 v23, v16, v23
    v_accvgpr_write_b32 a24, v20
    v_accvgpr_write_b32 a25, v21
    v_accvgpr_write_b32 a26, v22
    v_accvgpr_write_b32 a27, v23
    v_accvgpr_read_b32 v20, a36
    v_accvgpr_read_b32 v21, a37
    v_accvgpr_read_b32 v22, a38
    v_accvgpr_read_b32 v23, a39
    v_mul_f32 v20, v16, v20
    v_mul_f32 v21, v16, v21
    v_mul_f32 v22, v16, v22
    v_mul_f32 v23, v16, v23
    v_accvgpr_write_b32 a36, v20
    v_accvgpr_write_b32 a37, v21
    v_accvgpr_write_b32 a38, v22
    v_accvgpr_write_b32 a39, v23
    v_accvgpr_read_b32 v20, a48
    v_accvgpr_read_b32 v21, a49
    v_accvgpr_read_b32 v22, a50
    v_accvgpr_read_b32 v23, a51
    v_mul_f32 v20, v16, v20
    v_mul_f32 v21, v16, v21
    v_mul_f32 v22, v16, v22
    v_mul_f32 v23, v16, v23
    v_accvgpr_write_b32 a48, v20
    v_accvgpr_write_b32 a49, v21
    v_accvgpr_write_b32 a50, v22
    v_accvgpr_write_b32 a51, v23
    v_accvgpr_read_b32 v20, a60
    v_accvgpr_read_b32 v21, a61
    v_accvgpr_read_b32 v22, a62
    v_accvgpr_read_b32 v23, a63
    v_mul_f32 v20, v16, v20
    v_mul_f32 v21, v16, v21
    v_mul_f32 v22, v16, v22
    v_mul_f32 v23, v16, v23
    v_accvgpr_write_b32 a60, v20
    v_accvgpr_write_b32 a61, v21
    v_accvgpr_write_b32 a62, v22
    v_accvgpr_write_b32 a63, v23
    v_accvgpr_read_b32 v20, a72
    v_accvgpr_read_b32 v21, a73
    v_accvgpr_read_b32 v22, a74
    v_accvgpr_read_b32 v23, a75
    v_mul_f32 v20, v16, v20
    v_mul_f32 v21, v16, v21
    v_mul_f32 v22, v16, v22
    v_mul_f32 v23, v16, v23
    v_accvgpr_write_b32 a72, v20
    v_accvgpr_write_b32 a73, v21
    v_accvgpr_write_b32 a74, v22
    v_accvgpr_write_b32 a75, v23
    v_accvgpr_read_b32 v20, a84
    v_accvgpr_read_b32 v21, a85
    v_accvgpr_read_b32 v22, a86
    v_accvgpr_read_b32 v23, a87
    v_mul_f32 v20, v16, v20
    v_mul_f32 v21, v16, v21
    v_mul_f32 v22, v16, v22
    v_mul_f32 v23, v16, v23
    v_accvgpr_write_b32 a84, v20
    v_accvgpr_write_b32 a85, v21
    v_accvgpr_write_b32 a86, v22
    v_accvgpr_write_b32 a87, v23
    v_accvgpr_read_b32 v20, a96
    v_accvgpr_read_b32 v21, a97
    v_accvgpr_read_b32 v22, a98
    v_accvgpr_read_b32 v23, a99
    v_mul_f32 v20, v16, v20
    v_mul_f32 v21, v16, v21
    v_mul_f32 v22, v16, v22
    v_mul_f32 v23, v16, v23
    v_accvgpr_write_b32 a96, v20
    v_accvgpr_write_b32 a97, v21
    v_accvgpr_write_b32 a98, v22
    v_accvgpr_write_b32 a99, v23
    v_accvgpr_read_b32 v20, a108
    v_accvgpr_read_b32 v21, a109
    v_accvgpr_read_b32 v22, a110
    v_accvgpr_read_b32 v23, a111
    v_mul_f32 v20, v16, v20
    v_mul_f32 v21, v16, v21
    v_mul_f32 v22, v16, v22
    v_mul_f32 v23, v16, v23
    v_accvgpr_write_b32 a108, v20
    v_accvgpr_write_b32 a109, v21
    v_accvgpr_write_b32 a110, v22
    v_accvgpr_write_b32 a111, v23
    v_accvgpr_read_b32 v20, a120
    v_accvgpr_read_b32 v21, a121
    v_accvgpr_read_b32 v22, a122
    v_accvgpr_read_b32 v23, a123
    v_mul_f32 v20, v16, v20
    v_mul_f32 v21, v16, v21
    v_mul_f32 v22, v16, v22
    v_mul_f32 v23, v16, v23
    v_accvgpr_write_b32 a120, v20
    v_accvgpr_write_b32 a121, v21
    v_accvgpr_write_b32 a122, v22
    v_accvgpr_write_b32 a123, v23
    v_accvgpr_read_b32 v20, a132
    v_accvgpr_read_b32 v21, a133
    v_accvgpr_read_b32 v22, a134
    v_accvgpr_read_b32 v23, a135
    v_mul_f32 v20, v16, v20
    v_mul_f32 v21, v16, v21
    v_mul_f32 v22, v16, v22
    v_mul_f32 v23, v16, v23
    v_accvgpr_write_b32 a132, v20
    v_accvgpr_write_b32 a133, v21
    v_accvgpr_write_b32 a134, v22
    v_accvgpr_write_b32 a135, v23
    v_accvgpr_read_b32 v20, a144
    v_accvgpr_read_b32 v21, a145
    v_accvgpr_read_b32 v22, a146
    v_accvgpr_read_b32 v23, a147
    v_mul_f32 v20, v16, v20
    v_mul_f32 v21, v16, v21
    v_mul_f32 v22, v16, v22
    v_mul_f32 v23, v16, v23
    v_accvgpr_write_b32 a144, v20
    v_accvgpr_write_b32 a145, v21
    v_accvgpr_write_b32 a146, v22
    v_accvgpr_write_b32 a147, v23
    v_accvgpr_read_b32 v20, a156
    v_accvgpr_read_b32 v21, a157
    v_accvgpr_read_b32 v22, a158
    v_accvgpr_read_b32 v23, a159
    v_mul_f32 v20, v16, v20
    v_mul_f32 v21, v16, v21
    v_mul_f32 v22, v16, v22
    v_mul_f32 v23, v16, v23
    v_accvgpr_write_b32 a156, v20
    v_accvgpr_write_b32 a157, v21
    v_accvgpr_write_b32 a158, v22
    v_accvgpr_write_b32 a159, v23
    v_accvgpr_read_b32 v20, a168
    v_accvgpr_read_b32 v21, a169
    v_accvgpr_read_b32 v22, a170
    v_accvgpr_read_b32 v23, a171
    v_mul_f32 v20, v16, v20
    v_mul_f32 v21, v16, v21
    v_mul_f32 v22, v16, v22
    v_mul_f32 v23, v16, v23
    v_accvgpr_write_b32 a168, v20
    v_accvgpr_write_b32 a169, v21
    v_accvgpr_write_b32 a170, v22
    v_accvgpr_write_b32 a171, v23
    v_accvgpr_read_b32 v20, a180
    v_accvgpr_read_b32 v21, a181
    v_accvgpr_read_b32 v22, a182
    v_accvgpr_read_b32 v23, a183
    v_mul_f32 v20, v16, v20
    v_mul_f32 v21, v16, v21
    v_mul_f32 v22, v16, v22
    v_mul_f32 v23, v16, v23
    v_accvgpr_write_b32 a180, v20
    v_accvgpr_write_b32 a181, v21
    v_accvgpr_write_b32 a182, v22
    v_accvgpr_write_b32 a183, v23
    v_accvgpr_read_b32 v20, a192
    v_accvgpr_read_b32 v21, a193
    v_accvgpr_read_b32 v22, a194
    v_accvgpr_read_b32 v23, a195
    v_mul_f32 v20, v16, v20
    v_mul_f32 v21, v16, v21
    v_mul_f32 v22, v16, v22
    v_mul_f32 v23, v16, v23
    v_accvgpr_write_b32 a192, v20
    v_accvgpr_write_b32 a193, v21
    v_accvgpr_write_b32 a194, v22
    v_accvgpr_write_b32 a195, v23
    v_accvgpr_read_b32 v20, a4
    v_accvgpr_read_b32 v21, a5
    v_accvgpr_read_b32 v22, a6
    v_accvgpr_read_b32 v23, a7
    v_mul_f32 v20, v17, v20
    v_mul_f32 v21, v17, v21
    v_mul_f32 v22, v17, v22
    v_mul_f32 v23, v17, v23
    v_accvgpr_write_b32 a4, v20
    v_accvgpr_write_b32 a5, v21
    v_accvgpr_write_b32 a6, v22
    v_accvgpr_write_b32 a7, v23
    v_accvgpr_read_b32 v20, a16
    v_accvgpr_read_b32 v21, a17
    v_accvgpr_read_b32 v22, a18
    v_accvgpr_read_b32 v23, a19
    v_mul_f32 v20, v17, v20
    v_mul_f32 v21, v17, v21
    v_mul_f32 v22, v17, v22
    v_mul_f32 v23, v17, v23
    v_accvgpr_write_b32 a16, v20
    v_accvgpr_write_b32 a17, v21
    v_accvgpr_write_b32 a18, v22
    v_accvgpr_write_b32 a19, v23
    v_accvgpr_read_b32 v20, a28
    v_accvgpr_read_b32 v21, a29
    v_accvgpr_read_b32 v22, a30
    v_accvgpr_read_b32 v23, a31
    v_mul_f32 v20, v17, v20
    v_mul_f32 v21, v17, v21
    v_mul_f32 v22, v17, v22
    v_mul_f32 v23, v17, v23
    v_accvgpr_write_b32 a28, v20
    v_accvgpr_write_b32 a29, v21
    v_accvgpr_write_b32 a30, v22
    v_accvgpr_write_b32 a31, v23
    v_accvgpr_read_b32 v20, a40
    v_accvgpr_read_b32 v21, a41
    v_accvgpr_read_b32 v22, a42
    v_accvgpr_read_b32 v23, a43
    v_mul_f32 v20, v17, v20
    v_mul_f32 v21, v17, v21
    v_mul_f32 v22, v17, v22
    v_mul_f32 v23, v17, v23
    v_accvgpr_write_b32 a40, v20
    v_accvgpr_write_b32 a41, v21
    v_accvgpr_write_b32 a42, v22
    v_accvgpr_write_b32 a43, v23
    v_accvgpr_read_b32 v20, a52
    v_accvgpr_read_b32 v21, a53
    v_accvgpr_read_b32 v22, a54
    v_accvgpr_read_b32 v23, a55
    v_mul_f32 v20, v17, v20
    v_mul_f32 v21, v17, v21
    v_mul_f32 v22, v17, v22
    v_mul_f32 v23, v17, v23
    v_accvgpr_write_b32 a52, v20
    v_accvgpr_write_b32 a53, v21
    v_accvgpr_write_b32 a54, v22
    v_accvgpr_write_b32 a55, v23
    v_accvgpr_read_b32 v20, a64
    v_accvgpr_read_b32 v21, a65
    v_accvgpr_read_b32 v22, a66
    v_accvgpr_read_b32 v23, a67
    v_mul_f32 v20, v17, v20
    v_mul_f32 v21, v17, v21
    v_mul_f32 v22, v17, v22
    v_mul_f32 v23, v17, v23
    v_accvgpr_write_b32 a64, v20
    v_accvgpr_write_b32 a65, v21
    v_accvgpr_write_b32 a66, v22
    v_accvgpr_write_b32 a67, v23
    v_accvgpr_read_b32 v20, a76
    v_accvgpr_read_b32 v21, a77
    v_accvgpr_read_b32 v22, a78
    v_accvgpr_read_b32 v23, a79
    v_mul_f32 v20, v17, v20
    v_mul_f32 v21, v17, v21
    v_mul_f32 v22, v17, v22
    v_mul_f32 v23, v17, v23
    v_accvgpr_write_b32 a76, v20
    v_accvgpr_write_b32 a77, v21
    v_accvgpr_write_b32 a78, v22
    v_accvgpr_write_b32 a79, v23
    v_accvgpr_read_b32 v20, a88
    v_accvgpr_read_b32 v21, a89
    v_accvgpr_read_b32 v22, a90
    v_accvgpr_read_b32 v23, a91
    v_mul_f32 v20, v17, v20
    v_mul_f32 v21, v17, v21
    v_mul_f32 v22, v17, v22
    v_mul_f32 v23, v17, v23
    v_accvgpr_write_b32 a88, v20
    v_accvgpr_write_b32 a89, v21
    v_accvgpr_write_b32 a90, v22
    v_accvgpr_write_b32 a91, v23
    v_accvgpr_read_b32 v20, a100
    v_accvgpr_read_b32 v21, a101
    v_accvgpr_read_b32 v22, a102
    v_accvgpr_read_b32 v23, a103
    v_mul_f32 v20, v17, v20
    v_mul_f32 v21, v17, v21
    v_mul_f32 v22, v17, v22
    v_mul_f32 v23, v17, v23
    v_accvgpr_write_b32 a100, v20
    v_accvgpr_write_b32 a101, v21
    v_accvgpr_write_b32 a102, v22
    v_accvgpr_write_b32 a103, v23
    v_accvgpr_read_b32 v20, a112
    v_accvgpr_read_b32 v21, a113
    v_accvgpr_read_b32 v22, a114
    v_accvgpr_read_b32 v23, a115
    v_mul_f32 v20, v17, v20
    v_mul_f32 v21, v17, v21
    v_mul_f32 v22, v17, v22
    v_mul_f32 v23, v17, v23
    v_accvgpr_write_b32 a112, v20
    v_accvgpr_write_b32 a113, v21
    v_accvgpr_write_b32 a114, v22
    v_accvgpr_write_b32 a115, v23
    v_accvgpr_read_b32 v20, a124
    v_accvgpr_read_b32 v21, a125
    v_accvgpr_read_b32 v22, a126
    v_accvgpr_read_b32 v23, a127
    v_mul_f32 v20, v17, v20
    v_mul_f32 v21, v17, v21
    v_mul_f32 v22, v17, v22
    v_mul_f32 v23, v17, v23
    v_accvgpr_write_b32 a124, v20
    v_accvgpr_write_b32 a125, v21
    v_accvgpr_write_b32 a126, v22
    v_accvgpr_write_b32 a127, v23
    v_accvgpr_read_b32 v20, a136
    v_accvgpr_read_b32 v21, a137
    v_accvgpr_read_b32 v22, a138
    v_accvgpr_read_b32 v23, a139
    v_mul_f32 v20, v17, v20
    v_mul_f32 v21, v17, v21
    v_mul_f32 v22, v17, v22
    v_mul_f32 v23, v17, v23
    v_accvgpr_write_b32 a136, v20
    v_accvgpr_write_b32 a137, v21
    v_accvgpr_write_b32 a138, v22
    v_accvgpr_write_b32 a139, v23
    v_accvgpr_read_b32 v20, a148
    v_accvgpr_read_b32 v21, a149
    v_accvgpr_read_b32 v22, a150
    v_accvgpr_read_b32 v23, a151
    v_mul_f32 v20, v17, v20
    v_mul_f32 v21, v17, v21
    v_mul_f32 v22, v17, v22
    v_mul_f32 v23, v17, v23
    v_accvgpr_write_b32 a148, v20
    v_accvgpr_write_b32 a149, v21
    v_accvgpr_write_b32 a150, v22
    v_accvgpr_write_b32 a151, v23
    v_accvgpr_read_b32 v20, a160
    v_accvgpr_read_b32 v21, a161
    v_accvgpr_read_b32 v22, a162
    v_accvgpr_read_b32 v23, a163
    v_mul_f32 v20, v17, v20
    v_mul_f32 v21, v17, v21
    v_mul_f32 v22, v17, v22
    v_mul_f32 v23, v17, v23
    v_accvgpr_write_b32 a160, v20
    v_accvgpr_write_b32 a161, v21
    v_accvgpr_write_b32 a162, v22
    v_accvgpr_write_b32 a163, v23
    v_accvgpr_read_b32 v20, a172
    v_accvgpr_read_b32 v21, a173
    v_accvgpr_read_b32 v22, a174
    v_accvgpr_read_b32 v23, a175
    v_mul_f32 v20, v17, v20
    v_mul_f32 v21, v17, v21
    v_mul_f32 v22, v17, v22
    v_mul_f32 v23, v17, v23
    v_accvgpr_write_b32 a172, v20
    v_accvgpr_write_b32 a173, v21
    v_accvgpr_write_b32 a174, v22
    v_accvgpr_write_b32 a175, v23
    v_accvgpr_read_b32 v20, a184
    v_accvgpr_read_b32 v21, a185
    v_accvgpr_read_b32 v22, a186
    v_accvgpr_read_b32 v23, a187
    v_mul_f32 v20, v17, v20
    v_mul_f32 v21, v17, v21
    v_mul_f32 v22, v17, v22
    v_mul_f32 v23, v17, v23
    v_accvgpr_write_b32 a184, v20
    v_accvgpr_write_b32 a185, v21
    v_accvgpr_write_b32 a186, v22
    v_accvgpr_write_b32 a187, v23
    v_accvgpr_read_b32 v20, a196
    v_accvgpr_read_b32 v21, a197
    v_accvgpr_read_b32 v22, a198
    v_accvgpr_read_b32 v23, a199
    v_mul_f32 v20, v17, v20
    v_mul_f32 v21, v17, v21
    v_mul_f32 v22, v17, v22
    v_mul_f32 v23, v17, v23
    v_accvgpr_write_b32 a196, v20
    v_accvgpr_write_b32 a197, v21
    v_accvgpr_write_b32 a198, v22
    v_accvgpr_write_b32 a199, v23
    v_accvgpr_read_b32 v20, a8
    v_accvgpr_read_b32 v21, a9
    v_accvgpr_read_b32 v22, a10
    v_accvgpr_read_b32 v23, a11
    v_mul_f32 v20, v18, v20
    v_mul_f32 v21, v18, v21
    v_mul_f32 v22, v18, v22
    v_mul_f32 v23, v18, v23
    v_accvgpr_write_b32 a8, v20
    v_accvgpr_write_b32 a9, v21
    v_accvgpr_write_b32 a10, v22
    v_accvgpr_write_b32 a11, v23
    v_accvgpr_read_b32 v20, a20
    v_accvgpr_read_b32 v21, a21
    v_accvgpr_read_b32 v22, a22
    v_accvgpr_read_b32 v23, a23
    v_mul_f32 v20, v18, v20
    v_mul_f32 v21, v18, v21
    v_mul_f32 v22, v18, v22
    v_mul_f32 v23, v18, v23
    v_accvgpr_write_b32 a20, v20
    v_accvgpr_write_b32 a21, v21
    v_accvgpr_write_b32 a22, v22
    v_accvgpr_write_b32 a23, v23
    v_accvgpr_read_b32 v20, a32
    v_accvgpr_read_b32 v21, a33
    v_accvgpr_read_b32 v22, a34
    v_accvgpr_read_b32 v23, a35
    v_mul_f32 v20, v18, v20
    v_mul_f32 v21, v18, v21
    v_mul_f32 v22, v18, v22
    v_mul_f32 v23, v18, v23
    v_accvgpr_write_b32 a32, v20
    v_accvgpr_write_b32 a33, v21
    v_accvgpr_write_b32 a34, v22
    v_accvgpr_write_b32 a35, v23
    v_accvgpr_read_b32 v20, a44
    v_accvgpr_read_b32 v21, a45
    v_accvgpr_read_b32 v22, a46
    v_accvgpr_read_b32 v23, a47
    v_mul_f32 v20, v18, v20
    v_mul_f32 v21, v18, v21
    v_mul_f32 v22, v18, v22
    v_mul_f32 v23, v18, v23
    v_accvgpr_write_b32 a44, v20
    v_accvgpr_write_b32 a45, v21
    v_accvgpr_write_b32 a46, v22
    v_accvgpr_write_b32 a47, v23
    v_accvgpr_read_b32 v20, a56
    v_accvgpr_read_b32 v21, a57
    v_accvgpr_read_b32 v22, a58
    v_accvgpr_read_b32 v23, a59
    v_mul_f32 v20, v18, v20
    v_mul_f32 v21, v18, v21
    v_mul_f32 v22, v18, v22
    v_mul_f32 v23, v18, v23
    v_accvgpr_write_b32 a56, v20
    v_accvgpr_write_b32 a57, v21
    v_accvgpr_write_b32 a58, v22
    v_accvgpr_write_b32 a59, v23
    v_accvgpr_read_b32 v20, a68
    v_accvgpr_read_b32 v21, a69
    v_accvgpr_read_b32 v22, a70
    v_accvgpr_read_b32 v23, a71
    v_mul_f32 v20, v18, v20
    v_mul_f32 v21, v18, v21
    v_mul_f32 v22, v18, v22
    v_mul_f32 v23, v18, v23
    v_accvgpr_write_b32 a68, v20
    v_accvgpr_write_b32 a69, v21
    v_accvgpr_write_b32 a70, v22
    v_accvgpr_write_b32 a71, v23
    v_accvgpr_read_b32 v20, a80
    v_accvgpr_read_b32 v21, a81
    v_accvgpr_read_b32 v22, a82
    v_accvgpr_read_b32 v23, a83
    v_mul_f32 v20, v18, v20
    v_mul_f32 v21, v18, v21
    v_mul_f32 v22, v18, v22
    v_mul_f32 v23, v18, v23
    v_accvgpr_write_b32 a80, v20
    v_accvgpr_write_b32 a81, v21
    v_accvgpr_write_b32 a82, v22
    v_accvgpr_write_b32 a83, v23
    v_accvgpr_read_b32 v20, a92
    v_accvgpr_read_b32 v21, a93
    v_accvgpr_read_b32 v22, a94
    v_accvgpr_read_b32 v23, a95
    v_mul_f32 v20, v18, v20
    v_mul_f32 v21, v18, v21
    v_mul_f32 v22, v18, v22
    v_mul_f32 v23, v18, v23
    v_accvgpr_write_b32 a92, v20
    v_accvgpr_write_b32 a93, v21
    v_accvgpr_write_b32 a94, v22
    v_accvgpr_write_b32 a95, v23
    v_accvgpr_read_b32 v20, a104
    v_accvgpr_read_b32 v21, a105
    v_accvgpr_read_b32 v22, a106
    v_accvgpr_read_b32 v23, a107
    v_mul_f32 v20, v18, v20
    v_mul_f32 v21, v18, v21
    v_mul_f32 v22, v18, v22
    v_mul_f32 v23, v18, v23
    v_accvgpr_write_b32 a104, v20
    v_accvgpr_write_b32 a105, v21
    v_accvgpr_write_b32 a106, v22
    v_accvgpr_write_b32 a107, v23
    v_accvgpr_read_b32 v20, a116
    v_accvgpr_read_b32 v21, a117
    v_accvgpr_read_b32 v22, a118
    v_accvgpr_read_b32 v23, a119
    v_mul_f32 v20, v18, v20
    v_mul_f32 v21, v18, v21
    v_mul_f32 v22, v18, v22
    v_mul_f32 v23, v18, v23
    v_accvgpr_write_b32 a116, v20
    v_accvgpr_write_b32 a117, v21
    v_accvgpr_write_b32 a118, v22
    v_accvgpr_write_b32 a119, v23
    v_accvgpr_read_b32 v20, a128
    v_accvgpr_read_b32 v21, a129
    v_accvgpr_read_b32 v22, a130
    v_accvgpr_read_b32 v23, a131
    v_mul_f32 v20, v18, v20
    v_mul_f32 v21, v18, v21
    v_mul_f32 v22, v18, v22
    v_mul_f32 v23, v18, v23
    v_accvgpr_write_b32 a128, v20
    v_accvgpr_write_b32 a129, v21
    v_accvgpr_write_b32 a130, v22
    v_accvgpr_write_b32 a131, v23
    v_accvgpr_read_b32 v20, a140
    v_accvgpr_read_b32 v21, a141
    v_accvgpr_read_b32 v22, a142
    v_accvgpr_read_b32 v23, a143
    v_mul_f32 v20, v18, v20
    v_mul_f32 v21, v18, v21
    v_mul_f32 v22, v18, v22
    v_mul_f32 v23, v18, v23
    v_accvgpr_write_b32 a140, v20
    v_accvgpr_write_b32 a141, v21
    v_accvgpr_write_b32 a142, v22
    v_accvgpr_write_b32 a143, v23
    v_accvgpr_read_b32 v20, a152
    v_accvgpr_read_b32 v21, a153
    v_accvgpr_read_b32 v22, a154
    v_accvgpr_read_b32 v23, a155
    v_mul_f32 v20, v18, v20
    v_mul_f32 v21, v18, v21
    v_mul_f32 v22, v18, v22
    v_mul_f32 v23, v18, v23
    v_accvgpr_write_b32 a152, v20
    v_accvgpr_write_b32 a153, v21
    v_accvgpr_write_b32 a154, v22
    v_accvgpr_write_b32 a155, v23
    v_accvgpr_read_b32 v20, a164
    v_accvgpr_read_b32 v21, a165
    v_accvgpr_read_b32 v22, a166
    v_accvgpr_read_b32 v23, a167
    v_mul_f32 v20, v18, v20
    v_mul_f32 v21, v18, v21
    v_mul_f32 v22, v18, v22
    v_mul_f32 v23, v18, v23
    v_accvgpr_write_b32 a164, v20
    v_accvgpr_write_b32 a165, v21
    v_accvgpr_write_b32 a166, v22
    v_accvgpr_write_b32 a167, v23
    v_accvgpr_read_b32 v20, a176
    v_accvgpr_read_b32 v21, a177
    v_accvgpr_read_b32 v22, a178
    v_accvgpr_read_b32 v23, a179
    v_mul_f32 v20, v18, v20
    v_mul_f32 v21, v18, v21
    v_mul_f32 v22, v18, v22
    v_mul_f32 v23, v18, v23
    v_accvgpr_write_b32 a176, v20
    v_accvgpr_write_b32 a177, v21
    v_accvgpr_write_b32 a178, v22
    v_accvgpr_write_b32 a179, v23
    v_accvgpr_read_b32 v20, a188
    v_accvgpr_read_b32 v21, a189
    v_accvgpr_read_b32 v22, a190
    v_accvgpr_read_b32 v23, a191
    v_mul_f32 v20, v18, v20
    v_mul_f32 v21, v18, v21
    v_mul_f32 v22, v18, v22
    v_mul_f32 v23, v18, v23
    v_accvgpr_write_b32 a188, v20
    v_accvgpr_write_b32 a189, v21
    v_accvgpr_write_b32 a190, v22
    v_accvgpr_write_b32 a191, v23
    v_accvgpr_read_b32 v20, a200
    v_accvgpr_read_b32 v21, a201
    v_accvgpr_read_b32 v22, a202
    v_accvgpr_read_b32 v23, a203
    v_mul_f32 v20, v18, v20
    v_mul_f32 v21, v18, v21
    v_mul_f32 v22, v18, v22
    v_mul_f32 v23, v18, v23
    v_accvgpr_write_b32 a200, v20
    v_accvgpr_write_b32 a201, v21
    v_accvgpr_write_b32 a202, v22
    v_accvgpr_write_b32 a203, v23
    s_nop 1
    s_setpc_b64 s[36:37]
L_end:
    s_endpgm
.section .rodata,"a"
.p2align 6
.amdhsa_kernel concat_heads__mha_block_cached__mha_block_cached__near_ridge_kernel
  .amdhsa_next_free_vgpr 512
  .amdhsa_next_free_sgpr 102
  .amdhsa_accum_offset 256
  .amdhsa_group_segment_fixed_size 0
  .amdhsa_kernarg_size 104
  .amdhsa_user_sgpr_count 2
  .amdhsa_user_sgpr_kernarg_segment_ptr 1
  .amdhsa_system_sgpr_workgroup_id_x 1
.end_amdhsa_kernel
```
